```python
import torch

def _softmax(x, axis=-1):
    return torch.softmax(x, dim=axis)
def _gelu(x):
    return torch.nn.functional.gelu(x, approximate="tanh")
def _silu(x):
    return torch.nn.functional.silu(x)
def _sigmoid(x):
    return torch.sigmoid(x)
def _layernorm(x, axis=-1, eps=1e-5):
    m = x.mean(dim=axis, keepdim=True)
    v = x.var(dim=axis, keepdim=True, unbiased=False)
    return (x - m) / torch.sqrt(v + eps)
def _scatter_add(tgt, idx, src, axis=0):
    return tgt.clone().index_add_(axis, idx, src)
def _segment_sum(src, seg, n):
    out = torch.zeros((n,) + src.shape[1:], dtype=src.dtype)
    return out.index_add_(0, seg, src)
def _pad(x, pw):
    flat = tuple(v for pair in reversed(pw) for v in pair)
    return torch.nn.functional.pad(x, flat)

kernel_name = 'concat_heads__compressed_kv_cla__linear_kernel_hedgehog__prompt'

def setup_inputs():

    _w = (lambda a: (lambda t: t.to(torch.bfloat16) if t.is_floating_point() else t)(torch.as_tensor(a)))
    def _A_setup():
        B, H, Sq, Sk, D, M = 1, 16, 2048, 2048, 256, 448
        Dc = 4 * D
        return {
            "x": _w((lambda *s: torch.randn(*s, dtype=torch.bfloat16) * 0.8)(B, Sq, M)),
            "c_kv": _w((lambda *s: torch.randn(*s, dtype=torch.bfloat16) * 0.4)(B, Sk, Dc)),
            "w_q": _w((lambda *s: torch.randn(*s, dtype=torch.bfloat16) * 6.4)(M, H, D) * (M ** -0.5)),
            "w_uk": _w((lambda *s: torch.randn(*s, dtype=torch.bfloat16) * 6.4)(Dc, H, D) * (Dc ** -0.5)),
            "w_uv": _w((lambda *s: torch.randn(*s, dtype=torch.bfloat16) * 0.4)(Dc, H, D) * (Dc ** -0.5)),
            "w_o": _w((lambda *s: torch.randn(*s, dtype=torch.bfloat16) * 0.4)(H, D, M) * ((H * D) ** -0.5)),
        }
    _A_in = _A_setup()

    def _B_setup():
        B, S, D, H = 1, 2048, 448, 16
        Dh = D // H
        return {
            "x": _w((lambda *s: torch.randn(*s, dtype=torch.bfloat16) * 0.4)(B, S, D)),
            "wqkv": _w((lambda *s: torch.randn(*s, dtype=torch.bfloat16) * 0.4)(D, 3 * D)),
            "w_phi": _w((lambda *s: torch.randn(*s, dtype=torch.bfloat16) * 0.4)(H, Dh, Dh) * (Dh ** -0.5)),
            "wo": _w((lambda *s: torch.randn(*s, dtype=torch.bfloat16) * 0.05)(D, D)),
        }
    _B_in = _B_setup()

    return {
        "A_x": _A_in["x"],
        "A_c_kv": _A_in["c_kv"],
        "A_w_q": _A_in["w_q"],
        "A_w_uk": _A_in["w_uk"],
        "A_w_uv": _A_in["w_uv"],
        "A_w_o": _A_in["w_o"],
        "B_x": _B_in["x"],
        "B_wqkv": _B_in["wqkv"],
        "B_w_phi": _B_in["w_phi"],
        "B_wo": _B_in["wo"],
    }

def reference(A_x, A_c_kv, A_w_q, A_w_uk, A_w_uv, A_w_o, B_x, B_wqkv, B_w_phi, B_wo):
    def _A_ref(x, c_kv, w_q, w_uk, w_uv, w_o):
        B, Sq, M = x.shape[0], x.shape[1], x.shape[2]
        Sk = c_kv.shape[1]
        H, D = w_q.shape[1], w_q.shape[2]
        q = torch.einsum("bqm,mhd->bhqd", x, w_q)
        k = torch.einsum("bkc,chd->bhkd", c_kv, w_uk)
        v = torch.einsum("bkc,chd->bhkd", c_kv, w_uv)
        scores = torch.einsum("bhqd,bhkd->bhqk", q, k) * (D ** -0.5)
        off = Sk - Sq
        qi = torch.arange(Sq)[:, None]
        kj = torch.arange(Sk)[None, :]
        cmask = kj <= (qi + off)
        scores = torch.where(cmask[None, None], scores, -1e9)
        p = _softmax(scores, axis=-1)
        ctx = torch.einsum("bhqk,bhkd->bhqd", p, v)
        return torch.einsum("bhqd,hdm->bqm", ctx, w_o)

    def _B_ref(x, wqkv, w_phi, wo):
        B, S, D = x.shape
        H = 16; Dh = D // H
        qkv = (lambda x, *d: x.permute(*d))((x @ wqkv).reshape(B, S, 3, H, Dh), 2, 0, 3, 1, 4)
        q, k, v = qkv[0], qkv[1], qkv[2]
        pq = torch.einsum("bhsd,hdf->bhsf", q, w_phi)
        pk = torch.einsum("bhsd,hdf->bhsf", k, w_phi)
        phi_q = torch.concatenate([_softmax(pq, axis=-1), _softmax(-pq, axis=-1)], axis=-1)
        phi_k = torch.concatenate([_softmax(pk, axis=-1), _softmax(-pk, axis=-1)], axis=-1)
        kv = torch.einsum("bhsf,bhsd->bhfd", phi_k, v)
        z  = torch.einsum("bhsf->bhf", phi_k)
        num = torch.einsum("bhqf,bhfd->bhqd", phi_q, kv)
        den = torch.einsum("bhqf,bhf->bhq", phi_q, z)[..., None] + 1e-6
        o = num / den
        return (lambda x, *d: x.permute(*d))(o, 0, 2, 1, 3).reshape(B, S, D) @ wo

    a = _A_ref(A_x, A_c_kv, A_w_q, A_w_uk, A_w_uv, A_w_o)
    b = _B_ref(B_x, B_wqkv, B_w_phi, B_wo)
    return torch.concatenate([a, b], axis=-1)
```

```asm
; @launch grid=(256,1,1) block=(256,1,1) lds=163840
.amdgcn_target "amdgcn-amd-amdhsa--gfx950"
.text
.globl concat_heads__compressed_kv_cla__linear_kernel_hedgehog__prompt_kernel
.p2align 8
.type concat_heads__compressed_kv_cla__linear_kernel_hedgehog__prompt_kernel,@function
concat_heads__compressed_kv_cla__linear_kernel_hedgehog__prompt_kernel:
s_cmp_lt_u32 s2, 256
s_cbranch_scc1 GO
s_endpgm
GO:
s_load_dwordx16 s[32:47], s[0:1], 0
s_load_dwordx8 s[48:55], s[0:1], 64
s_load_dwordx2 s[8:9], s[0:1], 96
s_getpc_b64 s[4:5]
PC0:
v_lshrrev_b32 v112, 6, v0
v_and_b32 v113, 63, v0
v_readfirstlane_b32 s60, v112
v_lshlrev_b32 v1, 4, v113
s_bfe_u32 s3, s2, 327683
s_mul_i32 s3, s3, 4096
v_mul_u32_u24 v127, 16, v0
v_add_u32 v127, s3, v127
global_load_dword v126, v127, s[4:5]
s_and_b32 s3, s2, 7
s_bfe_u32 s63, s2, 0x10003
s_lshl_b32 s61, s3, 1
s_add_u32 s61, s61, s63
s_lshr_b32 s62, s2, 4
s_lshl_b32 s67, s60, 12
s_lshl_b32 s68, s60, 10
s_lshl_b32 s69, s60, 13
v_lshrrev_b32 v113, 7, v1
v_bfe_u32 v114, v1, 4, 3
v_lshrrev_b32 v115, 8, v1
v_xor_b32 v114, v114, v115
s_lshl_b32 s63, s60, 9
s_lshl_b32 s64, s60, 7
s_or_b32 s63, s63, s64
s_and_b32 s63, s63, 0x300
v_add_u32 v113, s63, v113
v_mul_u32_u24 v113, 2048, v113
v_xor_b32 v115, 0, v114
v_lshl_add_u32 v115, v115, 4, v113
v_add_u32 v20, 0, v115
v_xor_b32 v115, 4, v114
v_lshl_add_u32 v115, v115, 4, v113
v_add_u32 v21, 15360, v115
v_xor_b32 v115, 0, v114
v_lshl_add_u32 v115, v115, 4, v113
v_add_u32 v22, 30720, v115
v_xor_b32 v115, 4, v114
v_lshl_add_u32 v115, v115, 4, v113
v_add_u32 v23, 46080, v115
v_lshrrev_b32 v113, 8, v1
v_bfe_u32 v114, v1, 4, 4
v_lshlrev_b32 v115, 1, v113
v_xor_b32 v114, v114, v115
s_lshl_b32 s63, s60, 4
v_add_u32 v113, s63, v113
v_lshlrev_b32 v113, 13, v113
v_xor_b32 v115, 0, v114
v_lshl_add_u32 v115, v115, 4, v113
v_add_u32 v72, 0, v115
v_xor_b32 v115, 0, v114
v_lshl_add_u32 v115, v115, 4, v113
v_add_u32 v73, 31744, v115
v_xor_b32 v115, 8, v114
v_lshl_add_u32 v115, v115, 4, v113
v_add_u32 v74, 63488, v115
v_xor_b32 v115, 8, v114
v_lshl_add_u32 v115, v115, 4, v113
v_add_u32 v75, 95232, v115
s_add_u32 s75, s69, 65536
s_mov_b32 s73, s67
s_mov_b32 s72, s75
s_mov_b32 s74, 0
s_mov_b32 s70, 0
s_mov_b32 s71, 0
s_and_b32 s63, s62, 7
s_lshl_b32 s63, s63, 16
s_lshl_b32 s64, s61, 9
s_cmp_lt_u32 s62, 8
s_waitcnt lgkmcnt(0)
s_cselect_b64 s[38:39], s[38:39], s[40:41]
s_add_u32 s12, s34, s63
s_addc_u32 s13, s35, 0
s_sub_u32 s14, 0x400000, s63
s_mov_b32 s15, 0x20000
s_add_u32 s16, s38, s64
s_addc_u32 s17, s39, 0
s_sub_u32 s18, 0x800000, s64
s_mov_b32 s19, 0x20000
s_mov_b32 m0, s72
s_nop 0
buffer_load_dwordx4 v20, s[12:15], s70 offen offset:0 lds
buffer_load_dwordx4 v21, s[12:15], s70 offen offset:1024 lds
buffer_load_dwordx4 v22, s[12:15], s70 offen offset:2048 lds
buffer_load_dwordx4 v23, s[12:15], s70 offen offset:3072 lds
s_add_u32 s70, s70, 2097152
s_mov_b32 m0, s73
s_nop 0
buffer_load_dwordx4 v72, s[16:19], s71 offen offset:0 nt lds
buffer_load_dwordx4 v73, s[16:19], s71 offen offset:1024 nt lds
buffer_load_dwordx4 v74, s[16:19], s71 offen offset:2048 nt lds
buffer_load_dwordx4 v75, s[16:19], s71 offen offset:3072 nt lds
s_add_u32 m0, s72, 4096
s_nop 0
.p2align 3
buffer_load_dwordx4 v20, s[12:15], s70 offen offset:0 lds
buffer_load_dwordx4 v21, s[12:15], s70 offen offset:1024 lds
buffer_load_dwordx4 v22, s[12:15], s70 offen offset:2048 lds
buffer_load_dwordx4 v23, s[12:15], s70 offen offset:3072 lds
s_add_u32 s71, s71, 256
s_sub_u32 s70, s70, 2097024
s_add_u32 s72, s72, 32768
v_lshrrev_b32 v113, 6, v1
s_add_u32 m0, s73, 16384
v_bfe_u32 v114, v1, 4, 2
v_lshrrev_b32 v115, 9, v1
v_lshlrev_b32 v115, 1, v115
v_xor_b32 v114, v114, v115
s_lshl_b32 s63, s60, 4
v_add_u32 v113, s63, v113
v_mul_u32_u24 v113, 2688, v113
v_lshl_add_u32 v18, v114, 4, v113
s_mov_b32 s10, 0x10000000
s_mov_b32 s11, 0x20000
buffer_load_dwordx4 v72, s[16:19], s71 offen offset:0 nt lds
s_lshl_b32 s81, s61, 8
s_lshl_b32 s63, s62, 4
s_add_u32 s81, s81, s63
s_lshl_b32 s64, s60, 2
s_add_u32 s81, s81, s64
s_add_u32 s63, s63, s64
s_lshl_b32 s82, s63, 5
s_lshl_b32 s63, s61, 2
s_add_u32 s82, s82, s63
s_add_u32 s82, s82, 32768
buffer_load_dwordx4 v73, s[16:19], s71 offen offset:1024 nt lds
s_lshl_b32 s63, s61, 4
s_add_u32 s63, s63, s64
s_add_u32 s63, s63, 8192
s_cmp_eq_u32 s62, 6
s_cselect_b32 s63, s63, s81
v_mov_b32 v112, s81
v_writelane_b32 v112, s82, 1
v_writelane_b32 v112, s63, 2
s_lshl_b32 s63, s62, 9
s_lshl_b32 s64, s60, 7
s_add_u32 s63, s63, s64
buffer_load_dwordx4 v74, s[16:19], s71 offen offset:2048 nt lds
s_add_u32 s63, s63, 12288
s_cmp_eq_u32 s61, 0
s_cselect_b32 s63, s63, s81
v_writelane_b32 v112, s63, 3
s_sub_u32 s63, 15, s62
s_min_u32 s84, s63, s62
s_lshl_b32 s63, s61, 3
s_add_u32 s63, s63, s84
s_lshl_b32 s63, s63, 7
s_lshl_b32 s64, s60, 2
s_add_u32 s63, s63, s64
s_add_u32 s63, s63, 65536
buffer_load_dwordx4 v75, s[16:19], s71 offen offset:3072 nt lds
s_cmp_lt_u32 s62, 8
s_cselect_b32 s63, s63, s81
v_writelane_b32 v112, s63, 4
v_mov_b32 v122, v112
v_mov_b32 v123, 0
s_lshl_b32 s63, s2, 2
s_add_u32 s63, s63, s60
s_mul_i32 s79, s63, 12288
s_mov_b32 s3, 0
s_mov_b64 s[28:29], s[44:45]
s_mov_b32 s30, 1835008
s_mov_b32 m0, s72
s_mov_b32 s31, 0x20000
s_cmp_ge_u32 s63, 150
s_cselect_b64 s[28:29], s[32:33], s[28:29]
s_cselect_b32 s30, 1835008, s30
s_cselect_b32 s3, 1843200, s3
s_cmp_ge_u32 s63, 300
s_cselect_b64 s[28:29], s[48:49], s[28:29]
s_cselect_b32 s30, 25088, s30
s_cselect_b32 s3, 3686400, s3
s_cmp_ge_u32 s63, 303
s_cselect_b64 s[28:29], s[50:51], s[28:29]
s_cselect_b32 s30, 401408, s30
s_cselect_b32 s3, 3723264, s3
s_cmp_ge_u32 s63, 336
s_cselect_b64 s[28:29], s[36:37], s[28:29]
s_cselect_b32 s30, 3670016, s30
s_cselect_b32 s3, 4128768, s3
s_cmp_ge_u32 s63, 635
s_cselect_b64 s[28:29], s[42:43], s[28:29]
s_cselect_b32 s30, 3670016, s30
s_cselect_b32 s3, 7802880, s3
v_lshrrev_b32 v50, 4, v1
v_mul_u32_u24 v50, 16, v50
v_and_b32 v50, 0xfffc, v50
s_lshl_b32 s65, s63, 12
buffer_load_dwordx4 v20, s[12:15], s70 offen offset:0 lds
s_add_u32 s65, s65, 0
v_and_b32 v51, 0x200, v1
v_lshl_add_u32 v51, v51, 2, s65
s_sub_u32 s79, s79, s3
s_lshl_b32 s85, s63, 10
s_mov_b64 s[24:25], s[46:47]
s_mov_b32 s26, 1204224
s_mov_b32 s27, 0x20000
s_mov_b64 s[56:57], s[54:55]
s_mov_b32 s58, 256
s_mov_b32 s59, 0x20000
buffer_load_dwordx4 v21, s[12:15], s70 offen offset:1024 lds
s_bfe_u32 s63, s2, 0x20003
s_lshl_b32 s63, 4, s63
s_cmp_eq_u32 s60, 0
s_cselect_b32 s63, s63, 0
s_or_b32 s80, s63, 640
v_mov_b32 v2, 1
v_lshrrev_b32 v5, 2, v1
s_mov_b32 s83, 1048576
s_mul_i32 s63, s62, 114688
s_add_u32 s20, s44, s63
s_addc_u32 s21, s45, 0
s_mov_b32 s22, 114688
buffer_load_dwordx4 v22, s[12:15], s70 offen offset:2048 lds
s_mov_b32 s23, 0x20000
v_lshrrev_b32 v113, 7, v1
v_bfe_u32 v114, v1, 4, 3
v_lshrrev_b32 v115, 8, v1
v_xor_b32 v114, v114, v115
s_lshl_b32 s63, s60, 4
v_add_u32 v113, s63, v113
v_mul_u32_u24 v113, 896, v113
v_xor_b32 v115, 0, v114
v_lshl_add_u32 v115, v115, 4, v113
buffer_load_dwordx4 v23, s[12:15], s70 offen offset:3072 lds
v_add_u32 v36, 0, v115
v_xor_b32 v115, 4, v114
v_lshl_add_u32 v115, v115, 4, v113
v_add_u32 v37, 6144, v115
v_xor_b32 v115, 0, v114
v_lshl_add_u32 v115, v115, 4, v113
v_add_u32 v38, 55296, v115
v_xor_b32 v115, 4, v114
v_lshl_add_u32 v115, v115, 4, v113
v_add_u32 v39, 61440, v115
v_lshrrev_b32 v113, 8, v1
s_add_u32 s71, s71, 524032
v_bfe_u32 v114, v1, 6, 2
v_bfe_u32 v115, v1, 4, 2
v_lshl_add_u32 v114, v113, 3, v114
v_lshlrev_b32 v114, 6, v114
v_and_b32 v116, 1, v113
v_lshlrev_b32 v116, 5, v116
s_and_b32 s63, s61, 1
v_add_u32 v117, 0, v115
v_min_u32 v117, 6, v117
v_add_lshl_u32 v117, v117, s63, 3
s_add_u32 s70, s70, 2097152
v_xor_b32 v117, v117, v116
v_add_u32 v40, v117, v114
v_add_u32 v117, 4, v115
v_min_u32 v117, 6, v117
v_add_lshl_u32 v117, v117, s63, 3
v_xor_b32 v117, v117, v116
v_add_u32 v41, v117, v114
v_lshrrev_b32 v112, 6, v1
v_mul_u32_u24 v112, 56, v112
v_lshl_add_u32 v112, v115, 3, v112
s_xor_b32 s73, s73, 0x8000
v_add_u32 v46, 122880, v112
v_cmp_gt_u32 vcc, 3, v115
v_add_u32 v114, 32, v46
s_nop 0
v_cndmask_b32 v47, v46, v114, vcc
v_bfe_u32 v112, v1, 4, 4
v_lshrrev_b32 v113, 8, v1
v_lshlrev_b32 v113, 2, v113
v_sub_u32 v114, v112, v113
v_mov_b32 v115, 0x3f80
v_mov_b32 v116, 0x3f800000
s_mov_b32 m0, s73
v_cmp_eq_u32 vcc, 0, v114
s_nop 1
v_cndmask_b32 v117, 0, v115, vcc
v_cmp_eq_u32 vcc, 1, v114
s_nop 1
v_cndmask_b32 v56, v117, v116, vcc
v_mov_b32 v62, v56
v_mov_b32 v58, 0
v_mov_b32 v60, 0
v_cmp_eq_u32 vcc, 2, v114
buffer_load_dwordx4 v72, s[16:19], s71 offen offset:0 nt lds
s_nop 1
v_cndmask_b32 v117, 0, v115, vcc
v_cmp_eq_u32 vcc, 3, v114
s_nop 1
v_cndmask_b32 v57, v117, v116, vcc
v_mov_b32 v63, v57
v_mov_b32 v59, 0
v_mov_b32 v61, 0
v_lshrrev_b32 v113, 9, v1
v_bfe_u32 v114, v1, 4, 5
buffer_load_dwordx4 v73, s[16:19], s71 offen offset:1024 nt lds
v_lshlrev_b32 v115, 1, v113
v_xor_b32 v114, v114, v115
s_lshl_b32 s63, s60, 3
s_and_b32 s64, s63, 8
v_xor_b32 v114, s64, v114
v_add_u32 v113, s63, v113
v_lshlrev_b32 v113, 13, v113
v_xor_b32 v115, 0, v114
v_lshl_add_u32 v115, v115, 4, v113
v_add_u32 v24, 0, v115
buffer_load_dwordx4 v74, s[16:19], s71 offen offset:2048 nt lds
v_xor_b32 v115, 4, v114
v_lshl_add_u32 v115, v115, 4, v113
v_add_u32 v25, 15360, v115
v_xor_b32 v115, 0, v114
v_lshl_add_u32 v115, v115, 4, v113
v_add_u32 v26, 30720, v115
v_xor_b32 v115, 4, v114
v_lshl_add_u32 v115, v115, 4, v113
v_add_u32 v27, 46080, v115
v_bfe_u32 v112, v1, 4, 4
v_lshrrev_b32 v113, 8, v1
buffer_load_dwordx4 v75, s[16:19], s71 offen offset:3072 nt lds
v_lshrrev_b32 v114, 1, v112
v_xor_b32 v114, v114, v113
v_lshlrev_b32 v114, 4, v114
v_lshl_add_u32 v114, v112, 7, v114
v_add_u32 v19, s67, v114
s_and_b32 s63, s69, 0x4000
s_add_u32 s63, s63, 65536
v_add_u32 v16, s63, v114
v_bfe_u32 v114, v1, 6, 2
v_bfe_u32 v115, v1, 4, 2
s_add_u32 m0, s72, 4096
v_and_b32 v116, 1, v113
v_lshl_or_b32 v116, v116, 2, v114
v_lshl_add_u32 v117, v113, 3, v114
v_lshlrev_b32 v116, 5, v116
v_lshl_add_u32 v116, v115, 3, v116
v_lshl_add_u32 v118, v117, 9, v116
v_add_u32 v118, 65536, v118
s_and_b32 s3, s60, 1
s_lshl_b32 s63, s3, 7
v_lshl_add_u32 v119, v117, 8, v116
buffer_load_dwordx4 v20, s[12:15], s70 offen offset:0 lds
v_xor_b32 v119, s63, v119
v_xor_b32 v76, 0, v119
v_xor_b32 v77, 32, v119
v_xor_b32 v78, 64, v119
v_xor_b32 v79, 96, v119
v_xor_b32 v28, 0, v118
v_xor_b32 v29, 32, v118
v_xor_b32 v30, 64, v118
.p2align 3
v_xor_b32 v31, 96, v118
v_xor_b32 v32, 128, v118
v_xor_b32 v33, 160, v118
buffer_load_dwordx4 v21, s[12:15], s70 offen offset:1024 lds
v_xor_b32 v34, 192, v118
v_xor_b32 v35, 224, v118
v_add_u32 v3, s69, v1
v_add_u32 v4, 4096, v3
v_lshrrev_b32 v116, 7, v1
s_lshl_b32 s63, s60, 6
v_add_u32 v116, s63, v116
v_mul_u32_u24 v116, 896, v116
v_bfe_u32 v117, v1, 4, 3
v_lshlrev_b32 v118, 1, v113
buffer_load_dwordx4 v22, s[12:15], s70 offen offset:2048 lds
v_xor_b32 v117, v117, v118
v_lshl_add_u32 v8, v117, 4, v116
v_add_u32 v9, 6144, v8
v_add_u32 v10, 12288, v8
v_add_u32 v11, 18432, v8
v_lshrrev_b32 v116, 6, v1
v_bfe_u32 v117, v1, 7, 2
v_lshlrev_b32 v116, 7, v116
v_lshl_add_u32 v116, v117, 5, v116
v_lshl_add_u32 v12, v115, 3, v116
buffer_load_dwordx4 v23, s[12:15], s70 offen offset:3072 lds
v_xor_b32 v13, 32, v12
v_xor_b32 v14, 64, v12
v_xor_b32 v15, 96, v12
s_lshl_b32 s95, s61, 21
s_add_u32 s95, s95, 1048576
s_and_b32 s63, s62, 7
s_lshl_b32 s63, s63, 15
s_add_u32 s76, s95, s63
s_lshr_b32 s63, s60, 1
s_lshl_b32 s63, s63, 18
s_add_u32 s76, s76, s63
s_add_u32 s71, s71, 256
s_lshr_b32 s64, s62, 3
s_add_u32 s63, s64, 12
s_lshl_b32 s63, s3, s63
s_add_u32 s76, s76, s63
s_lshl_b32 s63, s64, 14
s_add_u32 s76, s76, s63
s_lshr_b32 s77, 8192, s64
s_sub_u32 s78, 1048576, s77
s_mov_b32 s91, s62
s_mov_b32 s88, 0
s_sub_u32 s70, s70, 2097024
s_mov_b32 s97, 0
s_mov_b32 s98, 0
s_lshl_b32 s63, s62, 1
s_add_u32 s63, s63, 2
s_cmp_ge_u32 s62, 10
s_cselect_b32 s89, 19, s63
s_cselect_b32 s92, 2, 1
s_cmp_lt_u32 s62, 6
s_cselect_b32 s92, 3, s92
s_mov_b32 s93, s95
s_add_u32 s94, s69, 98304
s_lshl_b32 s63, s61, 3
s_add_u32 s63, s63, s84
s_add_u32 s72, s72, 32768
s_lshl_b32 s63, s63, 2
s_add_u32 s63, s63, s60
s_mul_i32 s99, s63, 20480
s_add_u32 s99, s99, 100663296
s_lshl_b32 s63, s62, 3
s_add_u32 s63, s63, s60
s_mul_i32 s100, s63, 229376
s_lshl_b32 s63, s61, 10
s_add_u32 s100, s100, s63
s_add_u32 s100, s100, 67108864
buffer_store_dword v123, v122, s[8:11], 0 offen sc1
v_add_u32 v17, s74, v16
v_xor_b32 v42, 64, v17
s_waitcnt vmcnt(17)
s_barrier
.p2align 3
ds_read_b64_tr_b16 v[192:193], v76 offset:0
ds_read_b64_tr_b16 v[194:195], v76 offset:1024
ds_read_b64_tr_b16 v[196:197], v76 offset:8192
ds_read_b64_tr_b16 v[198:199], v76 offset:9216
ds_read_b64_tr_b16 v[200:201], v77 offset:0
ds_read_b64_tr_b16 v[202:203], v77 offset:1024
ds_read_b64_tr_b16 v[204:205], v77 offset:8192
ds_read_b64_tr_b16 v[206:207], v77 offset:9216
ds_read_b64_tr_b16 v[208:209], v78 offset:0
ds_read_b64_tr_b16 v[210:211], v78 offset:1024
ds_read_b64_tr_b16 v[212:213], v78 offset:8192
ds_read_b64_tr_b16 v[214:215], v78 offset:9216
ds_read_b64_tr_b16 v[216:217], v79 offset:0
ds_read_b64_tr_b16 v[218:219], v79 offset:1024
ds_read_b64_tr_b16 v[220:221], v79 offset:8192
ds_read_b64_tr_b16 v[222:223], v79 offset:9216
ds_read_b128 v[128:131], v17 offset:0
ds_read_b128 v[160:163], v42 offset:0
ds_read_b128 v[164:167], v42 offset:2048
ds_read_b128 v[132:135], v17 offset:2048
ds_read_b128 v[136:139], v17 offset:4096
ds_read_b128 v[168:171], v42 offset:4096
ds_read_b128 v[172:175], v42 offset:6144
ds_read_b128 v[140:143], v17 offset:6144
ds_read_b128 v[144:147], v17 offset:8192
ds_read_b128 v[176:179], v42 offset:8192
ds_read_b128 v[180:183], v42 offset:10240
ds_read_b128 v[148:151], v17 offset:10240
ds_read_b128 v[152:155], v17 offset:12288
ds_read_b128 v[184:187], v42 offset:12288
ds_read_b128 v[188:191], v42 offset:14336
ds_read_b128 v[156:159], v17 offset:14336
s_cmp_lt_u32 s62, 8
s_cbranch_scc1 KV_K
s_waitcnt lgkmcnt(8)
v_mfma_f32_16x16x32_bf16 a[0:3], v[128:131], v[192:195], 0
s_waitcnt vmcnt(9)
v_mfma_f32_16x16x32_bf16 a[0:3], v[160:163], v[196:199], a[0:3]
s_barrier
v_mfma_f32_16x16x32_bf16 a[4:7], v[164:167], v[196:199], 0
s_add_u32 m0, s73, 16384
v_mfma_f32_16x16x32_bf16 a[4:7], v[132:135], v[192:195], a[4:7]
v_mfma_f32_16x16x32_bf16 a[64:67], v[136:139], v[192:195], 0
buffer_load_dwordx4 v72, s[16:19], s71 offen offset:0 nt lds
v_mfma_f32_16x16x32_bf16 a[64:67], v[168:171], v[196:199], a[64:67]
ds_read_b64_tr_b16 v[224:225], v76 offset:16384
v_mfma_f32_16x16x32_bf16 a[68:71], v[172:175], v[196:199], 0
v_mfma_f32_16x16x32_bf16 a[68:71], v[140:143], v[192:195], a[68:71]
s_waitcnt lgkmcnt(1)
ds_read_b64_tr_b16 v[226:227], v76 offset:17408
v_mfma_f32_16x16x32_bf16 a[128:131], v[144:147], v[192:195], 0
v_mfma_f32_16x16x32_bf16 a[128:131], v[176:179], v[196:199], a[128:131]
buffer_load_dwordx4 v73, s[16:19], s71 offen offset:1024 nt lds
v_mfma_f32_16x16x32_bf16 a[132:135], v[180:183], v[196:199], 0
ds_read_b64_tr_b16 v[228:229], v76 offset:24576
v_mfma_f32_16x16x32_bf16 a[132:135], v[148:151], v[192:195], a[132:135]
v_mfma_f32_16x16x32_bf16 a[192:195], v[152:155], v[192:195], 0
ds_read_b64_tr_b16 v[230:231], v76 offset:25600
v_xor_b32 v76, 0x8000, v76
v_mfma_f32_16x16x32_bf16 a[192:195], v[184:187], v[196:199], a[192:195]
v_mfma_f32_16x16x32_bf16 a[196:199], v[188:191], v[196:199], 0
buffer_load_dwordx4 v74, s[16:19], s71 offen offset:2048 nt lds
v_mfma_f32_16x16x32_bf16 a[196:199], v[156:159], v[192:195], a[196:199]
v_mfma_f32_16x16x32_bf16 a[204:207], v[156:159], v[200:203], 0
v_mfma_f32_16x16x32_bf16 a[204:207], v[188:191], v[204:207], a[204:207]
ds_read_b64_tr_b16 v[232:233], v77 offset:16384
v_mfma_f32_16x16x32_bf16 a[200:203], v[184:187], v[204:207], 0
v_mfma_f32_16x16x32_bf16 a[200:203], v[152:155], v[200:203], a[200:203]
ds_read_b64_tr_b16 v[234:235], v77 offset:17408
v_mfma_f32_16x16x32_bf16 a[140:143], v[148:151], v[200:203], 0
buffer_load_dwordx4 v75, s[16:19], s71 offen offset:3072 nt lds
v_mfma_f32_16x16x32_bf16 a[140:143], v[180:183], v[204:207], a[140:143]
s_mov_b32 m0, s72
v_mfma_f32_16x16x32_bf16 a[136:139], v[176:179], v[204:207], 0
ds_read_b64_tr_b16 v[236:237], v77 offset:24576
v_mfma_f32_16x16x32_bf16 a[136:139], v[144:147], v[200:203], a[136:139]
v_mfma_f32_16x16x32_bf16 a[76:79], v[140:143], v[200:203], 0
ds_read_b64_tr_b16 v[238:239], v77 offset:25600
v_xor_b32 v77, 0x8000, v77
v_mfma_f32_16x16x32_bf16 a[76:79], v[172:175], v[204:207], a[76:79]
buffer_load_dwordx4 v20, s[12:15], s70 offen offset:0 lds
v_mfma_f32_16x16x32_bf16 a[72:75], v[168:171], v[204:207], 0
v_mfma_f32_16x16x32_bf16 a[72:75], v[136:139], v[200:203], a[72:75]
v_mfma_f32_16x16x32_bf16 a[12:15], v[132:135], v[200:203], 0
v_mfma_f32_16x16x32_bf16 a[12:15], v[164:167], v[204:207], a[12:15]
ds_read_b64_tr_b16 v[240:241], v78 offset:16384
v_mfma_f32_16x16x32_bf16 a[8:11], v[160:163], v[204:207], 0
buffer_load_dwordx4 v21, s[12:15], s70 offen offset:1024 lds
v_mfma_f32_16x16x32_bf16 a[8:11], v[128:131], v[200:203], a[8:11]
ds_read_b64_tr_b16 v[242:243], v78 offset:17408
v_mfma_f32_16x16x32_bf16 a[16:19], v[128:131], v[208:211], 0
v_mfma_f32_16x16x32_bf16 a[16:19], v[160:163], v[212:215], a[16:19]
v_mfma_f32_16x16x32_bf16 a[20:23], v[164:167], v[212:215], 0
ds_read_b64_tr_b16 v[244:245], v78 offset:24576
v_mfma_f32_16x16x32_bf16 a[20:23], v[132:135], v[208:211], a[20:23]
v_mfma_f32_16x16x32_bf16 a[80:83], v[136:139], v[208:211], 0
buffer_load_dwordx4 v22, s[12:15], s70 offen offset:2048 lds
v_mfma_f32_16x16x32_bf16 a[80:83], v[168:171], v[212:215], a[80:83]
ds_read_b64_tr_b16 v[246:247], v78 offset:25600
v_xor_b32 v78, 0x8000, v78
v_mfma_f32_16x16x32_bf16 a[84:87], v[172:175], v[212:215], 0
v_mfma_f32_16x16x32_bf16 a[84:87], v[140:143], v[208:211], a[84:87]
v_mfma_f32_16x16x32_bf16 a[144:147], v[144:147], v[208:211], 0
v_mfma_f32_16x16x32_bf16 a[144:147], v[176:179], v[212:215], a[144:147]
buffer_load_dwordx4 v23, s[12:15], s70 offen offset:3072 lds
v_mfma_f32_16x16x32_bf16 a[148:151], v[180:183], v[212:215], 0
ds_read_b64_tr_b16 v[248:249], v79 offset:16384
v_mfma_f32_16x16x32_bf16 a[148:151], v[148:151], v[208:211], a[148:151]
ds_read_b64_tr_b16 v[250:251], v79 offset:17408
v_mfma_f32_16x16x32_bf16 a[208:211], v[152:155], v[208:211], 0
v_mfma_f32_16x16x32_bf16 a[208:211], v[184:187], v[212:215], a[208:211]
v_mfma_f32_16x16x32_bf16 a[212:215], v[188:191], v[212:215], 0
buffer_load_dword v48, v1, s[24:27], s85 offen
v_mfma_f32_16x16x32_bf16 a[212:215], v[156:159], v[208:211], a[212:215]
s_add_u32 s85, s85, 1048576
ds_read_b64_tr_b16 v[252:253], v79 offset:24576
v_mfma_f32_16x16x32_bf16 a[220:223], v[156:159], v[216:219], 0
ds_read_b64_tr_b16 v[254:255], v79 offset:25600
v_xor_b32 v79, 0x8000, v79
v_mfma_f32_16x16x32_bf16 a[220:223], v[188:191], v[220:223], a[220:223]
v_mfma_f32_16x16x32_bf16 a[216:219], v[184:187], v[220:223], 0
v_mfma_f32_16x16x32_bf16 a[216:219], v[152:155], v[216:219], a[216:219]
v_mfma_f32_16x16x32_bf16 a[156:159], v[148:151], v[216:219], 0
v_mfma_f32_16x16x32_bf16 a[156:159], v[180:183], v[220:223], a[156:159]
v_mfma_f32_16x16x32_bf16 a[152:155], v[176:179], v[220:223], 0
v_mfma_f32_16x16x32_bf16 a[152:155], v[144:147], v[216:219], a[152:155]
s_add_u32 s71, s71, 524032
v_mfma_f32_16x16x32_bf16 a[92:95], v[140:143], v[216:219], 0
s_add_u32 s70, s70, 2097152
v_mfma_f32_16x16x32_bf16 a[92:95], v[172:175], v[220:223], a[92:95]
v_mfma_f32_16x16x32_bf16 a[88:91], v[168:171], v[220:223], 0
s_xor_b32 s73, s73, 0x8000
v_mfma_f32_16x16x32_bf16 a[88:91], v[136:139], v[216:219], a[88:91]
v_mfma_f32_16x16x32_bf16 a[28:31], v[132:135], v[216:219], 0
s_add_u32 s74, s74, 32768
v_mfma_f32_16x16x32_bf16 a[28:31], v[164:167], v[220:223], a[28:31]
s_cmp_ge_u32 s74, 98304
v_mfma_f32_16x16x32_bf16 a[24:27], v[160:163], v[220:223], 0
s_cselect_b32 s74, 0, s74
v_mfma_f32_16x16x32_bf16 a[24:27], v[128:131], v[216:219], a[24:27]
s_waitcnt lgkmcnt(0)
v_mfma_f32_16x16x32_bf16 a[32:35], v[128:131], v[224:227], 0
s_waitcnt vmcnt(10)
v_add_u32 v17, s74, v16
v_xor_b32 v42, 64, v17
v_mfma_f32_16x16x32_bf16 a[32:35], v[160:163], v[228:231], a[32:35]
s_barrier
v_mfma_f32_16x16x32_bf16 a[36:39], v[164:167], v[228:231], 0
v_mfma_f32_16x16x32_bf16 a[36:39], v[132:135], v[224:227], a[36:39]
ds_read_b64_tr_b16 v[192:193], v76 offset:0
v_mfma_f32_16x16x32_bf16 a[96:99], v[136:139], v[224:227], 0
buffer_load_dword v49, v1, s[24:27], s85 offen
v_mfma_f32_16x16x32_bf16 a[96:99], v[168:171], v[228:231], a[96:99]
s_add_u32 s85, s85, 1048576
v_mfma_f32_16x16x32_bf16 a[100:103], v[172:175], v[228:231], 0
s_mov_b32 m0, s73
ds_read_b64_tr_b16 v[194:195], v76 offset:1024
v_mfma_f32_16x16x32_bf16 a[100:103], v[140:143], v[224:227], a[100:103]
v_mfma_f32_16x16x32_bf16 a[160:163], v[144:147], v[224:227], 0
ds_read_b64_tr_b16 v[196:197], v76 offset:8192
v_mfma_f32_16x16x32_bf16 a[160:163], v[176:179], v[228:231], a[160:163]
buffer_load_dwordx4 v72, s[16:19], s71 offen offset:0 nt lds
v_mfma_f32_16x16x32_bf16 a[164:167], v[180:183], v[228:231], 0
v_mfma_f32_16x16x32_bf16 a[164:167], v[148:151], v[224:227], a[164:167]
ds_read_b64_tr_b16 v[198:199], v76 offset:9216
v_mfma_f32_16x16x32_bf16 a[224:227], v[152:155], v[224:227], 0
v_mfma_f32_16x16x32_bf16 a[224:227], v[184:187], v[228:231], a[224:227]
v_mfma_f32_16x16x32_bf16 a[228:231], v[188:191], v[228:231], 0
buffer_load_dwordx4 v73, s[16:19], s71 offen offset:1024 nt lds
v_mfma_f32_16x16x32_bf16 a[228:231], v[156:159], v[224:227], a[228:231]
ds_read_b64_tr_b16 v[200:201], v77 offset:0
v_mfma_f32_16x16x32_bf16 a[236:239], v[156:159], v[232:235], 0
v_mfma_f32_16x16x32_bf16 a[236:239], v[188:191], v[236:239], a[236:239]
ds_read_b64_tr_b16 v[202:203], v77 offset:1024
v_mfma_f32_16x16x32_bf16 a[232:235], v[184:187], v[236:239], 0
v_mfma_f32_16x16x32_bf16 a[232:235], v[152:155], v[232:235], a[232:235]
buffer_load_dwordx4 v74, s[16:19], s71 offen offset:2048 nt lds
v_mfma_f32_16x16x32_bf16 a[172:175], v[148:151], v[232:235], 0
ds_read_b64_tr_b16 v[204:205], v77 offset:8192
v_mfma_f32_16x16x32_bf16 a[172:175], v[180:183], v[236:239], a[172:175]
v_mfma_f32_16x16x32_bf16 a[168:171], v[176:179], v[236:239], 0
ds_read_b64_tr_b16 v[206:207], v77 offset:9216
v_mfma_f32_16x16x32_bf16 a[168:171], v[144:147], v[232:235], a[168:171]
v_mfma_f32_16x16x32_bf16 a[108:111], v[140:143], v[232:235], 0
buffer_load_dwordx4 v75, s[16:19], s71 offen offset:3072 nt lds
v_mfma_f32_16x16x32_bf16 a[108:111], v[172:175], v[236:239], a[108:111]
s_add_u32 m0, s72, 4096
ds_read_b64_tr_b16 v[208:209], v78 offset:0
v_mfma_f32_16x16x32_bf16 a[104:107], v[168:171], v[236:239], 0
v_mfma_f32_16x16x32_bf16 a[104:107], v[136:139], v[232:235], a[104:107]
v_mfma_f32_16x16x32_bf16 a[44:47], v[132:135], v[232:235], 0
ds_read_b64_tr_b16 v[210:211], v78 offset:1024
v_mfma_f32_16x16x32_bf16 a[44:47], v[164:167], v[236:239], a[44:47]
buffer_load_dwordx4 v20, s[12:15], s70 offen offset:0 lds
v_mfma_f32_16x16x32_bf16 a[40:43], v[160:163], v[236:239], 0
ds_read_b64_tr_b16 v[212:213], v78 offset:8192
v_mfma_f32_16x16x32_bf16 a[40:43], v[128:131], v[232:235], a[40:43]
v_mfma_f32_16x16x32_bf16 a[48:51], v[128:131], v[240:243], 0
v_mfma_f32_16x16x32_bf16 a[48:51], v[160:163], v[244:247], a[48:51]
ds_read_b64_tr_b16 v[214:215], v78 offset:9216
v_mfma_f32_16x16x32_bf16 a[52:55], v[164:167], v[244:247], 0
buffer_load_dwordx4 v21, s[12:15], s70 offen offset:1024 lds
v_mfma_f32_16x16x32_bf16 a[52:55], v[132:135], v[240:243], a[52:55]
v_mfma_f32_16x16x32_bf16 a[112:115], v[136:139], v[240:243], 0
ds_read_b64_tr_b16 v[216:217], v79 offset:0
v_mfma_f32_16x16x32_bf16 a[112:115], v[168:171], v[244:247], a[112:115]
v_mfma_f32_16x16x32_bf16 a[116:119], v[172:175], v[244:247], 0
v_mfma_f32_16x16x32_bf16 a[116:119], v[140:143], v[240:243], a[116:119]
buffer_load_dwordx4 v22, s[12:15], s70 offen offset:2048 lds
v_mfma_f32_16x16x32_bf16 a[176:179], v[144:147], v[240:243], 0
ds_read_b64_tr_b16 v[218:219], v79 offset:1024
v_mfma_f32_16x16x32_bf16 a[176:179], v[176:179], v[244:247], a[176:179]
ds_read_b64_tr_b16 v[220:221], v79 offset:8192
v_mfma_f32_16x16x32_bf16 a[180:183], v[180:183], v[244:247], 0
v_mfma_f32_16x16x32_bf16 a[180:183], v[148:151], v[240:243], a[180:183]
v_mfma_f32_16x16x32_bf16 a[240:243], v[152:155], v[240:243], 0
ds_read_b64_tr_b16 v[222:223], v79 offset:9216
v_mfma_f32_16x16x32_bf16 a[240:243], v[184:187], v[244:247], a[240:243]
buffer_load_dwordx4 v23, s[12:15], s70 offen offset:3072 lds
v_mfma_f32_16x16x32_bf16 a[244:247], v[188:191], v[244:247], 0
v_mfma_f32_16x16x32_bf16 a[244:247], v[156:159], v[240:243], a[244:247]
v_mfma_f32_16x16x32_bf16 a[56:59], v[128:131], v[248:251], 0
ds_read_b128 v[128:131], v17 offset:0
v_mfma_f32_16x16x32_bf16 a[56:59], v[160:163], v[252:255], a[56:59]
ds_read_b128 v[160:163], v42 offset:0
v_mfma_f32_16x16x32_bf16 a[60:63], v[164:167], v[252:255], 0
ds_read_b128 v[164:167], v42 offset:2048
v_mfma_f32_16x16x32_bf16 a[60:63], v[132:135], v[248:251], a[60:63]
ds_read_b128 v[132:135], v17 offset:2048
v_mfma_f32_16x16x32_bf16 a[120:123], v[136:139], v[248:251], 0
ds_read_b128 v[136:139], v17 offset:4096
v_mfma_f32_16x16x32_bf16 a[120:123], v[168:171], v[252:255], a[120:123]
ds_read_b128 v[168:171], v42 offset:4096
v_mfma_f32_16x16x32_bf16 a[124:127], v[172:175], v[252:255], 0
ds_read_b128 v[172:175], v42 offset:6144
v_mfma_f32_16x16x32_bf16 a[124:127], v[140:143], v[248:251], a[124:127]
s_add_u32 s71, s71, 256
ds_read_b128 v[140:143], v17 offset:6144
v_mfma_f32_16x16x32_bf16 a[184:187], v[144:147], v[248:251], 0
s_sub_u32 s70, s70, 2097024
ds_read_b128 v[144:147], v17 offset:8192
v_mfma_f32_16x16x32_bf16 a[184:187], v[176:179], v[252:255], a[184:187]
s_add_u32 s72, s72, 32768
ds_read_b128 v[176:179], v42 offset:8192
v_mfma_f32_16x16x32_bf16 a[188:191], v[180:183], v[252:255], 0
s_cmp_ge_u32 s72, 163840
ds_read_b128 v[180:183], v42 offset:10240
v_mfma_f32_16x16x32_bf16 a[188:191], v[148:151], v[248:251], a[188:191]
s_cselect_b32 s72, s75, s72
ds_read_b128 v[148:151], v17 offset:10240
v_mfma_f32_16x16x32_bf16 a[248:251], v[152:155], v[248:251], 0
ds_read_b128 v[152:155], v17 offset:12288
v_mfma_f32_16x16x32_bf16 a[248:251], v[184:187], v[252:255], a[248:251]
ds_read_b128 v[184:187], v42 offset:12288
v_mfma_f32_16x16x32_bf16 a[252:255], v[188:191], v[252:255], 0
ds_read_b128 v[188:191], v42 offset:14336
v_mfma_f32_16x16x32_bf16 a[252:255], v[156:159], v[248:251], a[252:255]
ds_read_b128 v[156:159], v17 offset:14336
s_mov_b32 s66, 11
s_branch KV_VL
ONCE2:
s_cmp_eq_u32 s66, 9
s_cbranch_scc0 SIDE1A
s_mul_i32 s63, s61, 56
s_and_b32 s63, s63, 0xfffffff0
s_add_u32 s24, s46, s63
s_addc_u32 s25, s47, 0
s_sub_u32 s26, 1204224, s63
s_mov_b32 s27, 0x20000
s_add_u32 s63, s62, 0
s_mul_i32 s64, s63, 43
s_lshr_b32 s64, s64, 7
s_mul_i32 s64, s64, 169344
s_mul_i32 s63, s63, 896
s_add_u32 s63, s63, s64
buffer_load_dwordx4 v[64:67], v18, s[24:27], s63 offen
s_add_u32 s63, s62, 16
s_mul_i32 s64, s63, 43
s_lshr_b32 s64, s64, 7
s_mul_i32 s64, s64, 169344
s_mul_i32 s63, s63, 896
s_add_u32 s63, s63, s64
buffer_load_dwordx4 v[68:71], v18, s[24:27], s63 offen
s_branch SIDE1C
SIDE1A:
s_cmp_eq_u32 s66, 7
s_cbranch_scc0 SIDE1B
s_lshl_b32 s63, s61, 17
s_add_u32 s85, s63, 134217728
s_add_u32 s85, s85, s68
s_lshl_b32 s63, s62, 12
s_add_u32 s63, s63, s85
s_add_u32 s64, s63, 65536
buffer_store_dwordx4 v[64:67], v1, s[8:11], s63 offen sc1
buffer_store_dwordx4 v[68:71], v1, s[8:11], s64 offen sc1
s_branch SIDE1C
SIDE1B:
buffer_store_byte v2, off, s[56:59], s2 sc1
SIDE1C:
s_branch BACK2
.p2align 5
KV_VL:
s_waitcnt lgkmcnt(8)
v_mfma_f32_16x16x32_bf16 a[0:3], v[128:131], v[192:195], a[0:3]
s_waitcnt vmcnt(8)
v_mfma_f32_16x16x32_bf16 a[0:3], v[160:163], v[196:199], a[0:3]
s_barrier
v_mfma_f32_16x16x32_bf16 a[4:7], v[164:167], v[196:199], a[4:7]
v_mfma_f32_16x16x32_bf16 a[4:7], v[132:135], v[192:195], a[4:7]
v_mfma_f32_16x16x32_bf16 a[64:67], v[136:139], v[192:195], a[64:67]
buffer_load_dword v6, v50, s[28:31], s79 offen
v_mfma_f32_16x16x32_bf16 a[64:67], v[168:171], v[196:199], a[64:67]
s_add_u32 s79, s79, 1024
ds_read_b64_tr_b16 v[224:225], v76 offset:16384
v_mfma_f32_16x16x32_bf16 a[68:71], v[172:175], v[196:199], a[68:71]
s_add_u32 m0, s73, 16384
v_mfma_f32_16x16x32_bf16 a[68:71], v[140:143], v[192:195], a[68:71]
s_waitcnt lgkmcnt(1)
ds_read_b64_tr_b16 v[226:227], v76 offset:17408
v_mfma_f32_16x16x32_bf16 a[128:131], v[144:147], v[192:195], a[128:131]
v_mfma_f32_16x16x32_bf16 a[128:131], v[176:179], v[196:199], a[128:131]
buffer_load_dwordx4 v72, s[16:19], s71 offen offset:0 nt lds
v_mfma_f32_16x16x32_bf16 a[132:135], v[180:183], v[196:199], a[132:135]
ds_read_b64_tr_b16 v[228:229], v76 offset:24576
v_mfma_f32_16x16x32_bf16 a[132:135], v[148:151], v[192:195], a[132:135]
v_mfma_f32_16x16x32_bf16 a[192:195], v[152:155], v[192:195], a[192:195]
ds_read_b64_tr_b16 v[230:231], v76 offset:25600
v_xor_b32 v76, 0x8000, v76
v_mfma_f32_16x16x32_bf16 a[192:195], v[184:187], v[196:199], a[192:195]
v_mfma_f32_16x16x32_bf16 a[196:199], v[188:191], v[196:199], a[196:199]
buffer_load_dwordx4 v73, s[16:19], s71 offen offset:1024 nt lds
v_mfma_f32_16x16x32_bf16 a[196:199], v[156:159], v[192:195], a[196:199]
v_mfma_f32_16x16x32_bf16 a[204:207], v[156:159], v[200:203], a[204:207]
v_mfma_f32_16x16x32_bf16 a[204:207], v[188:191], v[204:207], a[204:207]
ds_read_b64_tr_b16 v[232:233], v77 offset:16384
v_mfma_f32_16x16x32_bf16 a[200:203], v[184:187], v[204:207], a[200:203]
v_mfma_f32_16x16x32_bf16 a[200:203], v[152:155], v[200:203], a[200:203]
ds_read_b64_tr_b16 v[234:235], v77 offset:17408
v_mfma_f32_16x16x32_bf16 a[140:143], v[148:151], v[200:203], a[140:143]
buffer_load_dwordx4 v74, s[16:19], s71 offen offset:2048 nt lds
v_mfma_f32_16x16x32_bf16 a[140:143], v[180:183], v[204:207], a[140:143]
v_mfma_f32_16x16x32_bf16 a[136:139], v[176:179], v[204:207], a[136:139]
ds_read_b64_tr_b16 v[236:237], v77 offset:24576
v_mfma_f32_16x16x32_bf16 a[136:139], v[144:147], v[200:203], a[136:139]
v_mfma_f32_16x16x32_bf16 a[76:79], v[140:143], v[200:203], a[76:79]
ds_read_b64_tr_b16 v[238:239], v77 offset:25600
v_xor_b32 v77, 0x8000, v77
v_mfma_f32_16x16x32_bf16 a[76:79], v[172:175], v[204:207], a[76:79]
buffer_load_dwordx4 v75, s[16:19], s71 offen offset:3072 nt lds
v_mfma_f32_16x16x32_bf16 a[72:75], v[168:171], v[204:207], a[72:75]
s_mov_b32 m0, s72
v_mfma_f32_16x16x32_bf16 a[72:75], v[136:139], v[200:203], a[72:75]
v_mfma_f32_16x16x32_bf16 a[12:15], v[132:135], v[200:203], a[12:15]
v_mfma_f32_16x16x32_bf16 a[12:15], v[164:167], v[204:207], a[12:15]
ds_read_b64_tr_b16 v[240:241], v78 offset:16384
v_mfma_f32_16x16x32_bf16 a[8:11], v[160:163], v[204:207], a[8:11]
buffer_load_dwordx4 v20, s[12:15], s70 offen offset:0 lds
v_mfma_f32_16x16x32_bf16 a[8:11], v[128:131], v[200:203], a[8:11]
ds_read_b64_tr_b16 v[242:243], v78 offset:17408
v_mfma_f32_16x16x32_bf16 a[16:19], v[128:131], v[208:211], a[16:19]
v_mfma_f32_16x16x32_bf16 a[16:19], v[160:163], v[212:215], a[16:19]
v_mfma_f32_16x16x32_bf16 a[20:23], v[164:167], v[212:215], a[20:23]
ds_read_b64_tr_b16 v[244:245], v78 offset:24576
v_mfma_f32_16x16x32_bf16 a[20:23], v[132:135], v[208:211], a[20:23]
v_mfma_f32_16x16x32_bf16 a[80:83], v[136:139], v[208:211], a[80:83]
buffer_load_dwordx4 v21, s[12:15], s70 offen offset:1024 lds
v_mfma_f32_16x16x32_bf16 a[80:83], v[168:171], v[212:215], a[80:83]
ds_read_b64_tr_b16 v[246:247], v78 offset:25600
v_xor_b32 v78, 0x8000, v78
v_mfma_f32_16x16x32_bf16 a[84:87], v[172:175], v[212:215], a[84:87]
v_mfma_f32_16x16x32_bf16 a[84:87], v[140:143], v[208:211], a[84:87]
v_mfma_f32_16x16x32_bf16 a[144:147], v[144:147], v[208:211], a[144:147]
v_mfma_f32_16x16x32_bf16 a[144:147], v[176:179], v[212:215], a[144:147]
buffer_load_dwordx4 v22, s[12:15], s70 offen offset:2048 lds
v_mfma_f32_16x16x32_bf16 a[148:151], v[180:183], v[212:215], a[148:151]
ds_read_b64_tr_b16 v[248:249], v79 offset:16384
v_mfma_f32_16x16x32_bf16 a[148:151], v[148:151], v[208:211], a[148:151]
ds_read_b64_tr_b16 v[250:251], v79 offset:17408
v_mfma_f32_16x16x32_bf16 a[208:211], v[152:155], v[208:211], a[208:211]
v_mfma_f32_16x16x32_bf16 a[208:211], v[184:187], v[212:215], a[208:211]
v_mfma_f32_16x16x32_bf16 a[212:215], v[188:191], v[212:215], a[212:215]
buffer_load_dwordx4 v23, s[12:15], s70 offen offset:3072 lds
v_mfma_f32_16x16x32_bf16 a[212:215], v[156:159], v[208:211], a[212:215]
ds_read_b64_tr_b16 v[252:253], v79 offset:24576
v_mfma_f32_16x16x32_bf16 a[220:223], v[156:159], v[216:219], a[220:223]
ds_read_b64_tr_b16 v[254:255], v79 offset:25600
v_xor_b32 v79, 0x8000, v79
v_mfma_f32_16x16x32_bf16 a[220:223], v[188:191], v[220:223], a[220:223]
v_mfma_f32_16x16x32_bf16 a[216:219], v[184:187], v[220:223], a[216:219]
v_mfma_f32_16x16x32_bf16 a[216:219], v[152:155], v[216:219], a[216:219]
v_mfma_f32_16x16x32_bf16 a[156:159], v[148:151], v[216:219], a[156:159]
v_mfma_f32_16x16x32_bf16 a[156:159], v[180:183], v[220:223], a[156:159]
v_mfma_f32_16x16x32_bf16 a[152:155], v[176:179], v[220:223], a[152:155]
v_mfma_f32_16x16x32_bf16 a[152:155], v[144:147], v[216:219], a[152:155]
s_add_u32 s71, s71, 524032
v_mfma_f32_16x16x32_bf16 a[92:95], v[140:143], v[216:219], a[92:95]
s_add_u32 s70, s70, 2097152
v_mfma_f32_16x16x32_bf16 a[92:95], v[172:175], v[220:223], a[92:95]
v_mfma_f32_16x16x32_bf16 a[88:91], v[168:171], v[220:223], a[88:91]
s_xor_b32 s73, s73, 0x8000
v_mfma_f32_16x16x32_bf16 a[88:91], v[136:139], v[216:219], a[88:91]
v_mfma_f32_16x16x32_bf16 a[28:31], v[132:135], v[216:219], a[28:31]
s_add_u32 s74, s74, 32768
v_mfma_f32_16x16x32_bf16 a[28:31], v[164:167], v[220:223], a[28:31]
s_cmp_ge_u32 s74, 98304
v_mfma_f32_16x16x32_bf16 a[24:27], v[160:163], v[220:223], a[24:27]
s_cselect_b32 s74, 0, s74
v_mfma_f32_16x16x32_bf16 a[24:27], v[128:131], v[216:219], a[24:27]
s_waitcnt lgkmcnt(0)
v_mfma_f32_16x16x32_bf16 a[32:35], v[128:131], v[224:227], a[32:35]
s_waitcnt vmcnt(9)
v_add_u32 v17, s74, v16
v_xor_b32 v42, 64, v17
v_mfma_f32_16x16x32_bf16 a[32:35], v[160:163], v[228:231], a[32:35]
s_barrier
v_mfma_f32_16x16x32_bf16 a[36:39], v[164:167], v[228:231], a[36:39]
s_bitcmp1_b32 s80, s66
v_mfma_f32_16x16x32_bf16 a[36:39], v[132:135], v[224:227], a[36:39]
ds_read_b64_tr_b16 v[192:193], v76 offset:0
v_mfma_f32_16x16x32_bf16 a[96:99], v[136:139], v[224:227], a[96:99]
s_cbranch_scc1 ONCE2
BACK2:
v_mfma_f32_16x16x32_bf16 a[96:99], v[168:171], v[228:231], a[96:99]
v_mfma_f32_16x16x32_bf16 a[100:103], v[172:175], v[228:231], a[100:103]
s_mov_b32 m0, s73
ds_read_b64_tr_b16 v[194:195], v76 offset:1024
v_mfma_f32_16x16x32_bf16 a[100:103], v[140:143], v[224:227], a[100:103]
v_mfma_f32_16x16x32_bf16 a[160:163], v[144:147], v[224:227], a[160:163]
buffer_load_dwordx4 v72, s[16:19], s71 offen offset:0 nt lds
v_mfma_f32_16x16x32_bf16 a[160:163], v[176:179], v[228:231], a[160:163]
ds_read_b64_tr_b16 v[196:197], v76 offset:8192
v_mfma_f32_16x16x32_bf16 a[164:167], v[180:183], v[228:231], a[164:167]
v_mfma_f32_16x16x32_bf16 a[164:167], v[148:151], v[224:227], a[164:167]
ds_read_b64_tr_b16 v[198:199], v76 offset:9216
v_mfma_f32_16x16x32_bf16 a[224:227], v[152:155], v[224:227], a[224:227]
v_mfma_f32_16x16x32_bf16 a[224:227], v[184:187], v[228:231], a[224:227]
buffer_load_dwordx4 v73, s[16:19], s71 offen offset:1024 nt lds
v_mfma_f32_16x16x32_bf16 a[228:231], v[188:191], v[228:231], a[228:231]
ds_read_b64_tr_b16 v[200:201], v77 offset:0
v_mfma_f32_16x16x32_bf16 a[228:231], v[156:159], v[224:227], a[228:231]
v_mfma_f32_16x16x32_bf16 a[236:239], v[156:159], v[232:235], a[236:239]
v_mfma_f32_16x16x32_bf16 a[236:239], v[188:191], v[236:239], a[236:239]
ds_read_b64_tr_b16 v[202:203], v77 offset:1024
v_mfma_f32_16x16x32_bf16 a[232:235], v[184:187], v[236:239], a[232:235]
buffer_load_dwordx4 v74, s[16:19], s71 offen offset:2048 nt lds
v_mfma_f32_16x16x32_bf16 a[232:235], v[152:155], v[232:235], a[232:235]
ds_read_b64_tr_b16 v[204:205], v77 offset:8192
v_mfma_f32_16x16x32_bf16 a[172:175], v[148:151], v[232:235], a[172:175]
v_mfma_f32_16x16x32_bf16 a[172:175], v[180:183], v[236:239], a[172:175]
v_mfma_f32_16x16x32_bf16 a[168:171], v[176:179], v[236:239], a[168:171]
ds_read_b64_tr_b16 v[206:207], v77 offset:9216
v_mfma_f32_16x16x32_bf16 a[168:171], v[144:147], v[232:235], a[168:171]
buffer_load_dwordx4 v75, s[16:19], s71 offen offset:3072 nt lds
v_mfma_f32_16x16x32_bf16 a[108:111], v[140:143], v[232:235], a[108:111]
s_add_u32 m0, s72, 4096
v_mfma_f32_16x16x32_bf16 a[108:111], v[172:175], v[236:239], a[108:111]
ds_read_b64_tr_b16 v[208:209], v78 offset:0
v_mfma_f32_16x16x32_bf16 a[104:107], v[168:171], v[236:239], a[104:107]
v_mfma_f32_16x16x32_bf16 a[104:107], v[136:139], v[232:235], a[104:107]
v_mfma_f32_16x16x32_bf16 a[44:47], v[132:135], v[232:235], a[44:47]
ds_read_b64_tr_b16 v[210:211], v78 offset:1024
v_mfma_f32_16x16x32_bf16 a[44:47], v[164:167], v[236:239], a[44:47]
buffer_load_dwordx4 v20, s[12:15], s70 offen offset:0 lds
v_mfma_f32_16x16x32_bf16 a[40:43], v[160:163], v[236:239], a[40:43]
ds_read_b64_tr_b16 v[212:213], v78 offset:8192
v_mfma_f32_16x16x32_bf16 a[40:43], v[128:131], v[232:235], a[40:43]
v_mfma_f32_16x16x32_bf16 a[48:51], v[128:131], v[240:243], a[48:51]
v_mfma_f32_16x16x32_bf16 a[48:51], v[160:163], v[244:247], a[48:51]
ds_read_b64_tr_b16 v[214:215], v78 offset:9216
v_mfma_f32_16x16x32_bf16 a[52:55], v[164:167], v[244:247], a[52:55]
buffer_load_dwordx4 v21, s[12:15], s70 offen offset:1024 lds
v_mfma_f32_16x16x32_bf16 a[52:55], v[132:135], v[240:243], a[52:55]
v_mfma_f32_16x16x32_bf16 a[112:115], v[136:139], v[240:243], a[112:115]
ds_read_b64_tr_b16 v[216:217], v79 offset:0
v_mfma_f32_16x16x32_bf16 a[112:115], v[168:171], v[244:247], a[112:115]
v_mfma_f32_16x16x32_bf16 a[116:119], v[172:175], v[244:247], a[116:119]
v_mfma_f32_16x16x32_bf16 a[116:119], v[140:143], v[240:243], a[116:119]
buffer_load_dwordx4 v22, s[12:15], s70 offen offset:2048 lds
v_mfma_f32_16x16x32_bf16 a[176:179], v[144:147], v[240:243], a[176:179]
ds_read_b64_tr_b16 v[218:219], v79 offset:1024
v_mfma_f32_16x16x32_bf16 a[176:179], v[176:179], v[244:247], a[176:179]
ds_read_b64_tr_b16 v[220:221], v79 offset:8192
v_mfma_f32_16x16x32_bf16 a[180:183], v[180:183], v[244:247], a[180:183]
v_mfma_f32_16x16x32_bf16 a[180:183], v[148:151], v[240:243], a[180:183]
v_mfma_f32_16x16x32_bf16 a[240:243], v[152:155], v[240:243], a[240:243]
buffer_load_dwordx4 v23, s[12:15], s70 offen offset:3072 lds
v_mfma_f32_16x16x32_bf16 a[240:243], v[184:187], v[244:247], a[240:243]
ds_read_b64_tr_b16 v[222:223], v79 offset:9216
v_mfma_f32_16x16x32_bf16 a[244:247], v[188:191], v[244:247], a[244:247]
v_mfma_f32_16x16x32_bf16 a[244:247], v[156:159], v[240:243], a[244:247]
v_mfma_f32_16x16x32_bf16 a[56:59], v[128:131], v[248:251], a[56:59]
ds_read_b128 v[128:131], v17 offset:0
v_mfma_f32_16x16x32_bf16 a[56:59], v[160:163], v[252:255], a[56:59]
ds_read_b128 v[160:163], v42 offset:0
v_mfma_f32_16x16x32_bf16 a[60:63], v[164:167], v[252:255], a[60:63]
ds_read_b128 v[164:167], v42 offset:2048
v_mfma_f32_16x16x32_bf16 a[60:63], v[132:135], v[248:251], a[60:63]
ds_read_b128 v[132:135], v17 offset:2048
v_mfma_f32_16x16x32_bf16 a[120:123], v[136:139], v[248:251], a[120:123]
ds_read_b128 v[136:139], v17 offset:4096
v_mfma_f32_16x16x32_bf16 a[120:123], v[168:171], v[252:255], a[120:123]
ds_read_b128 v[168:171], v42 offset:4096
v_mfma_f32_16x16x32_bf16 a[124:127], v[172:175], v[252:255], a[124:127]
ds_read_b128 v[172:175], v42 offset:6144
v_mfma_f32_16x16x32_bf16 a[124:127], v[140:143], v[248:251], a[124:127]
s_add_u32 s71, s71, 256
ds_read_b128 v[140:143], v17 offset:6144
v_mfma_f32_16x16x32_bf16 a[184:187], v[144:147], v[248:251], a[184:187]
s_sub_u32 s70, s70, 2097024
ds_read_b128 v[144:147], v17 offset:8192
v_mfma_f32_16x16x32_bf16 a[184:187], v[176:179], v[252:255], a[184:187]
s_add_u32 s72, s72, 32768
ds_read_b128 v[176:179], v42 offset:8192
v_mfma_f32_16x16x32_bf16 a[188:191], v[180:183], v[252:255], a[188:191]
s_cmp_ge_u32 s72, 163840
ds_read_b128 v[180:183], v42 offset:10240
v_mfma_f32_16x16x32_bf16 a[188:191], v[148:151], v[248:251], a[188:191]
s_cselect_b32 s72, s75, s72
ds_read_b128 v[148:151], v17 offset:10240
v_mfma_f32_16x16x32_bf16 a[248:251], v[152:155], v[248:251], a[248:251]
ds_read_b128 v[152:155], v17 offset:12288
v_mfma_f32_16x16x32_bf16 a[248:251], v[184:187], v[252:255], a[248:251]
s_sub_u32 s66, s66, 1
ds_read_b128 v[184:187], v42 offset:12288
v_mfma_f32_16x16x32_bf16 a[252:255], v[188:191], v[252:255], a[252:255]
ds_read_b128 v[188:191], v42 offset:14336
v_mfma_f32_16x16x32_bf16 a[252:255], v[156:159], v[248:251], a[252:255]
ds_read_b128 v[156:159], v17 offset:14336
s_cbranch_scc0 KV_VL
s_waitcnt lgkmcnt(8)
v_mfma_f32_16x16x32_bf16 a[0:3], v[128:131], v[192:195], a[0:3]
s_waitcnt vmcnt(8)
v_mfma_f32_16x16x32_bf16 a[0:3], v[160:163], v[196:199], a[0:3]
s_barrier
v_mfma_f32_16x16x32_bf16 a[4:7], v[164:167], v[196:199], a[4:7]
v_mfma_f32_16x16x32_bf16 a[4:7], v[132:135], v[192:195], a[4:7]
v_mfma_f32_16x16x32_bf16 a[64:67], v[136:139], v[192:195], a[64:67]
buffer_load_dword v7, v5, s[56:59], 0 offen sc1
v_mfma_f32_16x16x32_bf16 a[64:67], v[168:171], v[196:199], a[64:67]
s_add_u32 m0, s73, 16384
ds_read_b64_tr_b16 v[224:225], v76 offset:16384
v_mfma_f32_16x16x32_bf16 a[68:71], v[172:175], v[196:199], a[68:71]
v_mfma_f32_16x16x32_bf16 a[68:71], v[140:143], v[192:195], a[68:71]
s_waitcnt lgkmcnt(1)
ds_read_b64_tr_b16 v[226:227], v76 offset:17408
v_mfma_f32_16x16x32_bf16 a[128:131], v[144:147], v[192:195], a[128:131]
v_mfma_f32_16x16x32_bf16 a[128:131], v[176:179], v[196:199], a[128:131]
buffer_load_dwordx4 v72, s[16:19], s71 offen offset:0 nt lds
v_mfma_f32_16x16x32_bf16 a[132:135], v[180:183], v[196:199], a[132:135]
ds_read_b64_tr_b16 v[228:229], v76 offset:24576
v_mfma_f32_16x16x32_bf16 a[132:135], v[148:151], v[192:195], a[132:135]
v_mfma_f32_16x16x32_bf16 a[192:195], v[152:155], v[192:195], a[192:195]
ds_read_b64_tr_b16 v[230:231], v76 offset:25600
v_xor_b32 v76, 0x8000, v76
v_mfma_f32_16x16x32_bf16 a[192:195], v[184:187], v[196:199], a[192:195]
v_mfma_f32_16x16x32_bf16 a[196:199], v[188:191], v[196:199], a[196:199]
buffer_load_dwordx4 v73, s[16:19], s71 offen offset:1024 nt lds
v_mfma_f32_16x16x32_bf16 a[196:199], v[156:159], v[192:195], a[196:199]
v_mfma_f32_16x16x32_bf16 a[204:207], v[156:159], v[200:203], a[204:207]
v_mfma_f32_16x16x32_bf16 a[204:207], v[188:191], v[204:207], a[204:207]
ds_read_b64_tr_b16 v[232:233], v77 offset:16384
v_mfma_f32_16x16x32_bf16 a[200:203], v[184:187], v[204:207], a[200:203]
v_mfma_f32_16x16x32_bf16 a[200:203], v[152:155], v[200:203], a[200:203]
ds_read_b64_tr_b16 v[234:235], v77 offset:17408
v_mfma_f32_16x16x32_bf16 a[140:143], v[148:151], v[200:203], a[140:143]
buffer_load_dwordx4 v74, s[16:19], s71 offen offset:2048 nt lds
v_mfma_f32_16x16x32_bf16 a[140:143], v[180:183], v[204:207], a[140:143]
v_mfma_f32_16x16x32_bf16 a[136:139], v[176:179], v[204:207], a[136:139]
ds_read_b64_tr_b16 v[236:237], v77 offset:24576
v_mfma_f32_16x16x32_bf16 a[136:139], v[144:147], v[200:203], a[136:139]
v_mfma_f32_16x16x32_bf16 a[76:79], v[140:143], v[200:203], a[76:79]
ds_read_b64_tr_b16 v[238:239], v77 offset:25600
v_xor_b32 v77, 0x8000, v77
v_mfma_f32_16x16x32_bf16 a[76:79], v[172:175], v[204:207], a[76:79]
buffer_load_dwordx4 v75, s[16:19], s71 offen offset:3072 nt lds
v_mfma_f32_16x16x32_bf16 a[72:75], v[168:171], v[204:207], a[72:75]
s_mov_b32 m0, s72
v_mfma_f32_16x16x32_bf16 a[72:75], v[136:139], v[200:203], a[72:75]
v_mfma_f32_16x16x32_bf16 a[12:15], v[132:135], v[200:203], a[12:15]
v_mfma_f32_16x16x32_bf16 a[12:15], v[164:167], v[204:207], a[12:15]
ds_read_b64_tr_b16 v[240:241], v78 offset:16384
v_mfma_f32_16x16x32_bf16 a[8:11], v[160:163], v[204:207], a[8:11]
buffer_load_dwordx4 v20, s[12:15], s70 offen offset:0 lds
v_mfma_f32_16x16x32_bf16 a[8:11], v[128:131], v[200:203], a[8:11]
ds_read_b64_tr_b16 v[242:243], v78 offset:17408
v_mfma_f32_16x16x32_bf16 a[16:19], v[128:131], v[208:211], a[16:19]
v_mfma_f32_16x16x32_bf16 a[16:19], v[160:163], v[212:215], a[16:19]
v_mfma_f32_16x16x32_bf16 a[20:23], v[164:167], v[212:215], a[20:23]
ds_read_b64_tr_b16 v[244:245], v78 offset:24576
v_mfma_f32_16x16x32_bf16 a[20:23], v[132:135], v[208:211], a[20:23]
v_mfma_f32_16x16x32_bf16 a[80:83], v[136:139], v[208:211], a[80:83]
buffer_load_dwordx4 v21, s[12:15], s70 offen offset:1024 lds
v_mfma_f32_16x16x32_bf16 a[80:83], v[168:171], v[212:215], a[80:83]
ds_read_b64_tr_b16 v[246:247], v78 offset:25600
v_xor_b32 v78, 0x8000, v78
v_mfma_f32_16x16x32_bf16 a[84:87], v[172:175], v[212:215], a[84:87]
v_mfma_f32_16x16x32_bf16 a[84:87], v[140:143], v[208:211], a[84:87]
v_mfma_f32_16x16x32_bf16 a[144:147], v[144:147], v[208:211], a[144:147]
v_mfma_f32_16x16x32_bf16 a[144:147], v[176:179], v[212:215], a[144:147]
buffer_load_dwordx4 v22, s[12:15], s70 offen offset:2048 lds
v_mfma_f32_16x16x32_bf16 a[148:151], v[180:183], v[212:215], a[148:151]
ds_read_b64_tr_b16 v[248:249], v79 offset:16384
v_mfma_f32_16x16x32_bf16 a[148:151], v[148:151], v[208:211], a[148:151]
ds_read_b64_tr_b16 v[250:251], v79 offset:17408
v_mfma_f32_16x16x32_bf16 a[208:211], v[152:155], v[208:211], a[208:211]
v_mfma_f32_16x16x32_bf16 a[208:211], v[184:187], v[212:215], a[208:211]
v_mfma_f32_16x16x32_bf16 a[212:215], v[188:191], v[212:215], a[212:215]
buffer_load_dwordx4 v23, s[12:15], s70 offen offset:3072 lds
v_mfma_f32_16x16x32_bf16 a[212:215], v[156:159], v[208:211], a[212:215]
ds_read_b64_tr_b16 v[252:253], v79 offset:24576
v_mfma_f32_16x16x32_bf16 a[220:223], v[156:159], v[216:219], a[220:223]
ds_read_b64_tr_b16 v[254:255], v79 offset:25600
v_xor_b32 v79, 0x8000, v79
v_mfma_f32_16x16x32_bf16 a[220:223], v[188:191], v[220:223], a[220:223]
v_mfma_f32_16x16x32_bf16 a[216:219], v[184:187], v[220:223], a[216:219]
v_mfma_f32_16x16x32_bf16 a[216:219], v[152:155], v[216:219], a[216:219]
v_mfma_f32_16x16x32_bf16 a[156:159], v[148:151], v[216:219], a[156:159]
v_mfma_f32_16x16x32_bf16 a[156:159], v[180:183], v[220:223], a[156:159]
v_mfma_f32_16x16x32_bf16 a[152:155], v[176:179], v[220:223], a[152:155]
v_mfma_f32_16x16x32_bf16 a[152:155], v[144:147], v[216:219], a[152:155]
s_add_u32 s71, s71, 524032
v_mfma_f32_16x16x32_bf16 a[92:95], v[140:143], v[216:219], a[92:95]
s_add_u32 s70, s70, 2097152
v_mfma_f32_16x16x32_bf16 a[92:95], v[172:175], v[220:223], a[92:95]
v_mfma_f32_16x16x32_bf16 a[88:91], v[168:171], v[220:223], a[88:91]
s_xor_b32 s73, s73, 0x8000
v_mfma_f32_16x16x32_bf16 a[88:91], v[136:139], v[216:219], a[88:91]
v_mfma_f32_16x16x32_bf16 a[28:31], v[132:135], v[216:219], a[28:31]
s_add_u32 s74, s74, 32768
v_mfma_f32_16x16x32_bf16 a[28:31], v[164:167], v[220:223], a[28:31]
s_cmp_ge_u32 s74, 98304
v_mfma_f32_16x16x32_bf16 a[24:27], v[160:163], v[220:223], a[24:27]
s_cselect_b32 s74, 0, s74
v_mfma_f32_16x16x32_bf16 a[24:27], v[128:131], v[216:219], a[24:27]
s_waitcnt lgkmcnt(0)
v_mfma_f32_16x16x32_bf16 a[32:35], v[128:131], v[224:227], a[32:35]
s_waitcnt vmcnt(9)
v_add_u32 v17, s74, v16
v_xor_b32 v42, 64, v17
v_mfma_f32_16x16x32_bf16 a[32:35], v[160:163], v[228:231], a[32:35]
s_barrier
v_mfma_f32_16x16x32_bf16 a[36:39], v[164:167], v[228:231], a[36:39]
s_mov_b32 m0, s73
v_mfma_f32_16x16x32_bf16 a[36:39], v[132:135], v[224:227], a[36:39]
ds_read_b64_tr_b16 v[192:193], v76 offset:0
v_mfma_f32_16x16x32_bf16 a[96:99], v[136:139], v[224:227], a[96:99]
buffer_load_dwordx4 v72, s[16:19], s71 offen offset:0 nt lds
v_mfma_f32_16x16x32_bf16 a[96:99], v[168:171], v[228:231], a[96:99]
v_mfma_f32_16x16x32_bf16 a[100:103], v[172:175], v[228:231], a[100:103]
ds_read_b64_tr_b16 v[194:195], v76 offset:1024
v_mfma_f32_16x16x32_bf16 a[100:103], v[140:143], v[224:227], a[100:103]
v_mfma_f32_16x16x32_bf16 a[160:163], v[144:147], v[224:227], a[160:163]
ds_read_b64_tr_b16 v[196:197], v76 offset:8192
v_mfma_f32_16x16x32_bf16 a[160:163], v[176:179], v[228:231], a[160:163]
buffer_load_dwordx4 v73, s[16:19], s71 offen offset:1024 nt lds
v_mfma_f32_16x16x32_bf16 a[164:167], v[180:183], v[228:231], a[164:167]
v_mfma_f32_16x16x32_bf16 a[164:167], v[148:151], v[224:227], a[164:167]
ds_read_b64_tr_b16 v[198:199], v76 offset:9216
v_mfma_f32_16x16x32_bf16 a[224:227], v[152:155], v[224:227], a[224:227]
v_mfma_f32_16x16x32_bf16 a[224:227], v[184:187], v[228:231], a[224:227]
v_mfma_f32_16x16x32_bf16 a[228:231], v[188:191], v[228:231], a[228:231]
buffer_load_dwordx4 v74, s[16:19], s71 offen offset:2048 nt lds
v_mfma_f32_16x16x32_bf16 a[228:231], v[156:159], v[224:227], a[228:231]
ds_read_b64_tr_b16 v[200:201], v77 offset:0
v_mfma_f32_16x16x32_bf16 a[236:239], v[156:159], v[232:235], a[236:239]
v_mfma_f32_16x16x32_bf16 a[236:239], v[188:191], v[236:239], a[236:239]
ds_read_b64_tr_b16 v[202:203], v77 offset:1024
v_mfma_f32_16x16x32_bf16 a[232:235], v[184:187], v[236:239], a[232:235]
v_mfma_f32_16x16x32_bf16 a[232:235], v[152:155], v[232:235], a[232:235]
buffer_load_dwordx4 v75, s[16:19], s71 offen offset:3072 nt lds
v_mfma_f32_16x16x32_bf16 a[172:175], v[148:151], v[232:235], a[172:175]
s_add_u32 m0, s72, 4096
ds_read_b64_tr_b16 v[204:205], v77 offset:8192
v_mfma_f32_16x16x32_bf16 a[172:175], v[180:183], v[236:239], a[172:175]
v_mfma_f32_16x16x32_bf16 a[168:171], v[176:179], v[236:239], a[168:171]
ds_read_b64_tr_b16 v[206:207], v77 offset:9216
v_mfma_f32_16x16x32_bf16 a[168:171], v[144:147], v[232:235], a[168:171]
v_mfma_f32_16x16x32_bf16 a[108:111], v[140:143], v[232:235], a[108:111]
buffer_load_dwordx4 v20, s[12:15], s70 offen offset:0 lds
v_mfma_f32_16x16x32_bf16 a[108:111], v[172:175], v[236:239], a[108:111]
ds_read_b64_tr_b16 v[208:209], v78 offset:0
v_mfma_f32_16x16x32_bf16 a[104:107], v[168:171], v[236:239], a[104:107]
v_mfma_f32_16x16x32_bf16 a[104:107], v[136:139], v[232:235], a[104:107]
v_mfma_f32_16x16x32_bf16 a[44:47], v[132:135], v[232:235], a[44:47]
ds_read_b64_tr_b16 v[210:211], v78 offset:1024
v_mfma_f32_16x16x32_bf16 a[44:47], v[164:167], v[236:239], a[44:47]
buffer_load_dwordx4 v21, s[12:15], s70 offen offset:1024 lds
v_mfma_f32_16x16x32_bf16 a[40:43], v[160:163], v[236:239], a[40:43]
ds_read_b64_tr_b16 v[212:213], v78 offset:8192
v_mfma_f32_16x16x32_bf16 a[40:43], v[128:131], v[232:235], a[40:43]
v_mfma_f32_16x16x32_bf16 a[48:51], v[128:131], v[240:243], a[48:51]
v_mfma_f32_16x16x32_bf16 a[48:51], v[160:163], v[244:247], a[48:51]
ds_read_b64_tr_b16 v[214:215], v78 offset:9216
v_mfma_f32_16x16x32_bf16 a[52:55], v[164:167], v[244:247], a[52:55]
buffer_load_dwordx4 v22, s[12:15], s70 offen offset:2048 lds
v_mfma_f32_16x16x32_bf16 a[52:55], v[132:135], v[240:243], a[52:55]
v_mfma_f32_16x16x32_bf16 a[112:115], v[136:139], v[240:243], a[112:115]
ds_read_b64_tr_b16 v[216:217], v79 offset:0
v_mfma_f32_16x16x32_bf16 a[112:115], v[168:171], v[244:247], a[112:115]
v_mfma_f32_16x16x32_bf16 a[116:119], v[172:175], v[244:247], a[116:119]
v_mfma_f32_16x16x32_bf16 a[116:119], v[140:143], v[240:243], a[116:119]
buffer_load_dwordx4 v23, s[12:15], s70 offen offset:3072 lds
v_mfma_f32_16x16x32_bf16 a[176:179], v[144:147], v[240:243], a[176:179]
s_mul_i32 s63, s61, 1568
ds_read_b64_tr_b16 v[218:219], v79 offset:1024
v_mfma_f32_16x16x32_bf16 a[176:179], v[176:179], v[244:247], a[176:179]
s_add_u32 s28, s48, s63
ds_read_b64_tr_b16 v[220:221], v79 offset:8192
v_mfma_f32_16x16x32_bf16 a[180:183], v[180:183], v[244:247], a[180:183]
s_addc_u32 s29, s49, 0
v_mfma_f32_16x16x32_bf16 a[180:183], v[148:151], v[240:243], a[180:183]
s_mov_b32 s30, 1568
v_mfma_f32_16x16x32_bf16 a[240:243], v[152:155], v[240:243], a[240:243]
s_add_u32 m0, s68, 122880
ds_read_b64_tr_b16 v[222:223], v79 offset:9216
v_mfma_f32_16x16x32_bf16 a[240:243], v[184:187], v[244:247], a[240:243]
buffer_load_dwordx4 v1, s[28:31], s68 offen offset:0 lds
v_mfma_f32_16x16x32_bf16 a[244:247], v[188:191], v[244:247], a[244:247]
v_mfma_f32_16x16x32_bf16 a[244:247], v[156:159], v[240:243], a[244:247]
v_mfma_f32_16x16x32_bf16 a[56:59], v[128:131], v[248:251], a[56:59]
ds_read_b128 v[128:131], v17 offset:0
v_mfma_f32_16x16x32_bf16 a[56:59], v[160:163], v[252:255], a[56:59]
ds_read_b128 v[160:163], v42 offset:0
v_mfma_f32_16x16x32_bf16 a[60:63], v[164:167], v[252:255], a[60:63]
ds_read_b128 v[164:167], v42 offset:2048
v_mfma_f32_16x16x32_bf16 a[60:63], v[132:135], v[248:251], a[60:63]
ds_read_b128 v[132:135], v17 offset:2048
v_mfma_f32_16x16x32_bf16 a[120:123], v[136:139], v[248:251], a[120:123]
ds_read_b128 v[136:139], v17 offset:4096
v_mfma_f32_16x16x32_bf16 a[120:123], v[168:171], v[252:255], a[120:123]
ds_read_b128 v[168:171], v42 offset:4096
v_mfma_f32_16x16x32_bf16 a[124:127], v[172:175], v[252:255], a[124:127]
ds_read_b128 v[172:175], v42 offset:6144
v_mfma_f32_16x16x32_bf16 a[124:127], v[140:143], v[248:251], a[124:127]
s_add_u32 s71, s71, 256
ds_read_b128 v[140:143], v17 offset:6144
v_mfma_f32_16x16x32_bf16 a[184:187], v[144:147], v[248:251], a[184:187]
ds_read_b128 v[144:147], v17 offset:8192
v_mfma_f32_16x16x32_bf16 a[184:187], v[176:179], v[252:255], a[184:187]
ds_read_b128 v[176:179], v42 offset:8192
v_mfma_f32_16x16x32_bf16 a[188:191], v[180:183], v[252:255], a[188:191]
ds_read_b128 v[180:183], v42 offset:10240
v_mfma_f32_16x16x32_bf16 a[188:191], v[148:151], v[248:251], a[188:191]
ds_read_b128 v[148:151], v17 offset:10240
v_mfma_f32_16x16x32_bf16 a[248:251], v[152:155], v[248:251], a[248:251]
ds_read_b128 v[152:155], v17 offset:12288
v_mfma_f32_16x16x32_bf16 a[248:251], v[184:187], v[252:255], a[248:251]
ds_read_b128 v[184:187], v42 offset:12288
v_mfma_f32_16x16x32_bf16 a[252:255], v[188:191], v[252:255], a[252:255]
ds_read_b128 v[188:191], v42 offset:14336
v_mfma_f32_16x16x32_bf16 a[252:255], v[156:159], v[248:251], a[252:255]
s_waitcnt lgkmcnt(6)
ds_read_b128 v[156:159], v17 offset:14336
v_mfma_f32_16x16x32_bf16 a[0:3], v[128:131], v[192:195], a[0:3]
s_waitcnt vmcnt(9)
v_mfma_f32_16x16x32_bf16 a[0:3], v[160:163], v[196:199], a[0:3]
s_barrier
v_cmp_ne_u32 vcc, 0x01010101, v7
s_nop 0
s_cmp_lg_u64 vcc, 0
s_cbranch_scc1 SPIN3_0
OK3_0:
v_mfma_f32_16x16x32_bf16 a[4:7], v[164:167], v[196:199], a[4:7]
s_add_u32 m0, s73, 16384
v_mfma_f32_16x16x32_bf16 a[4:7], v[132:135], v[192:195], a[4:7]
buffer_load_dwordx4 v72, s[16:19], s71 offen offset:0 nt lds
v_mfma_f32_16x16x32_bf16 a[64:67], v[136:139], v[192:195], a[64:67]
v_mfma_f32_16x16x32_bf16 a[64:67], v[168:171], v[196:199], a[64:67]
ds_read_b64_tr_b16 v[224:225], v76 offset:16384
v_mfma_f32_16x16x32_bf16 a[68:71], v[172:175], v[196:199], a[68:71]
v_mfma_f32_16x16x32_bf16 a[68:71], v[140:143], v[192:195], a[68:71]
ds_read_b64_tr_b16 v[226:227], v76 offset:17408
v_mfma_f32_16x16x32_bf16 a[128:131], v[144:147], v[192:195], a[128:131]
s_waitcnt lgkmcnt(2)
buffer_load_dwordx4 v73, s[16:19], s71 offen offset:1024 nt lds
v_mfma_f32_16x16x32_bf16 a[128:131], v[176:179], v[196:199], a[128:131]
v_mfma_f32_16x16x32_bf16 a[132:135], v[180:183], v[196:199], a[132:135]
ds_read_b64_tr_b16 v[228:229], v76 offset:24576
v_mfma_f32_16x16x32_bf16 a[132:135], v[148:151], v[192:195], a[132:135]
v_mfma_f32_16x16x32_bf16 a[192:195], v[152:155], v[192:195], a[192:195]
buffer_load_dwordx4 v74, s[16:19], s71 offen offset:2048 nt lds
v_mfma_f32_16x16x32_bf16 a[192:195], v[184:187], v[196:199], a[192:195]
ds_read_b64_tr_b16 v[230:231], v76 offset:25600
v_xor_b32 v76, 0x8000, v76
v_mfma_f32_16x16x32_bf16 a[196:199], v[188:191], v[196:199], a[196:199]
v_mfma_f32_16x16x32_bf16 a[196:199], v[156:159], v[192:195], a[196:199]
v_mfma_f32_16x16x32_bf16 a[204:207], v[156:159], v[200:203], a[204:207]
buffer_load_dwordx4 v75, s[16:19], s71 offen offset:3072 nt lds
v_mfma_f32_16x16x32_bf16 a[204:207], v[188:191], v[204:207], a[204:207]
s_add_u32 m0, s68, 98304
ds_read_b64_tr_b16 v[232:233], v77 offset:16384
v_mfma_f32_16x16x32_bf16 a[200:203], v[184:187], v[204:207], a[200:203]
s_add_u32 s65, s85, 0
v_mfma_f32_16x16x32_bf16 a[200:203], v[152:155], v[200:203], a[200:203]
ds_read_b64_tr_b16 v[234:235], v77 offset:17408
v_mfma_f32_16x16x32_bf16 a[140:143], v[148:151], v[200:203], a[140:143]
v_mfma_f32_16x16x32_bf16 a[140:143], v[180:183], v[204:207], a[140:143]
buffer_load_dwordx4 v1, s[8:11], s65 offen offset:0 sc1 lds
v_mfma_f32_16x16x32_bf16 a[136:139], v[176:179], v[204:207], a[136:139]
s_add_u32 m0, s68, 102400
ds_read_b64_tr_b16 v[236:237], v77 offset:24576
v_mfma_f32_16x16x32_bf16 a[136:139], v[144:147], v[200:203], a[136:139]
s_add_u32 s65, s85, 4096
v_mfma_f32_16x16x32_bf16 a[76:79], v[140:143], v[200:203], a[76:79]
ds_read_b64_tr_b16 v[238:239], v77 offset:25600
v_xor_b32 v77, 0x8000, v77
v_mfma_f32_16x16x32_bf16 a[76:79], v[172:175], v[204:207], a[76:79]
buffer_load_dwordx4 v1, s[8:11], s65 offen offset:0 sc1 lds
v_mfma_f32_16x16x32_bf16 a[72:75], v[168:171], v[204:207], a[72:75]
s_add_u32 m0, s68, 106496
v_mfma_f32_16x16x32_bf16 a[72:75], v[136:139], v[200:203], a[72:75]
s_add_u32 s65, s85, 8192
v_mfma_f32_16x16x32_bf16 a[12:15], v[132:135], v[200:203], a[12:15]
v_mfma_f32_16x16x32_bf16 a[12:15], v[164:167], v[204:207], a[12:15]
buffer_load_dwordx4 v1, s[8:11], s65 offen offset:0 sc1 lds
v_mfma_f32_16x16x32_bf16 a[8:11], v[160:163], v[204:207], a[8:11]
s_mov_b32 s65, 0
ds_read_b64_tr_b16 v[240:241], v78 offset:16384
v_mfma_f32_16x16x32_bf16 a[8:11], v[128:131], v[200:203], a[8:11]
s_add_u32 m0, s67, 0
ds_read_b64_tr_b16 v[242:243], v78 offset:17408
v_mfma_f32_16x16x32_bf16 a[16:19], v[128:131], v[208:211], a[16:19]
v_mfma_f32_16x16x32_bf16 a[16:19], v[160:163], v[212:215], a[16:19]
v_mfma_f32_16x16x32_bf16 a[20:23], v[164:167], v[212:215], a[20:23]
buffer_load_dwordx4 v36, s[20:23], s65 offen offset:0 lds
v_mfma_f32_16x16x32_bf16 a[20:23], v[132:135], v[208:211], a[20:23]
ds_read_b64_tr_b16 v[244:245], v78 offset:24576
v_mfma_f32_16x16x32_bf16 a[80:83], v[136:139], v[208:211], a[80:83]
ds_read_b64_tr_b16 v[246:247], v78 offset:25600
v_xor_b32 v78, 0x8000, v78
v_mfma_f32_16x16x32_bf16 a[80:83], v[168:171], v[212:215], a[80:83]
v_mfma_f32_16x16x32_bf16 a[84:87], v[172:175], v[212:215], a[84:87]
buffer_load_dwordx4 v37, s[20:23], s65 offen offset:1024 lds
v_mfma_f32_16x16x32_bf16 a[84:87], v[140:143], v[208:211], a[84:87]
v_mfma_f32_16x16x32_bf16 a[144:147], v[144:147], v[208:211], a[144:147]
buffer_load_dwordx4 v38, s[20:23], s65 offen offset:2048 lds
v_mfma_f32_16x16x32_bf16 a[144:147], v[176:179], v[212:215], a[144:147]
buffer_load_dwordx4 v39, s[20:23], s65 offen offset:3072 lds
v_mfma_f32_16x16x32_bf16 a[148:151], v[180:183], v[212:215], a[148:151]
s_mul_i32 s63, s62, 114688
ds_read_b64_tr_b16 v[248:249], v79 offset:16384
v_mfma_f32_16x16x32_bf16 a[148:151], v[148:151], v[208:211], a[148:151]
s_add_u32 s12, s32, s63
ds_read_b64_tr_b16 v[250:251], v79 offset:17408
v_mfma_f32_16x16x32_bf16 a[208:211], v[152:155], v[208:211], a[208:211]
s_addc_u32 s13, s33, 0
v_mfma_f32_16x16x32_bf16 a[208:211], v[184:187], v[212:215], a[208:211]
s_mov_b32 s14, 114688
v_mfma_f32_16x16x32_bf16 a[212:215], v[188:191], v[212:215], a[212:215]
s_lshl_b32 s63, s61, 9
ds_read_b64_tr_b16 v[252:253], v79 offset:24576
v_mfma_f32_16x16x32_bf16 a[212:215], v[156:159], v[208:211], a[212:215]
s_add_u32 s16, s36, s63
v_mfma_f32_16x16x32_bf16 a[220:223], v[156:159], v[216:219], a[220:223]
s_addc_u32 s17, s37, 0
ds_read_b64_tr_b16 v[254:255], v79 offset:25600
v_xor_b32 v79, 0x8000, v79
v_mfma_f32_16x16x32_bf16 a[220:223], v[188:191], v[220:223], a[220:223]
s_sub_u32 s18, 3670016, s63
v_mfma_f32_16x16x32_bf16 a[216:219], v[184:187], v[220:223], a[216:219]
v_mfma_f32_16x16x32_bf16 a[216:219], v[152:155], v[216:219], a[216:219]
v_mfma_f32_16x16x32_bf16 a[156:159], v[148:151], v[216:219], a[156:159]
v_mfma_f32_16x16x32_bf16 a[156:159], v[180:183], v[220:223], a[156:159]
v_mfma_f32_16x16x32_bf16 a[152:155], v[176:179], v[220:223], a[152:155]
v_mfma_f32_16x16x32_bf16 a[152:155], v[144:147], v[216:219], a[152:155]
v_mfma_f32_16x16x32_bf16 a[92:95], v[140:143], v[216:219], a[92:95]
v_mfma_f32_16x16x32_bf16 a[92:95], v[172:175], v[220:223], a[92:95]
v_mfma_f32_16x16x32_bf16 a[88:91], v[168:171], v[220:223], a[88:91]
v_mfma_f32_16x16x32_bf16 a[88:91], v[136:139], v[216:219], a[88:91]
v_mfma_f32_16x16x32_bf16 a[28:31], v[132:135], v[216:219], a[28:31]
s_add_u32 s74, s74, 32768
v_mfma_f32_16x16x32_bf16 a[28:31], v[164:167], v[220:223], a[28:31]
s_cmp_ge_u32 s74, 98304
v_mfma_f32_16x16x32_bf16 a[24:27], v[160:163], v[220:223], a[24:27]
s_cselect_b32 s74, 0, s74
v_mfma_f32_16x16x32_bf16 a[24:27], v[128:131], v[216:219], a[24:27]
s_waitcnt lgkmcnt(0)
v_mfma_f32_16x16x32_bf16 a[32:35], v[128:131], v[224:227], a[32:35]
s_waitcnt vmcnt(12)
v_add_u32 v17, s74, v16
v_xor_b32 v42, 64, v17
v_mfma_f32_16x16x32_bf16 a[32:35], v[160:163], v[228:231], a[32:35]
s_barrier
v_mfma_f32_16x16x32_bf16 a[36:39], v[164:167], v[228:231], a[36:39]
s_add_u32 m0, s68, 110592
v_mfma_f32_16x16x32_bf16 a[36:39], v[132:135], v[224:227], a[36:39]
s_add_u32 s65, s85, 12288
ds_read_b64_tr_b16 v[192:193], v76 offset:0
v_mfma_f32_16x16x32_bf16 a[96:99], v[136:139], v[224:227], a[96:99]
buffer_load_dwordx4 v1, s[8:11], s65 offen offset:0 sc1 lds
v_mfma_f32_16x16x32_bf16 a[96:99], v[168:171], v[228:231], a[96:99]
s_add_u32 m0, s68, 114688
v_mfma_f32_16x16x32_bf16 a[100:103], v[172:175], v[228:231], a[100:103]
s_add_u32 s65, s85, 16384
ds_read_b64_tr_b16 v[194:195], v76 offset:1024
v_mfma_f32_16x16x32_bf16 a[100:103], v[140:143], v[224:227], a[100:103]
buffer_load_dwordx4 v1, s[8:11], s65 offen offset:0 sc1 lds
v_mfma_f32_16x16x32_bf16 a[160:163], v[144:147], v[224:227], a[160:163]
s_add_u32 m0, s68, 118784
ds_read_b64_tr_b16 v[196:197], v76 offset:8192
v_mfma_f32_16x16x32_bf16 a[160:163], v[176:179], v[228:231], a[160:163]
s_add_u32 s65, s85, 20480
v_mfma_f32_16x16x32_bf16 a[164:167], v[180:183], v[228:231], a[164:167]
buffer_load_dwordx4 v1, s[8:11], s65 offen offset:0 sc1 lds
v_mfma_f32_16x16x32_bf16 a[164:167], v[148:151], v[224:227], a[164:167]
s_mov_b32 s65, 128
ds_read_b64_tr_b16 v[198:199], v76 offset:9216
v_mfma_f32_16x16x32_bf16 a[224:227], v[152:155], v[224:227], a[224:227]
s_add_u32 m0, s67, 16384
v_mfma_f32_16x16x32_bf16 a[224:227], v[184:187], v[228:231], a[224:227]
buffer_load_dwordx4 v36, s[20:23], s65 offen offset:0 lds
v_mfma_f32_16x16x32_bf16 a[228:231], v[188:191], v[228:231], a[228:231]
ds_read_b64_tr_b16 v[200:201], v77 offset:0
v_mfma_f32_16x16x32_bf16 a[228:231], v[156:159], v[224:227], a[228:231]
v_mfma_f32_16x16x32_bf16 a[236:239], v[156:159], v[232:235], a[236:239]
buffer_load_dwordx4 v37, s[20:23], s65 offen offset:1024 lds
v_mfma_f32_16x16x32_bf16 a[236:239], v[188:191], v[236:239], a[236:239]
ds_read_b64_tr_b16 v[202:203], v77 offset:1024
v_mfma_f32_16x16x32_bf16 a[232:235], v[184:187], v[236:239], a[232:235]
v_mfma_f32_16x16x32_bf16 a[232:235], v[152:155], v[232:235], a[232:235]
buffer_load_dwordx4 v38, s[20:23], s65 offen offset:2048 lds
v_mfma_f32_16x16x32_bf16 a[172:175], v[148:151], v[232:235], a[172:175]
ds_read_b64_tr_b16 v[204:205], v77 offset:8192
v_mfma_f32_16x16x32_bf16 a[172:175], v[180:183], v[236:239], a[172:175]
v_mfma_f32_16x16x32_bf16 a[168:171], v[176:179], v[236:239], a[168:171]
ds_read_b64_tr_b16 v[206:207], v77 offset:9216
v_mfma_f32_16x16x32_bf16 a[168:171], v[144:147], v[232:235], a[168:171]
buffer_load_dwordx4 v39, s[20:23], s65 offen offset:3072 lds
v_mfma_f32_16x16x32_bf16 a[108:111], v[140:143], v[232:235], a[108:111]
s_add_u32 m0, s68, 131072
v_mfma_f32_16x16x32_bf16 a[108:111], v[172:175], v[236:239], a[108:111]
s_add_u32 s65, s85, 24576
ds_read_b64_tr_b16 v[208:209], v78 offset:0
v_mfma_f32_16x16x32_bf16 a[104:107], v[168:171], v[236:239], a[104:107]
buffer_load_dwordx4 v1, s[8:11], s65 offen offset:0 sc1 lds
v_mfma_f32_16x16x32_bf16 a[104:107], v[136:139], v[232:235], a[104:107]
s_add_u32 m0, s68, 135168
v_mfma_f32_16x16x32_bf16 a[44:47], v[132:135], v[232:235], a[44:47]
s_add_u32 s65, s85, 28672
ds_read_b64_tr_b16 v[210:211], v78 offset:1024
v_mfma_f32_16x16x32_bf16 a[44:47], v[164:167], v[236:239], a[44:47]
buffer_load_dwordx4 v1, s[8:11], s65 offen offset:0 sc1 lds
v_mfma_f32_16x16x32_bf16 a[40:43], v[160:163], v[236:239], a[40:43]
s_add_u32 m0, s68, 139264
ds_read_b64_tr_b16 v[212:213], v78 offset:8192
v_mfma_f32_16x16x32_bf16 a[40:43], v[128:131], v[232:235], a[40:43]
s_add_u32 s65, s85, 32768
v_mfma_f32_16x16x32_bf16 a[48:51], v[128:131], v[240:243], a[48:51]
v_mfma_f32_16x16x32_bf16 a[48:51], v[160:163], v[244:247], a[48:51]
buffer_load_dwordx4 v1, s[8:11], s65 offen offset:0 sc1 lds
v_mfma_f32_16x16x32_bf16 a[52:55], v[164:167], v[244:247], a[52:55]
s_lshl_b32 s3, s62, 2
ds_read_b64_tr_b16 v[214:215], v78 offset:9216
v_mfma_f32_16x16x32_bf16 a[52:55], v[132:135], v[240:243], a[52:55]
s_add_u32 s3, s3, s60
v_mfma_f32_16x16x32_bf16 a[112:115], v[136:139], v[240:243], a[112:115]
s_mul_i32 s3, s3, 57344
ds_read_b64_tr_b16 v[216:217], v79 offset:0
v_mfma_f32_16x16x32_bf16 a[112:115], v[168:171], v[244:247], a[112:115]
ds_read_b64_tr_b16 v[218:219], v79 offset:1024
v_lshrrev_b32 v18, 7, v1
v_mfma_f32_16x16x32_bf16 a[116:119], v[172:175], v[244:247], a[116:119]
v_mfma_f32_16x16x32_bf16 a[116:119], v[140:143], v[240:243], a[116:119]
ds_read_b64_tr_b16 v[220:221], v79 offset:8192
v_mul_u32_u24 v18, 7680, v18
v_mfma_f32_16x16x32_bf16 a[176:179], v[144:147], v[240:243], a[176:179]
v_mfma_f32_16x16x32_bf16 a[176:179], v[176:179], v[244:247], a[176:179]
v_mfma_f32_16x16x32_bf16 a[180:183], v[180:183], v[244:247], a[180:183]
ds_read_b64_tr_b16 v[222:223], v79 offset:9216
v_lshl_add_u32 v18, v1, 2, v18
v_mfma_f32_16x16x32_bf16 a[180:183], v[148:151], v[240:243], a[180:183]
v_mfma_f32_16x16x32_bf16 a[240:243], v[152:155], v[240:243], a[240:243]
v_mfma_f32_16x16x32_bf16 a[240:243], v[184:187], v[244:247], a[240:243]
v_mfma_f32_16x16x32_bf16 a[244:247], v[188:191], v[244:247], a[244:247]
buffer_load_dword v18, v18, s[16:19], s3 offen
v_mfma_f32_16x16x32_bf16 a[244:247], v[156:159], v[240:243], a[244:247]
v_mfma_f32_16x16x32_bf16 a[56:59], v[128:131], v[248:251], a[56:59]
ds_read_b128 v[128:131], v17 offset:0
v_mfma_f32_16x16x32_bf16 a[56:59], v[160:163], v[252:255], a[56:59]
ds_read_b128 v[160:163], v42 offset:0
v_mfma_f32_16x16x32_bf16 a[60:63], v[164:167], v[252:255], a[60:63]
ds_read_b128 v[164:167], v42 offset:2048
v_mfma_f32_16x16x32_bf16 a[60:63], v[132:135], v[248:251], a[60:63]
ds_read_b128 v[132:135], v17 offset:2048
v_mfma_f32_16x16x32_bf16 a[120:123], v[136:139], v[248:251], a[120:123]
ds_read_b128 v[136:139], v17 offset:4096
v_mfma_f32_16x16x32_bf16 a[120:123], v[168:171], v[252:255], a[120:123]
ds_read_b128 v[168:171], v42 offset:4096
v_mfma_f32_16x16x32_bf16 a[124:127], v[172:175], v[252:255], a[124:127]
ds_read_b128 v[172:175], v42 offset:6144
v_mfma_f32_16x16x32_bf16 a[124:127], v[140:143], v[248:251], a[124:127]
ds_read_b128 v[140:143], v17 offset:6144
v_mfma_f32_16x16x32_bf16 a[184:187], v[144:147], v[248:251], a[184:187]
ds_read_b128 v[144:147], v17 offset:8192
v_mfma_f32_16x16x32_bf16 a[184:187], v[176:179], v[252:255], a[184:187]
ds_read_b128 v[176:179], v42 offset:8192
v_mfma_f32_16x16x32_bf16 a[188:191], v[180:183], v[252:255], a[188:191]
ds_read_b128 v[180:183], v42 offset:10240
v_mfma_f32_16x16x32_bf16 a[188:191], v[148:151], v[248:251], a[188:191]
ds_read_b128 v[148:151], v17 offset:10240
v_mfma_f32_16x16x32_bf16 a[248:251], v[152:155], v[248:251], a[248:251]
ds_read_b128 v[152:155], v17 offset:12288
v_mfma_f32_16x16x32_bf16 a[248:251], v[184:187], v[252:255], a[248:251]
ds_read_b128 v[184:187], v42 offset:12288
v_mfma_f32_16x16x32_bf16 a[252:255], v[188:191], v[252:255], a[252:255]
ds_read_b128 v[188:191], v42 offset:14336
v_mfma_f32_16x16x32_bf16 a[252:255], v[156:159], v[248:251], a[252:255]
s_waitcnt lgkmcnt(6)
ds_read_b128 v[156:159], v17 offset:14336
v_mfma_f32_16x16x32_bf16 a[0:3], v[128:131], v[192:195], a[0:3]
s_waitcnt vmcnt(18)
v_mfma_f32_16x16x32_bf16 a[0:3], v[160:163], v[196:199], a[0:3]
s_barrier
v_mfma_f32_16x16x32_bf16 a[4:7], v[164:167], v[196:199], a[4:7]
s_bfe_u32 s3, s2, 327683
v_mfma_f32_16x16x32_bf16 a[4:7], v[132:135], v[192:195], a[4:7]
s_lshl_b32 s3, s3, 2
v_mfma_f32_16x16x32_bf16 a[64:67], v[136:139], v[192:195], a[64:67]
s_add_u32 s3, s3, s60
v_mfma_f32_16x16x32_bf16 a[64:67], v[168:171], v[196:199], a[64:67]
s_mul_i32 s3, s3, 1024
ds_read_b64_tr_b16 v[224:225], v76 offset:16384
v_mfma_f32_16x16x32_bf16 a[68:71], v[172:175], v[196:199], a[68:71]
ds_read_b64_tr_b16 v[226:227], v76 offset:17408
v_mul_u32_u24 v6, 4, v5
v_mfma_f32_16x16x32_bf16 a[68:71], v[140:143], v[192:195], a[68:71]
v_mfma_f32_16x16x32_bf16 a[128:131], v[144:147], v[192:195], a[128:131]
s_waitcnt lgkmcnt(2)
v_mfma_f32_16x16x32_bf16 a[128:131], v[176:179], v[196:199], a[128:131]
ds_read_b64_tr_b16 v[228:229], v76 offset:24576
v_add_u32 v6, s3, v6
v_mfma_f32_16x16x32_bf16 a[132:135], v[180:183], v[196:199], a[132:135]
v_mfma_f32_16x16x32_bf16 a[132:135], v[148:151], v[192:195], a[132:135]
v_mfma_f32_16x16x32_bf16 a[192:195], v[152:155], v[192:195], a[192:195]
ds_read_b64_tr_b16 v[230:231], v76 offset:25600
v_xor_b32 v76, 0x8000, v76
v_mfma_f32_16x16x32_bf16 a[192:195], v[184:187], v[196:199], a[192:195]
v_mfma_f32_16x16x32_bf16 a[196:199], v[188:191], v[196:199], a[196:199]
global_load_dword v6, v6, s[4:5]
v_mfma_f32_16x16x32_bf16 a[196:199], v[156:159], v[192:195], a[196:199]
s_add_u32 m0, s68, 143360
v_mfma_f32_16x16x32_bf16 a[204:207], v[156:159], v[200:203], a[204:207]
s_add_u32 s65, s85, 36864
v_mfma_f32_16x16x32_bf16 a[204:207], v[188:191], v[204:207], a[204:207]
ds_read_b64_tr_b16 v[232:233], v77 offset:16384
v_mfma_f32_16x16x32_bf16 a[200:203], v[184:187], v[204:207], a[200:203]
v_mfma_f32_16x16x32_bf16 a[200:203], v[152:155], v[200:203], a[200:203]
ds_read_b64_tr_b16 v[234:235], v77 offset:17408
v_mfma_f32_16x16x32_bf16 a[140:143], v[148:151], v[200:203], a[140:143]
buffer_load_dwordx4 v1, s[8:11], s65 offen offset:0 sc1 lds
v_mfma_f32_16x16x32_bf16 a[140:143], v[180:183], v[204:207], a[140:143]
s_add_u32 m0, s68, 147456
v_mfma_f32_16x16x32_bf16 a[136:139], v[176:179], v[204:207], a[136:139]
s_add_u32 s65, s85, 40960
ds_read_b64_tr_b16 v[236:237], v77 offset:24576
v_mfma_f32_16x16x32_bf16 a[136:139], v[144:147], v[200:203], a[136:139]
v_mfma_f32_16x16x32_bf16 a[76:79], v[140:143], v[200:203], a[76:79]
ds_read_b64_tr_b16 v[238:239], v77 offset:25600
v_xor_b32 v77, 0x8000, v77
v_mfma_f32_16x16x32_bf16 a[76:79], v[172:175], v[204:207], a[76:79]
buffer_load_dwordx4 v1, s[8:11], s65 offen offset:0 sc1 lds
v_mfma_f32_16x16x32_bf16 a[72:75], v[168:171], v[204:207], a[72:75]
s_add_u32 m0, s68, 151552
v_mfma_f32_16x16x32_bf16 a[72:75], v[136:139], v[200:203], a[72:75]
s_add_u32 s65, s85, 45056
v_mfma_f32_16x16x32_bf16 a[12:15], v[132:135], v[200:203], a[12:15]
v_mfma_f32_16x16x32_bf16 a[12:15], v[164:167], v[204:207], a[12:15]
ds_read_b64_tr_b16 v[240:241], v78 offset:16384
v_mfma_f32_16x16x32_bf16 a[8:11], v[160:163], v[204:207], a[8:11]
buffer_load_dwordx4 v1, s[8:11], s65 offen offset:0 sc1 lds
v_mfma_f32_16x16x32_bf16 a[8:11], v[128:131], v[200:203], a[8:11]
s_add_u32 m0, s68, 32768
ds_read_b64_tr_b16 v[242:243], v78 offset:17408
v_mfma_f32_16x16x32_bf16 a[16:19], v[128:131], v[208:211], a[16:19]
s_add_u32 s65, s85, 49152
v_mfma_f32_16x16x32_bf16 a[16:19], v[160:163], v[212:215], a[16:19]
v_mfma_f32_16x16x32_bf16 a[20:23], v[164:167], v[212:215], a[20:23]
ds_read_b64_tr_b16 v[244:245], v78 offset:24576
v_mfma_f32_16x16x32_bf16 a[20:23], v[132:135], v[208:211], a[20:23]
v_mfma_f32_16x16x32_bf16 a[80:83], v[136:139], v[208:211], a[80:83]
buffer_load_dwordx4 v1, s[8:11], s65 offen offset:0 sc1 lds
v_mfma_f32_16x16x32_bf16 a[80:83], v[168:171], v[212:215], a[80:83]
s_add_u32 m0, s68, 36864
ds_read_b64_tr_b16 v[246:247], v78 offset:25600
v_xor_b32 v78, 0x8000, v78
v_mfma_f32_16x16x32_bf16 a[84:87], v[172:175], v[212:215], a[84:87]
s_add_u32 s65, s85, 53248
v_mfma_f32_16x16x32_bf16 a[84:87], v[140:143], v[208:211], a[84:87]
v_mfma_f32_16x16x32_bf16 a[144:147], v[144:147], v[208:211], a[144:147]
v_mfma_f32_16x16x32_bf16 a[144:147], v[176:179], v[212:215], a[144:147]
buffer_load_dwordx4 v1, s[8:11], s65 offen offset:0 sc1 lds
v_mfma_f32_16x16x32_bf16 a[148:151], v[180:183], v[212:215], a[148:151]
s_add_u32 m0, s68, 40960
ds_read_b64_tr_b16 v[248:249], v79 offset:16384
v_mfma_f32_16x16x32_bf16 a[148:151], v[148:151], v[208:211], a[148:151]
s_add_u32 s65, s85, 57344
ds_read_b64_tr_b16 v[250:251], v79 offset:17408
v_mfma_f32_16x16x32_bf16 a[208:211], v[152:155], v[208:211], a[208:211]
v_mfma_f32_16x16x32_bf16 a[208:211], v[184:187], v[212:215], a[208:211]
v_mfma_f32_16x16x32_bf16 a[212:215], v[188:191], v[212:215], a[212:215]
buffer_load_dwordx4 v1, s[8:11], s65 offen offset:0 sc1 lds
v_mfma_f32_16x16x32_bf16 a[212:215], v[156:159], v[208:211], a[212:215]
ds_read_b64_tr_b16 v[252:253], v79 offset:24576
v_mfma_f32_16x16x32_bf16 a[220:223], v[156:159], v[216:219], a[220:223]
ds_read_b64_tr_b16 v[254:255], v79 offset:25600
v_xor_b32 v79, 0x8000, v79
v_mfma_f32_16x16x32_bf16 a[220:223], v[188:191], v[220:223], a[220:223]
v_mfma_f32_16x16x32_bf16 a[216:219], v[184:187], v[220:223], a[216:219]
v_mfma_f32_16x16x32_bf16 a[216:219], v[152:155], v[216:219], a[216:219]
v_mfma_f32_16x16x32_bf16 a[156:159], v[148:151], v[216:219], a[156:159]
v_mfma_f32_16x16x32_bf16 a[156:159], v[180:183], v[220:223], a[156:159]
v_mfma_f32_16x16x32_bf16 a[152:155], v[176:179], v[220:223], a[152:155]
v_mfma_f32_16x16x32_bf16 a[152:155], v[144:147], v[216:219], a[152:155]
v_mfma_f32_16x16x32_bf16 a[92:95], v[140:143], v[216:219], a[92:95]
v_mfma_f32_16x16x32_bf16 a[92:95], v[172:175], v[220:223], a[92:95]
v_mfma_f32_16x16x32_bf16 a[88:91], v[168:171], v[220:223], a[88:91]
v_mfma_f32_16x16x32_bf16 a[88:91], v[136:139], v[216:219], a[88:91]
v_mfma_f32_16x16x32_bf16 a[28:31], v[132:135], v[216:219], a[28:31]
s_add_u32 s74, s74, 32768
v_mfma_f32_16x16x32_bf16 a[28:31], v[164:167], v[220:223], a[28:31]
s_cmp_ge_u32 s74, 98304
v_mfma_f32_16x16x32_bf16 a[24:27], v[160:163], v[220:223], a[24:27]
s_cselect_b32 s74, 0, s74
v_mfma_f32_16x16x32_bf16 a[24:27], v[128:131], v[216:219], a[24:27]
s_waitcnt lgkmcnt(0)
v_mfma_f32_16x16x32_bf16 a[32:35], v[128:131], v[224:227], a[32:35]
s_waitcnt vmcnt(18)
v_add_u32 v42, 0, v19
v_xor_b32 v43, 64, v42
v_mfma_f32_16x16x32_bf16 a[32:35], v[160:163], v[228:231], a[32:35]
s_barrier
v_add_u32 v44, 98304, v40
v_add_u32 v45, 98304, v41
v_mfma_f32_16x16x32_bf16 a[36:39], v[164:167], v[228:231], a[36:39]
s_mov_b32 s65, 256
v_mfma_f32_16x16x32_bf16 a[36:39], v[132:135], v[224:227], a[36:39]
s_add_u32 m0, s67, 65536
v_mfma_f32_16x16x32_bf16 a[96:99], v[136:139], v[224:227], a[96:99]
buffer_load_dwordx4 v36, s[20:23], s65 offen offset:0 lds
v_mfma_f32_16x16x32_bf16 a[96:99], v[168:171], v[228:231], a[96:99]
v_mfma_f32_16x16x32_bf16 a[100:103], v[172:175], v[228:231], a[100:103]
v_mfma_f32_16x16x32_bf16 a[100:103], v[140:143], v[224:227], a[100:103]
buffer_load_dwordx4 v37, s[20:23], s65 offen offset:1024 lds
v_mfma_f32_16x16x32_bf16 a[160:163], v[144:147], v[224:227], a[160:163]
v_mfma_f32_16x16x32_bf16 a[160:163], v[176:179], v[228:231], a[160:163]
v_mfma_f32_16x16x32_bf16 a[164:167], v[180:183], v[228:231], a[164:167]
v_mfma_f32_16x16x32_bf16 a[164:167], v[148:151], v[224:227], a[164:167]
buffer_load_dwordx4 v38, s[20:23], s65 offen offset:2048 lds
v_mfma_f32_16x16x32_bf16 a[224:227], v[152:155], v[224:227], a[224:227]
v_mfma_f32_16x16x32_bf16 a[224:227], v[184:187], v[228:231], a[224:227]
v_mfma_f32_16x16x32_bf16 a[228:231], v[188:191], v[228:231], a[228:231]
v_mfma_f32_16x16x32_bf16 a[228:231], v[156:159], v[224:227], a[228:231]
buffer_load_dwordx4 v39, s[20:23], s65 offen offset:3072 lds
v_mfma_f32_16x16x32_bf16 a[236:239], v[156:159], v[232:235], a[236:239]
s_mov_b32 s65, 384
v_mfma_f32_16x16x32_bf16 a[236:239], v[188:191], v[236:239], a[236:239]
s_add_u32 m0, s67, 81920
v_mfma_f32_16x16x32_bf16 a[232:235], v[184:187], v[236:239], a[232:235]
v_mfma_f32_16x16x32_bf16 a[232:235], v[152:155], v[232:235], a[232:235]
buffer_load_dwordx4 v36, s[20:23], s65 offen offset:0 lds
v_mfma_f32_16x16x32_bf16 a[172:175], v[148:151], v[232:235], a[172:175]
v_mfma_f32_16x16x32_bf16 a[172:175], v[180:183], v[236:239], a[172:175]
ds_read_b64_tr_b16 v[112:113], v46 offset:0
v_mfma_f32_16x16x32_bf16 a[168:171], v[176:179], v[236:239], a[168:171]
v_mfma_f32_16x16x32_bf16 a[168:171], v[144:147], v[232:235], a[168:171]
buffer_load_dwordx4 v37, s[20:23], s65 offen offset:1024 lds
v_mfma_f32_16x16x32_bf16 a[108:111], v[140:143], v[232:235], a[108:111]
ds_read_b64_tr_b16 v[114:115], v46 offset:896
v_mfma_f32_16x16x32_bf16 a[108:111], v[172:175], v[236:239], a[108:111]
ds_read_b64_tr_b16 v[116:117], v47 offset:0
v_accvgpr_read_b32 v52, a4
v_mfma_f32_16x16x32_bf16 a[104:107], v[168:171], v[236:239], a[104:107]
ds_read_b64_tr_b16 v[118:119], v47 offset:896
v_accvgpr_read_b32 v53, a5
v_mfma_f32_16x16x32_bf16 a[104:107], v[136:139], v[232:235], a[104:107]
buffer_load_dwordx4 v38, s[20:23], s65 offen offset:2048 lds
v_mfma_f32_16x16x32_bf16 a[44:47], v[132:135], v[232:235], a[44:47]
v_accvgpr_read_b32 v54, a6
v_accvgpr_read_b32 v55, a7
v_mfma_f32_16x16x32_bf16 a[44:47], v[164:167], v[236:239], a[44:47]
ds_read_b128 v[64:67], v42 offset:0
v_accvgpr_read_b32 v48, a0
v_mfma_f32_16x16x32_bf16 a[40:43], v[160:163], v[236:239], a[40:43]
ds_read_b128 v[68:71], v42 offset:2048
v_accvgpr_read_b32 v49, a1
v_mfma_f32_16x16x32_bf16 a[40:43], v[128:131], v[232:235], a[40:43]
buffer_load_dwordx4 v39, s[20:23], s65 offen offset:3072 lds
v_mfma_f32_16x16x32_bf16 a[48:51], v[128:131], v[240:243], a[48:51]
s_mov_b32 s65, 512
v_accvgpr_read_b32 v50, a2
v_accvgpr_read_b32 v51, a3
v_mfma_f32_16x16x32_bf16 a[48:51], v[160:163], v[244:247], a[48:51]
s_add_u32 m0, s67, 49152
ds_read_b64_tr_b16 v[80:81], v44 offset:0
v_cvt_pk_bf16_f32 v48, v48, v49
v_mfma_f32_16x16x32_bf16 a[52:55], v[164:167], v[244:247], a[52:55]
ds_read_b64_tr_b16 v[82:83], v44 offset:256
v_cvt_pk_bf16_f32 v49, v50, v51
v_mfma_f32_16x16x32_bf16 a[52:55], v[132:135], v[240:243], a[52:55]
buffer_load_dwordx4 v36, s[20:23], s65 offen offset:0 lds
v_mfma_f32_16x16x32_bf16 a[112:115], v[136:139], v[240:243], a[112:115]
v_cvt_pk_bf16_f32 v50, v52, v53
v_cvt_pk_bf16_f32 v51, v54, v55
v_mfma_f32_16x16x32_bf16 a[112:115], v[168:171], v[244:247], a[112:115]
buffer_store_dwordx4 v[48:51], v1, s[8:11], s76 offen offset:0 sc1
v_mfma_f32_16x16x32_bf16 a[116:119], v[172:175], v[244:247], a[116:119]
ds_read_b64_tr_b16 v[84:85], v45 offset:0
v_accvgpr_read_b32 v52, a12
v_mfma_f32_16x16x32_bf16 a[116:119], v[140:143], v[240:243], a[116:119]
buffer_load_dwordx4 v37, s[20:23], s65 offen offset:1024 lds
v_mfma_f32_16x16x32_bf16 a[176:179], v[144:147], v[240:243], a[176:179]
ds_read_b64_tr_b16 v[86:87], v45 offset:256
v_accvgpr_read_b32 v53, a13
v_mfma_f32_16x16x32_bf16 a[176:179], v[176:179], v[244:247], a[176:179]
ds_read_b64_tr_b16 v[88:89], v44 offset:4096
v_accvgpr_read_b32 v54, a14
v_mfma_f32_16x16x32_bf16 a[180:183], v[180:183], v[244:247], a[180:183]
v_accvgpr_read_b32 v55, a15
v_accvgpr_read_b32 v48, a8
v_mfma_f32_16x16x32_bf16 a[180:183], v[148:151], v[240:243], a[180:183]
buffer_load_dwordx4 v38, s[20:23], s65 offen offset:2048 lds
v_mfma_f32_16x16x32_bf16 a[240:243], v[152:155], v[240:243], a[240:243]
ds_read_b64_tr_b16 v[90:91], v44 offset:4352
v_accvgpr_read_b32 v49, a9
v_mfma_f32_16x16x32_bf16 a[240:243], v[184:187], v[244:247], a[240:243]
ds_read_b64_tr_b16 v[92:93], v45 offset:4096
v_accvgpr_read_b32 v50, a10
v_mfma_f32_16x16x32_bf16 a[244:247], v[188:191], v[244:247], a[244:247]
v_accvgpr_read_b32 v51, a11
v_cvt_pk_bf16_f32 v48, v48, v49
v_mfma_f32_16x16x32_bf16 a[244:247], v[156:159], v[240:243], a[244:247]
buffer_load_dwordx4 v39, s[20:23], s65 offen offset:3072 lds
v_mfma_f32_16x16x32_bf16 a[56:59], v[128:131], v[248:251], a[56:59]
ds_read_b64_tr_b16 v[94:95], v45 offset:4352
v_cvt_pk_bf16_f32 v49, v50, v51
v_mfma_f32_16x16x32_bf16 a[56:59], v[160:163], v[252:255], a[56:59]
ds_read_b64_tr_b16 v[96:97], v44 offset:8192
v_cvt_pk_bf16_f32 v50, v52, v53
v_mfma_f32_16x16x32_bf16 a[60:63], v[164:167], v[252:255], a[60:63]
ds_read_b64_tr_b16 v[98:99], v44 offset:8448
v_cvt_pk_bf16_f32 v51, v54, v55
v_mfma_f32_16x16x32_bf16 a[60:63], v[132:135], v[248:251], a[60:63]
buffer_store_dwordx4 v[48:51], v1, s[8:11], s76 offen offset:1024 sc1
v_mfma_f32_16x16x32_bf16 a[120:123], v[136:139], v[248:251], a[120:123]
v_accvgpr_read_b32 v52, a20
v_accvgpr_read_b32 v53, a21
v_mfma_f32_16x16x32_bf16 a[120:123], v[168:171], v[252:255], a[120:123]
ds_read_b64_tr_b16 v[100:101], v45 offset:8192
v_accvgpr_read_b32 v54, a22
v_mfma_f32_16x16x32_bf16 a[124:127], v[172:175], v[252:255], a[124:127]
ds_read_b64_tr_b16 v[102:103], v45 offset:8448
v_accvgpr_read_b32 v55, a23
v_mfma_f32_16x16x32_bf16 a[124:127], v[140:143], v[248:251], a[124:127]
v_accvgpr_read_b32 v48, a16
v_accvgpr_read_b32 v49, a17
v_mfma_f32_16x16x32_bf16 a[184:187], v[144:147], v[248:251], a[184:187]
v_mfma_f32_16x16x32_bf16 a[184:187], v[176:179], v[252:255], a[184:187]
v_accvgpr_read_b32 v50, a18
v_accvgpr_read_b32 v51, a19
v_mfma_f32_16x16x32_bf16 a[188:191], v[180:183], v[252:255], a[188:191]
v_mfma_f32_16x16x32_bf16 a[188:191], v[148:151], v[248:251], a[188:191]
v_cvt_pk_bf16_f32 v48, v48, v49
v_cvt_pk_bf16_f32 v49, v50, v51
v_mfma_f32_16x16x32_bf16 a[248:251], v[152:155], v[248:251], a[248:251]
v_mfma_f32_16x16x32_bf16 a[248:251], v[184:187], v[252:255], a[248:251]
v_cvt_pk_bf16_f32 v50, v52, v53
v_cvt_pk_bf16_f32 v51, v54, v55
v_mfma_f32_16x16x32_bf16 a[252:255], v[188:191], v[252:255], a[252:255]
v_mfma_f32_16x16x32_bf16 a[252:255], v[156:159], v[248:251], a[252:255]
buffer_store_dwordx4 v[48:51], v1, s[8:11], s76 offen offset:2048 sc1
s_branch KV_END
KV_K:
s_waitcnt lgkmcnt(8)
v_mfma_f32_16x16x32_bf16 a[0:3], v[192:195], v[128:131], 0
s_waitcnt vmcnt(9)
v_mfma_f32_16x16x32_bf16 a[0:3], v[196:199], v[160:163], a[0:3]
s_barrier
v_mfma_f32_16x16x32_bf16 a[32:35], v[196:199], v[164:167], 0
s_add_u32 m0, s73, 16384
v_mfma_f32_16x16x32_bf16 a[32:35], v[192:195], v[132:135], a[32:35]
v_mfma_f32_16x16x32_bf16 a[64:67], v[192:195], v[136:139], 0
buffer_load_dwordx4 v72, s[16:19], s71 offen offset:0 nt lds
v_mfma_f32_16x16x32_bf16 a[64:67], v[196:199], v[168:171], a[64:67]
ds_read_b64_tr_b16 v[224:225], v76 offset:16384
v_mfma_f32_16x16x32_bf16 a[96:99], v[196:199], v[172:175], 0
v_mfma_f32_16x16x32_bf16 a[96:99], v[192:195], v[140:143], a[96:99]
s_waitcnt lgkmcnt(1)
ds_read_b64_tr_b16 v[226:227], v76 offset:17408
v_mfma_f32_16x16x32_bf16 a[128:131], v[192:195], v[144:147], 0
v_mfma_f32_16x16x32_bf16 a[128:131], v[196:199], v[176:179], a[128:131]
buffer_load_dwordx4 v73, s[16:19], s71 offen offset:1024 nt lds
v_mfma_f32_16x16x32_bf16 a[160:163], v[196:199], v[180:183], 0
ds_read_b64_tr_b16 v[228:229], v76 offset:24576
v_mfma_f32_16x16x32_bf16 a[160:163], v[192:195], v[148:151], a[160:163]
v_mfma_f32_16x16x32_bf16 a[192:195], v[192:195], v[152:155], 0
ds_read_b64_tr_b16 v[230:231], v76 offset:25600
v_xor_b32 v76, 0x8000, v76
v_mfma_f32_16x16x32_bf16 a[192:195], v[196:199], v[184:187], a[192:195]
v_mfma_f32_16x16x32_bf16 a[224:227], v[196:199], v[188:191], 0
buffer_load_dwordx4 v74, s[16:19], s71 offen offset:2048 nt lds
v_mfma_f32_16x16x32_bf16 a[224:227], v[192:195], v[156:159], a[224:227]
v_mfma_f32_16x16x32_bf16 a[228:231], v[200:203], v[156:159], 0
v_mfma_f32_16x16x32_bf16 a[228:231], v[204:207], v[188:191], a[228:231]
ds_read_b64_tr_b16 v[232:233], v77 offset:16384
v_mfma_f32_16x16x32_bf16 a[196:199], v[204:207], v[184:187], 0
v_mfma_f32_16x16x32_bf16 a[196:199], v[200:203], v[152:155], a[196:199]
ds_read_b64_tr_b16 v[234:235], v77 offset:17408
v_mfma_f32_16x16x32_bf16 a[164:167], v[200:203], v[148:151], 0
buffer_load_dwordx4 v75, s[16:19], s71 offen offset:3072 nt lds
v_mfma_f32_16x16x32_bf16 a[164:167], v[204:207], v[180:183], a[164:167]
s_mov_b32 m0, s72
v_mfma_f32_16x16x32_bf16 a[132:135], v[204:207], v[176:179], 0
ds_read_b64_tr_b16 v[236:237], v77 offset:24576
v_mfma_f32_16x16x32_bf16 a[132:135], v[200:203], v[144:147], a[132:135]
v_mfma_f32_16x16x32_bf16 a[100:103], v[200:203], v[140:143], 0
ds_read_b64_tr_b16 v[238:239], v77 offset:25600
v_xor_b32 v77, 0x8000, v77
v_mfma_f32_16x16x32_bf16 a[100:103], v[204:207], v[172:175], a[100:103]
buffer_load_dwordx4 v20, s[12:15], s70 offen offset:0 lds
v_mfma_f32_16x16x32_bf16 a[68:71], v[204:207], v[168:171], 0
v_mfma_f32_16x16x32_bf16 a[68:71], v[200:203], v[136:139], a[68:71]
v_mfma_f32_16x16x32_bf16 a[36:39], v[200:203], v[132:135], 0
v_mfma_f32_16x16x32_bf16 a[36:39], v[204:207], v[164:167], a[36:39]
ds_read_b64_tr_b16 v[240:241], v78 offset:16384
v_mfma_f32_16x16x32_bf16 a[4:7], v[204:207], v[160:163], 0
buffer_load_dwordx4 v21, s[12:15], s70 offen offset:1024 lds
v_mfma_f32_16x16x32_bf16 a[4:7], v[200:203], v[128:131], a[4:7]
ds_read_b64_tr_b16 v[242:243], v78 offset:17408
v_mfma_f32_16x16x32_bf16 a[8:11], v[208:211], v[128:131], 0
v_mfma_f32_16x16x32_bf16 a[8:11], v[212:215], v[160:163], a[8:11]
v_mfma_f32_16x16x32_bf16 a[40:43], v[212:215], v[164:167], 0
ds_read_b64_tr_b16 v[244:245], v78 offset:24576
v_mfma_f32_16x16x32_bf16 a[40:43], v[208:211], v[132:135], a[40:43]
v_mfma_f32_16x16x32_bf16 a[72:75], v[208:211], v[136:139], 0
buffer_load_dwordx4 v22, s[12:15], s70 offen offset:2048 lds
v_mfma_f32_16x16x32_bf16 a[72:75], v[212:215], v[168:171], a[72:75]
ds_read_b64_tr_b16 v[246:247], v78 offset:25600
v_xor_b32 v78, 0x8000, v78
v_mfma_f32_16x16x32_bf16 a[104:107], v[212:215], v[172:175], 0
v_mfma_f32_16x16x32_bf16 a[104:107], v[208:211], v[140:143], a[104:107]
v_mfma_f32_16x16x32_bf16 a[136:139], v[208:211], v[144:147], 0
v_mfma_f32_16x16x32_bf16 a[136:139], v[212:215], v[176:179], a[136:139]
buffer_load_dwordx4 v23, s[12:15], s70 offen offset:3072 lds
v_mfma_f32_16x16x32_bf16 a[168:171], v[212:215], v[180:183], 0
ds_read_b64_tr_b16 v[248:249], v79 offset:16384
v_mfma_f32_16x16x32_bf16 a[168:171], v[208:211], v[148:151], a[168:171]
ds_read_b64_tr_b16 v[250:251], v79 offset:17408
v_mfma_f32_16x16x32_bf16 a[200:203], v[208:211], v[152:155], 0
v_mfma_f32_16x16x32_bf16 a[200:203], v[212:215], v[184:187], a[200:203]
v_mfma_f32_16x16x32_bf16 a[232:235], v[212:215], v[188:191], 0
buffer_load_dword v48, v1, s[24:27], s85 offen
v_mfma_f32_16x16x32_bf16 a[232:235], v[208:211], v[156:159], a[232:235]
s_add_u32 s85, s85, 1048576
ds_read_b64_tr_b16 v[252:253], v79 offset:24576
v_mfma_f32_16x16x32_bf16 a[236:239], v[216:219], v[156:159], 0
ds_read_b64_tr_b16 v[254:255], v79 offset:25600
v_xor_b32 v79, 0x8000, v79
v_mfma_f32_16x16x32_bf16 a[236:239], v[220:223], v[188:191], a[236:239]
v_mfma_f32_16x16x32_bf16 a[204:207], v[220:223], v[184:187], 0
v_mfma_f32_16x16x32_bf16 a[204:207], v[216:219], v[152:155], a[204:207]
v_mfma_f32_16x16x32_bf16 a[172:175], v[216:219], v[148:151], 0
v_mfma_f32_16x16x32_bf16 a[172:175], v[220:223], v[180:183], a[172:175]
v_mfma_f32_16x16x32_bf16 a[140:143], v[220:223], v[176:179], 0
v_mfma_f32_16x16x32_bf16 a[140:143], v[216:219], v[144:147], a[140:143]
s_add_u32 s71, s71, 524032
v_mfma_f32_16x16x32_bf16 a[108:111], v[216:219], v[140:143], 0
s_add_u32 s70, s70, 2097152
v_mfma_f32_16x16x32_bf16 a[108:111], v[220:223], v[172:175], a[108:111]
v_mfma_f32_16x16x32_bf16 a[76:79], v[220:223], v[168:171], 0
s_xor_b32 s73, s73, 0x8000
v_mfma_f32_16x16x32_bf16 a[76:79], v[216:219], v[136:139], a[76:79]
v_mfma_f32_16x16x32_bf16 a[44:47], v[216:219], v[132:135], 0
s_add_u32 s74, s74, 32768
v_mfma_f32_16x16x32_bf16 a[44:47], v[220:223], v[164:167], a[44:47]
s_cmp_ge_u32 s74, 98304
v_mfma_f32_16x16x32_bf16 a[12:15], v[220:223], v[160:163], 0
s_cselect_b32 s74, 0, s74
v_mfma_f32_16x16x32_bf16 a[12:15], v[216:219], v[128:131], a[12:15]
s_waitcnt lgkmcnt(0)
v_mfma_f32_16x16x32_bf16 a[16:19], v[224:227], v[128:131], 0
s_waitcnt vmcnt(10)
v_add_u32 v17, s74, v16
v_xor_b32 v42, 64, v17
v_mfma_f32_16x16x32_bf16 a[16:19], v[228:231], v[160:163], a[16:19]
s_barrier
v_mfma_f32_16x16x32_bf16 a[48:51], v[228:231], v[164:167], 0
v_mfma_f32_16x16x32_bf16 a[48:51], v[224:227], v[132:135], a[48:51]
ds_read_b64_tr_b16 v[192:193], v76 offset:0
v_mfma_f32_16x16x32_bf16 a[80:83], v[224:227], v[136:139], 0
buffer_load_dword v49, v1, s[24:27], s85 offen
v_mfma_f32_16x16x32_bf16 a[80:83], v[228:231], v[168:171], a[80:83]
s_add_u32 s85, s85, 1048576
v_mfma_f32_16x16x32_bf16 a[112:115], v[228:231], v[172:175], 0
s_mov_b32 m0, s73
ds_read_b64_tr_b16 v[194:195], v76 offset:1024
v_mfma_f32_16x16x32_bf16 a[112:115], v[224:227], v[140:143], a[112:115]
v_mfma_f32_16x16x32_bf16 a[144:147], v[224:227], v[144:147], 0
ds_read_b64_tr_b16 v[196:197], v76 offset:8192
v_mfma_f32_16x16x32_bf16 a[144:147], v[228:231], v[176:179], a[144:147]
buffer_load_dwordx4 v72, s[16:19], s71 offen offset:0 nt lds
v_mfma_f32_16x16x32_bf16 a[176:179], v[228:231], v[180:183], 0
v_mfma_f32_16x16x32_bf16 a[176:179], v[224:227], v[148:151], a[176:179]
ds_read_b64_tr_b16 v[198:199], v76 offset:9216
v_mfma_f32_16x16x32_bf16 a[208:211], v[224:227], v[152:155], 0
v_mfma_f32_16x16x32_bf16 a[208:211], v[228:231], v[184:187], a[208:211]
v_mfma_f32_16x16x32_bf16 a[240:243], v[228:231], v[188:191], 0
buffer_load_dwordx4 v73, s[16:19], s71 offen offset:1024 nt lds
v_mfma_f32_16x16x32_bf16 a[240:243], v[224:227], v[156:159], a[240:243]
ds_read_b64_tr_b16 v[200:201], v77 offset:0
v_mfma_f32_16x16x32_bf16 a[244:247], v[232:235], v[156:159], 0
v_mfma_f32_16x16x32_bf16 a[244:247], v[236:239], v[188:191], a[244:247]
ds_read_b64_tr_b16 v[202:203], v77 offset:1024
v_mfma_f32_16x16x32_bf16 a[212:215], v[236:239], v[184:187], 0
v_mfma_f32_16x16x32_bf16 a[212:215], v[232:235], v[152:155], a[212:215]
buffer_load_dwordx4 v74, s[16:19], s71 offen offset:2048 nt lds
v_mfma_f32_16x16x32_bf16 a[180:183], v[232:235], v[148:151], 0
ds_read_b64_tr_b16 v[204:205], v77 offset:8192
v_mfma_f32_16x16x32_bf16 a[180:183], v[236:239], v[180:183], a[180:183]
v_mfma_f32_16x16x32_bf16 a[148:151], v[236:239], v[176:179], 0
ds_read_b64_tr_b16 v[206:207], v77 offset:9216
v_mfma_f32_16x16x32_bf16 a[148:151], v[232:235], v[144:147], a[148:151]
v_mfma_f32_16x16x32_bf16 a[116:119], v[232:235], v[140:143], 0
buffer_load_dwordx4 v75, s[16:19], s71 offen offset:3072 nt lds
v_mfma_f32_16x16x32_bf16 a[116:119], v[236:239], v[172:175], a[116:119]
s_add_u32 m0, s72, 4096
ds_read_b64_tr_b16 v[208:209], v78 offset:0
v_mfma_f32_16x16x32_bf16 a[84:87], v[236:239], v[168:171], 0
v_mfma_f32_16x16x32_bf16 a[84:87], v[232:235], v[136:139], a[84:87]
v_mfma_f32_16x16x32_bf16 a[52:55], v[232:235], v[132:135], 0
ds_read_b64_tr_b16 v[210:211], v78 offset:1024
v_mfma_f32_16x16x32_bf16 a[52:55], v[236:239], v[164:167], a[52:55]
buffer_load_dwordx4 v20, s[12:15], s70 offen offset:0 lds
v_mfma_f32_16x16x32_bf16 a[20:23], v[236:239], v[160:163], 0
ds_read_b64_tr_b16 v[212:213], v78 offset:8192
v_mfma_f32_16x16x32_bf16 a[20:23], v[232:235], v[128:131], a[20:23]
v_mfma_f32_16x16x32_bf16 a[24:27], v[240:243], v[128:131], 0
v_mfma_f32_16x16x32_bf16 a[24:27], v[244:247], v[160:163], a[24:27]
ds_read_b64_tr_b16 v[214:215], v78 offset:9216
v_mfma_f32_16x16x32_bf16 a[56:59], v[244:247], v[164:167], 0
buffer_load_dwordx4 v21, s[12:15], s70 offen offset:1024 lds
v_mfma_f32_16x16x32_bf16 a[56:59], v[240:243], v[132:135], a[56:59]
v_mfma_f32_16x16x32_bf16 a[88:91], v[240:243], v[136:139], 0
ds_read_b64_tr_b16 v[216:217], v79 offset:0
v_mfma_f32_16x16x32_bf16 a[88:91], v[244:247], v[168:171], a[88:91]
v_mfma_f32_16x16x32_bf16 a[120:123], v[244:247], v[172:175], 0
v_mfma_f32_16x16x32_bf16 a[120:123], v[240:243], v[140:143], a[120:123]
buffer_load_dwordx4 v22, s[12:15], s70 offen offset:2048 lds
v_mfma_f32_16x16x32_bf16 a[152:155], v[240:243], v[144:147], 0
ds_read_b64_tr_b16 v[218:219], v79 offset:1024
v_mfma_f32_16x16x32_bf16 a[152:155], v[244:247], v[176:179], a[152:155]
ds_read_b64_tr_b16 v[220:221], v79 offset:8192
v_mfma_f32_16x16x32_bf16 a[184:187], v[244:247], v[180:183], 0
v_mfma_f32_16x16x32_bf16 a[184:187], v[240:243], v[148:151], a[184:187]
v_mfma_f32_16x16x32_bf16 a[216:219], v[240:243], v[152:155], 0
ds_read_b64_tr_b16 v[222:223], v79 offset:9216
v_mfma_f32_16x16x32_bf16 a[216:219], v[244:247], v[184:187], a[216:219]
buffer_load_dwordx4 v23, s[12:15], s70 offen offset:3072 lds
v_mfma_f32_16x16x32_bf16 a[248:251], v[244:247], v[188:191], 0
v_mfma_f32_16x16x32_bf16 a[248:251], v[240:243], v[156:159], a[248:251]
v_mfma_f32_16x16x32_bf16 a[28:31], v[248:251], v[128:131], 0
ds_read_b128 v[128:131], v17 offset:0
v_mfma_f32_16x16x32_bf16 a[28:31], v[252:255], v[160:163], a[28:31]
ds_read_b128 v[160:163], v42 offset:0
v_mfma_f32_16x16x32_bf16 a[60:63], v[252:255], v[164:167], 0
ds_read_b128 v[164:167], v42 offset:2048
v_mfma_f32_16x16x32_bf16 a[60:63], v[248:251], v[132:135], a[60:63]
ds_read_b128 v[132:135], v17 offset:2048
v_mfma_f32_16x16x32_bf16 a[92:95], v[248:251], v[136:139], 0
ds_read_b128 v[136:139], v17 offset:4096
v_mfma_f32_16x16x32_bf16 a[92:95], v[252:255], v[168:171], a[92:95]
ds_read_b128 v[168:171], v42 offset:4096
v_mfma_f32_16x16x32_bf16 a[124:127], v[252:255], v[172:175], 0
ds_read_b128 v[172:175], v42 offset:6144
v_mfma_f32_16x16x32_bf16 a[124:127], v[248:251], v[140:143], a[124:127]
s_add_u32 s71, s71, 256
ds_read_b128 v[140:143], v17 offset:6144
v_mfma_f32_16x16x32_bf16 a[156:159], v[248:251], v[144:147], 0
s_sub_u32 s70, s70, 2097024
ds_read_b128 v[144:147], v17 offset:8192
v_mfma_f32_16x16x32_bf16 a[156:159], v[252:255], v[176:179], a[156:159]
s_add_u32 s72, s72, 32768
ds_read_b128 v[176:179], v42 offset:8192
v_mfma_f32_16x16x32_bf16 a[188:191], v[252:255], v[180:183], 0
s_cmp_ge_u32 s72, 163840
ds_read_b128 v[180:183], v42 offset:10240
v_mfma_f32_16x16x32_bf16 a[188:191], v[248:251], v[148:151], a[188:191]
s_cselect_b32 s72, s75, s72
ds_read_b128 v[148:151], v17 offset:10240
v_mfma_f32_16x16x32_bf16 a[220:223], v[248:251], v[152:155], 0
ds_read_b128 v[152:155], v17 offset:12288
v_mfma_f32_16x16x32_bf16 a[220:223], v[252:255], v[184:187], a[220:223]
ds_read_b128 v[184:187], v42 offset:12288
v_mfma_f32_16x16x32_bf16 a[252:255], v[252:255], v[188:191], 0
ds_read_b128 v[188:191], v42 offset:14336
v_mfma_f32_16x16x32_bf16 a[252:255], v[248:251], v[156:159], a[252:255]
ds_read_b128 v[156:159], v17 offset:14336
s_mov_b32 s66, 11
s_branch KV_KL
ONCE5:
s_cmp_eq_u32 s66, 9
s_cbranch_scc0 SIDE4A
s_mul_i32 s63, s61, 56
s_and_b32 s63, s63, 0xfffffff0
s_add_u32 s24, s46, s63
s_addc_u32 s25, s47, 0
s_sub_u32 s26, 1204224, s63
s_mov_b32 s27, 0x20000
s_add_u32 s63, s62, 0
s_mul_i32 s64, s63, 43
s_lshr_b32 s64, s64, 7
s_mul_i32 s64, s64, 169344
s_mul_i32 s63, s63, 896
s_add_u32 s63, s63, s64
buffer_load_dwordx4 v[64:67], v18, s[24:27], s63 offen
s_add_u32 s63, s62, 16
s_mul_i32 s64, s63, 43
s_lshr_b32 s64, s64, 7
s_mul_i32 s64, s64, 169344
s_mul_i32 s63, s63, 896
s_add_u32 s63, s63, s64
buffer_load_dwordx4 v[68:71], v18, s[24:27], s63 offen
s_branch SIDE4C
SIDE4A:
s_cmp_eq_u32 s66, 7
s_cbranch_scc0 SIDE4B
s_lshl_b32 s63, s61, 17
s_add_u32 s85, s63, 134217728
s_add_u32 s85, s85, s68
s_lshl_b32 s63, s62, 12
s_add_u32 s63, s63, s85
s_add_u32 s64, s63, 65536
buffer_store_dwordx4 v[64:67], v1, s[8:11], s63 offen sc1
buffer_store_dwordx4 v[68:71], v1, s[8:11], s64 offen sc1
s_branch SIDE4C
SIDE4B:
buffer_store_byte v2, off, s[56:59], s2 sc1
SIDE4C:
s_branch BACK5
.p2align 5
KV_KL:
s_waitcnt lgkmcnt(8)
v_mfma_f32_16x16x32_bf16 a[0:3], v[192:195], v[128:131], a[0:3]
s_waitcnt vmcnt(8)
v_mfma_f32_16x16x32_bf16 a[0:3], v[196:199], v[160:163], a[0:3]
s_barrier
v_mfma_f32_16x16x32_bf16 a[32:35], v[196:199], v[164:167], a[32:35]
v_mfma_f32_16x16x32_bf16 a[32:35], v[192:195], v[132:135], a[32:35]
v_mfma_f32_16x16x32_bf16 a[64:67], v[192:195], v[136:139], a[64:67]
buffer_load_dword v6, v50, s[28:31], s79 offen
v_mfma_f32_16x16x32_bf16 a[64:67], v[196:199], v[168:171], a[64:67]
s_add_u32 s79, s79, 1024
ds_read_b64_tr_b16 v[224:225], v76 offset:16384
v_mfma_f32_16x16x32_bf16 a[96:99], v[196:199], v[172:175], a[96:99]
s_add_u32 m0, s73, 16384
v_mfma_f32_16x16x32_bf16 a[96:99], v[192:195], v[140:143], a[96:99]
s_waitcnt lgkmcnt(1)
ds_read_b64_tr_b16 v[226:227], v76 offset:17408
v_mfma_f32_16x16x32_bf16 a[128:131], v[192:195], v[144:147], a[128:131]
v_mfma_f32_16x16x32_bf16 a[128:131], v[196:199], v[176:179], a[128:131]
buffer_load_dwordx4 v72, s[16:19], s71 offen offset:0 nt lds
v_mfma_f32_16x16x32_bf16 a[160:163], v[196:199], v[180:183], a[160:163]
ds_read_b64_tr_b16 v[228:229], v76 offset:24576
v_mfma_f32_16x16x32_bf16 a[160:163], v[192:195], v[148:151], a[160:163]
v_mfma_f32_16x16x32_bf16 a[192:195], v[192:195], v[152:155], a[192:195]
ds_read_b64_tr_b16 v[230:231], v76 offset:25600
v_xor_b32 v76, 0x8000, v76
v_mfma_f32_16x16x32_bf16 a[192:195], v[196:199], v[184:187], a[192:195]
v_mfma_f32_16x16x32_bf16 a[224:227], v[196:199], v[188:191], a[224:227]
buffer_load_dwordx4 v73, s[16:19], s71 offen offset:1024 nt lds
v_mfma_f32_16x16x32_bf16 a[224:227], v[192:195], v[156:159], a[224:227]
v_mfma_f32_16x16x32_bf16 a[228:231], v[200:203], v[156:159], a[228:231]
v_mfma_f32_16x16x32_bf16 a[228:231], v[204:207], v[188:191], a[228:231]
ds_read_b64_tr_b16 v[232:233], v77 offset:16384
v_mfma_f32_16x16x32_bf16 a[196:199], v[204:207], v[184:187], a[196:199]
v_mfma_f32_16x16x32_bf16 a[196:199], v[200:203], v[152:155], a[196:199]
ds_read_b64_tr_b16 v[234:235], v77 offset:17408
v_mfma_f32_16x16x32_bf16 a[164:167], v[200:203], v[148:151], a[164:167]
buffer_load_dwordx4 v74, s[16:19], s71 offen offset:2048 nt lds
v_mfma_f32_16x16x32_bf16 a[164:167], v[204:207], v[180:183], a[164:167]
v_mfma_f32_16x16x32_bf16 a[132:135], v[204:207], v[176:179], a[132:135]
ds_read_b64_tr_b16 v[236:237], v77 offset:24576
v_mfma_f32_16x16x32_bf16 a[132:135], v[200:203], v[144:147], a[132:135]
v_mfma_f32_16x16x32_bf16 a[100:103], v[200:203], v[140:143], a[100:103]
ds_read_b64_tr_b16 v[238:239], v77 offset:25600
v_xor_b32 v77, 0x8000, v77
v_mfma_f32_16x16x32_bf16 a[100:103], v[204:207], v[172:175], a[100:103]
buffer_load_dwordx4 v75, s[16:19], s71 offen offset:3072 nt lds
v_mfma_f32_16x16x32_bf16 a[68:71], v[204:207], v[168:171], a[68:71]
s_mov_b32 m0, s72
v_mfma_f32_16x16x32_bf16 a[68:71], v[200:203], v[136:139], a[68:71]
v_mfma_f32_16x16x32_bf16 a[36:39], v[200:203], v[132:135], a[36:39]
v_mfma_f32_16x16x32_bf16 a[36:39], v[204:207], v[164:167], a[36:39]
ds_read_b64_tr_b16 v[240:241], v78 offset:16384
v_mfma_f32_16x16x32_bf16 a[4:7], v[204:207], v[160:163], a[4:7]
buffer_load_dwordx4 v20, s[12:15], s70 offen offset:0 lds
v_mfma_f32_16x16x32_bf16 a[4:7], v[200:203], v[128:131], a[4:7]
ds_read_b64_tr_b16 v[242:243], v78 offset:17408
v_mfma_f32_16x16x32_bf16 a[8:11], v[208:211], v[128:131], a[8:11]
v_mfma_f32_16x16x32_bf16 a[8:11], v[212:215], v[160:163], a[8:11]
v_mfma_f32_16x16x32_bf16 a[40:43], v[212:215], v[164:167], a[40:43]
ds_read_b64_tr_b16 v[244:245], v78 offset:24576
v_mfma_f32_16x16x32_bf16 a[40:43], v[208:211], v[132:135], a[40:43]
v_mfma_f32_16x16x32_bf16 a[72:75], v[208:211], v[136:139], a[72:75]
buffer_load_dwordx4 v21, s[12:15], s70 offen offset:1024 lds
v_mfma_f32_16x16x32_bf16 a[72:75], v[212:215], v[168:171], a[72:75]
ds_read_b64_tr_b16 v[246:247], v78 offset:25600
v_xor_b32 v78, 0x8000, v78
v_mfma_f32_16x16x32_bf16 a[104:107], v[212:215], v[172:175], a[104:107]
v_mfma_f32_16x16x32_bf16 a[104:107], v[208:211], v[140:143], a[104:107]
v_mfma_f32_16x16x32_bf16 a[136:139], v[208:211], v[144:147], a[136:139]
v_mfma_f32_16x16x32_bf16 a[136:139], v[212:215], v[176:179], a[136:139]
buffer_load_dwordx4 v22, s[12:15], s70 offen offset:2048 lds
v_mfma_f32_16x16x32_bf16 a[168:171], v[212:215], v[180:183], a[168:171]
ds_read_b64_tr_b16 v[248:249], v79 offset:16384
v_mfma_f32_16x16x32_bf16 a[168:171], v[208:211], v[148:151], a[168:171]
ds_read_b64_tr_b16 v[250:251], v79 offset:17408
v_mfma_f32_16x16x32_bf16 a[200:203], v[208:211], v[152:155], a[200:203]
v_mfma_f32_16x16x32_bf16 a[200:203], v[212:215], v[184:187], a[200:203]
v_mfma_f32_16x16x32_bf16 a[232:235], v[212:215], v[188:191], a[232:235]
buffer_load_dwordx4 v23, s[12:15], s70 offen offset:3072 lds
v_mfma_f32_16x16x32_bf16 a[232:235], v[208:211], v[156:159], a[232:235]
ds_read_b64_tr_b16 v[252:253], v79 offset:24576
v_mfma_f32_16x16x32_bf16 a[236:239], v[216:219], v[156:159], a[236:239]
ds_read_b64_tr_b16 v[254:255], v79 offset:25600
v_xor_b32 v79, 0x8000, v79
v_mfma_f32_16x16x32_bf16 a[236:239], v[220:223], v[188:191], a[236:239]
v_mfma_f32_16x16x32_bf16 a[204:207], v[220:223], v[184:187], a[204:207]
v_mfma_f32_16x16x32_bf16 a[204:207], v[216:219], v[152:155], a[204:207]
v_mfma_f32_16x16x32_bf16 a[172:175], v[216:219], v[148:151], a[172:175]
v_mfma_f32_16x16x32_bf16 a[172:175], v[220:223], v[180:183], a[172:175]
v_mfma_f32_16x16x32_bf16 a[140:143], v[220:223], v[176:179], a[140:143]
v_mfma_f32_16x16x32_bf16 a[140:143], v[216:219], v[144:147], a[140:143]
s_add_u32 s71, s71, 524032
v_mfma_f32_16x16x32_bf16 a[108:111], v[216:219], v[140:143], a[108:111]
s_add_u32 s70, s70, 2097152
v_mfma_f32_16x16x32_bf16 a[108:111], v[220:223], v[172:175], a[108:111]
v_mfma_f32_16x16x32_bf16 a[76:79], v[220:223], v[168:171], a[76:79]
s_xor_b32 s73, s73, 0x8000
v_mfma_f32_16x16x32_bf16 a[76:79], v[216:219], v[136:139], a[76:79]
v_mfma_f32_16x16x32_bf16 a[44:47], v[216:219], v[132:135], a[44:47]
s_add_u32 s74, s74, 32768
v_mfma_f32_16x16x32_bf16 a[44:47], v[220:223], v[164:167], a[44:47]
s_cmp_ge_u32 s74, 98304
v_mfma_f32_16x16x32_bf16 a[12:15], v[220:223], v[160:163], a[12:15]
s_cselect_b32 s74, 0, s74
v_mfma_f32_16x16x32_bf16 a[12:15], v[216:219], v[128:131], a[12:15]
s_waitcnt lgkmcnt(0)
v_mfma_f32_16x16x32_bf16 a[16:19], v[224:227], v[128:131], a[16:19]
s_waitcnt vmcnt(9)
v_add_u32 v17, s74, v16
v_xor_b32 v42, 64, v17
v_mfma_f32_16x16x32_bf16 a[16:19], v[228:231], v[160:163], a[16:19]
s_barrier
v_mfma_f32_16x16x32_bf16 a[48:51], v[228:231], v[164:167], a[48:51]
s_bitcmp1_b32 s80, s66
v_mfma_f32_16x16x32_bf16 a[48:51], v[224:227], v[132:135], a[48:51]
ds_read_b64_tr_b16 v[192:193], v76 offset:0
v_mfma_f32_16x16x32_bf16 a[80:83], v[224:227], v[136:139], a[80:83]
s_cbranch_scc1 ONCE5
BACK5:
v_mfma_f32_16x16x32_bf16 a[80:83], v[228:231], v[168:171], a[80:83]
v_mfma_f32_16x16x32_bf16 a[112:115], v[228:231], v[172:175], a[112:115]
s_mov_b32 m0, s73
ds_read_b64_tr_b16 v[194:195], v76 offset:1024
v_mfma_f32_16x16x32_bf16 a[112:115], v[224:227], v[140:143], a[112:115]
v_mfma_f32_16x16x32_bf16 a[144:147], v[224:227], v[144:147], a[144:147]
buffer_load_dwordx4 v72, s[16:19], s71 offen offset:0 nt lds
v_mfma_f32_16x16x32_bf16 a[144:147], v[228:231], v[176:179], a[144:147]
ds_read_b64_tr_b16 v[196:197], v76 offset:8192
v_mfma_f32_16x16x32_bf16 a[176:179], v[228:231], v[180:183], a[176:179]
v_mfma_f32_16x16x32_bf16 a[176:179], v[224:227], v[148:151], a[176:179]
ds_read_b64_tr_b16 v[198:199], v76 offset:9216
v_mfma_f32_16x16x32_bf16 a[208:211], v[224:227], v[152:155], a[208:211]
v_mfma_f32_16x16x32_bf16 a[208:211], v[228:231], v[184:187], a[208:211]
buffer_load_dwordx4 v73, s[16:19], s71 offen offset:1024 nt lds
v_mfma_f32_16x16x32_bf16 a[240:243], v[228:231], v[188:191], a[240:243]
ds_read_b64_tr_b16 v[200:201], v77 offset:0
v_mfma_f32_16x16x32_bf16 a[240:243], v[224:227], v[156:159], a[240:243]
v_mfma_f32_16x16x32_bf16 a[244:247], v[232:235], v[156:159], a[244:247]
v_mfma_f32_16x16x32_bf16 a[244:247], v[236:239], v[188:191], a[244:247]
ds_read_b64_tr_b16 v[202:203], v77 offset:1024
v_mfma_f32_16x16x32_bf16 a[212:215], v[236:239], v[184:187], a[212:215]
buffer_load_dwordx4 v74, s[16:19], s71 offen offset:2048 nt lds
v_mfma_f32_16x16x32_bf16 a[212:215], v[232:235], v[152:155], a[212:215]
ds_read_b64_tr_b16 v[204:205], v77 offset:8192
v_mfma_f32_16x16x32_bf16 a[180:183], v[232:235], v[148:151], a[180:183]
v_mfma_f32_16x16x32_bf16 a[180:183], v[236:239], v[180:183], a[180:183]
v_mfma_f32_16x16x32_bf16 a[148:151], v[236:239], v[176:179], a[148:151]
ds_read_b64_tr_b16 v[206:207], v77 offset:9216
v_mfma_f32_16x16x32_bf16 a[148:151], v[232:235], v[144:147], a[148:151]
buffer_load_dwordx4 v75, s[16:19], s71 offen offset:3072 nt lds
v_mfma_f32_16x16x32_bf16 a[116:119], v[232:235], v[140:143], a[116:119]
s_add_u32 m0, s72, 4096
v_mfma_f32_16x16x32_bf16 a[116:119], v[236:239], v[172:175], a[116:119]
ds_read_b64_tr_b16 v[208:209], v78 offset:0
v_mfma_f32_16x16x32_bf16 a[84:87], v[236:239], v[168:171], a[84:87]
v_mfma_f32_16x16x32_bf16 a[84:87], v[232:235], v[136:139], a[84:87]
v_mfma_f32_16x16x32_bf16 a[52:55], v[232:235], v[132:135], a[52:55]
ds_read_b64_tr_b16 v[210:211], v78 offset:1024
v_mfma_f32_16x16x32_bf16 a[52:55], v[236:239], v[164:167], a[52:55]
buffer_load_dwordx4 v20, s[12:15], s70 offen offset:0 lds
v_mfma_f32_16x16x32_bf16 a[20:23], v[236:239], v[160:163], a[20:23]
ds_read_b64_tr_b16 v[212:213], v78 offset:8192
v_mfma_f32_16x16x32_bf16 a[20:23], v[232:235], v[128:131], a[20:23]
v_mfma_f32_16x16x32_bf16 a[24:27], v[240:243], v[128:131], a[24:27]
v_mfma_f32_16x16x32_bf16 a[24:27], v[244:247], v[160:163], a[24:27]
ds_read_b64_tr_b16 v[214:215], v78 offset:9216
v_mfma_f32_16x16x32_bf16 a[56:59], v[244:247], v[164:167], a[56:59]
buffer_load_dwordx4 v21, s[12:15], s70 offen offset:1024 lds
v_mfma_f32_16x16x32_bf16 a[56:59], v[240:243], v[132:135], a[56:59]
v_mfma_f32_16x16x32_bf16 a[88:91], v[240:243], v[136:139], a[88:91]
ds_read_b64_tr_b16 v[216:217], v79 offset:0
v_mfma_f32_16x16x32_bf16 a[88:91], v[244:247], v[168:171], a[88:91]
v_mfma_f32_16x16x32_bf16 a[120:123], v[244:247], v[172:175], a[120:123]
v_mfma_f32_16x16x32_bf16 a[120:123], v[240:243], v[140:143], a[120:123]
buffer_load_dwordx4 v22, s[12:15], s70 offen offset:2048 lds
v_mfma_f32_16x16x32_bf16 a[152:155], v[240:243], v[144:147], a[152:155]
ds_read_b64_tr_b16 v[218:219], v79 offset:1024
v_mfma_f32_16x16x32_bf16 a[152:155], v[244:247], v[176:179], a[152:155]
ds_read_b64_tr_b16 v[220:221], v79 offset:8192
v_mfma_f32_16x16x32_bf16 a[184:187], v[244:247], v[180:183], a[184:187]
v_mfma_f32_16x16x32_bf16 a[184:187], v[240:243], v[148:151], a[184:187]
v_mfma_f32_16x16x32_bf16 a[216:219], v[240:243], v[152:155], a[216:219]
buffer_load_dwordx4 v23, s[12:15], s70 offen offset:3072 lds
v_mfma_f32_16x16x32_bf16 a[216:219], v[244:247], v[184:187], a[216:219]
ds_read_b64_tr_b16 v[222:223], v79 offset:9216
v_mfma_f32_16x16x32_bf16 a[248:251], v[244:247], v[188:191], a[248:251]
v_mfma_f32_16x16x32_bf16 a[248:251], v[240:243], v[156:159], a[248:251]
v_mfma_f32_16x16x32_bf16 a[28:31], v[248:251], v[128:131], a[28:31]
ds_read_b128 v[128:131], v17 offset:0
v_mfma_f32_16x16x32_bf16 a[28:31], v[252:255], v[160:163], a[28:31]
ds_read_b128 v[160:163], v42 offset:0
v_mfma_f32_16x16x32_bf16 a[60:63], v[252:255], v[164:167], a[60:63]
ds_read_b128 v[164:167], v42 offset:2048
v_mfma_f32_16x16x32_bf16 a[60:63], v[248:251], v[132:135], a[60:63]
ds_read_b128 v[132:135], v17 offset:2048
v_mfma_f32_16x16x32_bf16 a[92:95], v[248:251], v[136:139], a[92:95]
ds_read_b128 v[136:139], v17 offset:4096
v_mfma_f32_16x16x32_bf16 a[92:95], v[252:255], v[168:171], a[92:95]
ds_read_b128 v[168:171], v42 offset:4096
v_mfma_f32_16x16x32_bf16 a[124:127], v[252:255], v[172:175], a[124:127]
ds_read_b128 v[172:175], v42 offset:6144
v_mfma_f32_16x16x32_bf16 a[124:127], v[248:251], v[140:143], a[124:127]
s_add_u32 s71, s71, 256
ds_read_b128 v[140:143], v17 offset:6144
v_mfma_f32_16x16x32_bf16 a[156:159], v[248:251], v[144:147], a[156:159]
s_sub_u32 s70, s70, 2097024
ds_read_b128 v[144:147], v17 offset:8192
v_mfma_f32_16x16x32_bf16 a[156:159], v[252:255], v[176:179], a[156:159]
s_add_u32 s72, s72, 32768
ds_read_b128 v[176:179], v42 offset:8192
v_mfma_f32_16x16x32_bf16 a[188:191], v[252:255], v[180:183], a[188:191]
s_cmp_ge_u32 s72, 163840
ds_read_b128 v[180:183], v42 offset:10240
v_mfma_f32_16x16x32_bf16 a[188:191], v[248:251], v[148:151], a[188:191]
s_cselect_b32 s72, s75, s72
ds_read_b128 v[148:151], v17 offset:10240
v_mfma_f32_16x16x32_bf16 a[220:223], v[248:251], v[152:155], a[220:223]
ds_read_b128 v[152:155], v17 offset:12288
v_mfma_f32_16x16x32_bf16 a[220:223], v[252:255], v[184:187], a[220:223]
s_sub_u32 s66, s66, 1
ds_read_b128 v[184:187], v42 offset:12288
v_mfma_f32_16x16x32_bf16 a[252:255], v[252:255], v[188:191], a[252:255]
ds_read_b128 v[188:191], v42 offset:14336
v_mfma_f32_16x16x32_bf16 a[252:255], v[248:251], v[156:159], a[252:255]
ds_read_b128 v[156:159], v17 offset:14336
s_cbranch_scc0 KV_KL
s_waitcnt lgkmcnt(8)
v_mfma_f32_16x16x32_bf16 a[0:3], v[192:195], v[128:131], a[0:3]
s_waitcnt vmcnt(8)
v_mfma_f32_16x16x32_bf16 a[0:3], v[196:199], v[160:163], a[0:3]
s_barrier
v_mfma_f32_16x16x32_bf16 a[32:35], v[196:199], v[164:167], a[32:35]
v_mfma_f32_16x16x32_bf16 a[32:35], v[192:195], v[132:135], a[32:35]
v_mfma_f32_16x16x32_bf16 a[64:67], v[192:195], v[136:139], a[64:67]
buffer_load_dword v7, v5, s[56:59], 0 offen sc1
v_mfma_f32_16x16x32_bf16 a[64:67], v[196:199], v[168:171], a[64:67]
s_add_u32 m0, s73, 16384
ds_read_b64_tr_b16 v[224:225], v76 offset:16384
v_mfma_f32_16x16x32_bf16 a[96:99], v[196:199], v[172:175], a[96:99]
v_mfma_f32_16x16x32_bf16 a[96:99], v[192:195], v[140:143], a[96:99]
s_waitcnt lgkmcnt(1)
ds_read_b64_tr_b16 v[226:227], v76 offset:17408
v_mfma_f32_16x16x32_bf16 a[128:131], v[192:195], v[144:147], a[128:131]
v_mfma_f32_16x16x32_bf16 a[128:131], v[196:199], v[176:179], a[128:131]
buffer_load_dwordx4 v72, s[16:19], s71 offen offset:0 nt lds
v_mfma_f32_16x16x32_bf16 a[160:163], v[196:199], v[180:183], a[160:163]
ds_read_b64_tr_b16 v[228:229], v76 offset:24576
v_mfma_f32_16x16x32_bf16 a[160:163], v[192:195], v[148:151], a[160:163]
v_mfma_f32_16x16x32_bf16 a[192:195], v[192:195], v[152:155], a[192:195]
ds_read_b64_tr_b16 v[230:231], v76 offset:25600
v_xor_b32 v76, 0x8000, v76
v_mfma_f32_16x16x32_bf16 a[192:195], v[196:199], v[184:187], a[192:195]
v_mfma_f32_16x16x32_bf16 a[224:227], v[196:199], v[188:191], a[224:227]
buffer_load_dwordx4 v73, s[16:19], s71 offen offset:1024 nt lds
v_mfma_f32_16x16x32_bf16 a[224:227], v[192:195], v[156:159], a[224:227]
v_mfma_f32_16x16x32_bf16 a[228:231], v[200:203], v[156:159], a[228:231]
v_mfma_f32_16x16x32_bf16 a[228:231], v[204:207], v[188:191], a[228:231]
ds_read_b64_tr_b16 v[232:233], v77 offset:16384
v_mfma_f32_16x16x32_bf16 a[196:199], v[204:207], v[184:187], a[196:199]
v_mfma_f32_16x16x32_bf16 a[196:199], v[200:203], v[152:155], a[196:199]
ds_read_b64_tr_b16 v[234:235], v77 offset:17408
v_mfma_f32_16x16x32_bf16 a[164:167], v[200:203], v[148:151], a[164:167]
buffer_load_dwordx4 v74, s[16:19], s71 offen offset:2048 nt lds
v_mfma_f32_16x16x32_bf16 a[164:167], v[204:207], v[180:183], a[164:167]
v_mfma_f32_16x16x32_bf16 a[132:135], v[204:207], v[176:179], a[132:135]
ds_read_b64_tr_b16 v[236:237], v77 offset:24576
v_mfma_f32_16x16x32_bf16 a[132:135], v[200:203], v[144:147], a[132:135]
v_mfma_f32_16x16x32_bf16 a[100:103], v[200:203], v[140:143], a[100:103]
ds_read_b64_tr_b16 v[238:239], v77 offset:25600
v_xor_b32 v77, 0x8000, v77
v_mfma_f32_16x16x32_bf16 a[100:103], v[204:207], v[172:175], a[100:103]
buffer_load_dwordx4 v75, s[16:19], s71 offen offset:3072 nt lds
v_mfma_f32_16x16x32_bf16 a[68:71], v[204:207], v[168:171], a[68:71]
s_mov_b32 m0, s72
v_mfma_f32_16x16x32_bf16 a[68:71], v[200:203], v[136:139], a[68:71]
v_mfma_f32_16x16x32_bf16 a[36:39], v[200:203], v[132:135], a[36:39]
v_mfma_f32_16x16x32_bf16 a[36:39], v[204:207], v[164:167], a[36:39]
ds_read_b64_tr_b16 v[240:241], v78 offset:16384
v_mfma_f32_16x16x32_bf16 a[4:7], v[204:207], v[160:163], a[4:7]
buffer_load_dwordx4 v20, s[12:15], s70 offen offset:0 lds
v_mfma_f32_16x16x32_bf16 a[4:7], v[200:203], v[128:131], a[4:7]
ds_read_b64_tr_b16 v[242:243], v78 offset:17408
v_mfma_f32_16x16x32_bf16 a[8:11], v[208:211], v[128:131], a[8:11]
v_mfma_f32_16x16x32_bf16 a[8:11], v[212:215], v[160:163], a[8:11]
v_mfma_f32_16x16x32_bf16 a[40:43], v[212:215], v[164:167], a[40:43]
ds_read_b64_tr_b16 v[244:245], v78 offset:24576
v_mfma_f32_16x16x32_bf16 a[40:43], v[208:211], v[132:135], a[40:43]
v_mfma_f32_16x16x32_bf16 a[72:75], v[208:211], v[136:139], a[72:75]
buffer_load_dwordx4 v21, s[12:15], s70 offen offset:1024 lds
v_mfma_f32_16x16x32_bf16 a[72:75], v[212:215], v[168:171], a[72:75]
ds_read_b64_tr_b16 v[246:247], v78 offset:25600
v_xor_b32 v78, 0x8000, v78
v_mfma_f32_16x16x32_bf16 a[104:107], v[212:215], v[172:175], a[104:107]
v_mfma_f32_16x16x32_bf16 a[104:107], v[208:211], v[140:143], a[104:107]
v_mfma_f32_16x16x32_bf16 a[136:139], v[208:211], v[144:147], a[136:139]
v_mfma_f32_16x16x32_bf16 a[136:139], v[212:215], v[176:179], a[136:139]
buffer_load_dwordx4 v22, s[12:15], s70 offen offset:2048 lds
v_mfma_f32_16x16x32_bf16 a[168:171], v[212:215], v[180:183], a[168:171]
ds_read_b64_tr_b16 v[248:249], v79 offset:16384
v_mfma_f32_16x16x32_bf16 a[168:171], v[208:211], v[148:151], a[168:171]
ds_read_b64_tr_b16 v[250:251], v79 offset:17408
v_mfma_f32_16x16x32_bf16 a[200:203], v[208:211], v[152:155], a[200:203]
v_mfma_f32_16x16x32_bf16 a[200:203], v[212:215], v[184:187], a[200:203]
v_mfma_f32_16x16x32_bf16 a[232:235], v[212:215], v[188:191], a[232:235]
buffer_load_dwordx4 v23, s[12:15], s70 offen offset:3072 lds
v_mfma_f32_16x16x32_bf16 a[232:235], v[208:211], v[156:159], a[232:235]
ds_read_b64_tr_b16 v[252:253], v79 offset:24576
v_mfma_f32_16x16x32_bf16 a[236:239], v[216:219], v[156:159], a[236:239]
ds_read_b64_tr_b16 v[254:255], v79 offset:25600
v_xor_b32 v79, 0x8000, v79
v_mfma_f32_16x16x32_bf16 a[236:239], v[220:223], v[188:191], a[236:239]
v_mfma_f32_16x16x32_bf16 a[204:207], v[220:223], v[184:187], a[204:207]
v_mfma_f32_16x16x32_bf16 a[204:207], v[216:219], v[152:155], a[204:207]
v_mfma_f32_16x16x32_bf16 a[172:175], v[216:219], v[148:151], a[172:175]
v_mfma_f32_16x16x32_bf16 a[172:175], v[220:223], v[180:183], a[172:175]
v_mfma_f32_16x16x32_bf16 a[140:143], v[220:223], v[176:179], a[140:143]
v_mfma_f32_16x16x32_bf16 a[140:143], v[216:219], v[144:147], a[140:143]
s_add_u32 s71, s71, 524032
v_mfma_f32_16x16x32_bf16 a[108:111], v[216:219], v[140:143], a[108:111]
s_add_u32 s70, s70, 2097152
v_mfma_f32_16x16x32_bf16 a[108:111], v[220:223], v[172:175], a[108:111]
v_mfma_f32_16x16x32_bf16 a[76:79], v[220:223], v[168:171], a[76:79]
s_xor_b32 s73, s73, 0x8000
v_mfma_f32_16x16x32_bf16 a[76:79], v[216:219], v[136:139], a[76:79]
v_mfma_f32_16x16x32_bf16 a[44:47], v[216:219], v[132:135], a[44:47]
s_add_u32 s74, s74, 32768
v_mfma_f32_16x16x32_bf16 a[44:47], v[220:223], v[164:167], a[44:47]
s_cmp_ge_u32 s74, 98304
v_mfma_f32_16x16x32_bf16 a[12:15], v[220:223], v[160:163], a[12:15]
s_cselect_b32 s74, 0, s74
v_mfma_f32_16x16x32_bf16 a[12:15], v[216:219], v[128:131], a[12:15]
s_waitcnt lgkmcnt(0)
v_mfma_f32_16x16x32_bf16 a[16:19], v[224:227], v[128:131], a[16:19]
s_waitcnt vmcnt(9)
v_add_u32 v17, s74, v16
v_xor_b32 v42, 64, v17
v_mfma_f32_16x16x32_bf16 a[16:19], v[228:231], v[160:163], a[16:19]
s_barrier
v_mfma_f32_16x16x32_bf16 a[48:51], v[228:231], v[164:167], a[48:51]
s_mov_b32 m0, s73
v_mfma_f32_16x16x32_bf16 a[48:51], v[224:227], v[132:135], a[48:51]
ds_read_b64_tr_b16 v[192:193], v76 offset:0
v_mfma_f32_16x16x32_bf16 a[80:83], v[224:227], v[136:139], a[80:83]
buffer_load_dwordx4 v72, s[16:19], s71 offen offset:0 nt lds
v_mfma_f32_16x16x32_bf16 a[80:83], v[228:231], v[168:171], a[80:83]
v_mfma_f32_16x16x32_bf16 a[112:115], v[228:231], v[172:175], a[112:115]
ds_read_b64_tr_b16 v[194:195], v76 offset:1024
v_mfma_f32_16x16x32_bf16 a[112:115], v[224:227], v[140:143], a[112:115]
v_mfma_f32_16x16x32_bf16 a[144:147], v[224:227], v[144:147], a[144:147]
ds_read_b64_tr_b16 v[196:197], v76 offset:8192
v_mfma_f32_16x16x32_bf16 a[144:147], v[228:231], v[176:179], a[144:147]
buffer_load_dwordx4 v73, s[16:19], s71 offen offset:1024 nt lds
v_mfma_f32_16x16x32_bf16 a[176:179], v[228:231], v[180:183], a[176:179]
v_mfma_f32_16x16x32_bf16 a[176:179], v[224:227], v[148:151], a[176:179]
ds_read_b64_tr_b16 v[198:199], v76 offset:9216
v_mfma_f32_16x16x32_bf16 a[208:211], v[224:227], v[152:155], a[208:211]
v_mfma_f32_16x16x32_bf16 a[208:211], v[228:231], v[184:187], a[208:211]
v_mfma_f32_16x16x32_bf16 a[240:243], v[228:231], v[188:191], a[240:243]
buffer_load_dwordx4 v74, s[16:19], s71 offen offset:2048 nt lds
v_mfma_f32_16x16x32_bf16 a[240:243], v[224:227], v[156:159], a[240:243]
ds_read_b64_tr_b16 v[200:201], v77 offset:0
v_mfma_f32_16x16x32_bf16 a[244:247], v[232:235], v[156:159], a[244:247]
v_mfma_f32_16x16x32_bf16 a[244:247], v[236:239], v[188:191], a[244:247]
ds_read_b64_tr_b16 v[202:203], v77 offset:1024
v_mfma_f32_16x16x32_bf16 a[212:215], v[236:239], v[184:187], a[212:215]
v_mfma_f32_16x16x32_bf16 a[212:215], v[232:235], v[152:155], a[212:215]
buffer_load_dwordx4 v75, s[16:19], s71 offen offset:3072 nt lds
v_mfma_f32_16x16x32_bf16 a[180:183], v[232:235], v[148:151], a[180:183]
s_add_u32 m0, s72, 4096
ds_read_b64_tr_b16 v[204:205], v77 offset:8192
v_mfma_f32_16x16x32_bf16 a[180:183], v[236:239], v[180:183], a[180:183]
v_mfma_f32_16x16x32_bf16 a[148:151], v[236:239], v[176:179], a[148:151]
ds_read_b64_tr_b16 v[206:207], v77 offset:9216
v_mfma_f32_16x16x32_bf16 a[148:151], v[232:235], v[144:147], a[148:151]
v_mfma_f32_16x16x32_bf16 a[116:119], v[232:235], v[140:143], a[116:119]
buffer_load_dwordx4 v20, s[12:15], s70 offen offset:0 lds
v_mfma_f32_16x16x32_bf16 a[116:119], v[236:239], v[172:175], a[116:119]
ds_read_b64_tr_b16 v[208:209], v78 offset:0
v_mfma_f32_16x16x32_bf16 a[84:87], v[236:239], v[168:171], a[84:87]
v_mfma_f32_16x16x32_bf16 a[84:87], v[232:235], v[136:139], a[84:87]
v_mfma_f32_16x16x32_bf16 a[52:55], v[232:235], v[132:135], a[52:55]
ds_read_b64_tr_b16 v[210:211], v78 offset:1024
v_mfma_f32_16x16x32_bf16 a[52:55], v[236:239], v[164:167], a[52:55]
buffer_load_dwordx4 v21, s[12:15], s70 offen offset:1024 lds
v_mfma_f32_16x16x32_bf16 a[20:23], v[236:239], v[160:163], a[20:23]
ds_read_b64_tr_b16 v[212:213], v78 offset:8192
v_mfma_f32_16x16x32_bf16 a[20:23], v[232:235], v[128:131], a[20:23]
v_mfma_f32_16x16x32_bf16 a[24:27], v[240:243], v[128:131], a[24:27]
v_mfma_f32_16x16x32_bf16 a[24:27], v[244:247], v[160:163], a[24:27]
ds_read_b64_tr_b16 v[214:215], v78 offset:9216
v_mfma_f32_16x16x32_bf16 a[56:59], v[244:247], v[164:167], a[56:59]
buffer_load_dwordx4 v22, s[12:15], s70 offen offset:2048 lds
v_mfma_f32_16x16x32_bf16 a[56:59], v[240:243], v[132:135], a[56:59]
v_mfma_f32_16x16x32_bf16 a[88:91], v[240:243], v[136:139], a[88:91]
ds_read_b64_tr_b16 v[216:217], v79 offset:0
v_mfma_f32_16x16x32_bf16 a[88:91], v[244:247], v[168:171], a[88:91]
v_mfma_f32_16x16x32_bf16 a[120:123], v[244:247], v[172:175], a[120:123]
v_mfma_f32_16x16x32_bf16 a[120:123], v[240:243], v[140:143], a[120:123]
buffer_load_dwordx4 v23, s[12:15], s70 offen offset:3072 lds
v_mfma_f32_16x16x32_bf16 a[152:155], v[240:243], v[144:147], a[152:155]
s_mul_i32 s63, s61, 1568
ds_read_b64_tr_b16 v[218:219], v79 offset:1024
v_mfma_f32_16x16x32_bf16 a[152:155], v[244:247], v[176:179], a[152:155]
s_add_u32 s28, s48, s63
ds_read_b64_tr_b16 v[220:221], v79 offset:8192
v_mfma_f32_16x16x32_bf16 a[184:187], v[244:247], v[180:183], a[184:187]
s_addc_u32 s29, s49, 0
v_mfma_f32_16x16x32_bf16 a[184:187], v[240:243], v[148:151], a[184:187]
s_mov_b32 s30, 1568
v_mfma_f32_16x16x32_bf16 a[216:219], v[240:243], v[152:155], a[216:219]
s_add_u32 m0, s68, 122880
ds_read_b64_tr_b16 v[222:223], v79 offset:9216
v_mfma_f32_16x16x32_bf16 a[216:219], v[244:247], v[184:187], a[216:219]
buffer_load_dwordx4 v1, s[28:31], s68 offen offset:0 lds
v_mfma_f32_16x16x32_bf16 a[248:251], v[244:247], v[188:191], a[248:251]
v_mfma_f32_16x16x32_bf16 a[248:251], v[240:243], v[156:159], a[248:251]
v_mfma_f32_16x16x32_bf16 a[28:31], v[248:251], v[128:131], a[28:31]
ds_read_b128 v[128:131], v17 offset:0
v_mfma_f32_16x16x32_bf16 a[28:31], v[252:255], v[160:163], a[28:31]
ds_read_b128 v[160:163], v42 offset:0
v_mfma_f32_16x16x32_bf16 a[60:63], v[252:255], v[164:167], a[60:63]
ds_read_b128 v[164:167], v42 offset:2048
v_mfma_f32_16x16x32_bf16 a[60:63], v[248:251], v[132:135], a[60:63]
ds_read_b128 v[132:135], v17 offset:2048
v_mfma_f32_16x16x32_bf16 a[92:95], v[248:251], v[136:139], a[92:95]
ds_read_b128 v[136:139], v17 offset:4096
v_mfma_f32_16x16x32_bf16 a[92:95], v[252:255], v[168:171], a[92:95]
ds_read_b128 v[168:171], v42 offset:4096
v_mfma_f32_16x16x32_bf16 a[124:127], v[252:255], v[172:175], a[124:127]
ds_read_b128 v[172:175], v42 offset:6144
v_mfma_f32_16x16x32_bf16 a[124:127], v[248:251], v[140:143], a[124:127]
s_add_u32 s71, s71, 256
ds_read_b128 v[140:143], v17 offset:6144
v_mfma_f32_16x16x32_bf16 a[156:159], v[248:251], v[144:147], a[156:159]
ds_read_b128 v[144:147], v17 offset:8192
v_mfma_f32_16x16x32_bf16 a[156:159], v[252:255], v[176:179], a[156:159]
ds_read_b128 v[176:179], v42 offset:8192
v_mfma_f32_16x16x32_bf16 a[188:191], v[252:255], v[180:183], a[188:191]
ds_read_b128 v[180:183], v42 offset:10240
v_mfma_f32_16x16x32_bf16 a[188:191], v[248:251], v[148:151], a[188:191]
ds_read_b128 v[148:151], v17 offset:10240
v_mfma_f32_16x16x32_bf16 a[220:223], v[248:251], v[152:155], a[220:223]
ds_read_b128 v[152:155], v17 offset:12288
v_mfma_f32_16x16x32_bf16 a[220:223], v[252:255], v[184:187], a[220:223]
ds_read_b128 v[184:187], v42 offset:12288
v_mfma_f32_16x16x32_bf16 a[252:255], v[252:255], v[188:191], a[252:255]
ds_read_b128 v[188:191], v42 offset:14336
v_mfma_f32_16x16x32_bf16 a[252:255], v[248:251], v[156:159], a[252:255]
s_waitcnt lgkmcnt(6)
ds_read_b128 v[156:159], v17 offset:14336
v_mfma_f32_16x16x32_bf16 a[0:3], v[192:195], v[128:131], a[0:3]
s_waitcnt vmcnt(9)
v_mfma_f32_16x16x32_bf16 a[0:3], v[196:199], v[160:163], a[0:3]
s_barrier
v_cmp_ne_u32 vcc, 0x01010101, v7
s_nop 0
s_cmp_lg_u64 vcc, 0
s_cbranch_scc1 SPIN6_0
OK6_0:
v_mfma_f32_16x16x32_bf16 a[32:35], v[196:199], v[164:167], a[32:35]
s_add_u32 m0, s73, 16384
v_mfma_f32_16x16x32_bf16 a[32:35], v[192:195], v[132:135], a[32:35]
buffer_load_dwordx4 v72, s[16:19], s71 offen offset:0 nt lds
v_mfma_f32_16x16x32_bf16 a[64:67], v[192:195], v[136:139], a[64:67]
v_mfma_f32_16x16x32_bf16 a[64:67], v[196:199], v[168:171], a[64:67]
ds_read_b64_tr_b16 v[224:225], v76 offset:16384
v_mfma_f32_16x16x32_bf16 a[96:99], v[196:199], v[172:175], a[96:99]
v_mfma_f32_16x16x32_bf16 a[96:99], v[192:195], v[140:143], a[96:99]
ds_read_b64_tr_b16 v[226:227], v76 offset:17408
v_mfma_f32_16x16x32_bf16 a[128:131], v[192:195], v[144:147], a[128:131]
s_waitcnt lgkmcnt(2)
buffer_load_dwordx4 v73, s[16:19], s71 offen offset:1024 nt lds
v_mfma_f32_16x16x32_bf16 a[128:131], v[196:199], v[176:179], a[128:131]
v_mfma_f32_16x16x32_bf16 a[160:163], v[196:199], v[180:183], a[160:163]
ds_read_b64_tr_b16 v[228:229], v76 offset:24576
v_mfma_f32_16x16x32_bf16 a[160:163], v[192:195], v[148:151], a[160:163]
v_mfma_f32_16x16x32_bf16 a[192:195], v[192:195], v[152:155], a[192:195]
buffer_load_dwordx4 v74, s[16:19], s71 offen offset:2048 nt lds
v_mfma_f32_16x16x32_bf16 a[192:195], v[196:199], v[184:187], a[192:195]
ds_read_b64_tr_b16 v[230:231], v76 offset:25600
v_xor_b32 v76, 0x8000, v76
v_mfma_f32_16x16x32_bf16 a[224:227], v[196:199], v[188:191], a[224:227]
v_mfma_f32_16x16x32_bf16 a[224:227], v[192:195], v[156:159], a[224:227]
v_mfma_f32_16x16x32_bf16 a[228:231], v[200:203], v[156:159], a[228:231]
buffer_load_dwordx4 v75, s[16:19], s71 offen offset:3072 nt lds
v_mfma_f32_16x16x32_bf16 a[228:231], v[204:207], v[188:191], a[228:231]
s_add_u32 m0, s68, 98304
ds_read_b64_tr_b16 v[232:233], v77 offset:16384
v_mfma_f32_16x16x32_bf16 a[196:199], v[204:207], v[184:187], a[196:199]
s_add_u32 s65, s85, 0
v_mfma_f32_16x16x32_bf16 a[196:199], v[200:203], v[152:155], a[196:199]
ds_read_b64_tr_b16 v[234:235], v77 offset:17408
v_mfma_f32_16x16x32_bf16 a[164:167], v[200:203], v[148:151], a[164:167]
v_mfma_f32_16x16x32_bf16 a[164:167], v[204:207], v[180:183], a[164:167]
buffer_load_dwordx4 v1, s[8:11], s65 offen offset:0 sc1 lds
v_mfma_f32_16x16x32_bf16 a[132:135], v[204:207], v[176:179], a[132:135]
s_add_u32 m0, s68, 102400
ds_read_b64_tr_b16 v[236:237], v77 offset:24576
v_mfma_f32_16x16x32_bf16 a[132:135], v[200:203], v[144:147], a[132:135]
s_add_u32 s65, s85, 4096
v_mfma_f32_16x16x32_bf16 a[100:103], v[200:203], v[140:143], a[100:103]
ds_read_b64_tr_b16 v[238:239], v77 offset:25600
v_xor_b32 v77, 0x8000, v77
v_mfma_f32_16x16x32_bf16 a[100:103], v[204:207], v[172:175], a[100:103]
buffer_load_dwordx4 v1, s[8:11], s65 offen offset:0 sc1 lds
v_mfma_f32_16x16x32_bf16 a[68:71], v[204:207], v[168:171], a[68:71]
s_add_u32 m0, s68, 106496
v_mfma_f32_16x16x32_bf16 a[68:71], v[200:203], v[136:139], a[68:71]
s_add_u32 s65, s85, 8192
v_mfma_f32_16x16x32_bf16 a[36:39], v[200:203], v[132:135], a[36:39]
v_mfma_f32_16x16x32_bf16 a[36:39], v[204:207], v[164:167], a[36:39]
buffer_load_dwordx4 v1, s[8:11], s65 offen offset:0 sc1 lds
v_mfma_f32_16x16x32_bf16 a[4:7], v[204:207], v[160:163], a[4:7]
s_mov_b32 s65, 0
ds_read_b64_tr_b16 v[240:241], v78 offset:16384
v_mfma_f32_16x16x32_bf16 a[4:7], v[200:203], v[128:131], a[4:7]
s_add_u32 m0, s67, 0
ds_read_b64_tr_b16 v[242:243], v78 offset:17408
v_mfma_f32_16x16x32_bf16 a[8:11], v[208:211], v[128:131], a[8:11]
v_mfma_f32_16x16x32_bf16 a[8:11], v[212:215], v[160:163], a[8:11]
v_mfma_f32_16x16x32_bf16 a[40:43], v[212:215], v[164:167], a[40:43]
buffer_load_dwordx4 v36, s[20:23], s65 offen offset:0 lds
v_mfma_f32_16x16x32_bf16 a[40:43], v[208:211], v[132:135], a[40:43]
ds_read_b64_tr_b16 v[244:245], v78 offset:24576
v_mfma_f32_16x16x32_bf16 a[72:75], v[208:211], v[136:139], a[72:75]
ds_read_b64_tr_b16 v[246:247], v78 offset:25600
v_xor_b32 v78, 0x8000, v78
v_mfma_f32_16x16x32_bf16 a[72:75], v[212:215], v[168:171], a[72:75]
v_mfma_f32_16x16x32_bf16 a[104:107], v[212:215], v[172:175], a[104:107]
buffer_load_dwordx4 v37, s[20:23], s65 offen offset:1024 lds
v_mfma_f32_16x16x32_bf16 a[104:107], v[208:211], v[140:143], a[104:107]
v_mfma_f32_16x16x32_bf16 a[136:139], v[208:211], v[144:147], a[136:139]
buffer_load_dwordx4 v38, s[20:23], s65 offen offset:2048 lds
v_mfma_f32_16x16x32_bf16 a[136:139], v[212:215], v[176:179], a[136:139]
buffer_load_dwordx4 v39, s[20:23], s65 offen offset:3072 lds
v_mfma_f32_16x16x32_bf16 a[168:171], v[212:215], v[180:183], a[168:171]
s_mul_i32 s63, s62, 114688
ds_read_b64_tr_b16 v[248:249], v79 offset:16384
v_mfma_f32_16x16x32_bf16 a[168:171], v[208:211], v[148:151], a[168:171]
s_add_u32 s12, s32, s63
ds_read_b64_tr_b16 v[250:251], v79 offset:17408
v_mfma_f32_16x16x32_bf16 a[200:203], v[208:211], v[152:155], a[200:203]
s_addc_u32 s13, s33, 0
v_mfma_f32_16x16x32_bf16 a[200:203], v[212:215], v[184:187], a[200:203]
s_mov_b32 s14, 114688
v_mfma_f32_16x16x32_bf16 a[232:235], v[212:215], v[188:191], a[232:235]
s_lshl_b32 s63, s61, 9
ds_read_b64_tr_b16 v[252:253], v79 offset:24576
v_mfma_f32_16x16x32_bf16 a[232:235], v[208:211], v[156:159], a[232:235]
s_add_u32 s16, s36, s63
v_mfma_f32_16x16x32_bf16 a[236:239], v[216:219], v[156:159], a[236:239]
s_addc_u32 s17, s37, 0
ds_read_b64_tr_b16 v[254:255], v79 offset:25600
v_xor_b32 v79, 0x8000, v79
v_mfma_f32_16x16x32_bf16 a[236:239], v[220:223], v[188:191], a[236:239]
s_sub_u32 s18, 3670016, s63
v_mfma_f32_16x16x32_bf16 a[204:207], v[220:223], v[184:187], a[204:207]
v_mfma_f32_16x16x32_bf16 a[204:207], v[216:219], v[152:155], a[204:207]
v_mfma_f32_16x16x32_bf16 a[172:175], v[216:219], v[148:151], a[172:175]
v_mfma_f32_16x16x32_bf16 a[172:175], v[220:223], v[180:183], a[172:175]
v_mfma_f32_16x16x32_bf16 a[140:143], v[220:223], v[176:179], a[140:143]
v_mfma_f32_16x16x32_bf16 a[140:143], v[216:219], v[144:147], a[140:143]
v_mfma_f32_16x16x32_bf16 a[108:111], v[216:219], v[140:143], a[108:111]
v_mfma_f32_16x16x32_bf16 a[108:111], v[220:223], v[172:175], a[108:111]
v_mfma_f32_16x16x32_bf16 a[76:79], v[220:223], v[168:171], a[76:79]
v_mfma_f32_16x16x32_bf16 a[76:79], v[216:219], v[136:139], a[76:79]
v_mfma_f32_16x16x32_bf16 a[44:47], v[216:219], v[132:135], a[44:47]
s_add_u32 s74, s74, 32768
v_mfma_f32_16x16x32_bf16 a[44:47], v[220:223], v[164:167], a[44:47]
s_cmp_ge_u32 s74, 98304
v_mfma_f32_16x16x32_bf16 a[12:15], v[220:223], v[160:163], a[12:15]
s_cselect_b32 s74, 0, s74
v_mfma_f32_16x16x32_bf16 a[12:15], v[216:219], v[128:131], a[12:15]
s_waitcnt lgkmcnt(0)
v_mfma_f32_16x16x32_bf16 a[16:19], v[224:227], v[128:131], a[16:19]
s_waitcnt vmcnt(12)
v_add_u32 v17, s74, v16
v_xor_b32 v42, 64, v17
v_mfma_f32_16x16x32_bf16 a[16:19], v[228:231], v[160:163], a[16:19]
s_barrier
v_mfma_f32_16x16x32_bf16 a[48:51], v[228:231], v[164:167], a[48:51]
s_add_u32 m0, s68, 110592
v_mfma_f32_16x16x32_bf16 a[48:51], v[224:227], v[132:135], a[48:51]
s_add_u32 s65, s85, 12288
ds_read_b64_tr_b16 v[192:193], v76 offset:0
v_mfma_f32_16x16x32_bf16 a[80:83], v[224:227], v[136:139], a[80:83]
buffer_load_dwordx4 v1, s[8:11], s65 offen offset:0 sc1 lds
v_mfma_f32_16x16x32_bf16 a[80:83], v[228:231], v[168:171], a[80:83]
s_add_u32 m0, s68, 114688
v_mfma_f32_16x16x32_bf16 a[112:115], v[228:231], v[172:175], a[112:115]
s_add_u32 s65, s85, 16384
ds_read_b64_tr_b16 v[194:195], v76 offset:1024
v_mfma_f32_16x16x32_bf16 a[112:115], v[224:227], v[140:143], a[112:115]
buffer_load_dwordx4 v1, s[8:11], s65 offen offset:0 sc1 lds
v_mfma_f32_16x16x32_bf16 a[144:147], v[224:227], v[144:147], a[144:147]
s_add_u32 m0, s68, 118784
ds_read_b64_tr_b16 v[196:197], v76 offset:8192
v_mfma_f32_16x16x32_bf16 a[144:147], v[228:231], v[176:179], a[144:147]
s_add_u32 s65, s85, 20480
v_mfma_f32_16x16x32_bf16 a[176:179], v[228:231], v[180:183], a[176:179]
buffer_load_dwordx4 v1, s[8:11], s65 offen offset:0 sc1 lds
v_mfma_f32_16x16x32_bf16 a[176:179], v[224:227], v[148:151], a[176:179]
s_mov_b32 s65, 128
ds_read_b64_tr_b16 v[198:199], v76 offset:9216
v_mfma_f32_16x16x32_bf16 a[208:211], v[224:227], v[152:155], a[208:211]
s_add_u32 m0, s67, 16384
v_mfma_f32_16x16x32_bf16 a[208:211], v[228:231], v[184:187], a[208:211]
buffer_load_dwordx4 v36, s[20:23], s65 offen offset:0 lds
v_mfma_f32_16x16x32_bf16 a[240:243], v[228:231], v[188:191], a[240:243]
ds_read_b64_tr_b16 v[200:201], v77 offset:0
v_mfma_f32_16x16x32_bf16 a[240:243], v[224:227], v[156:159], a[240:243]
v_mfma_f32_16x16x32_bf16 a[244:247], v[232:235], v[156:159], a[244:247]
buffer_load_dwordx4 v37, s[20:23], s65 offen offset:1024 lds
v_mfma_f32_16x16x32_bf16 a[244:247], v[236:239], v[188:191], a[244:247]
ds_read_b64_tr_b16 v[202:203], v77 offset:1024
v_mfma_f32_16x16x32_bf16 a[212:215], v[236:239], v[184:187], a[212:215]
v_mfma_f32_16x16x32_bf16 a[212:215], v[232:235], v[152:155], a[212:215]
buffer_load_dwordx4 v38, s[20:23], s65 offen offset:2048 lds
v_mfma_f32_16x16x32_bf16 a[180:183], v[232:235], v[148:151], a[180:183]
ds_read_b64_tr_b16 v[204:205], v77 offset:8192
v_mfma_f32_16x16x32_bf16 a[180:183], v[236:239], v[180:183], a[180:183]
v_mfma_f32_16x16x32_bf16 a[148:151], v[236:239], v[176:179], a[148:151]
ds_read_b64_tr_b16 v[206:207], v77 offset:9216
v_mfma_f32_16x16x32_bf16 a[148:151], v[232:235], v[144:147], a[148:151]
buffer_load_dwordx4 v39, s[20:23], s65 offen offset:3072 lds
v_mfma_f32_16x16x32_bf16 a[116:119], v[232:235], v[140:143], a[116:119]
s_add_u32 m0, s68, 131072
v_mfma_f32_16x16x32_bf16 a[116:119], v[236:239], v[172:175], a[116:119]
s_add_u32 s65, s85, 24576
ds_read_b64_tr_b16 v[208:209], v78 offset:0
v_mfma_f32_16x16x32_bf16 a[84:87], v[236:239], v[168:171], a[84:87]
buffer_load_dwordx4 v1, s[8:11], s65 offen offset:0 sc1 lds
v_mfma_f32_16x16x32_bf16 a[84:87], v[232:235], v[136:139], a[84:87]
s_add_u32 m0, s68, 135168
v_mfma_f32_16x16x32_bf16 a[52:55], v[232:235], v[132:135], a[52:55]
s_add_u32 s65, s85, 28672
ds_read_b64_tr_b16 v[210:211], v78 offset:1024
v_mfma_f32_16x16x32_bf16 a[52:55], v[236:239], v[164:167], a[52:55]
buffer_load_dwordx4 v1, s[8:11], s65 offen offset:0 sc1 lds
v_mfma_f32_16x16x32_bf16 a[20:23], v[236:239], v[160:163], a[20:23]
s_add_u32 m0, s68, 139264
ds_read_b64_tr_b16 v[212:213], v78 offset:8192
v_mfma_f32_16x16x32_bf16 a[20:23], v[232:235], v[128:131], a[20:23]
s_add_u32 s65, s85, 32768
v_mfma_f32_16x16x32_bf16 a[24:27], v[240:243], v[128:131], a[24:27]
v_mfma_f32_16x16x32_bf16 a[24:27], v[244:247], v[160:163], a[24:27]
buffer_load_dwordx4 v1, s[8:11], s65 offen offset:0 sc1 lds
v_mfma_f32_16x16x32_bf16 a[56:59], v[244:247], v[164:167], a[56:59]
s_lshl_b32 s3, s62, 2
ds_read_b64_tr_b16 v[214:215], v78 offset:9216
v_mfma_f32_16x16x32_bf16 a[56:59], v[240:243], v[132:135], a[56:59]
s_add_u32 s3, s3, s60
v_mfma_f32_16x16x32_bf16 a[88:91], v[240:243], v[136:139], a[88:91]
s_mul_i32 s3, s3, 57344
ds_read_b64_tr_b16 v[216:217], v79 offset:0
v_mfma_f32_16x16x32_bf16 a[88:91], v[244:247], v[168:171], a[88:91]
ds_read_b64_tr_b16 v[218:219], v79 offset:1024
v_lshrrev_b32 v18, 7, v1
v_mfma_f32_16x16x32_bf16 a[120:123], v[244:247], v[172:175], a[120:123]
v_mfma_f32_16x16x32_bf16 a[120:123], v[240:243], v[140:143], a[120:123]
ds_read_b64_tr_b16 v[220:221], v79 offset:8192
v_mul_u32_u24 v18, 7680, v18
v_mfma_f32_16x16x32_bf16 a[152:155], v[240:243], v[144:147], a[152:155]
v_mfma_f32_16x16x32_bf16 a[152:155], v[244:247], v[176:179], a[152:155]
v_mfma_f32_16x16x32_bf16 a[184:187], v[244:247], v[180:183], a[184:187]
ds_read_b64_tr_b16 v[222:223], v79 offset:9216
v_lshl_add_u32 v18, v1, 2, v18
v_mfma_f32_16x16x32_bf16 a[184:187], v[240:243], v[148:151], a[184:187]
v_mfma_f32_16x16x32_bf16 a[216:219], v[240:243], v[152:155], a[216:219]
v_mfma_f32_16x16x32_bf16 a[216:219], v[244:247], v[184:187], a[216:219]
v_mfma_f32_16x16x32_bf16 a[248:251], v[244:247], v[188:191], a[248:251]
buffer_load_dword v18, v18, s[16:19], s3 offen
v_mfma_f32_16x16x32_bf16 a[248:251], v[240:243], v[156:159], a[248:251]
v_mfma_f32_16x16x32_bf16 a[28:31], v[248:251], v[128:131], a[28:31]
ds_read_b128 v[128:131], v17 offset:0
v_mfma_f32_16x16x32_bf16 a[28:31], v[252:255], v[160:163], a[28:31]
ds_read_b128 v[160:163], v42 offset:0
v_mfma_f32_16x16x32_bf16 a[60:63], v[252:255], v[164:167], a[60:63]
ds_read_b128 v[164:167], v42 offset:2048
v_mfma_f32_16x16x32_bf16 a[60:63], v[248:251], v[132:135], a[60:63]
ds_read_b128 v[132:135], v17 offset:2048
v_mfma_f32_16x16x32_bf16 a[92:95], v[248:251], v[136:139], a[92:95]
ds_read_b128 v[136:139], v17 offset:4096
v_mfma_f32_16x16x32_bf16 a[92:95], v[252:255], v[168:171], a[92:95]
ds_read_b128 v[168:171], v42 offset:4096
v_mfma_f32_16x16x32_bf16 a[124:127], v[252:255], v[172:175], a[124:127]
ds_read_b128 v[172:175], v42 offset:6144
v_mfma_f32_16x16x32_bf16 a[124:127], v[248:251], v[140:143], a[124:127]
ds_read_b128 v[140:143], v17 offset:6144
v_mfma_f32_16x16x32_bf16 a[156:159], v[248:251], v[144:147], a[156:159]
ds_read_b128 v[144:147], v17 offset:8192
v_mfma_f32_16x16x32_bf16 a[156:159], v[252:255], v[176:179], a[156:159]
ds_read_b128 v[176:179], v42 offset:8192
v_mfma_f32_16x16x32_bf16 a[188:191], v[252:255], v[180:183], a[188:191]
ds_read_b128 v[180:183], v42 offset:10240
v_mfma_f32_16x16x32_bf16 a[188:191], v[248:251], v[148:151], a[188:191]
ds_read_b128 v[148:151], v17 offset:10240
v_mfma_f32_16x16x32_bf16 a[220:223], v[248:251], v[152:155], a[220:223]
ds_read_b128 v[152:155], v17 offset:12288
v_mfma_f32_16x16x32_bf16 a[220:223], v[252:255], v[184:187], a[220:223]
ds_read_b128 v[184:187], v42 offset:12288
v_mfma_f32_16x16x32_bf16 a[252:255], v[252:255], v[188:191], a[252:255]
ds_read_b128 v[188:191], v42 offset:14336
v_mfma_f32_16x16x32_bf16 a[252:255], v[248:251], v[156:159], a[252:255]
s_waitcnt lgkmcnt(6)
ds_read_b128 v[156:159], v17 offset:14336
v_mfma_f32_16x16x32_bf16 a[0:3], v[192:195], v[128:131], a[0:3]
s_waitcnt vmcnt(18)
v_mfma_f32_16x16x32_bf16 a[0:3], v[196:199], v[160:163], a[0:3]
s_barrier
v_mfma_f32_16x16x32_bf16 a[32:35], v[196:199], v[164:167], a[32:35]
s_bfe_u32 s3, s2, 327683
v_mfma_f32_16x16x32_bf16 a[32:35], v[192:195], v[132:135], a[32:35]
s_lshl_b32 s3, s3, 2
v_mfma_f32_16x16x32_bf16 a[64:67], v[192:195], v[136:139], a[64:67]
s_add_u32 s3, s3, s60
v_mfma_f32_16x16x32_bf16 a[64:67], v[196:199], v[168:171], a[64:67]
s_mul_i32 s3, s3, 1024
ds_read_b64_tr_b16 v[224:225], v76 offset:16384
v_mfma_f32_16x16x32_bf16 a[96:99], v[196:199], v[172:175], a[96:99]
ds_read_b64_tr_b16 v[226:227], v76 offset:17408
v_mul_u32_u24 v6, 4, v5
v_mfma_f32_16x16x32_bf16 a[96:99], v[192:195], v[140:143], a[96:99]
v_mfma_f32_16x16x32_bf16 a[128:131], v[192:195], v[144:147], a[128:131]
s_waitcnt lgkmcnt(2)
v_mfma_f32_16x16x32_bf16 a[128:131], v[196:199], v[176:179], a[128:131]
ds_read_b64_tr_b16 v[228:229], v76 offset:24576
v_add_u32 v6, s3, v6
v_mfma_f32_16x16x32_bf16 a[160:163], v[196:199], v[180:183], a[160:163]
v_mfma_f32_16x16x32_bf16 a[160:163], v[192:195], v[148:151], a[160:163]
v_mfma_f32_16x16x32_bf16 a[192:195], v[192:195], v[152:155], a[192:195]
ds_read_b64_tr_b16 v[230:231], v76 offset:25600
v_xor_b32 v76, 0x8000, v76
v_mfma_f32_16x16x32_bf16 a[192:195], v[196:199], v[184:187], a[192:195]
v_mfma_f32_16x16x32_bf16 a[224:227], v[196:199], v[188:191], a[224:227]
global_load_dword v6, v6, s[4:5]
v_mfma_f32_16x16x32_bf16 a[224:227], v[192:195], v[156:159], a[224:227]
s_add_u32 m0, s68, 143360
v_mfma_f32_16x16x32_bf16 a[228:231], v[200:203], v[156:159], a[228:231]
s_add_u32 s65, s85, 36864
v_mfma_f32_16x16x32_bf16 a[228:231], v[204:207], v[188:191], a[228:231]
ds_read_b64_tr_b16 v[232:233], v77 offset:16384
v_mfma_f32_16x16x32_bf16 a[196:199], v[204:207], v[184:187], a[196:199]
v_mfma_f32_16x16x32_bf16 a[196:199], v[200:203], v[152:155], a[196:199]
ds_read_b64_tr_b16 v[234:235], v77 offset:17408
v_mfma_f32_16x16x32_bf16 a[164:167], v[200:203], v[148:151], a[164:167]
buffer_load_dwordx4 v1, s[8:11], s65 offen offset:0 sc1 lds
v_mfma_f32_16x16x32_bf16 a[164:167], v[204:207], v[180:183], a[164:167]
s_add_u32 m0, s68, 147456
v_mfma_f32_16x16x32_bf16 a[132:135], v[204:207], v[176:179], a[132:135]
s_add_u32 s65, s85, 40960
ds_read_b64_tr_b16 v[236:237], v77 offset:24576
v_mfma_f32_16x16x32_bf16 a[132:135], v[200:203], v[144:147], a[132:135]
v_mfma_f32_16x16x32_bf16 a[100:103], v[200:203], v[140:143], a[100:103]
ds_read_b64_tr_b16 v[238:239], v77 offset:25600
v_xor_b32 v77, 0x8000, v77
v_mfma_f32_16x16x32_bf16 a[100:103], v[204:207], v[172:175], a[100:103]
buffer_load_dwordx4 v1, s[8:11], s65 offen offset:0 sc1 lds
v_mfma_f32_16x16x32_bf16 a[68:71], v[204:207], v[168:171], a[68:71]
s_add_u32 m0, s68, 151552
v_mfma_f32_16x16x32_bf16 a[68:71], v[200:203], v[136:139], a[68:71]
s_add_u32 s65, s85, 45056
v_mfma_f32_16x16x32_bf16 a[36:39], v[200:203], v[132:135], a[36:39]
v_mfma_f32_16x16x32_bf16 a[36:39], v[204:207], v[164:167], a[36:39]
ds_read_b64_tr_b16 v[240:241], v78 offset:16384
v_mfma_f32_16x16x32_bf16 a[4:7], v[204:207], v[160:163], a[4:7]
buffer_load_dwordx4 v1, s[8:11], s65 offen offset:0 sc1 lds
v_mfma_f32_16x16x32_bf16 a[4:7], v[200:203], v[128:131], a[4:7]
s_add_u32 m0, s68, 32768
ds_read_b64_tr_b16 v[242:243], v78 offset:17408
v_mfma_f32_16x16x32_bf16 a[8:11], v[208:211], v[128:131], a[8:11]
s_add_u32 s65, s85, 49152
v_mfma_f32_16x16x32_bf16 a[8:11], v[212:215], v[160:163], a[8:11]
v_mfma_f32_16x16x32_bf16 a[40:43], v[212:215], v[164:167], a[40:43]
ds_read_b64_tr_b16 v[244:245], v78 offset:24576
v_mfma_f32_16x16x32_bf16 a[40:43], v[208:211], v[132:135], a[40:43]
v_mfma_f32_16x16x32_bf16 a[72:75], v[208:211], v[136:139], a[72:75]
buffer_load_dwordx4 v1, s[8:11], s65 offen offset:0 sc1 lds
v_mfma_f32_16x16x32_bf16 a[72:75], v[212:215], v[168:171], a[72:75]
s_add_u32 m0, s68, 36864
ds_read_b64_tr_b16 v[246:247], v78 offset:25600
v_xor_b32 v78, 0x8000, v78
v_mfma_f32_16x16x32_bf16 a[104:107], v[212:215], v[172:175], a[104:107]
s_add_u32 s65, s85, 53248
v_mfma_f32_16x16x32_bf16 a[104:107], v[208:211], v[140:143], a[104:107]
v_mfma_f32_16x16x32_bf16 a[136:139], v[208:211], v[144:147], a[136:139]
v_mfma_f32_16x16x32_bf16 a[136:139], v[212:215], v[176:179], a[136:139]
buffer_load_dwordx4 v1, s[8:11], s65 offen offset:0 sc1 lds
v_mfma_f32_16x16x32_bf16 a[168:171], v[212:215], v[180:183], a[168:171]
s_add_u32 m0, s68, 40960
ds_read_b64_tr_b16 v[248:249], v79 offset:16384
v_mfma_f32_16x16x32_bf16 a[168:171], v[208:211], v[148:151], a[168:171]
s_add_u32 s65, s85, 57344
ds_read_b64_tr_b16 v[250:251], v79 offset:17408
v_mfma_f32_16x16x32_bf16 a[200:203], v[208:211], v[152:155], a[200:203]
v_mfma_f32_16x16x32_bf16 a[200:203], v[212:215], v[184:187], a[200:203]
v_mfma_f32_16x16x32_bf16 a[232:235], v[212:215], v[188:191], a[232:235]
buffer_load_dwordx4 v1, s[8:11], s65 offen offset:0 sc1 lds
v_mfma_f32_16x16x32_bf16 a[232:235], v[208:211], v[156:159], a[232:235]
ds_read_b64_tr_b16 v[252:253], v79 offset:24576
v_mfma_f32_16x16x32_bf16 a[236:239], v[216:219], v[156:159], a[236:239]
ds_read_b64_tr_b16 v[254:255], v79 offset:25600
v_xor_b32 v79, 0x8000, v79
v_mfma_f32_16x16x32_bf16 a[236:239], v[220:223], v[188:191], a[236:239]
v_mfma_f32_16x16x32_bf16 a[204:207], v[220:223], v[184:187], a[204:207]
v_mfma_f32_16x16x32_bf16 a[204:207], v[216:219], v[152:155], a[204:207]
v_mfma_f32_16x16x32_bf16 a[172:175], v[216:219], v[148:151], a[172:175]
v_mfma_f32_16x16x32_bf16 a[172:175], v[220:223], v[180:183], a[172:175]
v_mfma_f32_16x16x32_bf16 a[140:143], v[220:223], v[176:179], a[140:143]
v_mfma_f32_16x16x32_bf16 a[140:143], v[216:219], v[144:147], a[140:143]
v_mfma_f32_16x16x32_bf16 a[108:111], v[216:219], v[140:143], a[108:111]
v_mfma_f32_16x16x32_bf16 a[108:111], v[220:223], v[172:175], a[108:111]
v_mfma_f32_16x16x32_bf16 a[76:79], v[220:223], v[168:171], a[76:79]
v_mfma_f32_16x16x32_bf16 a[76:79], v[216:219], v[136:139], a[76:79]
v_mfma_f32_16x16x32_bf16 a[44:47], v[216:219], v[132:135], a[44:47]
s_add_u32 s74, s74, 32768
v_mfma_f32_16x16x32_bf16 a[44:47], v[220:223], v[164:167], a[44:47]
s_cmp_ge_u32 s74, 98304
v_mfma_f32_16x16x32_bf16 a[12:15], v[220:223], v[160:163], a[12:15]
s_cselect_b32 s74, 0, s74
v_mfma_f32_16x16x32_bf16 a[12:15], v[216:219], v[128:131], a[12:15]
s_waitcnt lgkmcnt(0)
v_mfma_f32_16x16x32_bf16 a[16:19], v[224:227], v[128:131], a[16:19]
s_waitcnt vmcnt(18)
v_add_u32 v42, 0, v19
v_xor_b32 v43, 64, v42
v_mfma_f32_16x16x32_bf16 a[16:19], v[228:231], v[160:163], a[16:19]
s_barrier
v_add_u32 v44, 98304, v40
v_add_u32 v45, 98304, v41
v_mfma_f32_16x16x32_bf16 a[48:51], v[228:231], v[164:167], a[48:51]
s_mov_b32 s65, 256
v_mfma_f32_16x16x32_bf16 a[48:51], v[224:227], v[132:135], a[48:51]
s_add_u32 m0, s67, 65536
v_mfma_f32_16x16x32_bf16 a[80:83], v[224:227], v[136:139], a[80:83]
buffer_load_dwordx4 v36, s[20:23], s65 offen offset:0 lds
v_mfma_f32_16x16x32_bf16 a[80:83], v[228:231], v[168:171], a[80:83]
v_mfma_f32_16x16x32_bf16 a[112:115], v[228:231], v[172:175], a[112:115]
v_mfma_f32_16x16x32_bf16 a[112:115], v[224:227], v[140:143], a[112:115]
buffer_load_dwordx4 v37, s[20:23], s65 offen offset:1024 lds
v_mfma_f32_16x16x32_bf16 a[144:147], v[224:227], v[144:147], a[144:147]
v_mfma_f32_16x16x32_bf16 a[144:147], v[228:231], v[176:179], a[144:147]
v_mfma_f32_16x16x32_bf16 a[176:179], v[228:231], v[180:183], a[176:179]
v_mfma_f32_16x16x32_bf16 a[176:179], v[224:227], v[148:151], a[176:179]
buffer_load_dwordx4 v38, s[20:23], s65 offen offset:2048 lds
v_mfma_f32_16x16x32_bf16 a[208:211], v[224:227], v[152:155], a[208:211]
v_mfma_f32_16x16x32_bf16 a[208:211], v[228:231], v[184:187], a[208:211]
v_mfma_f32_16x16x32_bf16 a[240:243], v[228:231], v[188:191], a[240:243]
v_mfma_f32_16x16x32_bf16 a[240:243], v[224:227], v[156:159], a[240:243]
buffer_load_dwordx4 v39, s[20:23], s65 offen offset:3072 lds
v_mfma_f32_16x16x32_bf16 a[244:247], v[232:235], v[156:159], a[244:247]
s_mov_b32 s65, 384
v_mfma_f32_16x16x32_bf16 a[244:247], v[236:239], v[188:191], a[244:247]
s_add_u32 m0, s67, 81920
v_mfma_f32_16x16x32_bf16 a[212:215], v[236:239], v[184:187], a[212:215]
v_mfma_f32_16x16x32_bf16 a[212:215], v[232:235], v[152:155], a[212:215]
buffer_load_dwordx4 v36, s[20:23], s65 offen offset:0 lds
v_mfma_f32_16x16x32_bf16 a[180:183], v[232:235], v[148:151], a[180:183]
v_mfma_f32_16x16x32_bf16 a[180:183], v[236:239], v[180:183], a[180:183]
ds_read_b64_tr_b16 v[112:113], v46 offset:0
v_mfma_f32_16x16x32_bf16 a[148:151], v[236:239], v[176:179], a[148:151]
v_mfma_f32_16x16x32_bf16 a[148:151], v[232:235], v[144:147], a[148:151]
buffer_load_dwordx4 v37, s[20:23], s65 offen offset:1024 lds
v_mfma_f32_16x16x32_bf16 a[116:119], v[232:235], v[140:143], a[116:119]
ds_read_b64_tr_b16 v[114:115], v46 offset:896
v_mfma_f32_16x16x32_bf16 a[116:119], v[236:239], v[172:175], a[116:119]
ds_read_b64_tr_b16 v[116:117], v47 offset:0
v_accvgpr_read_b32 v52, a4
v_mfma_f32_16x16x32_bf16 a[84:87], v[236:239], v[168:171], a[84:87]
ds_read_b64_tr_b16 v[118:119], v47 offset:896
v_accvgpr_read_b32 v53, a5
v_mfma_f32_16x16x32_bf16 a[84:87], v[232:235], v[136:139], a[84:87]
buffer_load_dwordx4 v38, s[20:23], s65 offen offset:2048 lds
v_mfma_f32_16x16x32_bf16 a[52:55], v[232:235], v[132:135], a[52:55]
v_accvgpr_read_b32 v54, a6
v_accvgpr_read_b32 v55, a7
v_mfma_f32_16x16x32_bf16 a[52:55], v[236:239], v[164:167], a[52:55]
ds_read_b128 v[64:67], v42 offset:0
v_accvgpr_read_b32 v48, a0
v_mfma_f32_16x16x32_bf16 a[20:23], v[236:239], v[160:163], a[20:23]
ds_read_b128 v[68:71], v42 offset:2048
v_accvgpr_read_b32 v49, a1
v_mfma_f32_16x16x32_bf16 a[20:23], v[232:235], v[128:131], a[20:23]
buffer_load_dwordx4 v39, s[20:23], s65 offen offset:3072 lds
v_mfma_f32_16x16x32_bf16 a[24:27], v[240:243], v[128:131], a[24:27]
s_mov_b32 s65, 512
v_accvgpr_read_b32 v50, a2
v_accvgpr_read_b32 v51, a3
v_mfma_f32_16x16x32_bf16 a[24:27], v[244:247], v[160:163], a[24:27]
s_add_u32 m0, s67, 49152
ds_read_b64_tr_b16 v[80:81], v44 offset:0
v_cvt_pk_bf16_f32 v48, v48, v49
v_mfma_f32_16x16x32_bf16 a[56:59], v[244:247], v[164:167], a[56:59]
ds_read_b64_tr_b16 v[82:83], v44 offset:256
v_cvt_pk_bf16_f32 v49, v50, v51
v_mfma_f32_16x16x32_bf16 a[56:59], v[240:243], v[132:135], a[56:59]
buffer_load_dwordx4 v36, s[20:23], s65 offen offset:0 lds
v_mfma_f32_16x16x32_bf16 a[88:91], v[240:243], v[136:139], a[88:91]
v_cvt_pk_bf16_f32 v50, v52, v53
v_cvt_pk_bf16_f32 v51, v54, v55
v_mfma_f32_16x16x32_bf16 a[88:91], v[244:247], v[168:171], a[88:91]
buffer_store_dwordx4 v[48:51], v1, s[8:11], s76 offen offset:0 sc1
v_mfma_f32_16x16x32_bf16 a[120:123], v[244:247], v[172:175], a[120:123]
ds_read_b64_tr_b16 v[84:85], v45 offset:0
v_accvgpr_read_b32 v52, a12
v_mfma_f32_16x16x32_bf16 a[120:123], v[240:243], v[140:143], a[120:123]
buffer_load_dwordx4 v37, s[20:23], s65 offen offset:1024 lds
v_mfma_f32_16x16x32_bf16 a[152:155], v[240:243], v[144:147], a[152:155]
ds_read_b64_tr_b16 v[86:87], v45 offset:256
v_accvgpr_read_b32 v53, a13
v_mfma_f32_16x16x32_bf16 a[152:155], v[244:247], v[176:179], a[152:155]
ds_read_b64_tr_b16 v[88:89], v44 offset:4096
v_accvgpr_read_b32 v54, a14
v_mfma_f32_16x16x32_bf16 a[184:187], v[244:247], v[180:183], a[184:187]
v_accvgpr_read_b32 v55, a15
v_accvgpr_read_b32 v48, a8
v_mfma_f32_16x16x32_bf16 a[184:187], v[240:243], v[148:151], a[184:187]
buffer_load_dwordx4 v38, s[20:23], s65 offen offset:2048 lds
v_mfma_f32_16x16x32_bf16 a[216:219], v[240:243], v[152:155], a[216:219]
ds_read_b64_tr_b16 v[90:91], v44 offset:4352
v_accvgpr_read_b32 v49, a9
v_mfma_f32_16x16x32_bf16 a[216:219], v[244:247], v[184:187], a[216:219]
ds_read_b64_tr_b16 v[92:93], v45 offset:4096
v_accvgpr_read_b32 v50, a10
v_mfma_f32_16x16x32_bf16 a[248:251], v[244:247], v[188:191], a[248:251]
v_accvgpr_read_b32 v51, a11
v_cvt_pk_bf16_f32 v48, v48, v49
v_mfma_f32_16x16x32_bf16 a[248:251], v[240:243], v[156:159], a[248:251]
buffer_load_dwordx4 v39, s[20:23], s65 offen offset:3072 lds
v_mfma_f32_16x16x32_bf16 a[28:31], v[248:251], v[128:131], a[28:31]
ds_read_b64_tr_b16 v[94:95], v45 offset:4352
v_cvt_pk_bf16_f32 v49, v50, v51
v_mfma_f32_16x16x32_bf16 a[28:31], v[252:255], v[160:163], a[28:31]
ds_read_b64_tr_b16 v[96:97], v44 offset:8192
v_cvt_pk_bf16_f32 v50, v52, v53
v_mfma_f32_16x16x32_bf16 a[60:63], v[252:255], v[164:167], a[60:63]
ds_read_b64_tr_b16 v[98:99], v44 offset:8448
v_cvt_pk_bf16_f32 v51, v54, v55
v_mfma_f32_16x16x32_bf16 a[60:63], v[248:251], v[132:135], a[60:63]
buffer_store_dwordx4 v[48:51], v1, s[8:11], s76 offen offset:1024 sc1
v_mfma_f32_16x16x32_bf16 a[92:95], v[248:251], v[136:139], a[92:95]
v_accvgpr_read_b32 v52, a20
v_accvgpr_read_b32 v53, a21
v_mfma_f32_16x16x32_bf16 a[92:95], v[252:255], v[168:171], a[92:95]
ds_read_b64_tr_b16 v[100:101], v45 offset:8192
v_accvgpr_read_b32 v54, a22
v_mfma_f32_16x16x32_bf16 a[124:127], v[252:255], v[172:175], a[124:127]
ds_read_b64_tr_b16 v[102:103], v45 offset:8448
v_accvgpr_read_b32 v55, a23
v_mfma_f32_16x16x32_bf16 a[124:127], v[248:251], v[140:143], a[124:127]
v_accvgpr_read_b32 v48, a16
v_accvgpr_read_b32 v49, a17
v_mfma_f32_16x16x32_bf16 a[156:159], v[248:251], v[144:147], a[156:159]
v_mfma_f32_16x16x32_bf16 a[156:159], v[252:255], v[176:179], a[156:159]
v_accvgpr_read_b32 v50, a18
v_accvgpr_read_b32 v51, a19
v_mfma_f32_16x16x32_bf16 a[188:191], v[252:255], v[180:183], a[188:191]
v_mfma_f32_16x16x32_bf16 a[188:191], v[248:251], v[148:151], a[188:191]
v_cvt_pk_bf16_f32 v48, v48, v49
v_cvt_pk_bf16_f32 v49, v50, v51
v_mfma_f32_16x16x32_bf16 a[220:223], v[248:251], v[152:155], a[220:223]
v_mfma_f32_16x16x32_bf16 a[220:223], v[252:255], v[184:187], a[220:223]
v_cvt_pk_bf16_f32 v50, v52, v53
v_cvt_pk_bf16_f32 v51, v54, v55
v_mfma_f32_16x16x32_bf16 a[252:255], v[252:255], v[188:191], a[252:255]
v_mfma_f32_16x16x32_bf16 a[252:255], v[248:251], v[156:159], a[252:255]
buffer_store_dwordx4 v[48:51], v1, s[8:11], s76 offen offset:2048 sc1
KV_END:
s_waitcnt lgkmcnt(5)
v_mfma_f32_16x16x32_bf16 v[128:131], v[80:83], v[64:67], 0
ds_read_b64_tr_b16 v[104:105], v44 offset:2048
v_mfma_f32_16x16x32_bf16 v[136:139], v[80:83], v[68:71], 0
ds_read_b64_tr_b16 v[106:107], v44 offset:2304
v_mfma_f32_16x16x32_bf16 v[132:135], v[84:87], v[64:67], 0
ds_read_b128 v[72:75], v43 offset:0
v_accvgpr_read_b32 v52, a28
v_mfma_f32_16x16x32_bf16 v[140:143], v[84:87], v[68:71], 0
ds_read_b128 v[76:79], v43 offset:2048
v_accvgpr_read_b32 v53, a29
v_mfma_f32_16x16x32_bf16 v[144:147], v[88:91], v[64:67], 0
ds_read_b64_tr_b16 v[108:109], v45 offset:2048
ds_read_b64_tr_b16 v[110:111], v45 offset:2304
v_mfma_f32_16x16x32_bf16 v[152:155], v[88:91], v[68:71], 0
s_waitcnt lgkmcnt(7)
ds_read_b64_tr_b16 v[80:81], v44 offset:6144
ds_read_b64_tr_b16 v[82:83], v44 offset:6400
v_mfma_f32_16x16x32_bf16 v[148:151], v[92:95], v[64:67], 0
ds_read_b64_tr_b16 v[84:85], v45 offset:6144
ds_read_b64_tr_b16 v[86:87], v45 offset:6400
v_mfma_f32_16x16x32_bf16 v[156:159], v[92:95], v[68:71], 0
ds_read_b64_tr_b16 v[88:89], v44 offset:10240
ds_read_b64_tr_b16 v[90:91], v44 offset:10496
v_mfma_f32_16x16x32_bf16 v[160:163], v[64:67], v[96:99], 0
ds_read_b64_tr_b16 v[92:93], v45 offset:10240
ds_read_b64_tr_b16 v[94:95], v45 offset:10496
v_mfma_f32_16x16x32_bf16 v[164:167], v[68:71], v[96:99], 0
s_waitcnt lgkmcnt(11)
v_accvgpr_read_b32 v54, a30
v_accvgpr_read_b32 v55, a31
v_mfma_f32_16x16x32_bf16 v[168:171], v[64:67], v[100:103], 0
v_add_u32 v42, 16384, v19
v_xor_b32 v43, 64, v42
v_mfma_f32_16x16x32_bf16 v[172:175], v[68:71], v[100:103], 0
s_waitcnt vmcnt(26) lgkmcnt(0)
v_add_u32 v44, 110592, v40
v_add_u32 v45, 110592, v41
v_mfma_f32_16x16x32_bf16 v[128:131], v[104:107], v[72:75], v[128:131]
s_barrier
v_accvgpr_read_b32 v48, a24
v_accvgpr_read_b32 v49, a25
v_mfma_f32_16x16x32_bf16 v[136:139], v[104:107], v[76:79], v[136:139]
s_add_u32 m0, s68, 98304
ds_read_b64_tr_b16 v[96:97], v44 offset:0
v_accvgpr_read_b32 v50, a26
v_mfma_f32_16x16x32_bf16 v[132:135], v[108:111], v[72:75], v[132:135]
s_add_u32 s65, s85, 61440
ds_read_b64_tr_b16 v[98:99], v44 offset:256
v_accvgpr_read_b32 v51, a27
v_mfma_f32_16x16x32_bf16 v[140:143], v[108:111], v[76:79], v[140:143]
ds_read_b128 v[64:67], v42 offset:0
ds_read_b128 v[68:71], v42 offset:2048
v_mfma_f32_16x16x32_bf16 v[144:147], v[80:83], v[72:75], v[144:147]
buffer_load_dwordx4 v1, s[8:11], s65 offen offset:0 sc1 lds
v_mfma_f32_16x16x32_bf16 v[152:155], v[80:83], v[76:79], v[152:155]
s_add_u32 m0, s68, 102400
ds_read_b64_tr_b16 v[100:101], v45 offset:0
ds_read_b64_tr_b16 v[102:103], v45 offset:256
v_mfma_f32_16x16x32_bf16 v[148:151], v[84:87], v[72:75], v[148:151]
s_add_u32 s65, s85, 65536
v_cvt_pk_bf16_f32 v48, v48, v49
v_cvt_pk_bf16_f32 v49, v50, v51
v_mfma_f32_16x16x32_bf16 v[156:159], v[84:87], v[76:79], v[156:159]
ds_read_b64_tr_b16 v[104:105], v44 offset:4096
ds_read_b64_tr_b16 v[106:107], v44 offset:4352
v_mfma_f32_16x16x32_bf16 v[160:163], v[72:75], v[88:91], v[160:163]
buffer_load_dwordx4 v1, s[8:11], s65 offen offset:0 sc1 lds
v_mfma_f32_16x16x32_bf16 v[164:167], v[76:79], v[88:91], v[164:167]
s_add_u32 m0, s68, 106496
ds_read_b64_tr_b16 v[108:109], v45 offset:4096
ds_read_b64_tr_b16 v[110:111], v45 offset:4352
v_mfma_f32_16x16x32_bf16 v[168:171], v[72:75], v[92:95], v[168:171]
s_add_u32 s65, s85, 69632
ds_read_b64_tr_b16 v[80:81], v44 offset:8192
ds_read_b64_tr_b16 v[82:83], v44 offset:8448
v_mfma_f32_16x16x32_bf16 v[172:175], v[76:79], v[92:95], v[172:175]
s_waitcnt lgkmcnt(8)
ds_read_b64_tr_b16 v[84:85], v45 offset:8192
ds_read_b64_tr_b16 v[86:87], v45 offset:8448
v_mfma_f32_16x16x32_bf16 v[128:131], v[96:99], v[64:67], v[128:131]
v_cvt_pk_bf16_f32 v50, v52, v53
v_cvt_pk_bf16_f32 v51, v54, v55
v_mfma_f32_16x16x32_bf16 v[136:139], v[96:99], v[68:71], v[136:139]
s_waitcnt lgkmcnt(8)
buffer_load_dwordx4 v1, s[8:11], s65 offen offset:0 sc1 lds
v_mfma_f32_16x16x32_bf16 v[132:135], v[100:103], v[64:67], v[132:135]
s_mov_b32 s65, 640
ds_read_b64_tr_b16 v[88:89], v44 offset:2048
ds_read_b64_tr_b16 v[90:91], v44 offset:2304
v_mfma_f32_16x16x32_bf16 v[140:143], v[100:103], v[68:71], v[140:143]
s_waitcnt lgkmcnt(8)
s_add_u32 m0, s67, 0
ds_read_b128 v[72:75], v43 offset:0
ds_read_b128 v[76:79], v43 offset:2048
v_mfma_f32_16x16x32_bf16 v[144:147], v[104:107], v[64:67], v[144:147]
ds_read_b64_tr_b16 v[92:93], v45 offset:2048
ds_read_b64_tr_b16 v[94:95], v45 offset:2304
v_mfma_f32_16x16x32_bf16 v[152:155], v[104:107], v[68:71], v[152:155]
s_waitcnt lgkmcnt(8)
ds_read_b64_tr_b16 v[96:97], v44 offset:6144
ds_read_b64_tr_b16 v[98:99], v44 offset:6400
v_mfma_f32_16x16x32_bf16 v[148:151], v[108:111], v[64:67], v[148:151]
buffer_load_dwordx4 v36, s[20:23], s65 offen offset:0 lds
ds_read_b64_tr_b16 v[100:101], v45 offset:6144
ds_read_b64_tr_b16 v[102:103], v45 offset:6400
v_mfma_f32_16x16x32_bf16 v[156:159], v[108:111], v[68:71], v[156:159]
buffer_load_dwordx4 v37, s[20:23], s65 offen offset:1024 lds
ds_read_b64_tr_b16 v[104:105], v44 offset:10240
ds_read_b64_tr_b16 v[106:107], v44 offset:10496
v_mfma_f32_16x16x32_bf16 v[160:163], v[64:67], v[80:83], v[160:163]
buffer_load_dwordx4 v38, s[20:23], s65 offen offset:2048 lds
ds_read_b64_tr_b16 v[108:109], v45 offset:10240
ds_read_b64_tr_b16 v[110:111], v45 offset:10496
v_mfma_f32_16x16x32_bf16 v[164:167], v[68:71], v[80:83], v[164:167]
s_waitcnt lgkmcnt(12)
buffer_load_dwordx4 v39, s[20:23], s65 offen offset:3072 lds
v_mfma_f32_16x16x32_bf16 v[168:171], v[64:67], v[84:87], v[168:171]
v_add_u32 v42, 65536, v19
v_xor_b32 v43, 64, v42
v_mfma_f32_16x16x32_bf16 v[172:175], v[68:71], v[84:87], v[172:175]
s_waitcnt vmcnt(18) lgkmcnt(0)
v_add_u32 v44, 131072, v40
v_add_u32 v45, 131072, v41
v_mfma_f32_16x16x32_bf16 v[128:131], v[88:91], v[72:75], v[128:131]
s_barrier
buffer_store_dwordx4 v[48:51], v1, s[8:11], s76 offen offset:3072 sc1
v_mfma_f32_16x16x32_bf16 v[136:139], v[88:91], v[76:79], v[136:139]
s_add_u32 s76, s76, s77
s_add_u32 m0, s68, 110592
ds_read_b64_tr_b16 v[80:81], v44 offset:0
v_mfma_f32_16x16x32_bf16 v[132:135], v[92:95], v[72:75], v[132:135]
s_add_u32 s65, s85, 73728
ds_read_b64_tr_b16 v[82:83], v44 offset:256
v_accvgpr_read_b32 v52, a36
v_mfma_f32_16x16x32_bf16 v[140:143], v[92:95], v[76:79], v[140:143]
ds_read_b128 v[64:67], v42 offset:0
ds_read_b128 v[68:71], v42 offset:2048
v_mfma_f32_16x16x32_bf16 v[144:147], v[96:99], v[72:75], v[144:147]
v_accvgpr_read_b32 v53, a37
v_accvgpr_read_b32 v54, a38
v_mfma_f32_16x16x32_bf16 v[152:155], v[96:99], v[76:79], v[152:155]
ds_read_b64_tr_b16 v[84:85], v45 offset:0
ds_read_b64_tr_b16 v[86:87], v45 offset:256
v_mfma_f32_16x16x32_bf16 v[148:151], v[100:103], v[72:75], v[148:151]
v_accvgpr_read_b32 v55, a39
v_accvgpr_read_b32 v48, a32
v_mfma_f32_16x16x32_bf16 v[156:159], v[100:103], v[76:79], v[156:159]
ds_read_b64_tr_b16 v[88:89], v44 offset:4096
ds_read_b64_tr_b16 v[90:91], v44 offset:4352
v_mfma_f32_16x16x32_bf16 v[160:163], v[72:75], v[104:107], v[160:163]
v_accvgpr_read_b32 v49, a33
v_accvgpr_read_b32 v50, a34
v_mfma_f32_16x16x32_bf16 v[164:167], v[76:79], v[104:107], v[164:167]
buffer_load_dwordx4 v1, s[8:11], s65 offen offset:0 sc1 lds
ds_read_b64_tr_b16 v[92:93], v45 offset:4096
ds_read_b64_tr_b16 v[94:95], v45 offset:4352
v_mfma_f32_16x16x32_bf16 v[168:171], v[72:75], v[108:111], v[168:171]
s_add_u32 m0, s68, 114688
ds_read_b64_tr_b16 v[96:97], v44 offset:8192
ds_read_b64_tr_b16 v[98:99], v44 offset:8448
v_mfma_f32_16x16x32_bf16 v[172:175], v[76:79], v[108:111], v[172:175]
s_waitcnt lgkmcnt(8)
s_add_u32 s65, s85, 77824
ds_read_b64_tr_b16 v[100:101], v45 offset:8192
ds_read_b64_tr_b16 v[102:103], v45 offset:8448
v_mfma_f32_16x16x32_bf16 v[128:131], v[80:83], v[64:67], v[128:131]
buffer_load_dwordx4 v1, s[8:11], s65 offen offset:0 sc1 lds
v_mfma_f32_16x16x32_bf16 v[136:139], v[80:83], v[68:71], v[136:139]
s_waitcnt lgkmcnt(8)
s_add_u32 m0, s68, 118784
v_accvgpr_read_b32 v51, a35
v_cvt_pk_bf16_f32 v48, v48, v49
v_mfma_f32_16x16x32_bf16 v[132:135], v[84:87], v[64:67], v[132:135]
s_add_u32 s65, s85, 81920
ds_read_b64_tr_b16 v[104:105], v44 offset:2048
ds_read_b64_tr_b16 v[106:107], v44 offset:2304
v_mfma_f32_16x16x32_bf16 v[140:143], v[84:87], v[68:71], v[140:143]
s_waitcnt lgkmcnt(8)
buffer_load_dwordx4 v1, s[8:11], s65 offen offset:0 sc1 lds
ds_read_b128 v[72:75], v43 offset:0
ds_read_b128 v[76:79], v43 offset:2048
v_mfma_f32_16x16x32_bf16 v[144:147], v[88:91], v[64:67], v[144:147]
s_mov_b32 s65, 768
ds_read_b64_tr_b16 v[108:109], v45 offset:2048
ds_read_b64_tr_b16 v[110:111], v45 offset:2304
v_mfma_f32_16x16x32_bf16 v[152:155], v[88:91], v[68:71], v[152:155]
s_waitcnt lgkmcnt(8)
s_add_u32 m0, s67, 16384
ds_read_b64_tr_b16 v[80:81], v44 offset:6144
ds_read_b64_tr_b16 v[82:83], v44 offset:6400
v_mfma_f32_16x16x32_bf16 v[148:151], v[92:95], v[64:67], v[148:151]
buffer_load_dwordx4 v36, s[20:23], s65 offen offset:0 lds
ds_read_b64_tr_b16 v[84:85], v45 offset:6144
ds_read_b64_tr_b16 v[86:87], v45 offset:6400
v_mfma_f32_16x16x32_bf16 v[156:159], v[92:95], v[68:71], v[156:159]
buffer_load_dwordx4 v37, s[20:23], s65 offen offset:1024 lds
ds_read_b64_tr_b16 v[88:89], v44 offset:10240
ds_read_b64_tr_b16 v[90:91], v44 offset:10496
v_mfma_f32_16x16x32_bf16 v[160:163], v[64:67], v[96:99], v[160:163]
buffer_load_dwordx4 v38, s[20:23], s65 offen offset:2048 lds
ds_read_b64_tr_b16 v[92:93], v45 offset:10240
ds_read_b64_tr_b16 v[94:95], v45 offset:10496
v_mfma_f32_16x16x32_bf16 v[164:167], v[68:71], v[96:99], v[164:167]
s_waitcnt lgkmcnt(12)
buffer_load_dwordx4 v39, s[20:23], s65 offen offset:3072 lds
v_mfma_f32_16x16x32_bf16 v[168:171], v[64:67], v[100:103], v[168:171]
v_add_u32 v42, 81920, v19
v_xor_b32 v43, 64, v42
v_mfma_f32_16x16x32_bf16 v[172:175], v[68:71], v[100:103], v[172:175]
s_waitcnt lgkmcnt(8)
s_waitcnt vmcnt(22)
v_add_u32 v44, 143360, v40
v_add_u32 v45, 143360, v41
v_mfma_f32_16x16x32_bf16 v[128:131], v[104:107], v[72:75], v[128:131]
s_barrier
v_cvt_pk_bf16_f32 v49, v50, v51
v_cvt_pk_bf16_f32 v50, v52, v53
v_mfma_f32_16x16x32_bf16 v[136:139], v[104:107], v[76:79], v[136:139]
ds_read_b64_tr_b16 v[96:97], v44 offset:0
v_cvt_pk_bf16_f32 v51, v54, v55
v_mfma_f32_16x16x32_bf16 v[132:135], v[108:111], v[72:75], v[132:135]
ds_read_b64_tr_b16 v[98:99], v44 offset:256
ds_read_b128 v[64:67], v42 offset:0
v_mfma_f32_16x16x32_bf16 v[140:143], v[108:111], v[76:79], v[140:143]
s_waitcnt lgkmcnt(3)
ds_read_b128 v[68:71], v42 offset:2048
v_mfma_f32_16x16x32_bf16 v[144:147], v[80:83], v[72:75], v[144:147]
buffer_store_dwordx4 v[48:51], v1, s[8:11], s76 offen offset:0 sc1
v_mfma_f32_16x16x32_bf16 v[152:155], v[80:83], v[76:79], v[152:155]
ds_read_b64_tr_b16 v[100:101], v45 offset:0
ds_read_b64_tr_b16 v[102:103], v45 offset:256
v_mfma_f32_16x16x32_bf16 v[148:151], v[84:87], v[72:75], v[148:151]
v_accvgpr_read_b32 v52, a44
v_accvgpr_read_b32 v53, a45
v_mfma_f32_16x16x32_bf16 v[156:159], v[84:87], v[76:79], v[156:159]
ds_read_b64_tr_b16 v[104:105], v44 offset:4096
ds_read_b64_tr_b16 v[106:107], v44 offset:4352
v_mfma_f32_16x16x32_bf16 v[160:163], v[72:75], v[88:91], v[160:163]
v_accvgpr_read_b32 v54, a46
v_accvgpr_read_b32 v55, a47
v_mfma_f32_16x16x32_bf16 v[164:167], v[76:79], v[88:91], v[164:167]
ds_read_b64_tr_b16 v[108:109], v45 offset:4096
ds_read_b64_tr_b16 v[110:111], v45 offset:4352
v_mfma_f32_16x16x32_bf16 v[168:171], v[72:75], v[92:95], v[168:171]
ds_read_b64_tr_b16 v[80:81], v44 offset:8192
ds_read_b64_tr_b16 v[82:83], v44 offset:8448
v_mfma_f32_16x16x32_bf16 v[172:175], v[76:79], v[92:95], v[172:175]
s_waitcnt lgkmcnt(8)
ds_read_b64_tr_b16 v[84:85], v45 offset:8192
ds_read_b64_tr_b16 v[86:87], v45 offset:8448
v_accvgpr_read_b32 v48, a40
v_mfma_f32_16x16x32_bf16 v[128:131], v[96:99], v[64:67], v[128:131]
v_accvgpr_read_b32 v49, a41
v_accvgpr_read_b32 v50, a42
v_mfma_f32_16x16x32_bf16 v[136:139], v[96:99], v[68:71], v[136:139]
s_waitcnt lgkmcnt(8)
v_accvgpr_read_b32 v51, a43
v_cvt_pk_bf16_f32 v48, v48, v49
v_mfma_f32_16x16x32_bf16 v[132:135], v[100:103], v[64:67], v[132:135]
ds_read_b64_tr_b16 v[88:89], v44 offset:2048
ds_read_b64_tr_b16 v[90:91], v44 offset:2304
v_cvt_pk_bf16_f32 v49, v50, v51
v_cvt_pk_bf16_f32 v50, v52, v53
v_mfma_f32_16x16x32_bf16 v[140:143], v[100:103], v[68:71], v[140:143]
s_waitcnt lgkmcnt(8)
ds_read_b128 v[72:75], v43 offset:0
ds_read_b128 v[76:79], v43 offset:2048
v_cvt_pk_bf16_f32 v51, v54, v55
v_mfma_f32_16x16x32_bf16 v[144:147], v[104:107], v[64:67], v[144:147]
buffer_store_dwordx4 v[48:51], v1, s[8:11], s76 offen offset:1024 sc1
ds_read_b64_tr_b16 v[92:93], v45 offset:2048
ds_read_b64_tr_b16 v[94:95], v45 offset:2304
v_mfma_f32_16x16x32_bf16 v[152:155], v[104:107], v[68:71], v[152:155]
s_waitcnt lgkmcnt(8)
ds_read_b64_tr_b16 v[96:97], v44 offset:6144
ds_read_b64_tr_b16 v[98:99], v44 offset:6400
v_accvgpr_read_b32 v52, a52
v_accvgpr_read_b32 v53, a53
v_mfma_f32_16x16x32_bf16 v[148:151], v[108:111], v[64:67], v[148:151]
ds_read_b64_tr_b16 v[100:101], v45 offset:6144
ds_read_b64_tr_b16 v[102:103], v45 offset:6400
v_accvgpr_read_b32 v54, a54
v_accvgpr_read_b32 v55, a55
v_mfma_f32_16x16x32_bf16 v[156:159], v[108:111], v[68:71], v[156:159]
ds_read_b64_tr_b16 v[104:105], v44 offset:10240
ds_read_b64_tr_b16 v[106:107], v44 offset:10496
v_accvgpr_read_b32 v48, a48
v_accvgpr_read_b32 v49, a49
v_mfma_f32_16x16x32_bf16 v[160:163], v[64:67], v[80:83], v[160:163]
ds_read_b64_tr_b16 v[108:109], v45 offset:10240
ds_read_b64_tr_b16 v[110:111], v45 offset:10496
v_accvgpr_read_b32 v50, a50
v_accvgpr_read_b32 v51, a51
v_mfma_f32_16x16x32_bf16 v[164:167], v[68:71], v[80:83], v[164:167]
s_waitcnt lgkmcnt(12)
v_cvt_pk_bf16_f32 v48, v48, v49
v_cvt_pk_bf16_f32 v49, v50, v51
v_mfma_f32_16x16x32_bf16 v[168:171], v[64:67], v[84:87], v[168:171]
v_add_u32 v42, 49152, v19
v_xor_b32 v43, 64, v42
v_cvt_pk_bf16_f32 v50, v52, v53
v_cvt_pk_bf16_f32 v51, v54, v55
v_mfma_f32_16x16x32_bf16 v[172:175], v[68:71], v[84:87], v[172:175]
s_waitcnt vmcnt(19) lgkmcnt(0)
buffer_store_dwordx4 v[48:51], v1, s[8:11], s76 offen offset:2048 sc1
v_add_u32 v44, 32768, v40
v_add_u32 v45, 32768, v41
v_mfma_f32_16x16x32_bf16 v[128:131], v[88:91], v[72:75], v[128:131]
s_barrier
ds_read_b64_tr_b16 v[80:81], v44 offset:0
v_mfma_f32_16x16x32_bf16 v[136:139], v[88:91], v[76:79], v[136:139]
s_mov_b32 s65, 0
ds_read_b64_tr_b16 v[82:83], v44 offset:256
v_mfma_f32_16x16x32_bf16 v[132:135], v[92:95], v[72:75], v[132:135]
s_add_u32 m0, s67, 65536
ds_read_b128 v[64:67], v42 offset:0
v_mfma_f32_16x16x32_bf16 v[140:143], v[92:95], v[76:79], v[140:143]
ds_read_b128 v[68:71], v42 offset:2048
v_mfma_f32_16x16x32_bf16 v[144:147], v[96:99], v[72:75], v[144:147]
buffer_load_dwordx4 v24, s[16:19], s65 offen offset:0 lds
v_mfma_f32_16x16x32_bf16 v[152:155], v[96:99], v[76:79], v[152:155]
ds_read_b64_tr_b16 v[84:85], v45 offset:0
ds_read_b64_tr_b16 v[86:87], v45 offset:256
v_mfma_f32_16x16x32_bf16 v[148:151], v[100:103], v[72:75], v[148:151]
buffer_load_dwordx4 v25, s[16:19], s65 offen offset:1024 lds
v_mfma_f32_16x16x32_bf16 v[156:159], v[100:103], v[76:79], v[156:159]
ds_read_b64_tr_b16 v[88:89], v44 offset:4096
ds_read_b64_tr_b16 v[90:91], v44 offset:4352
v_mfma_f32_16x16x32_bf16 v[160:163], v[72:75], v[104:107], v[160:163]
ds_read_b64_tr_b16 v[92:93], v45 offset:4096
ds_read_b64_tr_b16 v[94:95], v45 offset:4352
v_mfma_f32_16x16x32_bf16 v[164:167], v[76:79], v[104:107], v[164:167]
buffer_load_dwordx4 v26, s[16:19], s65 offen offset:2048 lds
v_mfma_f32_16x16x32_bf16 v[168:171], v[72:75], v[108:111], v[168:171]
ds_read_b64_tr_b16 v[96:97], v44 offset:8192
ds_read_b64_tr_b16 v[98:99], v44 offset:8448
v_mfma_f32_16x16x32_bf16 v[172:175], v[76:79], v[108:111], v[172:175]
s_waitcnt lgkmcnt(8)
ds_read_b64_tr_b16 v[100:101], v45 offset:8192
ds_read_b64_tr_b16 v[102:103], v45 offset:8448
v_mfma_f32_16x16x32_bf16 v[128:131], v[80:83], v[64:67], v[128:131]
buffer_load_dwordx4 v27, s[16:19], s65 offen offset:3072 lds
v_mfma_f32_16x16x32_bf16 v[136:139], v[80:83], v[68:71], v[136:139]
s_waitcnt lgkmcnt(8)
s_mov_b32 s65, 262144
ds_read_b64_tr_b16 v[104:105], v44 offset:2048
ds_read_b64_tr_b16 v[106:107], v44 offset:2304
v_mfma_f32_16x16x32_bf16 v[132:135], v[84:87], v[64:67], v[132:135]
s_add_u32 m0, s67, 81920
ds_read_b128 v[72:75], v43 offset:0
v_mfma_f32_16x16x32_bf16 v[140:143], v[84:87], v[68:71], v[140:143]
s_waitcnt lgkmcnt(7)
ds_read_b128 v[76:79], v43 offset:2048
ds_read_b64_tr_b16 v[108:109], v45 offset:2048
v_mfma_f32_16x16x32_bf16 v[144:147], v[88:91], v[64:67], v[144:147]
ds_read_b64_tr_b16 v[110:111], v45 offset:2304
v_mfma_f32_16x16x32_bf16 v[152:155], v[88:91], v[68:71], v[152:155]
ds_read_b64_tr_b16 v[80:81], v44 offset:6144
ds_read_b64_tr_b16 v[82:83], v44 offset:6400
v_mfma_f32_16x16x32_bf16 v[148:151], v[92:95], v[64:67], v[148:151]
ds_read_b64_tr_b16 v[84:85], v45 offset:6144
ds_read_b64_tr_b16 v[86:87], v45 offset:6400
v_mfma_f32_16x16x32_bf16 v[156:159], v[92:95], v[68:71], v[156:159]
s_waitcnt lgkmcnt(10)
ds_read_b64_tr_b16 v[88:89], v44 offset:10240
ds_read_b64_tr_b16 v[90:91], v44 offset:10496
v_mfma_f32_16x16x32_bf16 v[160:163], v[64:67], v[96:99], v[160:163]
ds_read_b64_tr_b16 v[92:93], v45 offset:10240
ds_read_b64_tr_b16 v[94:95], v45 offset:10496
v_mfma_f32_16x16x32_bf16 v[164:167], v[68:71], v[96:99], v[164:167]
buffer_load_dwordx4 v24, s[16:19], s65 offen offset:0 lds
v_mfma_f32_16x16x32_bf16 v[168:171], v[64:67], v[100:103], v[168:171]
v_add_u32 v42, 0, v19
v_xor_b32 v43, 64, v42
v_mfma_f32_16x16x32_bf16 v[172:175], v[68:71], v[100:103], v[172:175]
s_waitcnt vmcnt(16) lgkmcnt(0)
v_add_u32 v44, 98304, v40
v_add_u32 v45, 98304, v41
v_mfma_f32_16x16x32_bf16 v[128:131], v[104:107], v[72:75], v[128:131]
s_barrier
buffer_load_dwordx4 v25, s[16:19], s65 offen offset:1024 lds
v_mfma_f32_16x16x32_bf16 v[136:139], v[104:107], v[76:79], v[136:139]
buffer_load_dwordx4 v26, s[16:19], s65 offen offset:2048 lds
v_mfma_f32_16x16x32_bf16 v[132:135], v[108:111], v[72:75], v[132:135]
ds_read_b64_tr_b16 v[96:97], v44 offset:0
ds_read_b64_tr_b16 v[98:99], v44 offset:256
v_mfma_f32_16x16x32_bf16 v[140:143], v[108:111], v[76:79], v[140:143]
ds_read_b128 v[64:67], v42 offset:0
ds_read_b128 v[68:71], v42 offset:2048
v_mfma_f32_16x16x32_bf16 v[144:147], v[80:83], v[72:75], v[144:147]
buffer_load_dwordx4 v27, s[16:19], s65 offen offset:3072 lds
v_mfma_f32_16x16x32_bf16 v[152:155], v[80:83], v[76:79], v[152:155]
s_mov_b32 s65, 0
ds_read_b64_tr_b16 v[100:101], v45 offset:0
ds_read_b64_tr_b16 v[102:103], v45 offset:256
v_mfma_f32_16x16x32_bf16 v[148:151], v[84:87], v[72:75], v[148:151]
s_add_u32 m0, s67, 131072
ds_read_b64_tr_b16 v[104:105], v44 offset:4096
v_mfma_f32_16x16x32_bf16 v[156:159], v[84:87], v[76:79], v[156:159]
ds_read_b64_tr_b16 v[106:107], v44 offset:4352
v_mfma_f32_16x16x32_bf16 v[160:163], v[72:75], v[88:91], v[160:163]
buffer_load_dwordx4 v36, s[12:15], s65 offen offset:0 lds
v_mfma_f32_16x16x32_bf16 v[164:167], v[76:79], v[88:91], v[164:167]
ds_read_b64_tr_b16 v[108:109], v45 offset:4096
ds_read_b64_tr_b16 v[110:111], v45 offset:4352
v_mfma_f32_16x16x32_bf16 v[168:171], v[72:75], v[92:95], v[168:171]
ds_read_b64_tr_b16 v[80:81], v44 offset:8192
ds_read_b64_tr_b16 v[82:83], v44 offset:8448
v_mfma_f32_16x16x32_bf16 v[172:175], v[76:79], v[92:95], v[172:175]
s_waitcnt lgkmcnt(8)
ds_read_b64_tr_b16 v[84:85], v45 offset:8192
ds_read_b64_tr_b16 v[86:87], v45 offset:8448
v_mfma_f32_16x16x32_bf16 v[128:131], v[96:99], v[64:67], v[128:131]
buffer_load_dwordx4 v37, s[12:15], s65 offen offset:1024 lds
v_mfma_f32_16x16x32_bf16 v[136:139], v[96:99], v[68:71], v[136:139]
s_waitcnt lgkmcnt(7)
buffer_load_dwordx4 v38, s[12:15], s65 offen offset:2048 lds
v_mfma_f32_16x16x32_bf16 v[132:135], v[100:103], v[64:67], v[132:135]
ds_read_b64_tr_b16 v[88:89], v44 offset:2048
ds_read_b64_tr_b16 v[90:91], v44 offset:2304
v_mfma_f32_16x16x32_bf16 v[140:143], v[100:103], v[68:71], v[140:143]
s_waitcnt lgkmcnt(8)
ds_read_b128 v[72:75], v43 offset:0
ds_read_b128 v[76:79], v43 offset:2048
v_mfma_f32_16x16x32_bf16 v[144:147], v[104:107], v[64:67], v[144:147]
ds_read_b64_tr_b16 v[92:93], v45 offset:2048
ds_read_b64_tr_b16 v[94:95], v45 offset:2304
v_mfma_f32_16x16x32_bf16 v[152:155], v[104:107], v[68:71], v[152:155]
s_waitcnt lgkmcnt(8)
buffer_load_dwordx4 v39, s[12:15], s65 offen offset:3072 lds
ds_read_b64_tr_b16 v[96:97], v44 offset:6144
ds_read_b64_tr_b16 v[98:99], v44 offset:6400
v_mfma_f32_16x16x32_bf16 v[148:151], v[108:111], v[64:67], v[148:151]
s_mov_b32 s65, 524288
ds_read_b64_tr_b16 v[100:101], v45 offset:6144
ds_read_b64_tr_b16 v[102:103], v45 offset:6400
v_mfma_f32_16x16x32_bf16 v[156:159], v[108:111], v[68:71], v[156:159]
s_add_u32 m0, s67, 32768
ds_read_b64_tr_b16 v[104:105], v44 offset:10240
ds_read_b64_tr_b16 v[106:107], v44 offset:10496
v_mfma_f32_16x16x32_bf16 v[160:163], v[64:67], v[80:83], v[160:163]
ds_read_b64_tr_b16 v[108:109], v45 offset:10240
ds_read_b64_tr_b16 v[110:111], v45 offset:10496
v_mfma_f32_16x16x32_bf16 v[164:167], v[68:71], v[80:83], v[164:167]
s_waitcnt lgkmcnt(12)
buffer_load_dwordx4 v24, s[16:19], s65 offen offset:0 lds
v_mfma_f32_16x16x32_bf16 v[168:171], v[64:67], v[84:87], v[168:171]
v_add_u32 v42, 16384, v19
v_xor_b32 v43, 64, v42
v_mfma_f32_16x16x32_bf16 v[172:175], v[68:71], v[84:87], v[172:175]
s_waitcnt lgkmcnt(8)
s_waitcnt vmcnt(16)
v_add_u32 v44, 110592, v40
v_add_u32 v45, 110592, v41
v_mfma_f32_16x16x32_bf16 v[128:131], v[88:91], v[72:75], v[128:131]
s_barrier
buffer_load_dwordx4 v25, s[16:19], s65 offen offset:1024 lds
v_mfma_f32_16x16x32_bf16 v[136:139], v[88:91], v[76:79], v[136:139]
ds_read_b64_tr_b16 v[80:81], v44 offset:0
v_mfma_f32_16x16x32_bf16 v[132:135], v[92:95], v[72:75], v[132:135]
ds_read_b64_tr_b16 v[82:83], v44 offset:256
ds_read_b128 v[64:67], v42 offset:0
v_mfma_f32_16x16x32_bf16 v[140:143], v[92:95], v[76:79], v[140:143]
s_waitcnt lgkmcnt(3)
ds_read_b128 v[68:71], v42 offset:2048
v_mfma_f32_16x16x32_bf16 v[144:147], v[96:99], v[72:75], v[144:147]
buffer_load_dwordx4 v26, s[16:19], s65 offen offset:2048 lds
v_mfma_f32_16x16x32_bf16 v[152:155], v[96:99], v[76:79], v[152:155]
ds_read_b64_tr_b16 v[84:85], v45 offset:0
ds_read_b64_tr_b16 v[86:87], v45 offset:256
v_mfma_f32_16x16x32_bf16 v[148:151], v[100:103], v[72:75], v[148:151]
buffer_load_dwordx4 v27, s[16:19], s65 offen offset:3072 lds
v_mfma_f32_16x16x32_bf16 v[156:159], v[100:103], v[76:79], v[156:159]
s_mov_b32 s65, 786432
ds_read_b64_tr_b16 v[88:89], v44 offset:4096
ds_read_b64_tr_b16 v[90:91], v44 offset:4352
v_mfma_f32_16x16x32_bf16 v[160:163], v[72:75], v[104:107], v[160:163]
s_add_u32 m0, s67, 49152
ds_read_b64_tr_b16 v[92:93], v45 offset:4096
ds_read_b64_tr_b16 v[94:95], v45 offset:4352
v_mfma_f32_16x16x32_bf16 v[164:167], v[76:79], v[104:107], v[164:167]
buffer_load_dwordx4 v24, s[16:19], s65 offen offset:0 lds
v_mfma_f32_16x16x32_bf16 v[168:171], v[72:75], v[108:111], v[168:171]
ds_read_b64_tr_b16 v[96:97], v44 offset:8192
ds_read_b64_tr_b16 v[98:99], v44 offset:8448
v_mfma_f32_16x16x32_bf16 v[172:175], v[76:79], v[108:111], v[172:175]
s_waitcnt lgkmcnt(8)
ds_read_b64_tr_b16 v[100:101], v45 offset:8192
ds_read_b64_tr_b16 v[102:103], v45 offset:8448
v_mfma_f32_16x16x32_bf16 v[128:131], v[80:83], v[64:67], v[128:131]
ds_read_b64_tr_b16 v[104:105], v44 offset:2048
v_mfma_f32_16x16x32_bf16 v[136:139], v[80:83], v[68:71], v[136:139]
s_waitcnt lgkmcnt(9)
buffer_load_dwordx4 v25, s[16:19], s65 offen offset:1024 lds
v_mfma_f32_16x16x32_bf16 v[132:135], v[84:87], v[64:67], v[132:135]
ds_read_b64_tr_b16 v[106:107], v44 offset:2304
ds_read_b128 v[72:75], v43 offset:0
v_mfma_f32_16x16x32_bf16 v[140:143], v[84:87], v[68:71], v[140:143]
s_waitcnt lgkmcnt(7)
ds_read_b128 v[76:79], v43 offset:2048
ds_read_b64_tr_b16 v[108:109], v45 offset:2048
v_mfma_f32_16x16x32_bf16 v[144:147], v[88:91], v[64:67], v[144:147]
ds_read_b64_tr_b16 v[110:111], v45 offset:2304
v_mfma_f32_16x16x32_bf16 v[152:155], v[88:91], v[68:71], v[152:155]
ds_read_b64_tr_b16 v[80:81], v44 offset:6144
ds_read_b64_tr_b16 v[82:83], v44 offset:6400
v_mfma_f32_16x16x32_bf16 v[148:151], v[92:95], v[64:67], v[148:151]
ds_read_b64_tr_b16 v[84:85], v45 offset:6144
ds_read_b64_tr_b16 v[86:87], v45 offset:6400
v_mfma_f32_16x16x32_bf16 v[156:159], v[92:95], v[68:71], v[156:159]
s_waitcnt lgkmcnt(9)
ds_read_b64_tr_b16 v[88:89], v44 offset:10240
ds_read_b64_tr_b16 v[90:91], v44 offset:10496
v_mfma_f32_16x16x32_bf16 v[160:163], v[64:67], v[96:99], v[160:163]
ds_read_b64_tr_b16 v[92:93], v45 offset:10240
ds_read_b64_tr_b16 v[94:95], v45 offset:10496
v_mfma_f32_16x16x32_bf16 v[164:167], v[68:71], v[96:99], v[164:167]
buffer_load_dwordx4 v26, s[16:19], s65 offen offset:2048 lds
v_mfma_f32_16x16x32_bf16 v[168:171], v[64:67], v[100:103], v[168:171]
buffer_load_dwordx4 v27, s[16:19], s65 offen offset:3072 lds
v_mfma_f32_16x16x32_bf16 v[172:175], v[68:71], v[100:103], v[172:175]
s_waitcnt lgkmcnt(8)
s_mov_b32 s65, 128
v_mfma_f32_16x16x32_bf16 v[128:131], v[104:107], v[72:75], v[128:131]
s_add_u32 m0, s67, 147456
v_mfma_f32_16x16x32_bf16 v[136:139], v[104:107], v[76:79], v[136:139]
buffer_load_dwordx4 v36, s[12:15], s65 offen offset:0 lds
v_mfma_f32_16x16x32_bf16 v[132:135], v[108:111], v[72:75], v[132:135]
v_mfma_f32_16x16x32_bf16 v[140:143], v[108:111], v[76:79], v[140:143]
s_waitcnt lgkmcnt(0)
buffer_load_dwordx4 v37, s[12:15], s65 offen offset:1024 lds
v_mfma_f32_16x16x32_bf16 v[144:147], v[80:83], v[72:75], v[144:147]
v_mfma_f32_16x16x32_bf16 v[152:155], v[80:83], v[76:79], v[152:155]
v_mfma_f32_16x16x32_bf16 v[148:151], v[84:87], v[72:75], v[148:151]
buffer_load_dwordx4 v38, s[12:15], s65 offen offset:2048 lds
v_mfma_f32_16x16x32_bf16 v[156:159], v[84:87], v[76:79], v[156:159]
v_mfma_f32_16x16x32_bf16 v[160:163], v[72:75], v[88:91], v[160:163]
v_mfma_f32_16x16x32_bf16 v[164:167], v[76:79], v[88:91], v[164:167]
v_mfma_f32_16x16x32_bf16 v[168:171], v[72:75], v[92:95], v[168:171]
buffer_load_dwordx4 v39, s[12:15], s65 offen offset:3072 lds
v_mfma_f32_16x16x32_bf16 v[172:175], v[76:79], v[92:95], v[172:175]
s_barrier
.p2align 3
s_mov_b32 s65, 1048576
v_mov_b32 v189, 768
v_mov_b32 v188, 0xff800000
v_mov_b32 v190, 0x3fb8aa3b
v_mov_b32 v191, 0xbfb8aa3b
v_cmp_le_u32 s[86:87], v189, v1
s_nop 1
.p2align 3
v_cvt_pk_bf16_f32 v232, v128, v129
v_cvt_pk_bf16_f32 v233, v130, v131
v_cvt_pk_bf16_f32 v234, v132, v133
v_cvt_pk_bf16_f32 v235, v134, v135
v_cvt_pk_bf16_f32 v236, v136, v137
v_cvt_pk_bf16_f32 v237, v138, v139
v_cvt_pk_bf16_f32 v238, v140, v141
v_cvt_pk_bf16_f32 v239, v142, v143
s_nop 1
v_mfma_f32_16x16x32_bf16 v[128:131], v[112:115], v[232:235], 0
v_mfma_f32_16x16x32_bf16 v[132:135], v[116:119], v[232:235], 0
v_mfma_f32_16x16x32_bf16 v[136:139], v[112:115], v[236:239], 0
v_mfma_f32_16x16x32_bf16 v[140:143], v[116:119], v[236:239], 0
v_accvgpr_read_b32 v52, a60
v_accvgpr_read_b32 v53, a61
v_accvgpr_read_b32 v54, a62
v_accvgpr_read_b32 v55, a63
v_accvgpr_read_b32 v48, a56
s_add_u32 m0, s67, 0
.p2align 3
v_accvgpr_read_b32 v49, a57
v_accvgpr_read_b32 v50, a58
v_accvgpr_read_b32 v51, a59
v_cvt_pk_bf16_f32 v48, v48, v49
v_cvt_pk_bf16_f32 v49, v50, v51
v_cvt_pk_bf16_f32 v50, v52, v53
v_cvt_pk_bf16_f32 v51, v54, v55
buffer_store_dwordx4 v[48:51], v1, s[8:11], s76 offen offset:3072 sc1
v_max3_f32 v176, v128, v129, v130
v_max3_f32 v178, -v128, -v129, -v130
v_max3_f32 v180, v136, v137, v138
v_max3_f32 v182, -v136, -v137, -v138
v_max3_f32 v176, v131, v132, v176
v_max3_f32 v178, -v131, -v132, v178
v_max3_f32 v180, v139, v140, v180
v_max3_f32 v182, -v139, -v140, v182
v_max3_f32 v176, v133, v134, v176
v_max3_f32 v178, -v133, -v134, v178
v_max3_f32 v180, v141, v142, v180
v_max3_f32 v182, -v141, -v142, v182
v_max_f32_e64 v176, v135, v176
v_max_f32_e64 v178, -v135, v178
v_max_f32_e64 v180, v143, v180
v_max_f32_e64 v182, -v143, v182
buffer_load_dwordx4 v24, s[16:19], s65 offen offset:0 lds
s_nop 0
v_permlane32_swap_b32 v176, v178
v_permlane32_swap_b32 v180, v182
v_max_f32 v176, v176, v178
v_max_f32 v180, v180, v182
s_nop 1
v_permlane16_swap_b32 v176, v180
v_max_f32 v178, v176, v180
v_mul_f32 v176, v191, v178
v_mul_f32 v180, v191, v178
s_nop 1
v_permlane16_swap_b32 v176, v180
v_mov_b32 v178, v176
v_mov_b32 v182, v180
s_nop 0
v_permlane32_swap_b32 v176, v178
v_permlane32_swap_b32 v180, v182
.p2align 3
v_cndmask_b32 v177, v176, v188, s[86:87]
v_cndmask_b32 v179, v178, v188, s[86:87]
v_cndmask_b32 v181, v180, v188, s[86:87]
v_cndmask_b32 v183, v182, v188, s[86:87]
v_pk_fma_f32 v[192:193], v[128:129], v[190:191], v[176:177] op_sel:[0,0,0] op_sel_hi:[1,0,0]
v_pk_fma_f32 v[194:195], v[130:131], v[190:191], v[176:177] op_sel:[0,0,0] op_sel_hi:[1,0,0]
v_pk_fma_f32 v[196:197], v[132:133], v[190:191], v[176:177] op_sel:[0,0,1] op_sel_hi:[1,0,1]
buffer_load_dwordx4 v25, s[16:19], s65 offen offset:1024 lds
v_pk_fma_f32 v[198:199], v[134:135], v[190:191], v[176:177] op_sel:[0,0,1] op_sel_hi:[1,0,1]
v_exp_f32 v192, v192
v_exp_f32 v193, v193
v_exp_f32 v194, v194
v_exp_f32 v195, v195
v_exp_f32 v196, v196
v_exp_f32 v197, v197
v_exp_f32 v198, v198
v_exp_f32 v199, v199
v_pk_fma_f32 v[200:201], v[128:129], v[190:191], v[178:179] op_sel:[0,1,0] op_sel_hi:[1,1,0]
v_pk_fma_f32 v[202:203], v[130:131], v[190:191], v[178:179] op_sel:[0,1,0] op_sel_hi:[1,1,0]
v_pk_fma_f32 v[204:205], v[132:133], v[190:191], v[178:179] op_sel:[0,1,1] op_sel_hi:[1,1,1]
v_pk_fma_f32 v[206:207], v[134:135], v[190:191], v[178:179] op_sel:[0,1,1] op_sel_hi:[1,1,1]
v_exp_f32 v200, v200
v_exp_f32 v201, v201
v_exp_f32 v202, v202
v_exp_f32 v203, v203
v_exp_f32 v204, v204
v_exp_f32 v205, v205
v_exp_f32 v206, v206
v_exp_f32 v207, v207
v_pk_fma_f32 v[208:209], v[136:137], v[190:191], v[180:181] op_sel:[0,0,0] op_sel_hi:[1,0,0]
v_pk_fma_f32 v[210:211], v[138:139], v[190:191], v[180:181] op_sel:[0,0,0] op_sel_hi:[1,0,0]
v_pk_fma_f32 v[212:213], v[140:141], v[190:191], v[180:181] op_sel:[0,0,1] op_sel_hi:[1,0,1]
v_pk_fma_f32 v[214:215], v[142:143], v[190:191], v[180:181] op_sel:[0,0,1] op_sel_hi:[1,0,1]
buffer_load_dwordx4 v26, s[16:19], s65 offen offset:2048 lds
v_exp_f32 v208, v208
v_exp_f32 v209, v209
v_exp_f32 v210, v210
v_exp_f32 v211, v211
v_exp_f32 v212, v212
v_exp_f32 v213, v213
v_exp_f32 v214, v214
v_exp_f32 v215, v215
v_pk_fma_f32 v[216:217], v[136:137], v[190:191], v[182:183] op_sel:[0,1,0] op_sel_hi:[1,1,0]
v_pk_fma_f32 v[218:219], v[138:139], v[190:191], v[182:183] op_sel:[0,1,0] op_sel_hi:[1,1,0]
v_pk_fma_f32 v[220:221], v[140:141], v[190:191], v[182:183] op_sel:[0,1,1] op_sel_hi:[1,1,1]
v_pk_fma_f32 v[222:223], v[142:143], v[190:191], v[182:183] op_sel:[0,1,1] op_sel_hi:[1,1,1]
v_exp_f32 v216, v216
v_exp_f32 v217, v217
v_exp_f32 v218, v218
v_exp_f32 v219, v219
v_exp_f32 v220, v220
v_exp_f32 v221, v221
v_exp_f32 v222, v222
v_exp_f32 v223, v223
s_add_u32 s76, s76, s78
.p2align 3
v_accvgpr_read_b32 v52, a68
v_accvgpr_read_b32 v53, a69
v_accvgpr_read_b32 v54, a70
buffer_load_dwordx4 v27, s[16:19], s65 offen offset:3072 lds
v_accvgpr_read_b32 v55, a71
v_accvgpr_read_b32 v48, a64
v_accvgpr_read_b32 v49, a65
v_accvgpr_read_b32 v50, a66
v_accvgpr_read_b32 v51, a67
v_cvt_pk_bf16_f32 v48, v48, v49
v_cvt_pk_bf16_f32 v49, v50, v51
v_cvt_pk_bf16_f32 v50, v52, v53
v_cvt_pk_bf16_f32 v51, v54, v55
buffer_store_dwordx4 v[48:51], v1, s[8:11], s76 offen offset:0 sc1
v_pk_add_f32 v[184:185], v[192:193], v[194:195]
v_pk_add_f32 v[186:187], v[196:197], v[198:199]
v_pk_add_f32 v[184:185], v[184:185], v[186:187]
v_add_f32 v176, v184, v185
v_pk_add_f32 v[184:185], v[200:201], v[202:203]
v_pk_add_f32 v[186:187], v[204:205], v[206:207]
v_pk_add_f32 v[184:185], v[184:185], v[186:187]
v_add_f32 v178, v184, v185
v_pk_add_f32 v[184:185], v[208:209], v[210:211]
v_pk_add_f32 v[186:187], v[212:213], v[214:215]
v_pk_add_f32 v[184:185], v[184:185], v[186:187]
v_add_f32 v180, v184, v185
v_pk_add_f32 v[184:185], v[216:217], v[218:219]
v_pk_add_f32 v[186:187], v[220:221], v[222:223]
s_mov_b32 s65, 1310720
v_pk_add_f32 v[184:185], v[184:185], v[186:187]
v_add_f32 v182, v184, v185
s_nop 0
v_permlane32_swap_b32 v176, v178
v_permlane32_swap_b32 v180, v182
v_add_f32 v176, v176, v178
v_add_f32 v180, v180, v182
s_nop 1
v_permlane16_swap_b32 v176, v180
v_add_f32 v178, v176, v180
v_rcp_f32 v176, v178
v_rcp_f32 v180, v178
s_nop 1
v_permlane16_swap_b32 v176, v180
v_mov_b32 v178, v176
v_mov_b32 v182, v180
s_nop 0
v_permlane32_swap_b32 v176, v178
v_permlane32_swap_b32 v180, v182
.p2align 3
v_pk_mul_f32 v[192:193], v[192:193], v[176:177] op_sel_hi:[1,0]
v_pk_mul_f32 v[194:195], v[194:195], v[176:177] op_sel_hi:[1,0]
v_pk_mul_f32 v[196:197], v[196:197], v[176:177] op_sel_hi:[1,0]
v_pk_mul_f32 v[198:199], v[198:199], v[176:177] op_sel_hi:[1,0]
v_cvt_pk_bf16_f32 v192, v192, v193
s_add_u32 m0, s67, 16384
v_cvt_pk_bf16_f32 v193, v194, v195
v_cvt_pk_bf16_f32 v194, v196, v197
v_cvt_pk_bf16_f32 v195, v198, v199
v_pk_mul_f32 v[200:201], v[200:201], v[178:179] op_sel_hi:[1,0]
v_pk_mul_f32 v[202:203], v[202:203], v[178:179] op_sel_hi:[1,0]
v_pk_mul_f32 v[204:205], v[204:205], v[178:179] op_sel_hi:[1,0]
v_pk_mul_f32 v[206:207], v[206:207], v[178:179] op_sel_hi:[1,0]
v_cvt_pk_bf16_f32 v200, v200, v201
v_cvt_pk_bf16_f32 v201, v202, v203
v_cvt_pk_bf16_f32 v202, v204, v205
v_cvt_pk_bf16_f32 v203, v206, v207
v_pk_mul_f32 v[208:209], v[208:209], v[180:181] op_sel_hi:[1,0]
v_pk_mul_f32 v[210:211], v[210:211], v[180:181] op_sel_hi:[1,0]
v_pk_mul_f32 v[212:213], v[212:213], v[180:181] op_sel_hi:[1,0]
v_pk_mul_f32 v[214:215], v[214:215], v[180:181] op_sel_hi:[1,0]
v_cvt_pk_bf16_f32 v208, v208, v209
v_cvt_pk_bf16_f32 v209, v210, v211
v_cvt_pk_bf16_f32 v210, v212, v213
v_cvt_pk_bf16_f32 v211, v214, v215
v_pk_mul_f32 v[216:217], v[216:217], v[182:183] op_sel_hi:[1,0]
v_pk_mul_f32 v[218:219], v[218:219], v[182:183] op_sel_hi:[1,0]
v_pk_mul_f32 v[220:221], v[220:221], v[182:183] op_sel_hi:[1,0]
v_pk_mul_f32 v[222:223], v[222:223], v[182:183] op_sel_hi:[1,0]
v_cvt_pk_bf16_f32 v216, v216, v217
v_cvt_pk_bf16_f32 v217, v218, v219
buffer_load_dwordx4 v24, s[16:19], s65 offen offset:0 lds
v_cvt_pk_bf16_f32 v218, v220, v221
v_cvt_pk_bf16_f32 v219, v222, v223
s_lshl_b32 s63, s62, 3
s_add_u32 s63, s63, s60
s_lshl_b32 s63, s63, 15
s_lshl_b32 s64, s61, 11
s_add_u32 s63, s63, s64
.p2align 3
s_add_u32 s63, s63, 117440512
s_add_u32 s64, s63, 131072
buffer_store_dwordx4 v[192:195], v1, s[8:11], s63 offen offset:0 sc1
buffer_store_dwordx4 v[200:203], v1, s[8:11], s63 offen offset:1024 sc1
buffer_store_dwordx4 v[208:211], v1, s[8:11], s64 offen offset:0 sc1
buffer_store_dwordx4 v[216:219], v1, s[8:11], s64 offen offset:1024 sc1
v_cvt_pk_bf16_f32 v232, v144, v145
v_cvt_pk_bf16_f32 v233, v146, v147
v_cvt_pk_bf16_f32 v234, v148, v149
v_cvt_pk_bf16_f32 v235, v150, v151
v_cvt_pk_bf16_f32 v236, v152, v153
v_cvt_pk_bf16_f32 v237, v154, v155
v_cvt_pk_bf16_f32 v238, v156, v157
v_cvt_pk_bf16_f32 v239, v158, v159
s_nop 1
v_mfma_f32_16x16x32_bf16 v[144:147], v[112:115], v[232:235], 0
v_mfma_f32_16x16x32_bf16 v[148:151], v[116:119], v[232:235], 0
buffer_load_dwordx4 v25, s[16:19], s65 offen offset:1024 lds
v_mfma_f32_16x16x32_bf16 v[152:155], v[112:115], v[236:239], 0
v_mfma_f32_16x16x32_bf16 v[156:159], v[116:119], v[236:239], 0
.p2align 3
v_accvgpr_read_b32 v52, a76
v_accvgpr_read_b32 v53, a77
v_accvgpr_read_b32 v54, a78
v_accvgpr_read_b32 v55, a79
v_accvgpr_read_b32 v48, a72
v_accvgpr_read_b32 v49, a73
v_accvgpr_read_b32 v50, a74
v_accvgpr_read_b32 v51, a75
v_cvt_pk_bf16_f32 v48, v48, v49
v_cvt_pk_bf16_f32 v49, v50, v51
v_cvt_pk_bf16_f32 v50, v52, v53
v_cvt_pk_bf16_f32 v51, v54, v55
buffer_store_dwordx4 v[48:51], v1, s[8:11], s76 offen offset:1024 sc1
v_max3_f32 v176, v144, v145, v146
v_max3_f32 v178, -v144, -v145, -v146
v_max3_f32 v180, v152, v153, v154
v_max3_f32 v182, -v152, -v153, -v154
v_max3_f32 v176, v147, v148, v176
v_max3_f32 v178, -v147, -v148, v178
v_max3_f32 v180, v155, v156, v180
v_max3_f32 v182, -v155, -v156, v182
v_max3_f32 v176, v149, v150, v176
buffer_load_dwordx4 v26, s[16:19], s65 offen offset:2048 lds
v_max3_f32 v178, -v149, -v150, v178
v_max3_f32 v180, v157, v158, v180
v_max3_f32 v182, -v157, -v158, v182
v_max_f32_e64 v176, v151, v176
v_max_f32_e64 v178, -v151, v178
v_max_f32_e64 v180, v159, v180
v_max_f32_e64 v182, -v159, v182
s_nop 0
v_permlane32_swap_b32 v176, v178
v_permlane32_swap_b32 v180, v182
v_max_f32 v176, v176, v178
v_max_f32 v180, v180, v182
s_nop 1
v_permlane16_swap_b32 v176, v180
v_max_f32 v178, v176, v180
v_mul_f32 v176, v191, v178
v_mul_f32 v180, v191, v178
s_nop 1
v_permlane16_swap_b32 v176, v180
v_mov_b32 v178, v176
v_mov_b32 v182, v180
s_nop 0
v_permlane32_swap_b32 v176, v178
v_permlane32_swap_b32 v180, v182
.p2align 3
buffer_load_dwordx4 v27, s[16:19], s65 offen offset:3072 lds
v_cndmask_b32 v177, v176, v188, s[86:87]
v_cndmask_b32 v179, v178, v188, s[86:87]
v_cndmask_b32 v181, v180, v188, s[86:87]
v_cndmask_b32 v183, v182, v188, s[86:87]
v_pk_fma_f32 v[192:193], v[144:145], v[190:191], v[176:177] op_sel:[0,0,0] op_sel_hi:[1,0,0]
v_pk_fma_f32 v[194:195], v[146:147], v[190:191], v[176:177] op_sel:[0,0,0] op_sel_hi:[1,0,0]
v_pk_fma_f32 v[196:197], v[148:149], v[190:191], v[176:177] op_sel:[0,0,1] op_sel_hi:[1,0,1]
v_pk_fma_f32 v[198:199], v[150:151], v[190:191], v[176:177] op_sel:[0,0,1] op_sel_hi:[1,0,1]
v_exp_f32 v192, v192
v_exp_f32 v193, v193
v_exp_f32 v194, v194
v_exp_f32 v195, v195
v_exp_f32 v196, v196
v_exp_f32 v197, v197
v_exp_f32 v198, v198
v_exp_f32 v199, v199
v_pk_fma_f32 v[200:201], v[144:145], v[190:191], v[178:179] op_sel:[0,1,0] op_sel_hi:[1,1,0]
v_pk_fma_f32 v[202:203], v[146:147], v[190:191], v[178:179] op_sel:[0,1,0] op_sel_hi:[1,1,0]
v_pk_fma_f32 v[204:205], v[148:149], v[190:191], v[178:179] op_sel:[0,1,1] op_sel_hi:[1,1,1]
v_pk_fma_f32 v[206:207], v[150:151], v[190:191], v[178:179] op_sel:[0,1,1] op_sel_hi:[1,1,1]
v_exp_f32 v200, v200
v_exp_f32 v201, v201
v_exp_f32 v202, v202
v_exp_f32 v203, v203
v_exp_f32 v204, v204
v_exp_f32 v205, v205
v_exp_f32 v206, v206
v_exp_f32 v207, v207
v_pk_fma_f32 v[208:209], v[152:153], v[190:191], v[180:181] op_sel:[0,0,0] op_sel_hi:[1,0,0]
v_pk_fma_f32 v[210:211], v[154:155], v[190:191], v[180:181] op_sel:[0,0,0] op_sel_hi:[1,0,0]
v_pk_fma_f32 v[212:213], v[156:157], v[190:191], v[180:181] op_sel:[0,0,1] op_sel_hi:[1,0,1]
v_pk_fma_f32 v[214:215], v[158:159], v[190:191], v[180:181] op_sel:[0,0,1] op_sel_hi:[1,0,1]
v_exp_f32 v208, v208
v_exp_f32 v209, v209
v_exp_f32 v210, v210
v_exp_f32 v211, v211
v_exp_f32 v212, v212
v_exp_f32 v213, v213
v_exp_f32 v214, v214
v_exp_f32 v215, v215
v_pk_fma_f32 v[216:217], v[152:153], v[190:191], v[182:183] op_sel:[0,1,0] op_sel_hi:[1,1,0]
v_pk_fma_f32 v[218:219], v[154:155], v[190:191], v[182:183] op_sel:[0,1,0] op_sel_hi:[1,1,0]
v_pk_fma_f32 v[220:221], v[156:157], v[190:191], v[182:183] op_sel:[0,1,1] op_sel_hi:[1,1,1]
v_pk_fma_f32 v[222:223], v[158:159], v[190:191], v[182:183] op_sel:[0,1,1] op_sel_hi:[1,1,1]
v_exp_f32 v216, v216
v_exp_f32 v217, v217
v_exp_f32 v218, v218
v_exp_f32 v219, v219
v_exp_f32 v220, v220
v_exp_f32 v221, v221
v_exp_f32 v222, v222
v_exp_f32 v223, v223
.p2align 3
v_accvgpr_read_b32 v52, a84
v_accvgpr_read_b32 v53, a85
v_accvgpr_read_b32 v54, a86
v_accvgpr_read_b32 v55, a87
v_accvgpr_read_b32 v48, a80
v_accvgpr_read_b32 v49, a81
v_accvgpr_read_b32 v50, a82
v_accvgpr_read_b32 v51, a83
v_cvt_pk_bf16_f32 v48, v48, v49
v_cvt_pk_bf16_f32 v49, v50, v51
v_cvt_pk_bf16_f32 v50, v52, v53
v_cvt_pk_bf16_f32 v51, v54, v55
buffer_store_dwordx4 v[48:51], v1, s[8:11], s76 offen offset:2048 sc1
v_accvgpr_read_b32 v52, a92
v_accvgpr_read_b32 v53, a93
v_accvgpr_read_b32 v54, a94
v_accvgpr_read_b32 v55, a95
v_accvgpr_read_b32 v48, a88
v_accvgpr_read_b32 v49, a89
v_accvgpr_read_b32 v50, a90
v_accvgpr_read_b32 v51, a91
v_cvt_pk_bf16_f32 v48, v48, v49
v_cvt_pk_bf16_f32 v49, v50, v51
v_cvt_pk_bf16_f32 v50, v52, v53
v_cvt_pk_bf16_f32 v51, v54, v55
buffer_store_dwordx4 v[48:51], v1, s[8:11], s76 offen offset:3072 sc1
v_pk_add_f32 v[184:185], v[192:193], v[194:195]
v_pk_add_f32 v[186:187], v[196:197], v[198:199]
v_pk_add_f32 v[184:185], v[184:185], v[186:187]
v_add_f32 v176, v184, v185
v_pk_add_f32 v[184:185], v[200:201], v[202:203]
v_pk_add_f32 v[186:187], v[204:205], v[206:207]
v_pk_add_f32 v[184:185], v[184:185], v[186:187]
v_add_f32 v178, v184, v185
v_pk_add_f32 v[184:185], v[208:209], v[210:211]
v_pk_add_f32 v[186:187], v[212:213], v[214:215]
v_pk_add_f32 v[184:185], v[184:185], v[186:187]
v_add_f32 v180, v184, v185
v_pk_add_f32 v[184:185], v[216:217], v[218:219]
v_pk_add_f32 v[186:187], v[220:221], v[222:223]
v_pk_add_f32 v[184:185], v[184:185], v[186:187]
v_add_f32 v182, v184, v185
s_nop 0
v_permlane32_swap_b32 v176, v178
v_permlane32_swap_b32 v180, v182
v_add_f32 v176, v176, v178
v_add_f32 v180, v180, v182
s_nop 1
v_permlane16_swap_b32 v176, v180
v_add_f32 v178, v176, v180
v_rcp_f32 v176, v178
v_rcp_f32 v180, v178
s_nop 1
v_permlane16_swap_b32 v176, v180
v_mov_b32 v178, v176
v_mov_b32 v182, v180
s_nop 0
v_permlane32_swap_b32 v176, v178
v_permlane32_swap_b32 v180, v182
.p2align 3
v_pk_mul_f32 v[192:193], v[192:193], v[176:177] op_sel_hi:[1,0]
v_pk_mul_f32 v[194:195], v[194:195], v[176:177] op_sel_hi:[1,0]
v_pk_mul_f32 v[196:197], v[196:197], v[176:177] op_sel_hi:[1,0]
v_pk_mul_f32 v[198:199], v[198:199], v[176:177] op_sel_hi:[1,0]
v_cvt_pk_bf16_f32 v192, v192, v193
v_cvt_pk_bf16_f32 v193, v194, v195
v_cvt_pk_bf16_f32 v194, v196, v197
v_cvt_pk_bf16_f32 v195, v198, v199
v_pk_mul_f32 v[200:201], v[200:201], v[178:179] op_sel_hi:[1,0]
v_pk_mul_f32 v[202:203], v[202:203], v[178:179] op_sel_hi:[1,0]
v_pk_mul_f32 v[204:205], v[204:205], v[178:179] op_sel_hi:[1,0]
v_pk_mul_f32 v[206:207], v[206:207], v[178:179] op_sel_hi:[1,0]
v_cvt_pk_bf16_f32 v200, v200, v201
v_cvt_pk_bf16_f32 v201, v202, v203
v_cvt_pk_bf16_f32 v202, v204, v205
v_cvt_pk_bf16_f32 v203, v206, v207
v_pk_mul_f32 v[208:209], v[208:209], v[180:181] op_sel_hi:[1,0]
v_pk_mul_f32 v[210:211], v[210:211], v[180:181] op_sel_hi:[1,0]
v_pk_mul_f32 v[212:213], v[212:213], v[180:181] op_sel_hi:[1,0]
v_pk_mul_f32 v[214:215], v[214:215], v[180:181] op_sel_hi:[1,0]
v_cvt_pk_bf16_f32 v208, v208, v209
v_cvt_pk_bf16_f32 v209, v210, v211
v_cvt_pk_bf16_f32 v210, v212, v213
v_cvt_pk_bf16_f32 v211, v214, v215
v_pk_mul_f32 v[216:217], v[216:217], v[182:183] op_sel_hi:[1,0]
v_pk_mul_f32 v[218:219], v[218:219], v[182:183] op_sel_hi:[1,0]
v_pk_mul_f32 v[220:221], v[220:221], v[182:183] op_sel_hi:[1,0]
v_pk_mul_f32 v[222:223], v[222:223], v[182:183] op_sel_hi:[1,0]
v_cvt_pk_bf16_f32 v216, v216, v217
v_cvt_pk_bf16_f32 v217, v218, v219
v_cvt_pk_bf16_f32 v218, v220, v221
v_cvt_pk_bf16_f32 v219, v222, v223
s_nop 1
v_mfma_f32_16x16x32_bf16 v[128:131], v[192:195], v[56:59], 0
v_mfma_f32_16x16x32_bf16 v[132:135], v[208:211], v[56:59], 0
v_mfma_f32_16x16x32_bf16 v[136:139], v[192:195], v[60:63], 0
v_mfma_f32_16x16x32_bf16 v[140:143], v[208:211], v[60:63], 0
v_mfma_f32_16x16x32_bf16 v[144:147], v[200:203], v[56:59], 0
v_mfma_f32_16x16x32_bf16 v[148:151], v[216:219], v[56:59], 0
v_mfma_f32_16x16x32_bf16 v[152:155], v[200:203], v[60:63], 0
v_mfma_f32_16x16x32_bf16 v[156:159], v[216:219], v[60:63], 0
.p2align 3
v_cvt_pk_bf16_f32 v232, v160, v161
v_cvt_pk_bf16_f32 v233, v162, v163
v_cvt_pk_bf16_f32 v234, v164, v165
v_cvt_pk_bf16_f32 v235, v166, v167
v_cvt_pk_bf16_f32 v236, v168, v169
v_cvt_pk_bf16_f32 v237, v170, v171
v_cvt_pk_bf16_f32 v238, v172, v173
v_cvt_pk_bf16_f32 v239, v174, v175
v_bfe_u32 v176, v1, 4, 4
v_cmp_eq_u32 vcc, 12, v176
v_mov_b32 v177, 0x3f803f80
s_nop 0
v_cndmask_b32 v177, 0, v177, vcc
v_cmp_gt_u32 vcc, 12, v176
s_nop 1
v_cndmask_b32 v236, v177, v236, vcc
v_cndmask_b32 v237, v177, v237, vcc
v_cndmask_b32 v238, v177, v238, vcc
v_cndmask_b32 v239, v177, v239, vcc
.p2align 3
v_cvt_pk_bf16_f32 v128, v128, v129
v_cvt_pk_bf16_f32 v129, v130, v131
v_cvt_pk_bf16_f32 v130, v132, v133
v_cvt_pk_bf16_f32 v131, v134, v135
v_cvt_pk_bf16_f32 v136, v136, v137
v_cvt_pk_bf16_f32 v137, v138, v139
v_cvt_pk_bf16_f32 v138, v140, v141
v_cvt_pk_bf16_f32 v139, v142, v143
v_cvt_pk_bf16_f32 v144, v144, v145
v_cvt_pk_bf16_f32 v145, v146, v147
v_cvt_pk_bf16_f32 v146, v148, v149
v_cvt_pk_bf16_f32 v147, v150, v151
v_cvt_pk_bf16_f32 v152, v152, v153
v_cvt_pk_bf16_f32 v153, v154, v155
v_cvt_pk_bf16_f32 v154, v156, v157
v_cvt_pk_bf16_f32 v155, v158, v159
s_nop 1
v_mfma_f32_16x16x32_bf16 v[192:195], v[128:131], v[232:235], 0
v_mfma_f32_16x16x32_bf16 v[196:199], v[136:139], v[232:235], 0
v_mfma_f32_16x16x32_bf16 v[200:203], v[128:131], v[236:239], 0
v_mfma_f32_16x16x32_bf16 v[204:207], v[136:139], v[236:239], 0
v_mfma_f32_16x16x32_bf16 v[208:211], v[144:147], v[232:235], 0
v_mfma_f32_16x16x32_bf16 v[212:215], v[152:155], v[232:235], 0
v_mfma_f32_16x16x32_bf16 v[216:219], v[144:147], v[236:239], 0
v_mfma_f32_16x16x32_bf16 v[220:223], v[152:155], v[236:239], 0
s_add_u32 s63, s69, 98304
v_add_u32 v176, s63, v1
s_lshl_b32 s63, s60, 11
s_add_u32 s63, s63, 98304
v_add_u32 v177, s63, v1
s_add_u32 s76, s76, s77
.p2align 3
v_accvgpr_read_b32 v52, a100
v_accvgpr_read_b32 v53, a101
v_accvgpr_read_b32 v54, a102
v_accvgpr_read_b32 v55, a103
v_accvgpr_read_b32 v48, a96
v_accvgpr_read_b32 v49, a97
v_accvgpr_read_b32 v50, a98
v_accvgpr_read_b32 v51, a99
v_cvt_pk_bf16_f32 v48, v48, v49
v_cvt_pk_bf16_f32 v49, v50, v51
v_cvt_pk_bf16_f32 v50, v52, v53
v_cvt_pk_bf16_f32 v51, v54, v55
buffer_store_dwordx4 v[48:51], v1, s[8:11], s76 offen offset:0 sc1
ds_write_b128 v176, v[192:195] offset:0
ds_write_b128 v176, v[196:199] offset:1024
ds_write_b128 v176, v[200:203] offset:2048
ds_write_b128 v176, v[204:207] offset:3072
ds_write_b128 v176, v[208:211] offset:4096
ds_write_b128 v176, v[212:215] offset:5120
ds_write_b128 v176, v[216:219] offset:6144
ds_write_b128 v176, v[220:223] offset:7168
v_accvgpr_read_b32 v52, a108
v_accvgpr_read_b32 v53, a109
v_accvgpr_read_b32 v54, a110
v_accvgpr_read_b32 v55, a111
v_accvgpr_read_b32 v48, a104
v_accvgpr_read_b32 v49, a105
v_accvgpr_read_b32 v50, a106
v_accvgpr_read_b32 v51, a107
v_cvt_pk_bf16_f32 v48, v48, v49
v_cvt_pk_bf16_f32 v49, v50, v51
v_cvt_pk_bf16_f32 v50, v52, v53
v_cvt_pk_bf16_f32 v51, v54, v55
buffer_store_dwordx4 v[48:51], v1, s[8:11], s76 offen offset:1024 sc1
s_waitcnt lgkmcnt(0)
s_barrier
.p2align 3
ds_read_b128 v[128:131], v177 offset:0
ds_read_b128 v[132:135], v177 offset:1024
ds_read_b128 v[136:139], v177 offset:8192
ds_read_b128 v[140:143], v177 offset:9216
ds_read_b128 v[144:147], v177 offset:16384
ds_read_b128 v[148:151], v177 offset:17408
ds_read_b128 v[152:155], v177 offset:24576
ds_read_b128 v[156:159], v177 offset:25600
s_lshl_b32 s63, s61, 4
s_add_u32 s63, s63, s62
s_lshl_b32 s63, s63, 2
s_add_u32 s63, s63, s60
s_lshl_b32 s63, s63, 10
.p2align 3
s_add_u32 s63, s63, 125829120
v_accvgpr_read_b32 v52, a116
v_accvgpr_read_b32 v53, a117
v_accvgpr_read_b32 v54, a118
v_accvgpr_read_b32 v55, a119
v_accvgpr_read_b32 v48, a112
v_accvgpr_read_b32 v49, a113
v_accvgpr_read_b32 v50, a114
v_accvgpr_read_b32 v51, a115
v_cvt_pk_bf16_f32 v48, v48, v49
v_cvt_pk_bf16_f32 v49, v50, v51
v_cvt_pk_bf16_f32 v50, v52, v53
v_cvt_pk_bf16_f32 v51, v54, v55
buffer_store_dwordx4 v[48:51], v1, s[8:11], s76 offen offset:2048 sc1
v_accvgpr_read_b32 v52, a124
v_accvgpr_read_b32 v53, a125
v_accvgpr_read_b32 v54, a126
v_accvgpr_read_b32 v55, a127
v_accvgpr_read_b32 v48, a120
v_accvgpr_read_b32 v49, a121
v_accvgpr_read_b32 v50, a122
v_accvgpr_read_b32 v51, a123
v_cvt_pk_bf16_f32 v48, v48, v49
v_cvt_pk_bf16_f32 v49, v50, v51
v_cvt_pk_bf16_f32 v50, v52, v53
v_cvt_pk_bf16_f32 v51, v54, v55
buffer_store_dwordx4 v[48:51], v1, s[8:11], s76 offen offset:3072 sc1
v_add_u32 v42, 131072, v19
v_xor_b32 v43, 64, v42
s_waitcnt vmcnt(33) lgkmcnt(0)
s_barrier
.p2align 3
ds_read_b128 v[64:67], v42 offset:0
ds_read_b128 v[72:75], v43 offset:0
ds_read_b64_tr_b16 a[0:1], v28 offset:0
ds_read_b64_tr_b16 a[2:3], v28 offset:2048
ds_read_b64_tr_b16 a[4:5], v28 offset:16384
ds_read_b64_tr_b16 a[6:7], v28 offset:18432
ds_read_b128 v[68:71], v42 offset:2048
ds_read_b128 v[76:79], v43 offset:2048
ds_read_b64_tr_b16 a[8:9], v29 offset:0
ds_read_b64_tr_b16 a[10:11], v29 offset:2048
ds_read_b64_tr_b16 a[12:13], v29 offset:16384
ds_read_b64_tr_b16 a[14:15], v29 offset:18432
ds_read_b64_tr_b16 a[16:17], v30 offset:0
ds_read_b64_tr_b16 a[18:19], v30 offset:2048
ds_read_b64_tr_b16 a[20:21], v30 offset:16384
ds_read_b64_tr_b16 a[22:23], v30 offset:18432
v_pk_add_f32 v[128:129], v[128:129], v[136:137]
v_pk_add_f32 v[130:131], v[130:131], v[138:139]
v_pk_add_f32 v[132:133], v[132:133], v[140:141]
v_pk_add_f32 v[134:135], v[134:135], v[142:143]
v_pk_add_f32 v[128:129], v[128:129], v[144:145]
v_pk_add_f32 v[130:131], v[130:131], v[146:147]
v_pk_add_f32 v[132:133], v[132:133], v[148:149]
v_pk_add_f32 v[134:135], v[134:135], v[150:151]
v_pk_add_f32 v[128:129], v[128:129], v[152:153]
v_pk_add_f32 v[130:131], v[130:131], v[154:155]
v_pk_add_f32 v[132:133], v[132:133], v[156:157]
v_pk_add_f32 v[134:135], v[134:135], v[158:159]
v_cvt_pk_bf16_f32 v128, v128, v129
v_cvt_pk_bf16_f32 v129, v130, v131
v_cvt_pk_bf16_f32 v130, v132, v133
v_cvt_pk_bf16_f32 v131, v134, v135
buffer_store_dwordx4 v[128:131], v1, s[8:11], s63 offen sc1
s_nop 0
s_waitcnt lgkmcnt(5)
v_mfma_f32_16x16x32_bf16 v[128:131], a[0:3], v[64:67], 0
ds_read_b64_tr_b16 a[24:25], v31 offset:0
v_mfma_f32_16x16x32_bf16 v[128:131], a[4:7], v[72:75], v[128:131]
s_mov_b32 s65, 256
ds_read_b64_tr_b16 a[26:27], v31 offset:2048
v_mfma_f32_16x16x32_bf16 v[192:195], a[4:7], v[76:79], 0
s_add_u32 m0, s67, 98304
ds_read_b64_tr_b16 a[28:29], v31 offset:16384
v_mfma_f32_16x16x32_bf16 v[192:195], a[0:3], v[68:71], v[192:195]
buffer_load_dwordx4 v36, s[12:15], s65 offen offset:0 lds
v_mfma_f32_16x16x32_bf16 v[196:199], a[8:11], v[68:71], 0
s_waitcnt lgkmcnt(4)
ds_read_b64_tr_b16 a[30:31], v31 offset:18432
ds_read_b64_tr_b16 a[32:33], v28 offset:256
v_mfma_f32_16x16x32_bf16 v[196:199], a[12:15], v[76:79], v[196:199]
ds_read_b64_tr_b16 a[34:35], v28 offset:2304
v_mfma_f32_16x16x32_bf16 v[132:135], a[12:15], v[72:75], 0
ds_read_b64_tr_b16 a[36:37], v28 offset:16640
ds_read_b64_tr_b16 a[38:39], v28 offset:18688
v_mfma_f32_16x16x32_bf16 v[132:135], a[8:11], v[64:67], v[132:135]
buffer_load_dwordx4 v37, s[12:15], s65 offen offset:1024 lds
v_mfma_f32_16x16x32_bf16 v[136:139], a[16:19], v[64:67], 0
s_waitcnt lgkmcnt(6)
ds_read_b64_tr_b16 a[40:41], v29 offset:256
ds_read_b64_tr_b16 a[42:43], v29 offset:2304
v_mfma_f32_16x16x32_bf16 v[136:139], a[20:23], v[72:75], v[136:139]
ds_read_b64_tr_b16 a[44:45], v29 offset:16640
v_mfma_f32_16x16x32_bf16 v[200:203], a[20:23], v[76:79], 0
ds_read_b64_tr_b16 a[46:47], v29 offset:18688
ds_read_b64_tr_b16 a[48:49], v30 offset:256
v_mfma_f32_16x16x32_bf16 v[200:203], a[16:19], v[68:71], v[200:203]
ds_read_b64_tr_b16 a[50:51], v30 offset:2304
v_mfma_f32_16x16x32_bf16 v[204:207], a[24:27], v[68:71], 0
s_waitcnt lgkmcnt(8)
buffer_load_dwordx4 v38, s[12:15], s65 offen offset:2048 lds
v_mfma_f32_16x16x32_bf16 v[204:207], a[28:31], v[76:79], v[204:207]
ds_read_b64_tr_b16 a[52:53], v30 offset:16640
ds_read_b64_tr_b16 a[54:55], v30 offset:18688
v_mfma_f32_16x16x32_bf16 v[140:143], a[28:31], v[72:75], 0
ds_read_b64_tr_b16 a[56:57], v31 offset:256
ds_read_b64_tr_b16 a[58:59], v31 offset:2304
v_mfma_f32_16x16x32_bf16 v[140:143], a[24:27], v[64:67], v[140:143]
ds_read_b64_tr_b16 a[60:61], v31 offset:16640
v_mfma_f32_16x16x32_bf16 v[144:147], a[32:35], v[64:67], 0
s_waitcnt lgkmcnt(8)
ds_read_b64_tr_b16 a[62:63], v31 offset:18688
v_mfma_f32_16x16x32_bf16 v[144:147], a[36:39], v[72:75], v[144:147]
buffer_load_dwordx4 v39, s[12:15], s65 offen offset:3072 lds
v_mfma_f32_16x16x32_bf16 v[208:211], a[36:39], v[76:79], 0
ds_read_b64_tr_b16 a[0:1], v32 offset:0
ds_read_b64_tr_b16 a[2:3], v32 offset:2048
v_mfma_f32_16x16x32_bf16 v[208:211], a[32:35], v[68:71], v[208:211]
ds_read_b64_tr_b16 a[4:5], v32 offset:16384
ds_read_b64_tr_b16 a[6:7], v32 offset:18432
v_mfma_f32_16x16x32_bf16 v[212:215], a[40:43], v[68:71], 0
s_waitcnt lgkmcnt(8)
ds_read_b64_tr_b16 a[8:9], v33 offset:0
v_mfma_f32_16x16x32_bf16 v[212:215], a[44:47], v[76:79], v[212:215]
ds_read_b64_tr_b16 a[10:11], v33 offset:2048
v_mfma_f32_16x16x32_bf16 v[148:151], a[44:47], v[72:75], 0
ds_read_b64_tr_b16 a[12:13], v33 offset:16384
v_mfma_f32_16x16x32_bf16 v[148:151], a[40:43], v[64:67], v[148:151]
ds_read_b64_tr_b16 a[14:15], v33 offset:18432
ds_read_b64_tr_b16 a[16:17], v34 offset:0
v_mfma_f32_16x16x32_bf16 v[152:155], a[48:51], v[64:67], 0
ds_read_b64_tr_b16 a[18:19], v34 offset:2048
v_mfma_f32_16x16x32_bf16 v[152:155], a[52:55], v[72:75], v[152:155]
ds_read_b64_tr_b16 a[20:21], v34 offset:16384
v_mfma_f32_16x16x32_bf16 v[216:219], a[52:55], v[76:79], 0
ds_read_b64_tr_b16 a[22:23], v34 offset:18432
v_mfma_f32_16x16x32_bf16 v[216:219], a[48:51], v[68:71], v[216:219]
s_waitcnt lgkmcnt(7)
ds_read_b64_tr_b16 a[24:25], v35 offset:0
ds_read_b64_tr_b16 a[26:27], v35 offset:2048
v_mfma_f32_16x16x32_bf16 v[220:223], a[56:59], v[68:71], 0
ds_read_b64_tr_b16 a[28:29], v35 offset:16384
v_mfma_f32_16x16x32_bf16 v[220:223], a[60:63], v[76:79], v[220:223]
ds_read_b64_tr_b16 a[30:31], v35 offset:18432
v_mfma_f32_16x16x32_bf16 v[156:159], a[60:63], v[72:75], 0
ds_read_b64_tr_b16 a[32:33], v32 offset:256
v_mfma_f32_16x16x32_bf16 v[156:159], a[56:59], v[64:67], v[156:159]
ds_read_b64_tr_b16 a[34:35], v32 offset:2304
ds_read_b64_tr_b16 a[36:37], v32 offset:16640
v_mfma_f32_16x16x32_bf16 v[160:163], a[0:3], v[64:67], 0
ds_read_b64_tr_b16 a[38:39], v32 offset:18688
v_mfma_f32_16x16x32_bf16 v[160:163], a[4:7], v[72:75], v[160:163]
ds_read_b64_tr_b16 a[40:41], v33 offset:256
v_mfma_f32_16x16x32_bf16 v[224:227], a[4:7], v[76:79], 0
ds_read_b64_tr_b16 a[42:43], v33 offset:2304
v_mfma_f32_16x16x32_bf16 v[224:227], a[0:3], v[68:71], v[224:227]
s_waitcnt lgkmcnt(7)
ds_read_b64_tr_b16 a[44:45], v33 offset:16640
ds_read_b64_tr_b16 a[46:47], v33 offset:18688
v_mfma_f32_16x16x32_bf16 v[228:231], a[8:11], v[68:71], 0
ds_read_b64_tr_b16 a[48:49], v34 offset:256
v_mfma_f32_16x16x32_bf16 v[228:231], a[12:15], v[76:79], v[228:231]
ds_read_b64_tr_b16 a[50:51], v34 offset:2304
v_mfma_f32_16x16x32_bf16 v[164:167], a[12:15], v[72:75], 0
ds_read_b64_tr_b16 a[52:53], v34 offset:16640
v_mfma_f32_16x16x32_bf16 v[164:167], a[8:11], v[64:67], v[164:167]
ds_read_b64_tr_b16 a[54:55], v34 offset:18688
v_mfma_f32_16x16x32_bf16 v[168:171], a[16:19], v[64:67], 0
ds_read_b64_tr_b16 a[56:57], v35 offset:256
ds_read_b64_tr_b16 a[58:59], v35 offset:2304
v_mfma_f32_16x16x32_bf16 v[168:171], a[20:23], v[72:75], v[168:171]
ds_read_b64_tr_b16 a[60:61], v35 offset:16640
ds_read_b64_tr_b16 a[62:63], v35 offset:18688
v_mfma_f32_16x16x32_bf16 v[232:235], a[20:23], v[76:79], 0
v_add_u32 v42, 147456, v19
v_xor_b32 v43, 64, v42
v_mfma_f32_16x16x32_bf16 v[232:235], a[16:19], v[68:71], v[232:235]
v_mfma_f32_16x16x32_bf16 v[236:239], a[24:27], v[68:71], 0
s_waitcnt lgkmcnt(6)
v_add_u32 v28, 4294934528, v28
v_add_u32 v29, 4294934528, v29
v_mfma_f32_16x16x32_bf16 v[236:239], a[28:31], v[76:79], v[236:239]
v_mfma_f32_16x16x32_bf16 v[172:175], a[28:31], v[72:75], 0
v_add_u32 v30, 4294934528, v30
v_add_u32 v31, 4294934528, v31
v_mfma_f32_16x16x32_bf16 v[172:175], a[24:27], v[64:67], v[172:175]
v_mfma_f32_16x16x32_bf16 v[176:179], a[32:35], v[64:67], 0
v_add_u32 v32, 4294934528, v32
v_add_u32 v33, 4294934528, v33
v_mfma_f32_16x16x32_bf16 v[176:179], a[36:39], v[72:75], v[176:179]
v_add_u32 v34, 4294934528, v34
v_add_u32 v35, 4294934528, v35
v_mfma_f32_16x16x32_bf16 v[240:243], a[36:39], v[76:79], 0
s_waitcnt vmcnt(26) lgkmcnt(0)
v_mfma_f32_16x16x32_bf16 v[240:243], a[32:35], v[68:71], v[240:243]
s_barrier
v_mfma_f32_16x16x32_bf16 v[244:247], a[40:43], v[68:71], 0
ds_read_b128 v[80:83], v42 offset:0
v_mfma_f32_16x16x32_bf16 v[244:247], a[44:47], v[76:79], v[244:247]
s_mov_b32 s65, 1572864
ds_read_b128 v[88:91], v43 offset:0
v_mfma_f32_16x16x32_bf16 v[180:183], a[44:47], v[72:75], 0
s_add_u32 m0, s67, 65536
ds_read_b64_tr_b16 a[0:1], v28 offset:0
v_mfma_f32_16x16x32_bf16 v[180:183], a[40:43], v[64:67], v[180:183]
buffer_load_dwordx4 v24, s[16:19], s65 offen offset:0 lds
v_mfma_f32_16x16x32_bf16 v[184:187], a[48:51], v[64:67], 0
ds_read_b64_tr_b16 a[2:3], v28 offset:2048
ds_read_b64_tr_b16 a[4:5], v28 offset:16384
v_mfma_f32_16x16x32_bf16 v[184:187], a[52:55], v[72:75], v[184:187]
ds_read_b64_tr_b16 a[6:7], v28 offset:18432
ds_read_b128 v[84:87], v42 offset:2048
v_mfma_f32_16x16x32_bf16 v[248:251], a[52:55], v[76:79], 0
ds_read_b128 v[92:95], v43 offset:2048
v_mfma_f32_16x16x32_bf16 v[248:251], a[48:51], v[68:71], v[248:251]
ds_read_b64_tr_b16 a[8:9], v29 offset:0
ds_read_b64_tr_b16 a[10:11], v29 offset:2048
v_mfma_f32_16x16x32_bf16 v[252:255], a[56:59], v[68:71], 0
buffer_load_dwordx4 v25, s[16:19], s65 offen offset:1024 lds
v_mfma_f32_16x16x32_bf16 v[252:255], a[60:63], v[76:79], v[252:255]
ds_read_b64_tr_b16 a[12:13], v29 offset:16384
ds_read_b64_tr_b16 a[14:15], v29 offset:18432
v_mfma_f32_16x16x32_bf16 v[188:191], a[60:63], v[72:75], 0
ds_read_b64_tr_b16 a[16:17], v30 offset:0
ds_read_b64_tr_b16 a[18:19], v30 offset:2048
v_mfma_f32_16x16x32_bf16 v[188:191], a[56:59], v[64:67], v[188:191]
s_waitcnt lgkmcnt(9)
ds_read_b64_tr_b16 a[20:21], v30 offset:16384
ds_read_b64_tr_b16 a[22:23], v30 offset:18432
v_mfma_f32_16x16x32_bf16 v[128:131], a[0:3], v[80:83], v[128:131]
s_waitcnt lgkmcnt(9)
ds_read_b64_tr_b16 a[24:25], v31 offset:0
v_mfma_f32_16x16x32_bf16 v[128:131], a[4:7], v[88:91], v[128:131]
s_waitcnt lgkmcnt(9)
buffer_load_dwordx4 v26, s[16:19], s65 offen offset:2048 lds
v_mfma_f32_16x16x32_bf16 v[192:195], a[4:7], v[92:95], v[192:195]
ds_read_b64_tr_b16 a[26:27], v31 offset:2048
ds_read_b64_tr_b16 a[28:29], v31 offset:16384
v_mfma_f32_16x16x32_bf16 v[192:195], a[0:3], v[84:87], v[192:195]
s_waitcnt lgkmcnt(9)
ds_read_b64_tr_b16 a[30:31], v31 offset:18432
v_mfma_f32_16x16x32_bf16 v[196:199], a[8:11], v[84:87], v[196:199]
s_waitcnt lgkmcnt(8)
ds_read_b64_tr_b16 a[32:33], v28 offset:256
v_mfma_f32_16x16x32_bf16 v[196:199], a[12:15], v[92:95], v[196:199]
ds_read_b64_tr_b16 a[34:35], v28 offset:2304
v_mfma_f32_16x16x32_bf16 v[132:135], a[12:15], v[88:91], v[132:135]
buffer_load_dwordx4 v27, s[16:19], s65 offen offset:3072 lds
v_mfma_f32_16x16x32_bf16 v[132:135], a[8:11], v[80:83], v[132:135]
s_waitcnt lgkmcnt(5)
s_mov_b32 s65, 384
ds_read_b64_tr_b16 a[36:37], v28 offset:16640
ds_read_b64_tr_b16 a[38:39], v28 offset:18688
v_mfma_f32_16x16x32_bf16 v[136:139], a[16:19], v[80:83], v[136:139]
s_add_u32 m0, s67, 131072
ds_read_b64_tr_b16 a[40:41], v29 offset:256
ds_read_b64_tr_b16 a[42:43], v29 offset:2304
v_mfma_f32_16x16x32_bf16 v[136:139], a[20:23], v[88:91], v[136:139]
ds_read_b64_tr_b16 a[44:45], v29 offset:16640
v_mfma_f32_16x16x32_bf16 v[200:203], a[20:23], v[92:95], v[200:203]
ds_read_b64_tr_b16 a[46:47], v29 offset:18688
ds_read_b64_tr_b16 a[48:49], v30 offset:256
v_mfma_f32_16x16x32_bf16 v[200:203], a[16:19], v[84:87], v[200:203]
s_waitcnt lgkmcnt(8)
buffer_load_dwordx4 v36, s[12:15], s65 offen offset:0 lds
v_mfma_f32_16x16x32_bf16 v[204:207], a[24:27], v[84:87], v[204:207]
ds_read_b64_tr_b16 a[50:51], v30 offset:2304
ds_read_b64_tr_b16 a[52:53], v30 offset:16640
v_mfma_f32_16x16x32_bf16 v[204:207], a[28:31], v[92:95], v[204:207]
ds_read_b64_tr_b16 a[54:55], v30 offset:18688
v_mfma_f32_16x16x32_bf16 v[140:143], a[28:31], v[88:91], v[140:143]
ds_read_b64_tr_b16 a[56:57], v31 offset:256
ds_read_b64_tr_b16 a[58:59], v31 offset:2304
v_mfma_f32_16x16x32_bf16 v[140:143], a[24:27], v[80:83], v[140:143]
s_waitcnt lgkmcnt(8)
ds_read_b64_tr_b16 a[60:61], v31 offset:16640
v_mfma_f32_16x16x32_bf16 v[144:147], a[32:35], v[80:83], v[144:147]
buffer_load_dwordx4 v37, s[12:15], s65 offen offset:1024 lds
v_mfma_f32_16x16x32_bf16 v[144:147], a[36:39], v[88:91], v[144:147]
ds_read_b64_tr_b16 a[62:63], v31 offset:18688
ds_read_b64_tr_b16 a[0:1], v32 offset:0
v_mfma_f32_16x16x32_bf16 v[208:211], a[36:39], v[92:95], v[208:211]
ds_read_b64_tr_b16 a[2:3], v32 offset:2048
v_mfma_f32_16x16x32_bf16 v[208:211], a[32:35], v[84:87], v[208:211]
ds_read_b64_tr_b16 a[4:5], v32 offset:16384
ds_read_b64_tr_b16 a[6:7], v32 offset:18432
v_mfma_f32_16x16x32_bf16 v[212:215], a[40:43], v[84:87], v[212:215]
s_waitcnt lgkmcnt(8)
ds_read_b64_tr_b16 a[8:9], v33 offset:0
v_mfma_f32_16x16x32_bf16 v[212:215], a[44:47], v[92:95], v[212:215]
buffer_load_dwordx4 v38, s[12:15], s65 offen offset:2048 lds
v_mfma_f32_16x16x32_bf16 v[148:151], a[44:47], v[88:91], v[148:151]
ds_read_b64_tr_b16 a[10:11], v33 offset:2048
ds_read_b64_tr_b16 a[12:13], v33 offset:16384
v_mfma_f32_16x16x32_bf16 v[148:151], a[40:43], v[80:83], v[148:151]
ds_read_b64_tr_b16 a[14:15], v33 offset:18432
ds_read_b64_tr_b16 a[16:17], v34 offset:0
v_mfma_f32_16x16x32_bf16 v[152:155], a[48:51], v[80:83], v[152:155]
ds_read_b64_tr_b16 a[18:19], v34 offset:2048
v_mfma_f32_16x16x32_bf16 v[152:155], a[52:55], v[88:91], v[152:155]
ds_read_b64_tr_b16 a[20:21], v34 offset:16384
v_mfma_f32_16x16x32_bf16 v[216:219], a[52:55], v[92:95], v[216:219]
buffer_load_dwordx4 v39, s[12:15], s65 offen offset:3072 lds
v_mfma_f32_16x16x32_bf16 v[216:219], a[48:51], v[84:87], v[216:219]
s_waitcnt lgkmcnt(6)
s_mov_b32 s65, 1835008
ds_read_b64_tr_b16 a[22:23], v34 offset:18432
ds_read_b64_tr_b16 a[24:25], v35 offset:0
v_mfma_f32_16x16x32_bf16 v[220:223], a[56:59], v[84:87], v[220:223]
s_add_u32 m0, s67, 81920
ds_read_b64_tr_b16 a[26:27], v35 offset:2048
ds_read_b64_tr_b16 a[28:29], v35 offset:16384
v_mfma_f32_16x16x32_bf16 v[220:223], a[60:63], v[92:95], v[220:223]
ds_read_b64_tr_b16 a[30:31], v35 offset:18432
v_mfma_f32_16x16x32_bf16 v[156:159], a[60:63], v[88:91], v[156:159]
ds_read_b64_tr_b16 a[32:33], v32 offset:256
v_mfma_f32_16x16x32_bf16 v[156:159], a[56:59], v[80:83], v[156:159]
ds_read_b64_tr_b16 a[34:35], v32 offset:2304
ds_read_b64_tr_b16 a[36:37], v32 offset:16640
v_mfma_f32_16x16x32_bf16 v[160:163], a[0:3], v[80:83], v[160:163]
buffer_load_dwordx4 v24, s[16:19], s65 offen offset:0 lds
v_mfma_f32_16x16x32_bf16 v[160:163], a[4:7], v[88:91], v[160:163]
ds_read_b64_tr_b16 a[38:39], v32 offset:18688
ds_read_b64_tr_b16 a[40:41], v33 offset:256
v_mfma_f32_16x16x32_bf16 v[224:227], a[4:7], v[92:95], v[224:227]
ds_read_b64_tr_b16 a[42:43], v33 offset:2304
v_mfma_f32_16x16x32_bf16 v[224:227], a[0:3], v[84:87], v[224:227]
s_waitcnt lgkmcnt(7)
ds_read_b64_tr_b16 a[44:45], v33 offset:16640
ds_read_b64_tr_b16 a[46:47], v33 offset:18688
v_mfma_f32_16x16x32_bf16 v[228:231], a[8:11], v[84:87], v[228:231]
buffer_load_dwordx4 v25, s[16:19], s65 offen offset:1024 lds
v_mfma_f32_16x16x32_bf16 v[228:231], a[12:15], v[92:95], v[228:231]
ds_read_b64_tr_b16 a[48:49], v34 offset:256
ds_read_b64_tr_b16 a[50:51], v34 offset:2304
v_mfma_f32_16x16x32_bf16 v[164:167], a[12:15], v[88:91], v[164:167]
ds_read_b64_tr_b16 a[52:53], v34 offset:16640
v_mfma_f32_16x16x32_bf16 v[164:167], a[8:11], v[80:83], v[164:167]
ds_read_b64_tr_b16 a[54:55], v34 offset:18688
v_mfma_f32_16x16x32_bf16 v[168:171], a[16:19], v[80:83], v[168:171]
ds_read_b64_tr_b16 a[56:57], v35 offset:256
ds_read_b64_tr_b16 a[58:59], v35 offset:2304
v_mfma_f32_16x16x32_bf16 v[168:171], a[20:23], v[88:91], v[168:171]
ds_read_b64_tr_b16 a[60:61], v35 offset:16640
ds_read_b64_tr_b16 a[62:63], v35 offset:18688
v_mfma_f32_16x16x32_bf16 v[232:235], a[20:23], v[92:95], v[232:235]
buffer_load_dwordx4 v26, s[16:19], s65 offen offset:2048 lds
v_mfma_f32_16x16x32_bf16 v[232:235], a[16:19], v[84:87], v[232:235]
v_add_u32 v42, 98304, v19
v_xor_b32 v43, 64, v42
v_mfma_f32_16x16x32_bf16 v[236:239], a[24:27], v[84:87], v[236:239]
s_waitcnt lgkmcnt(6)
v_add_u32 v28, 4294934528, v28
v_add_u32 v29, 4294934528, v29
v_mfma_f32_16x16x32_bf16 v[236:239], a[28:31], v[92:95], v[236:239]
v_mfma_f32_16x16x32_bf16 v[172:175], a[28:31], v[88:91], v[172:175]
buffer_load_dwordx4 v27, s[16:19], s65 offen offset:3072 lds
v_mfma_f32_16x16x32_bf16 v[172:175], a[24:27], v[80:83], v[172:175]
v_add_u32 v30, 4294934528, v30
v_add_u32 v31, 4294934528, v31
v_mfma_f32_16x16x32_bf16 v[176:179], a[32:35], v[80:83], v[176:179]
v_add_u32 v32, 4294934528, v32
v_add_u32 v33, 4294934528, v33
v_mfma_f32_16x16x32_bf16 v[176:179], a[36:39], v[88:91], v[176:179]
v_add_u32 v34, 4294934528, v34
v_add_u32 v35, 4294934528, v35
v_mfma_f32_16x16x32_bf16 v[240:243], a[36:39], v[92:95], v[240:243]
s_waitcnt vmcnt(12) lgkmcnt(0)
v_mfma_f32_16x16x32_bf16 v[240:243], a[32:35], v[84:87], v[240:243]
s_barrier
v_mfma_f32_16x16x32_bf16 v[244:247], a[40:43], v[84:87], v[244:247]
ds_read_b128 v[64:67], v42 offset:0
v_mfma_f32_16x16x32_bf16 v[244:247], a[44:47], v[92:95], v[244:247]
s_mov_b32 s65, 2097152
ds_read_b128 v[72:75], v43 offset:0
v_mfma_f32_16x16x32_bf16 v[180:183], a[44:47], v[88:91], v[180:183]
s_add_u32 m0, s67, 32768
ds_read_b64_tr_b16 a[0:1], v28 offset:0
v_mfma_f32_16x16x32_bf16 v[180:183], a[40:43], v[80:83], v[180:183]
buffer_load_dwordx4 v24, s[16:19], s65 offen offset:0 lds
v_mfma_f32_16x16x32_bf16 v[184:187], a[48:51], v[80:83], v[184:187]
ds_read_b64_tr_b16 a[2:3], v28 offset:2048
ds_read_b64_tr_b16 a[4:5], v28 offset:16384
v_mfma_f32_16x16x32_bf16 v[184:187], a[52:55], v[88:91], v[184:187]
ds_read_b64_tr_b16 a[6:7], v28 offset:18432
ds_read_b128 v[68:71], v42 offset:2048
v_mfma_f32_16x16x32_bf16 v[248:251], a[52:55], v[92:95], v[248:251]
ds_read_b128 v[76:79], v43 offset:2048
v_mfma_f32_16x16x32_bf16 v[248:251], a[48:51], v[84:87], v[248:251]
ds_read_b64_tr_b16 a[8:9], v29 offset:0
ds_read_b64_tr_b16 a[10:11], v29 offset:2048
v_mfma_f32_16x16x32_bf16 v[252:255], a[56:59], v[84:87], v[252:255]
buffer_load_dwordx4 v25, s[16:19], s65 offen offset:1024 lds
v_mfma_f32_16x16x32_bf16 v[252:255], a[60:63], v[92:95], v[252:255]
ds_read_b64_tr_b16 a[12:13], v29 offset:16384
ds_read_b64_tr_b16 a[14:15], v29 offset:18432
v_mfma_f32_16x16x32_bf16 v[188:191], a[60:63], v[88:91], v[188:191]
ds_read_b64_tr_b16 a[16:17], v30 offset:0
ds_read_b64_tr_b16 a[18:19], v30 offset:2048
v_mfma_f32_16x16x32_bf16 v[188:191], a[56:59], v[80:83], v[188:191]
s_waitcnt lgkmcnt(9)
ds_read_b64_tr_b16 a[20:21], v30 offset:16384
ds_read_b64_tr_b16 a[22:23], v30 offset:18432
v_mfma_f32_16x16x32_bf16 v[128:131], a[0:3], v[64:67], v[128:131]
s_waitcnt lgkmcnt(9)
s_waitcnt vmcnt(18)
ds_read_b64_tr_b16 a[24:25], v31 offset:0
v_mfma_f32_16x16x32_bf16 v[128:131], a[4:7], v[72:75], v[128:131]
s_waitcnt lgkmcnt(9)
v_mov_b32 v6, 1
buffer_store_dword v6, off, s[8:11], s81 sc1
ds_read_b64_tr_b16 a[26:27], v31 offset:2048
v_mfma_f32_16x16x32_bf16 v[192:195], a[4:7], v[76:79], v[192:195]
buffer_load_dwordx4 v26, s[16:19], s65 offen offset:2048 lds
v_mfma_f32_16x16x32_bf16 v[192:195], a[0:3], v[68:71], v[192:195]
s_waitcnt lgkmcnt(8)
ds_read_b64_tr_b16 a[28:29], v31 offset:16384
ds_read_b64_tr_b16 a[30:31], v31 offset:18432
v_mfma_f32_16x16x32_bf16 v[196:199], a[8:11], v[68:71], v[196:199]
s_waitcnt lgkmcnt(8)
ds_read_b64_tr_b16 a[32:33], v28 offset:256
v_mfma_f32_16x16x32_bf16 v[196:199], a[12:15], v[76:79], v[196:199]
ds_read_b64_tr_b16 a[34:35], v28 offset:2304
v_mfma_f32_16x16x32_bf16 v[132:135], a[12:15], v[72:75], v[132:135]
buffer_load_dwordx4 v27, s[16:19], s65 offen offset:3072 lds
v_mfma_f32_16x16x32_bf16 v[132:135], a[8:11], v[64:67], v[132:135]
s_waitcnt lgkmcnt(5)
s_mov_b32 s65, 512
ds_read_b64_tr_b16 a[36:37], v28 offset:16640
ds_read_b64_tr_b16 a[38:39], v28 offset:18688
v_mfma_f32_16x16x32_bf16 v[136:139], a[16:19], v[64:67], v[136:139]
s_add_u32 m0, s67, 147456
ds_read_b64_tr_b16 a[40:41], v29 offset:256
ds_read_b64_tr_b16 a[42:43], v29 offset:2304
v_mfma_f32_16x16x32_bf16 v[136:139], a[20:23], v[72:75], v[136:139]
ds_read_b64_tr_b16 a[44:45], v29 offset:16640
v_mfma_f32_16x16x32_bf16 v[200:203], a[20:23], v[76:79], v[200:203]
ds_read_b64_tr_b16 a[46:47], v29 offset:18688
ds_read_b64_tr_b16 a[48:49], v30 offset:256
v_mfma_f32_16x16x32_bf16 v[200:203], a[16:19], v[68:71], v[200:203]
s_waitcnt lgkmcnt(8)
buffer_load_dwordx4 v36, s[12:15], s65 offen offset:0 lds
v_mfma_f32_16x16x32_bf16 v[204:207], a[24:27], v[68:71], v[204:207]
ds_read_b64_tr_b16 a[50:51], v30 offset:2304
ds_read_b64_tr_b16 a[52:53], v30 offset:16640
v_mfma_f32_16x16x32_bf16 v[204:207], a[28:31], v[76:79], v[204:207]
ds_read_b64_tr_b16 a[54:55], v30 offset:18688
v_mfma_f32_16x16x32_bf16 v[140:143], a[28:31], v[72:75], v[140:143]
ds_read_b64_tr_b16 a[56:57], v31 offset:256
ds_read_b64_tr_b16 a[58:59], v31 offset:2304
v_mfma_f32_16x16x32_bf16 v[140:143], a[24:27], v[64:67], v[140:143]
s_waitcnt lgkmcnt(8)
ds_read_b64_tr_b16 a[60:61], v31 offset:16640
v_mfma_f32_16x16x32_bf16 v[144:147], a[32:35], v[64:67], v[144:147]
buffer_load_dwordx4 v37, s[12:15], s65 offen offset:1024 lds
v_mfma_f32_16x16x32_bf16 v[144:147], a[36:39], v[72:75], v[144:147]
ds_read_b64_tr_b16 a[62:63], v31 offset:18688
ds_read_b64_tr_b16 a[0:1], v32 offset:0
v_mfma_f32_16x16x32_bf16 v[208:211], a[36:39], v[76:79], v[208:211]
ds_read_b64_tr_b16 a[2:3], v32 offset:2048
v_mfma_f32_16x16x32_bf16 v[208:211], a[32:35], v[68:71], v[208:211]
ds_read_b64_tr_b16 a[4:5], v32 offset:16384
ds_read_b64_tr_b16 a[6:7], v32 offset:18432
v_mfma_f32_16x16x32_bf16 v[212:215], a[40:43], v[68:71], v[212:215]
s_waitcnt lgkmcnt(8)
ds_read_b64_tr_b16 a[8:9], v33 offset:0
v_mfma_f32_16x16x32_bf16 v[212:215], a[44:47], v[76:79], v[212:215]
buffer_load_dwordx4 v38, s[12:15], s65 offen offset:2048 lds
v_mfma_f32_16x16x32_bf16 v[148:151], a[44:47], v[72:75], v[148:151]
s_add_u32 s76, s76, s78
s_sub_u32 s76, s76, 1572864
ds_read_b64_tr_b16 a[10:11], v33 offset:2048
v_mfma_f32_16x16x32_bf16 v[148:151], a[40:43], v[64:67], v[148:151]
ds_read_b64_tr_b16 a[12:13], v33 offset:16384
v_accvgpr_read_b32 v52, a132
v_mfma_f32_16x16x32_bf16 v[152:155], a[48:51], v[64:67], v[152:155]
ds_read_b64_tr_b16 a[14:15], v33 offset:18432
ds_read_b64_tr_b16 a[16:17], v34 offset:0
v_mfma_f32_16x16x32_bf16 v[152:155], a[52:55], v[72:75], v[152:155]
ds_read_b64_tr_b16 a[18:19], v34 offset:2048
v_accvgpr_read_b32 v53, a133
v_mfma_f32_16x16x32_bf16 v[216:219], a[52:55], v[76:79], v[216:219]
ds_read_b64_tr_b16 a[20:21], v34 offset:16384
ds_read_b64_tr_b16 a[22:23], v34 offset:18432
v_mfma_f32_16x16x32_bf16 v[216:219], a[48:51], v[68:71], v[216:219]
s_waitcnt lgkmcnt(7)
buffer_load_dwordx4 v39, s[12:15], s65 offen offset:3072 lds
v_mfma_f32_16x16x32_bf16 v[220:223], a[56:59], v[68:71], v[220:223]
s_mov_b32 s65, 2359296
ds_read_b64_tr_b16 a[24:25], v35 offset:0
v_accvgpr_read_b32 v54, a134
v_mfma_f32_16x16x32_bf16 v[220:223], a[60:63], v[76:79], v[220:223]
s_add_u32 m0, s67, 49152
ds_read_b64_tr_b16 a[26:27], v35 offset:2048
ds_read_b64_tr_b16 a[28:29], v35 offset:16384
v_mfma_f32_16x16x32_bf16 v[156:159], a[60:63], v[72:75], v[156:159]
ds_read_b64_tr_b16 a[30:31], v35 offset:18432
v_accvgpr_read_b32 v55, a135
v_mfma_f32_16x16x32_bf16 v[156:159], a[56:59], v[64:67], v[156:159]
ds_read_b64_tr_b16 a[32:33], v32 offset:256
ds_read_b64_tr_b16 a[34:35], v32 offset:2304
v_mfma_f32_16x16x32_bf16 v[160:163], a[0:3], v[64:67], v[160:163]
buffer_load_dwordx4 v24, s[16:19], s65 offen offset:0 lds
v_mfma_f32_16x16x32_bf16 v[160:163], a[4:7], v[72:75], v[160:163]
ds_read_b64_tr_b16 a[36:37], v32 offset:16640
ds_read_b64_tr_b16 a[38:39], v32 offset:18688
v_mfma_f32_16x16x32_bf16 v[224:227], a[4:7], v[76:79], v[224:227]
ds_read_b64_tr_b16 a[40:41], v33 offset:256
v_accvgpr_read_b32 v48, a128
v_mfma_f32_16x16x32_bf16 v[224:227], a[0:3], v[68:71], v[224:227]
s_waitcnt lgkmcnt(8)
ds_read_b64_tr_b16 a[42:43], v33 offset:2304
ds_read_b64_tr_b16 a[44:45], v33 offset:16640
v_mfma_f32_16x16x32_bf16 v[228:231], a[8:11], v[68:71], v[228:231]
ds_read_b64_tr_b16 a[46:47], v33 offset:18688
v_accvgpr_read_b32 v49, a129
v_mfma_f32_16x16x32_bf16 v[228:231], a[12:15], v[76:79], v[228:231]
buffer_load_dwordx4 v25, s[16:19], s65 offen offset:1024 lds
v_mfma_f32_16x16x32_bf16 v[164:167], a[12:15], v[72:75], v[164:167]
ds_read_b64_tr_b16 a[48:49], v34 offset:256
ds_read_b64_tr_b16 a[50:51], v34 offset:2304
v_mfma_f32_16x16x32_bf16 v[164:167], a[8:11], v[64:67], v[164:167]
ds_read_b64_tr_b16 a[52:53], v34 offset:16640
ds_read_b64_tr_b16 a[54:55], v34 offset:18688
v_mfma_f32_16x16x32_bf16 v[168:171], a[16:19], v[64:67], v[168:171]
ds_read_b64_tr_b16 a[56:57], v35 offset:256
ds_read_b64_tr_b16 a[58:59], v35 offset:2304
v_mfma_f32_16x16x32_bf16 v[168:171], a[20:23], v[72:75], v[168:171]
ds_read_b64_tr_b16 a[60:61], v35 offset:16640
ds_read_b64_tr_b16 a[62:63], v35 offset:18688
v_mfma_f32_16x16x32_bf16 v[232:235], a[20:23], v[76:79], v[232:235]
buffer_load_dwordx4 v26, s[16:19], s65 offen offset:2048 lds
v_mfma_f32_16x16x32_bf16 v[232:235], a[16:19], v[68:71], v[232:235]
s_waitcnt lgkmcnt(8)
v_accvgpr_read_b32 v50, a130
v_add_u32 v42, 131072, v19
v_mfma_f32_16x16x32_bf16 v[236:239], a[24:27], v[68:71], v[236:239]
v_xor_b32 v43, 64, v42
v_add_u32 v28, 65536, v28
v_mfma_f32_16x16x32_bf16 v[236:239], a[28:31], v[76:79], v[236:239]
v_accvgpr_read_b32 v51, a131
v_add_u32 v29, 65536, v29
v_mfma_f32_16x16x32_bf16 v[172:175], a[28:31], v[72:75], v[172:175]
buffer_load_dwordx4 v27, s[16:19], s65 offen offset:3072 lds
v_mfma_f32_16x16x32_bf16 v[172:175], a[24:27], v[64:67], v[172:175]
v_add_u32 v30, 65536, v30
v_add_u32 v31, 65536, v31
v_mfma_f32_16x16x32_bf16 v[176:179], a[32:35], v[64:67], v[176:179]
v_add_u32 v32, 65536, v32
v_add_u32 v33, 65536, v33
v_mfma_f32_16x16x32_bf16 v[176:179], a[36:39], v[72:75], v[176:179]
v_cvt_pk_bf16_f32 v48, v48, v49
v_add_u32 v34, 65536, v34
v_mfma_f32_16x16x32_bf16 v[240:243], a[36:39], v[76:79], v[240:243]
s_waitcnt vmcnt(13) lgkmcnt(0)
v_add_u32 v35, 65536, v35
v_cvt_pk_bf16_f32 v49, v50, v51
v_mfma_f32_16x16x32_bf16 v[240:243], a[32:35], v[68:71], v[240:243]
s_barrier
v_mfma_f32_16x16x32_bf16 v[244:247], a[40:43], v[68:71], v[244:247]
ds_read_b128 v[80:83], v42 offset:0
v_cvt_pk_bf16_f32 v50, v52, v53
v_mfma_f32_16x16x32_bf16 v[244:247], a[44:47], v[76:79], v[244:247]
s_mov_b32 s65, 2621440
ds_read_b128 v[88:91], v43 offset:0
v_mfma_f32_16x16x32_bf16 v[180:183], a[44:47], v[72:75], v[180:183]
s_add_u32 m0, s67, 0
ds_read_b64_tr_b16 a[0:1], v28 offset:0
v_mfma_f32_16x16x32_bf16 v[180:183], a[40:43], v[64:67], v[180:183]
buffer_load_dwordx4 v24, s[16:19], s65 offen offset:0 lds
v_mfma_f32_16x16x32_bf16 v[184:187], a[48:51], v[64:67], v[184:187]
ds_read_b64_tr_b16 a[2:3], v28 offset:2048
v_cvt_pk_bf16_f32 v51, v54, v55
v_mfma_f32_16x16x32_bf16 v[184:187], a[52:55], v[72:75], v[184:187]
ds_read_b64_tr_b16 a[4:5], v28 offset:16384
ds_read_b64_tr_b16 a[6:7], v28 offset:18432
v_mfma_f32_16x16x32_bf16 v[248:251], a[52:55], v[76:79], v[248:251]
ds_read_b128 v[84:87], v42 offset:2048
ds_read_b128 v[92:95], v43 offset:2048
v_mfma_f32_16x16x32_bf16 v[248:251], a[48:51], v[68:71], v[248:251]
ds_read_b64_tr_b16 a[8:9], v29 offset:0
ds_read_b64_tr_b16 a[10:11], v29 offset:2048
v_mfma_f32_16x16x32_bf16 v[252:255], a[56:59], v[68:71], v[252:255]
buffer_load_dwordx4 v25, s[16:19], s65 offen offset:1024 lds
v_mfma_f32_16x16x32_bf16 v[252:255], a[60:63], v[76:79], v[252:255]
ds_read_b64_tr_b16 a[12:13], v29 offset:16384
ds_read_b64_tr_b16 a[14:15], v29 offset:18432
v_mfma_f32_16x16x32_bf16 v[188:191], a[60:63], v[72:75], v[188:191]
ds_read_b64_tr_b16 a[16:17], v30 offset:0
ds_read_b64_tr_b16 a[18:19], v30 offset:2048
v_mfma_f32_16x16x32_bf16 v[188:191], a[56:59], v[64:67], v[188:191]
s_waitcnt lgkmcnt(10)
ds_read_b64_tr_b16 a[20:21], v30 offset:16384
ds_read_b64_tr_b16 a[22:23], v30 offset:18432
v_mfma_f32_16x16x32_bf16 v[128:131], a[0:3], v[80:83], v[128:131]
s_waitcnt lgkmcnt(10)
buffer_store_dwordx4 v[48:51], v1, s[8:11], s76 offen offset:0 sc1
v_mfma_f32_16x16x32_bf16 v[128:131], a[4:7], v[88:91], v[128:131]
s_waitcnt lgkmcnt(8)
ds_read_b64_tr_b16 a[24:25], v31 offset:0
v_accvgpr_read_b32 v52, a140
v_mfma_f32_16x16x32_bf16 v[192:195], a[4:7], v[92:95], v[192:195]
buffer_load_dwordx4 v26, s[16:19], s65 offen offset:2048 lds
v_mfma_f32_16x16x32_bf16 v[192:195], a[0:3], v[84:87], v[192:195]
s_waitcnt lgkmcnt(7)
ds_read_b64_tr_b16 a[26:27], v31 offset:2048
v_accvgpr_read_b32 v53, a141
v_mfma_f32_16x16x32_bf16 v[196:199], a[8:11], v[84:87], v[196:199]
s_waitcnt lgkmcnt(6)
ds_read_b64_tr_b16 a[28:29], v31 offset:16384
ds_read_b64_tr_b16 a[30:31], v31 offset:18432
v_mfma_f32_16x16x32_bf16 v[196:199], a[12:15], v[92:95], v[196:199]
ds_read_b64_tr_b16 a[32:33], v28 offset:256
v_accvgpr_read_b32 v54, a142
v_mfma_f32_16x16x32_bf16 v[132:135], a[12:15], v[88:91], v[132:135]
ds_read_b64_tr_b16 a[34:35], v28 offset:2304
ds_read_b64_tr_b16 a[36:37], v28 offset:16640
v_mfma_f32_16x16x32_bf16 v[132:135], a[8:11], v[80:83], v[132:135]
s_waitcnt lgkmcnt(7)
buffer_load_dwordx4 v27, s[16:19], s65 offen offset:3072 lds
v_mfma_f32_16x16x32_bf16 v[136:139], a[16:19], v[80:83], v[136:139]
s_mov_b32 s65, 640
ds_read_b64_tr_b16 a[38:39], v28 offset:18688
v_accvgpr_read_b32 v55, a143
v_mfma_f32_16x16x32_bf16 v[136:139], a[20:23], v[88:91], v[136:139]
s_add_u32 m0, s67, 98304
ds_read_b64_tr_b16 a[40:41], v29 offset:256
ds_read_b64_tr_b16 a[42:43], v29 offset:2304
v_mfma_f32_16x16x32_bf16 v[200:203], a[20:23], v[92:95], v[200:203]
ds_read_b64_tr_b16 a[44:45], v29 offset:16640
v_accvgpr_read_b32 v48, a136
v_mfma_f32_16x16x32_bf16 v[200:203], a[16:19], v[84:87], v[200:203]
s_waitcnt lgkmcnt(7)
ds_read_b64_tr_b16 a[46:47], v29 offset:18688
ds_read_b64_tr_b16 a[48:49], v30 offset:256
v_mfma_f32_16x16x32_bf16 v[204:207], a[24:27], v[84:87], v[204:207]
buffer_load_dwordx4 v36, s[12:15], s65 offen offset:0 lds
v_mfma_f32_16x16x32_bf16 v[204:207], a[28:31], v[92:95], v[204:207]
ds_read_b64_tr_b16 a[50:51], v30 offset:2304
v_accvgpr_read_b32 v49, a137
v_mfma_f32_16x16x32_bf16 v[140:143], a[28:31], v[88:91], v[140:143]
ds_read_b64_tr_b16 a[52:53], v30 offset:16640
ds_read_b64_tr_b16 a[54:55], v30 offset:18688
v_mfma_f32_16x16x32_bf16 v[140:143], a[24:27], v[80:83], v[140:143]
s_waitcnt lgkmcnt(8)
ds_read_b64_tr_b16 a[56:57], v31 offset:256
ds_read_b64_tr_b16 a[58:59], v31 offset:2304
v_mfma_f32_16x16x32_bf16 v[144:147], a[32:35], v[80:83], v[144:147]
ds_read_b64_tr_b16 a[60:61], v31 offset:16640
v_accvgpr_read_b32 v50, a138
v_mfma_f32_16x16x32_bf16 v[144:147], a[36:39], v[88:91], v[144:147]
buffer_load_dwordx4 v37, s[12:15], s65 offen offset:1024 lds
v_mfma_f32_16x16x32_bf16 v[208:211], a[36:39], v[92:95], v[208:211]
ds_read_b64_tr_b16 a[62:63], v31 offset:18688
ds_read_b64_tr_b16 a[0:1], v32 offset:0
v_mfma_f32_16x16x32_bf16 v[208:211], a[32:35], v[84:87], v[208:211]
s_waitcnt lgkmcnt(8)
ds_read_b64_tr_b16 a[2:3], v32 offset:2048
v_accvgpr_read_b32 v51, a139
v_mfma_f32_16x16x32_bf16 v[212:215], a[40:43], v[84:87], v[212:215]
ds_read_b64_tr_b16 a[4:5], v32 offset:16384
ds_read_b64_tr_b16 a[6:7], v32 offset:18432
v_mfma_f32_16x16x32_bf16 v[212:215], a[44:47], v[92:95], v[212:215]
ds_read_b64_tr_b16 a[8:9], v33 offset:0
ds_read_b64_tr_b16 a[10:11], v33 offset:2048
v_mfma_f32_16x16x32_bf16 v[148:151], a[44:47], v[88:91], v[148:151]
buffer_load_dwordx4 v38, s[12:15], s65 offen offset:2048 lds
v_mfma_f32_16x16x32_bf16 v[148:151], a[40:43], v[80:83], v[148:151]
s_waitcnt lgkmcnt(7)
ds_read_b64_tr_b16 a[12:13], v33 offset:16384
v_cvt_pk_bf16_f32 v48, v48, v49
v_mfma_f32_16x16x32_bf16 v[152:155], a[48:51], v[80:83], v[152:155]
ds_read_b64_tr_b16 a[14:15], v33 offset:18432
ds_read_b64_tr_b16 a[16:17], v34 offset:0
v_mfma_f32_16x16x32_bf16 v[152:155], a[52:55], v[88:91], v[152:155]
ds_read_b64_tr_b16 a[18:19], v34 offset:2048
v_cvt_pk_bf16_f32 v49, v50, v51
v_mfma_f32_16x16x32_bf16 v[216:219], a[52:55], v[92:95], v[216:219]
ds_read_b64_tr_b16 a[20:21], v34 offset:16384
ds_read_b64_tr_b16 a[22:23], v34 offset:18432
v_mfma_f32_16x16x32_bf16 v[216:219], a[48:51], v[84:87], v[216:219]
buffer_load_dwordx4 v39, s[12:15], s65 offen offset:3072 lds
v_mfma_f32_16x16x32_bf16 v[220:223], a[56:59], v[84:87], v[220:223]
s_waitcnt lgkmcnt(6)
s_mov_b32 s65, 2883584
ds_read_b64_tr_b16 a[24:25], v35 offset:0
v_cvt_pk_bf16_f32 v50, v52, v53
v_mfma_f32_16x16x32_bf16 v[220:223], a[60:63], v[92:95], v[220:223]
s_add_u32 m0, s67, 16384
ds_read_b64_tr_b16 a[26:27], v35 offset:2048
ds_read_b64_tr_b16 a[28:29], v35 offset:16384
v_mfma_f32_16x16x32_bf16 v[156:159], a[60:63], v[88:91], v[156:159]
ds_read_b64_tr_b16 a[30:31], v35 offset:18432
ds_read_b64_tr_b16 a[32:33], v32 offset:256
v_mfma_f32_16x16x32_bf16 v[156:159], a[56:59], v[80:83], v[156:159]
ds_read_b64_tr_b16 a[34:35], v32 offset:2304
v_cvt_pk_bf16_f32 v51, v54, v55
v_mfma_f32_16x16x32_bf16 v[160:163], a[0:3], v[80:83], v[160:163]
buffer_load_dwordx4 v24, s[16:19], s65 offen offset:0 lds
v_mfma_f32_16x16x32_bf16 v[160:163], a[4:7], v[88:91], v[160:163]
ds_read_b64_tr_b16 a[36:37], v32 offset:16640
ds_read_b64_tr_b16 a[38:39], v32 offset:18688
v_mfma_f32_16x16x32_bf16 v[224:227], a[4:7], v[92:95], v[224:227]
ds_read_b64_tr_b16 a[40:41], v33 offset:256
ds_read_b64_tr_b16 a[42:43], v33 offset:2304
v_mfma_f32_16x16x32_bf16 v[224:227], a[0:3], v[84:87], v[224:227]
ds_read_b64_tr_b16 a[44:45], v33 offset:16640
ds_read_b64_tr_b16 a[46:47], v33 offset:18688
v_mfma_f32_16x16x32_bf16 v[228:231], a[8:11], v[84:87], v[228:231]
s_waitcnt lgkmcnt(9)
buffer_store_dwordx4 v[48:51], v1, s[8:11], s76 offen offset:1024 sc1
v_mfma_f32_16x16x32_bf16 v[228:231], a[12:15], v[92:95], v[228:231]
buffer_load_dwordx4 v25, s[16:19], s65 offen offset:1024 lds
v_mfma_f32_16x16x32_bf16 v[164:167], a[12:15], v[88:91], v[164:167]
ds_read_b64_tr_b16 a[48:49], v34 offset:256
ds_read_b64_tr_b16 a[50:51], v34 offset:2304
v_mfma_f32_16x16x32_bf16 v[164:167], a[8:11], v[80:83], v[164:167]
ds_read_b64_tr_b16 a[52:53], v34 offset:16640
ds_read_b64_tr_b16 a[54:55], v34 offset:18688
v_mfma_f32_16x16x32_bf16 v[168:171], a[16:19], v[80:83], v[168:171]
ds_read_b64_tr_b16 a[56:57], v35 offset:256
ds_read_b64_tr_b16 a[58:59], v35 offset:2304
v_mfma_f32_16x16x32_bf16 v[168:171], a[20:23], v[88:91], v[168:171]
ds_read_b64_tr_b16 a[60:61], v35 offset:16640
ds_read_b64_tr_b16 a[62:63], v35 offset:18688
v_mfma_f32_16x16x32_bf16 v[232:235], a[20:23], v[92:95], v[232:235]
v_accvgpr_read_b32 v52, a148
v_accvgpr_read_b32 v53, a149
v_mfma_f32_16x16x32_bf16 v[232:235], a[16:19], v[84:87], v[232:235]
buffer_load_dwordx4 v26, s[16:19], s65 offen offset:2048 lds
v_mfma_f32_16x16x32_bf16 v[236:239], a[24:27], v[84:87], v[236:239]
s_waitcnt lgkmcnt(8)
v_add_u32 v42, 147456, v19
v_xor_b32 v43, 64, v42
v_mfma_f32_16x16x32_bf16 v[236:239], a[28:31], v[92:95], v[236:239]
v_add_u32 v28, 4294934528, v28
v_add_u32 v29, 4294934528, v29
v_mfma_f32_16x16x32_bf16 v[172:175], a[28:31], v[88:91], v[172:175]
v_accvgpr_read_b32 v54, a150
v_add_u32 v30, 4294934528, v30
v_mfma_f32_16x16x32_bf16 v[172:175], a[24:27], v[80:83], v[172:175]
buffer_load_dwordx4 v27, s[16:19], s65 offen offset:3072 lds
v_mfma_f32_16x16x32_bf16 v[176:179], a[32:35], v[80:83], v[176:179]
v_add_u32 v31, 4294934528, v31
v_add_u32 v32, 4294934528, v32
v_mfma_f32_16x16x32_bf16 v[176:179], a[36:39], v[88:91], v[176:179]
v_add_u32 v33, 4294934528, v33
v_accvgpr_read_b32 v55, a151
v_mfma_f32_16x16x32_bf16 v[240:243], a[36:39], v[92:95], v[240:243]
s_waitcnt vmcnt(14) lgkmcnt(0)
v_add_u32 v34, 4294934528, v34
v_add_u32 v35, 4294934528, v35
v_mfma_f32_16x16x32_bf16 v[240:243], a[32:35], v[84:87], v[240:243]
s_barrier
v_accvgpr_read_b32 v48, a144
v_mfma_f32_16x16x32_bf16 v[244:247], a[40:43], v[84:87], v[244:247]
ds_read_b128 v[64:67], v42 offset:0
v_accvgpr_read_b32 v49, a145
v_mfma_f32_16x16x32_bf16 v[244:247], a[44:47], v[92:95], v[244:247]
s_mov_b32 s65, 3145728
ds_read_b128 v[72:75], v43 offset:0
v_mfma_f32_16x16x32_bf16 v[180:183], a[44:47], v[88:91], v[180:183]
s_add_u32 m0, s67, 65536
ds_read_b64_tr_b16 a[0:1], v28 offset:0
v_mfma_f32_16x16x32_bf16 v[180:183], a[40:43], v[80:83], v[180:183]
buffer_load_dwordx4 v24, s[16:19], s65 offen offset:0 lds
v_mfma_f32_16x16x32_bf16 v[184:187], a[48:51], v[80:83], v[184:187]
ds_read_b64_tr_b16 a[2:3], v28 offset:2048
v_accvgpr_read_b32 v50, a146
v_mfma_f32_16x16x32_bf16 v[184:187], a[52:55], v[88:91], v[184:187]
ds_read_b64_tr_b16 a[4:5], v28 offset:16384
ds_read_b64_tr_b16 a[6:7], v28 offset:18432
v_mfma_f32_16x16x32_bf16 v[248:251], a[52:55], v[92:95], v[248:251]
ds_read_b128 v[68:71], v42 offset:2048
v_accvgpr_read_b32 v51, a147
v_mfma_f32_16x16x32_bf16 v[248:251], a[48:51], v[84:87], v[248:251]
ds_read_b128 v[76:79], v43 offset:2048
ds_read_b64_tr_b16 a[8:9], v29 offset:0
v_mfma_f32_16x16x32_bf16 v[252:255], a[56:59], v[84:87], v[252:255]
ds_read_b64_tr_b16 a[10:11], v29 offset:2048
ds_read_b64_tr_b16 a[12:13], v29 offset:16384
v_mfma_f32_16x16x32_bf16 v[252:255], a[60:63], v[92:95], v[252:255]
ds_read_b64_tr_b16 a[14:15], v29 offset:18432
v_mfma_f32_16x16x32_bf16 v[188:191], a[60:63], v[88:91], v[188:191]
ds_read_b64_tr_b16 a[16:17], v30 offset:0
ds_read_b64_tr_b16 a[18:19], v30 offset:2048
v_mfma_f32_16x16x32_bf16 v[188:191], a[56:59], v[80:83], v[188:191]
s_waitcnt lgkmcnt(10)
ds_read_b64_tr_b16 a[20:21], v30 offset:16384
ds_read_b64_tr_b16 a[22:23], v30 offset:18432
v_mfma_f32_16x16x32_bf16 v[128:131], a[0:3], v[64:67], v[128:131]
s_waitcnt lgkmcnt(10)
buffer_load_dwordx4 v25, s[16:19], s65 offen offset:1024 lds
v_mfma_f32_16x16x32_bf16 v[128:131], a[4:7], v[72:75], v[128:131]
s_waitcnt lgkmcnt(8)
ds_read_b64_tr_b16 a[24:25], v31 offset:0
v_cvt_pk_bf16_f32 v48, v48, v49
v_mfma_f32_16x16x32_bf16 v[192:195], a[4:7], v[76:79], v[192:195]
buffer_load_dwordx4 v26, s[16:19], s65 offen offset:2048 lds
v_mfma_f32_16x16x32_bf16 v[192:195], a[0:3], v[68:71], v[192:195]
s_waitcnt lgkmcnt(6)
ds_read_b64_tr_b16 a[26:27], v31 offset:2048
v_cvt_pk_bf16_f32 v49, v50, v51
v_mfma_f32_16x16x32_bf16 v[196:199], a[8:11], v[68:71], v[196:199]
s_waitcnt lgkmcnt(6)
ds_read_b64_tr_b16 a[28:29], v31 offset:16384
ds_read_b64_tr_b16 a[30:31], v31 offset:18432
v_mfma_f32_16x16x32_bf16 v[196:199], a[12:15], v[76:79], v[196:199]
ds_read_b64_tr_b16 a[32:33], v28 offset:256
v_cvt_pk_bf16_f32 v50, v52, v53
v_mfma_f32_16x16x32_bf16 v[132:135], a[12:15], v[72:75], v[132:135]
ds_read_b64_tr_b16 a[34:35], v28 offset:2304
ds_read_b64_tr_b16 a[36:37], v28 offset:16640
v_mfma_f32_16x16x32_bf16 v[132:135], a[8:11], v[64:67], v[132:135]
s_waitcnt lgkmcnt(7)
buffer_load_dwordx4 v27, s[16:19], s65 offen offset:3072 lds
v_mfma_f32_16x16x32_bf16 v[136:139], a[16:19], v[64:67], v[136:139]
s_lshl_b32 s64, s61, 8
s_mov_b32 s65, 768
ds_read_b64_tr_b16 a[38:39], v28 offset:18688
v_mfma_f32_16x16x32_bf16 v[136:139], a[20:23], v[72:75], v[136:139]
s_add_u32 m0, s67, 131072
buffer_load_dword v7, v5, s[8:11], s64 offen sc1
v_mfma_f32_16x16x32_bf16 v[200:203], a[20:23], v[76:79], v[200:203]
ds_read_b64_tr_b16 a[40:41], v29 offset:256
v_cvt_pk_bf16_f32 v51, v54, v55
v_mfma_f32_16x16x32_bf16 v[200:203], a[16:19], v[68:71], v[200:203]
s_waitcnt lgkmcnt(5)
ds_read_b64_tr_b16 a[42:43], v29 offset:2304
ds_read_b64_tr_b16 a[44:45], v29 offset:16640
v_mfma_f32_16x16x32_bf16 v[204:207], a[24:27], v[68:71], v[204:207]
ds_read_b64_tr_b16 a[46:47], v29 offset:18688
ds_read_b64_tr_b16 a[48:49], v30 offset:256
v_mfma_f32_16x16x32_bf16 v[204:207], a[28:31], v[76:79], v[204:207]
buffer_load_dwordx4 v36, s[12:15], s65 offen offset:0 lds
v_mfma_f32_16x16x32_bf16 v[140:143], a[28:31], v[72:75], v[140:143]
ds_read_b64_tr_b16 a[50:51], v30 offset:2304
ds_read_b64_tr_b16 a[52:53], v30 offset:16640
v_mfma_f32_16x16x32_bf16 v[140:143], a[24:27], v[64:67], v[140:143]
s_waitcnt lgkmcnt(7)
buffer_store_dwordx4 v[48:51], v1, s[8:11], s76 offen offset:2048 sc1
v_mfma_f32_16x16x32_bf16 v[144:147], a[32:35], v[64:67], v[144:147]
ds_read_b64_tr_b16 a[54:55], v30 offset:18688
v_accvgpr_read_b32 v52, a156
v_mfma_f32_16x16x32_bf16 v[144:147], a[36:39], v[72:75], v[144:147]
ds_read_b64_tr_b16 a[56:57], v31 offset:256
ds_read_b64_tr_b16 a[58:59], v31 offset:2304
v_mfma_f32_16x16x32_bf16 v[208:211], a[36:39], v[76:79], v[208:211]
ds_read_b64_tr_b16 a[60:61], v31 offset:16640
v_accvgpr_read_b32 v53, a157
v_mfma_f32_16x16x32_bf16 v[208:211], a[32:35], v[68:71], v[208:211]
s_waitcnt lgkmcnt(6)
buffer_load_dwordx4 v37, s[12:15], s65 offen offset:1024 lds
v_mfma_f32_16x16x32_bf16 v[212:215], a[40:43], v[68:71], v[212:215]
ds_read_b64_tr_b16 a[62:63], v31 offset:18688
ds_read_b64_tr_b16 a[0:1], v32 offset:0
v_mfma_f32_16x16x32_bf16 v[212:215], a[44:47], v[76:79], v[212:215]
ds_read_b64_tr_b16 a[2:3], v32 offset:2048
ds_read_b64_tr_b16 a[4:5], v32 offset:16384
v_mfma_f32_16x16x32_bf16 v[148:151], a[44:47], v[72:75], v[148:151]
ds_read_b64_tr_b16 a[6:7], v32 offset:18432
v_accvgpr_read_b32 v54, a158
v_mfma_f32_16x16x32_bf16 v[148:151], a[40:43], v[64:67], v[148:151]
s_waitcnt lgkmcnt(8)
ds_read_b64_tr_b16 a[8:9], v33 offset:0
ds_read_b64_tr_b16 a[10:11], v33 offset:2048
v_mfma_f32_16x16x32_bf16 v[152:155], a[48:51], v[64:67], v[152:155]
buffer_load_dwordx4 v38, s[12:15], s65 offen offset:2048 lds
v_mfma_f32_16x16x32_bf16 v[152:155], a[52:55], v[72:75], v[152:155]
ds_read_b64_tr_b16 a[12:13], v33 offset:16384
v_accvgpr_read_b32 v55, a159
v_mfma_f32_16x16x32_bf16 v[216:219], a[52:55], v[76:79], v[216:219]
ds_read_b64_tr_b16 a[14:15], v33 offset:18432
ds_read_b64_tr_b16 a[16:17], v34 offset:0
v_mfma_f32_16x16x32_bf16 v[216:219], a[48:51], v[68:71], v[216:219]
s_waitcnt lgkmcnt(8)
ds_read_b64_tr_b16 a[18:19], v34 offset:2048
v_accvgpr_read_b32 v48, a152
v_mfma_f32_16x16x32_bf16 v[220:223], a[56:59], v[68:71], v[220:223]
ds_read_b64_tr_b16 a[20:21], v34 offset:16384
ds_read_b64_tr_b16 a[22:23], v34 offset:18432
v_mfma_f32_16x16x32_bf16 v[220:223], a[60:63], v[76:79], v[220:223]
buffer_load_dwordx4 v39, s[12:15], s65 offen offset:3072 lds
v_mfma_f32_16x16x32_bf16 v[156:159], a[60:63], v[72:75], v[156:159]
s_mov_b32 s65, 3407872
ds_read_b64_tr_b16 a[24:25], v35 offset:0
ds_read_b64_tr_b16 a[26:27], v35 offset:2048
v_mfma_f32_16x16x32_bf16 v[156:159], a[56:59], v[64:67], v[156:159]
s_waitcnt lgkmcnt(8)
s_add_u32 m0, s67, 81920
ds_read_b64_tr_b16 a[28:29], v35 offset:16384
v_accvgpr_read_b32 v49, a153
v_mfma_f32_16x16x32_bf16 v[160:163], a[0:3], v[64:67], v[160:163]
ds_read_b64_tr_b16 a[30:31], v35 offset:18432
ds_read_b64_tr_b16 a[32:33], v32 offset:256
v_mfma_f32_16x16x32_bf16 v[160:163], a[4:7], v[72:75], v[160:163]
ds_read_b64_tr_b16 a[34:35], v32 offset:2304
v_accvgpr_read_b32 v50, a154
v_mfma_f32_16x16x32_bf16 v[224:227], a[4:7], v[76:79], v[224:227]
buffer_load_dwordx4 v24, s[16:19], s65 offen offset:0 lds
v_mfma_f32_16x16x32_bf16 v[224:227], a[0:3], v[68:71], v[224:227]
ds_read_b64_tr_b16 a[36:37], v32 offset:16640
ds_read_b64_tr_b16 a[38:39], v32 offset:18688
v_mfma_f32_16x16x32_bf16 v[228:231], a[8:11], v[68:71], v[228:231]
s_waitcnt lgkmcnt(8)
ds_read_b64_tr_b16 a[40:41], v33 offset:256
ds_read_b64_tr_b16 a[42:43], v33 offset:2304
v_mfma_f32_16x16x32_bf16 v[228:231], a[12:15], v[76:79], v[228:231]
ds_read_b64_tr_b16 a[44:45], v33 offset:16640
ds_read_b64_tr_b16 a[46:47], v33 offset:18688
v_mfma_f32_16x16x32_bf16 v[164:167], a[12:15], v[72:75], v[164:167]
ds_read_b64_tr_b16 a[48:49], v34 offset:256
ds_read_b64_tr_b16 a[50:51], v34 offset:2304
v_mfma_f32_16x16x32_bf16 v[164:167], a[8:11], v[64:67], v[164:167]
ds_read_b64_tr_b16 a[52:53], v34 offset:16640
ds_read_b64_tr_b16 a[54:55], v34 offset:18688
v_mfma_f32_16x16x32_bf16 v[168:171], a[16:19], v[64:67], v[168:171]
ds_read_b64_tr_b16 a[56:57], v35 offset:256
ds_read_b64_tr_b16 a[58:59], v35 offset:2304
v_mfma_f32_16x16x32_bf16 v[168:171], a[20:23], v[72:75], v[168:171]
ds_read_b64_tr_b16 a[60:61], v35 offset:16640
ds_read_b64_tr_b16 a[62:63], v35 offset:18688
v_mfma_f32_16x16x32_bf16 v[232:235], a[20:23], v[76:79], v[232:235]
buffer_load_dwordx4 v25, s[16:19], s65 offen offset:1024 lds
v_mfma_f32_16x16x32_bf16 v[232:235], a[16:19], v[68:71], v[232:235]
s_waitcnt lgkmcnt(10)
v_accvgpr_read_b32 v51, a155
v_cvt_pk_bf16_f32 v48, v48, v49
v_mfma_f32_16x16x32_bf16 v[236:239], a[24:27], v[68:71], v[236:239]
buffer_load_dwordx4 v26, s[16:19], s65 offen offset:2048 lds
v_mfma_f32_16x16x32_bf16 v[236:239], a[28:31], v[76:79], v[236:239]
v_add_u32 v42, 98304, v19
v_cvt_pk_bf16_f32 v49, v50, v51
v_mfma_f32_16x16x32_bf16 v[172:175], a[28:31], v[72:75], v[172:175]
v_xor_b32 v43, 64, v42
v_add_u32 v28, 4294934528, v28
v_mfma_f32_16x16x32_bf16 v[172:175], a[24:27], v[64:67], v[172:175]
v_add_u32 v29, 4294934528, v29
v_cvt_pk_bf16_f32 v50, v52, v53
v_mfma_f32_16x16x32_bf16 v[176:179], a[32:35], v[64:67], v[176:179]
v_add_u32 v30, 4294934528, v30
v_add_u32 v31, 4294934528, v31
v_mfma_f32_16x16x32_bf16 v[176:179], a[36:39], v[72:75], v[176:179]
buffer_load_dwordx4 v27, s[16:19], s65 offen offset:3072 lds
v_add_u32 v32, 4294934528, v32
v_add_u32 v33, 4294934528, v33
v_mfma_f32_16x16x32_bf16 v[240:243], a[36:39], v[76:79], v[240:243]
s_waitcnt vmcnt(14) lgkmcnt(0)
v_add_u32 v34, 4294934528, v34
v_add_u32 v35, 4294934528, v35
v_mfma_f32_16x16x32_bf16 v[240:243], a[32:35], v[68:71], v[240:243]
s_barrier
v_cvt_pk_bf16_f32 v51, v54, v55
v_mfma_f32_16x16x32_bf16 v[244:247], a[40:43], v[68:71], v[244:247]
s_bfe_u32 s3, s2, 327683
buffer_store_dwordx4 v[48:51], v1, s[8:11], s76 offen offset:3072 sc1
v_mfma_f32_16x16x32_bf16 v[244:247], a[44:47], v[76:79], v[244:247]
s_add_u32 s76, s76, s77
s_lshl_b32 s3, s3, 2
ds_read_b128 v[80:83], v42 offset:0
v_mfma_f32_16x16x32_bf16 v[180:183], a[44:47], v[72:75], v[180:183]
s_add_u32 s3, s3, s60
ds_read_b128 v[88:91], v43 offset:0
v_accvgpr_read_b32 v52, a164
v_mfma_f32_16x16x32_bf16 v[180:183], a[40:43], v[64:67], v[180:183]
s_mul_i32 s3, s3, 1024
ds_read_b64_tr_b16 a[0:1], v28 offset:0
ds_read_b64_tr_b16 a[2:3], v28 offset:2048
v_mfma_f32_16x16x32_bf16 v[184:187], a[48:51], v[64:67], v[184:187]
ds_read_b64_tr_b16 a[4:5], v28 offset:16384
v_mul_u32_u24 v6, 4, v5
v_mfma_f32_16x16x32_bf16 v[184:187], a[52:55], v[72:75], v[184:187]
ds_read_b64_tr_b16 a[6:7], v28 offset:18432
v_add_u32 v6, s3, v6
v_mfma_f32_16x16x32_bf16 v[248:251], a[52:55], v[76:79], v[248:251]
ds_read_b128 v[84:87], v42 offset:2048
v_accvgpr_read_b32 v53, a165
v_mfma_f32_16x16x32_bf16 v[248:251], a[48:51], v[68:71], v[248:251]
ds_read_b128 v[92:95], v43 offset:2048
v_accvgpr_read_b32 v54, a166
v_mfma_f32_16x16x32_bf16 v[252:255], a[56:59], v[68:71], v[252:255]
ds_read_b64_tr_b16 a[8:9], v29 offset:0
ds_read_b64_tr_b16 a[10:11], v29 offset:2048
v_mfma_f32_16x16x32_bf16 v[252:255], a[60:63], v[76:79], v[252:255]
ds_read_b64_tr_b16 a[12:13], v29 offset:16384
ds_read_b64_tr_b16 a[14:15], v29 offset:18432
v_mfma_f32_16x16x32_bf16 v[188:191], a[60:63], v[72:75], v[188:191]
ds_read_b64_tr_b16 a[16:17], v30 offset:0
ds_read_b64_tr_b16 a[18:19], v30 offset:2048
v_mfma_f32_16x16x32_bf16 v[188:191], a[56:59], v[64:67], v[188:191]
s_waitcnt lgkmcnt(9)
global_load_dword v6, v6, s[4:5]
ds_read_b64_tr_b16 a[20:21], v30 offset:16384
ds_read_b64_tr_b16 a[22:23], v30 offset:18432
v_mfma_f32_16x16x32_bf16 v[128:131], a[0:3], v[80:83], v[128:131]
s_waitcnt lgkmcnt(10)
s_waitcnt vmcnt(11)
v_cmp_eq_u32 vcc, 0, v7
s_nop 0
s_cmp_lg_u64 vcc, 0
s_cbranch_scc1 SPIN7_0
OK7_0:
v_mfma_f32_16x16x32_bf16 v[128:131], a[4:7], v[88:91], v[128:131]
s_waitcnt lgkmcnt(8)
s_sub_u32 s65, s94, s67
ds_read_b64_tr_b16 a[24:25], v31 offset:0
v_accvgpr_read_b32 v55, a167
v_mfma_f32_16x16x32_bf16 v[192:195], a[4:7], v[92:95], v[192:195]
s_mov_b64 s[28:29], s[8:9]
s_add_u32 m0, s65, 16384
ds_read_b64_tr_b16 a[26:27], v31 offset:2048
v_mfma_f32_16x16x32_bf16 v[192:195], a[0:3], v[84:87], v[192:195]
s_waitcnt lgkmcnt(8)
s_mov_b64 s[20:21], s[8:9]
s_add_u32 s65, s93, s67
ds_read_b64_tr_b16 a[28:29], v31 offset:16384
v_mfma_f32_16x16x32_bf16 v[196:199], a[8:11], v[84:87], v[196:199]
s_waitcnt lgkmcnt(7)
ds_read_b64_tr_b16 a[30:31], v31 offset:18432
v_accvgpr_read_b32 v48, a160
v_mfma_f32_16x16x32_bf16 v[196:199], a[12:15], v[92:95], v[196:199]
s_cmp_eq_u32 s92, 2
s_cselect_b32 s22, s10, 0
ds_read_b64_tr_b16 a[32:33], v28 offset:256
v_mfma_f32_16x16x32_bf16 v[132:135], a[12:15], v[88:91], v[132:135]
s_add_u32 s72, s99, 4236247040
buffer_load_dwordx4 v1, s[8:11], s65 offen offset:0 sc1 lds
v_mfma_f32_16x16x32_bf16 v[132:135], a[8:11], v[80:83], v[132:135]
s_waitcnt lgkmcnt(5)
ds_read_b64_tr_b16 a[34:35], v28 offset:2304
v_accvgpr_read_b32 v49, a161
v_mfma_f32_16x16x32_bf16 v[136:139], a[16:19], v[80:83], v[136:139]
s_mov_b32 s79, s81
ds_read_b64_tr_b16 a[36:37], v28 offset:16640
ds_read_b64_tr_b16 a[38:39], v28 offset:18688
v_mfma_f32_16x16x32_bf16 v[136:139], a[20:23], v[88:91], v[136:139]
s_mov_b32 s74, 1
buffer_load_dwordx4 v1, s[8:11], s65 offen offset:1024 sc1 lds
v_mfma_f32_16x16x32_bf16 v[200:203], a[20:23], v[92:95], v[200:203]
ds_read_b64_tr_b16 a[40:41], v29 offset:256
v_accvgpr_read_b32 v50, a162
v_mfma_f32_16x16x32_bf16 v[200:203], a[16:19], v[84:87], v[200:203]
s_waitcnt lgkmcnt(5)
s_lshl_b32 s80, s61, 3
ds_read_b64_tr_b16 a[42:43], v29 offset:2304
ds_read_b64_tr_b16 a[44:45], v29 offset:16640
v_mfma_f32_16x16x32_bf16 v[204:207], a[24:27], v[84:87], v[204:207]
s_add_u32 s80, s80, s84
ds_read_b64_tr_b16 a[46:47], v29 offset:18688
v_accvgpr_read_b32 v51, a163
v_mfma_f32_16x16x32_bf16 v[204:207], a[28:31], v[92:95], v[204:207]
buffer_load_dwordx4 v1, s[8:11], s65 offen offset:2048 sc1 lds
v_mfma_f32_16x16x32_bf16 v[140:143], a[28:31], v[88:91], v[140:143]
s_lshl_b32 s80, s80, 7
ds_read_b64_tr_b16 a[48:49], v30 offset:256
ds_read_b64_tr_b16 a[50:51], v30 offset:2304
v_mfma_f32_16x16x32_bf16 v[140:143], a[24:27], v[80:83], v[140:143]
s_waitcnt lgkmcnt(6)
s_lshl_b32 s63, s60, 2
ds_read_b64_tr_b16 a[52:53], v30 offset:16640
ds_read_b64_tr_b16 a[54:55], v30 offset:18688
v_mfma_f32_16x16x32_bf16 v[144:147], a[32:35], v[80:83], v[144:147]
ds_read_b64_tr_b16 a[56:57], v31 offset:256
v_cvt_pk_bf16_f32 v48, v48, v49
v_mfma_f32_16x16x32_bf16 v[144:147], a[36:39], v[88:91], v[144:147]
s_add_u32 s80, s80, s63
buffer_load_dwordx4 v1, s[8:11], s65 offen offset:3072 sc1 lds
v_mfma_f32_16x16x32_bf16 v[208:211], a[36:39], v[92:95], v[208:211]
s_add_u32 s80, s80, 65536
s_add_u32 s93, s93, 16384
ds_read_b64_tr_b16 a[58:59], v31 offset:2304
v_mfma_f32_16x16x32_bf16 v[208:211], a[32:35], v[84:87], v[208:211]
s_waitcnt lgkmcnt(6)
s_add_u32 s94, s94, 32768
ds_read_b64_tr_b16 a[60:61], v31 offset:16640
ds_read_b64_tr_b16 a[62:63], v31 offset:18688
v_mfma_f32_16x16x32_bf16 v[212:215], a[40:43], v[84:87], v[212:215]
s_lshl_b32 s3, s60, 4
s_and_b32 s94, s94, 0x1ffff
ds_read_b64_tr_b16 a[0:1], v32 offset:0
v_mfma_f32_16x16x32_bf16 v[212:215], a[44:47], v[92:95], v[212:215]
s_cmp_lg_u32 s92, 2
s_subb_u32 s63, s89, 2
s_add_u32 s93, s93, 32768
v_mfma_f32_16x16x32_bf16 v[148:151], a[44:47], v[88:91], v[148:151]
s_add_u32 s94, s94, 32768
ds_read_b64_tr_b16 a[2:3], v32 offset:2048
v_cvt_pk_bf16_f32 v49, v50, v51
v_mfma_f32_16x16x32_bf16 v[148:151], a[40:43], v[80:83], v[148:151]
s_waitcnt lgkmcnt(5)
s_max_i32 s90, s63, 0
s_mov_b32 m0, s94
ds_read_b64_tr_b16 a[4:5], v32 offset:16384
v_mfma_f32_16x16x32_bf16 v[152:155], a[48:51], v[80:83], v[152:155]
s_mul_i32 s63, s61, 229376
ds_read_b64_tr_b16 a[6:7], v32 offset:18432
v_cvt_pk_bf16_f32 v50, v52, v53
v_mfma_f32_16x16x32_bf16 v[152:155], a[52:55], v[88:91], v[152:155]
buffer_load_dwordx4 v3, s[8:11], s93 offen offset:0 sc1 lds
v_mfma_f32_16x16x32_bf16 v[216:219], a[52:55], v[92:95], v[216:219]
s_add_u32 s16, s42, s63
s_addc_u32 s17, s43, 0
ds_read_b64_tr_b16 a[8:9], v33 offset:0
v_mfma_f32_16x16x32_bf16 v[216:219], a[48:51], v[84:87], v[216:219]
s_waitcnt lgkmcnt(4)
s_add_u32 s64, s95, 1261568
ds_read_b64_tr_b16 a[10:11], v33 offset:2048
ds_read_b64_tr_b16 a[12:13], v33 offset:16384
v_mfma_f32_16x16x32_bf16 v[220:223], a[56:59], v[84:87], v[220:223]
ds_read_b64_tr_b16 a[14:15], v33 offset:18432
v_cvt_pk_bf16_f32 v51, v54, v55
v_mfma_f32_16x16x32_bf16 v[220:223], a[60:63], v[92:95], v[220:223]
s_cmp_eq_u32 s92, 3
s_cselect_b64 vcc, -1, 0
s_cselect_b64 s[16:17], s[8:9], s[16:17]
s_cselect_b32 s18, s10, 229376
s_cselect_b32 s101, s64, 0
s_mov_b32 s71, 128
s_cselect_b32 s71, 32768, s71
s_mov_b32 s70, 28672
s_cselect_b32 s70, 4096, s70
s_cselect_b32 s73, s60, 0
v_mfma_f32_16x16x32_bf16 v[156:159], a[60:63], v[88:91], v[156:159]
s_add_u32 s70, s70, s101
ds_read_b64_tr_b16 a[16:17], v34 offset:0
ds_read_b64_tr_b16 a[18:19], v34 offset:2048
v_mfma_f32_16x16x32_bf16 v[156:159], a[56:59], v[80:83], v[156:159]
s_waitcnt lgkmcnt(6)
ds_read_b64_tr_b16 a[20:21], v34 offset:16384
ds_read_b64_tr_b16 a[22:23], v34 offset:18432
v_mfma_f32_16x16x32_bf16 v[160:163], a[0:3], v[80:83], v[160:163]
s_lshl_b32 s63, s91, 7
ds_read_b64_tr_b16 a[24:25], v35 offset:0
ds_read_b64_tr_b16 a[26:27], v35 offset:2048
v_mfma_f32_16x16x32_bf16 v[160:163], a[4:7], v[88:91], v[160:163]
s_lshl_b32 s64, s88, 5
ds_read_b64_tr_b16 a[28:29], v35 offset:16384
ds_read_b64_tr_b16 a[30:31], v35 offset:18432
v_mfma_f32_16x16x32_bf16 v[224:227], a[4:7], v[92:95], v[224:227]
ds_read_b64_tr_b16 a[32:33], v32 offset:256
ds_read_b64_tr_b16 a[34:35], v32 offset:2304
v_mfma_f32_16x16x32_bf16 v[224:227], a[0:3], v[84:87], v[224:227]
s_waitcnt lgkmcnt(10)
s_sub_i32 s63, s63, s64
ds_read_b64_tr_b16 a[36:37], v32 offset:16640
ds_read_b64_tr_b16 a[38:39], v32 offset:18688
v_mfma_f32_16x16x32_bf16 v[228:231], a[8:11], v[84:87], v[228:231]
ds_read_b64_tr_b16 a[40:41], v33 offset:256
ds_read_b64_tr_b16 a[42:43], v33 offset:2304
v_mfma_f32_16x16x32_bf16 v[228:231], a[12:15], v[92:95], v[228:231]
ds_read_b64_tr_b16 a[44:45], v33 offset:16640
ds_read_b64_tr_b16 a[46:47], v33 offset:18688
v_mfma_f32_16x16x32_bf16 v[164:167], a[12:15], v[88:91], v[164:167]
ds_read_b64_tr_b16 a[48:49], v34 offset:256
ds_read_b64_tr_b16 a[50:51], v34 offset:2304
v_mfma_f32_16x16x32_bf16 v[164:167], a[8:11], v[80:83], v[164:167]
s_waitcnt lgkmcnt(12)
ds_read_b64_tr_b16 a[52:53], v34 offset:16640
ds_read_b64_tr_b16 a[54:55], v34 offset:18688
v_mfma_f32_16x16x32_bf16 v[168:171], a[16:19], v[80:83], v[168:171]
buffer_load_dwordx4 v3, s[8:11], s93 offen offset:1024 sc1 lds
ds_read_b64_tr_b16 a[56:57], v35 offset:256
ds_read_b64_tr_b16 a[58:59], v35 offset:2304
v_mfma_f32_16x16x32_bf16 v[168:171], a[20:23], v[88:91], v[168:171]
buffer_load_dwordx4 v3, s[8:11], s93 offen offset:2048 sc1 lds
ds_read_b64_tr_b16 a[60:61], v35 offset:16640
ds_read_b64_tr_b16 a[62:63], v35 offset:18688
v_mfma_f32_16x16x32_bf16 v[232:235], a[20:23], v[92:95], v[232:235]
buffer_load_dwordx4 v3, s[8:11], s93 offen offset:3072 sc1 lds
v_mfma_f32_16x16x32_bf16 v[232:235], a[16:19], v[84:87], v[232:235]
s_add_u32 m0, s94, 4096
buffer_store_dwordx4 v[48:51], v1, s[8:11], s76 offen offset:0 sc1
v_mfma_f32_16x16x32_bf16 v[236:239], a[24:27], v[84:87], v[236:239]
s_waitcnt lgkmcnt(8)
buffer_load_dwordx4 v4, s[8:11], s93 offen offset:0 sc1 lds
v_mfma_f32_16x16x32_bf16 v[236:239], a[28:31], v[92:95], v[236:239]
buffer_load_dwordx4 v4, s[8:11], s93 offen offset:1024 sc1 lds
v_mfma_f32_16x16x32_bf16 v[172:175], a[28:31], v[88:91], v[172:175]
buffer_load_dwordx4 v4, s[8:11], s93 offen offset:2048 sc1 lds
v_add_u32 v42, 131072, v19
v_xor_b32 v43, 64, v42
v_mfma_f32_16x16x32_bf16 v[172:175], a[24:27], v[80:83], v[172:175]
buffer_load_dwordx4 v4, s[8:11], s93 offen offset:3072 sc1 lds
v_add_u32 v28, 65536, v28
v_add_u32 v29, 65536, v29
v_mfma_f32_16x16x32_bf16 v[176:179], a[32:35], v[80:83], v[176:179]
s_add_u32 s93, s93, 4294934528
v_add_u32 v30, 65536, v30
v_add_u32 v31, 65536, v31
v_mfma_f32_16x16x32_bf16 v[176:179], a[36:39], v[88:91], v[176:179]
s_add_u32 s94, s94, 4294934528
v_add_u32 v32, 65536, v32
v_add_u32 v33, 65536, v33
v_mfma_f32_16x16x32_bf16 v[240:243], a[36:39], v[92:95], v[240:243]
s_waitcnt vmcnt(15) lgkmcnt(0)
v_add_u32 v34, 65536, v34
v_add_u32 v35, 65536, v35
v_mfma_f32_16x16x32_bf16 v[240:243], a[32:35], v[84:87], v[240:243]
s_barrier
v_accvgpr_read_b32 v52, a172
v_accvgpr_read_b32 v53, a173
v_mfma_f32_16x16x32_bf16 v[244:247], a[40:43], v[84:87], v[244:247]
v_accvgpr_read_b32 v54, a174
v_accvgpr_read_b32 v55, a175
v_mfma_f32_16x16x32_bf16 v[244:247], a[44:47], v[92:95], v[244:247]
v_accvgpr_read_b32 v48, a168
v_accvgpr_read_b32 v49, a169
v_mfma_f32_16x16x32_bf16 v[180:183], a[44:47], v[88:91], v[180:183]
s_mov_b32 m0, s94
ds_read_b128 v[64:67], v42 offset:0
v_accvgpr_read_b32 v50, a170
v_mfma_f32_16x16x32_bf16 v[180:183], a[40:43], v[80:83], v[180:183]
ds_read_b128 v[72:75], v43 offset:0
v_accvgpr_read_b32 v51, a171
v_mfma_f32_16x16x32_bf16 v[184:187], a[48:51], v[80:83], v[184:187]
ds_read_b64_tr_b16 a[0:1], v28 offset:0
v_cvt_pk_bf16_f32 v48, v48, v49
v_mfma_f32_16x16x32_bf16 v[184:187], a[52:55], v[88:91], v[184:187]
ds_read_b64_tr_b16 a[2:3], v28 offset:2048
ds_read_b64_tr_b16 a[4:5], v28 offset:16384
v_mfma_f32_16x16x32_bf16 v[248:251], a[52:55], v[92:95], v[248:251]
ds_read_b64_tr_b16 a[6:7], v28 offset:18432
v_cvt_pk_bf16_f32 v49, v50, v51
v_mfma_f32_16x16x32_bf16 v[248:251], a[48:51], v[84:87], v[248:251]
ds_read_b128 v[68:71], v42 offset:2048
ds_read_b128 v[76:79], v43 offset:2048
v_mfma_f32_16x16x32_bf16 v[252:255], a[56:59], v[84:87], v[252:255]
ds_read_b64_tr_b16 a[8:9], v29 offset:0
ds_read_b64_tr_b16 a[10:11], v29 offset:2048
v_mfma_f32_16x16x32_bf16 v[252:255], a[60:63], v[92:95], v[252:255]
ds_read_b64_tr_b16 a[12:13], v29 offset:16384
ds_read_b64_tr_b16 a[14:15], v29 offset:18432
v_mfma_f32_16x16x32_bf16 v[188:191], a[60:63], v[88:91], v[188:191]
ds_read_b64_tr_b16 a[16:17], v30 offset:0
ds_read_b64_tr_b16 a[18:19], v30 offset:2048
v_mfma_f32_16x16x32_bf16 v[188:191], a[56:59], v[80:83], v[188:191]
s_waitcnt lgkmcnt(10)
ds_read_b64_tr_b16 a[20:21], v30 offset:16384
ds_read_b64_tr_b16 a[22:23], v30 offset:18432
v_mfma_f32_16x16x32_bf16 v[128:131], a[0:3], v[64:67], v[128:131]
s_waitcnt lgkmcnt(10)
buffer_load_dwordx4 v3, s[8:11], s93 offen offset:0 sc1 lds
v_mfma_f32_16x16x32_bf16 v[128:131], a[4:7], v[72:75], v[128:131]
s_waitcnt lgkmcnt(8)
buffer_load_dwordx4 v3, s[8:11], s93 offen offset:1024 sc1 lds
v_mfma_f32_16x16x32_bf16 v[192:195], a[4:7], v[76:79], v[192:195]
ds_read_b64_tr_b16 a[24:25], v31 offset:0
v_cvt_pk_bf16_f32 v50, v52, v53
v_mfma_f32_16x16x32_bf16 v[192:195], a[0:3], v[68:71], v[192:195]
s_waitcnt lgkmcnt(7)
ds_read_b64_tr_b16 a[26:27], v31 offset:2048
v_bfe_u32 v22, v1, 4, 4
v_mfma_f32_16x16x32_bf16 v[196:199], a[8:11], v[68:71], v[196:199]
s_waitcnt lgkmcnt(6)
ds_read_b64_tr_b16 a[28:29], v31 offset:16384
ds_read_b64_tr_b16 a[30:31], v31 offset:18432
v_cvt_pk_bf16_f32 v51, v54, v55
v_mfma_f32_16x16x32_bf16 v[196:199], a[12:15], v[76:79], v[196:199]
buffer_store_dwordx4 v[48:51], v1, s[8:11], s76 offen offset:1024 sc1
v_mfma_f32_16x16x32_bf16 v[132:135], a[12:15], v[72:75], v[132:135]
buffer_load_dwordx4 v3, s[8:11], s93 offen offset:2048 sc1 lds
v_mfma_f32_16x16x32_bf16 v[132:135], a[8:11], v[64:67], v[132:135]
s_waitcnt lgkmcnt(4)
ds_read_b64_tr_b16 a[32:33], v28 offset:256
ds_read_b64_tr_b16 a[34:35], v28 offset:2304
v_mfma_f32_16x16x32_bf16 v[136:139], a[16:19], v[64:67], v[136:139]
ds_read_b64_tr_b16 a[36:37], v28 offset:16640
ds_read_b64_tr_b16 a[38:39], v28 offset:18688
v_mfma_f32_16x16x32_bf16 v[136:139], a[20:23], v[72:75], v[136:139]
v_lshrrev_b32 v23, 8, v1
v_lshlrev_b32 v23, 2, v23
v_mfma_f32_16x16x32_bf16 v[200:203], a[20:23], v[76:79], v[200:203]
buffer_load_dwordx4 v3, s[8:11], s93 offen offset:3072 sc1 lds
v_mfma_f32_16x16x32_bf16 v[200:203], a[16:19], v[68:71], v[200:203]
s_waitcnt lgkmcnt(4)
s_add_u32 m0, s94, 4096
ds_read_b64_tr_b16 a[40:41], v29 offset:256
ds_read_b64_tr_b16 a[42:43], v29 offset:2304
v_mfma_f32_16x16x32_bf16 v[204:207], a[24:27], v[68:71], v[204:207]
ds_read_b64_tr_b16 a[44:45], v29 offset:16640
ds_read_b64_tr_b16 a[46:47], v29 offset:18688
v_mfma_f32_16x16x32_bf16 v[204:207], a[28:31], v[76:79], v[204:207]
v_sub_u32 v22, v22, v23
v_add_u32 v17, s3, v22
v_mfma_f32_16x16x32_bf16 v[140:143], a[28:31], v[72:75], v[140:143]
v_add_u32 v22, s63, v17
v_cvt_f32_i32 v22, v22
v_mfma_f32_16x16x32_bf16 v[140:143], a[24:27], v[64:67], v[140:143]
s_waitcnt lgkmcnt(4)
ds_read_b64_tr_b16 a[48:49], v30 offset:256
ds_read_b64_tr_b16 a[50:51], v30 offset:2304
v_mfma_f32_16x16x32_bf16 v[144:147], a[32:35], v[64:67], v[144:147]
ds_read_b64_tr_b16 a[52:53], v30 offset:16640
ds_read_b64_tr_b16 a[54:55], v30 offset:18688
v_mfma_f32_16x16x32_bf16 v[144:147], a[36:39], v[72:75], v[144:147]
buffer_load_dwordx4 v4, s[8:11], s93 offen offset:0 sc1 lds
v_mfma_f32_16x16x32_bf16 v[208:211], a[36:39], v[76:79], v[208:211]
v_add_f32 v22, 0.5, v22
v_mul_f32 v16, 0x71800000, v22
v_mfma_f32_16x16x32_bf16 v[208:211], a[32:35], v[68:71], v[208:211]
s_waitcnt lgkmcnt(4)
buffer_load_dwordx4 v4, s[8:11], s93 offen offset:1024 sc1 lds
ds_read_b64_tr_b16 a[56:57], v31 offset:256
ds_read_b64_tr_b16 a[58:59], v31 offset:2304
v_mfma_f32_16x16x32_bf16 v[212:215], a[40:43], v[68:71], v[212:215]
buffer_load_dwordx4 v4, s[8:11], s93 offen offset:2048 sc1 lds
ds_read_b64_tr_b16 a[60:61], v31 offset:16640
ds_read_b64_tr_b16 a[62:63], v31 offset:18688
v_mfma_f32_16x16x32_bf16 v[212:215], a[44:47], v[76:79], v[212:215]
buffer_load_dwordx4 v4, s[8:11], s93 offen offset:3072 sc1 lds
v_mfma_f32_16x16x32_bf16 v[148:151], a[44:47], v[72:75], v[148:151]
s_add_u32 s93, s93, 65536
v_mov_b32 v22, 1035512379
v_mov_b32 v23, 1035512379
v_mfma_f32_16x16x32_bf16 v[148:151], a[40:43], v[64:67], v[148:151]
s_waitcnt lgkmcnt(4)
s_add_u32 s94, s94, 65536
ds_read_b64_tr_b16 a[0:1], v32 offset:0
ds_read_b64_tr_b16 a[2:3], v32 offset:2048
v_mfma_f32_16x16x32_bf16 v[152:155], a[48:51], v[64:67], v[152:155]
ds_read_b64_tr_b16 a[4:5], v32 offset:16384
ds_read_b64_tr_b16 a[6:7], v32 offset:18432
v_mfma_f32_16x16x32_bf16 v[152:155], a[52:55], v[72:75], v[152:155]
v_mov_b32 v20, 0xec800000
v_mov_b32 v21, 0xec800000
v_mfma_f32_16x16x32_bf16 v[216:219], a[52:55], v[76:79], v[216:219]
ds_read_b64_tr_b16 a[8:9], v33 offset:0
v_add_f32 v96, 0x00000000, v16
v_mfma_f32_16x16x32_bf16 v[216:219], a[48:51], v[68:71], v[216:219]
s_waitcnt lgkmcnt(5)
ds_read_b64_tr_b16 a[10:11], v33 offset:2048
v_min_f32 v96, 0, v96
v_mfma_f32_16x16x32_bf16 v[220:223], a[56:59], v[68:71], v[220:223]
ds_read_b64_tr_b16 a[12:13], v33 offset:16384
ds_read_b64_tr_b16 a[14:15], v33 offset:18432
v_mfma_f32_16x16x32_bf16 v[220:223], a[60:63], v[76:79], v[220:223]
v_add_f32 v97, 0xf1800000, v16
v_min_f32 v97, 0, v97
v_mfma_f32_16x16x32_bf16 v[156:159], a[60:63], v[72:75], v[156:159]
ds_read_b64_tr_b16 a[16:17], v34 offset:0
ds_read_b64_tr_b16 a[18:19], v34 offset:2048
v_mfma_f32_16x16x32_bf16 v[156:159], a[56:59], v[64:67], v[156:159]
s_waitcnt lgkmcnt(6)
ds_read_b64_tr_b16 a[20:21], v34 offset:16384
ds_read_b64_tr_b16 a[22:23], v34 offset:18432
v_mfma_f32_16x16x32_bf16 v[160:163], a[0:3], v[64:67], v[160:163]
ds_read_b64_tr_b16 a[24:25], v35 offset:0
ds_read_b64_tr_b16 a[26:27], v35 offset:2048
v_mfma_f32_16x16x32_bf16 v[160:163], a[4:7], v[72:75], v[160:163]
ds_read_b64_tr_b16 a[28:29], v35 offset:16384
ds_read_b64_tr_b16 a[30:31], v35 offset:18432
v_mfma_f32_16x16x32_bf16 v[224:227], a[4:7], v[76:79], v[224:227]
ds_read_b64_tr_b16 a[32:33], v32 offset:256
ds_read_b64_tr_b16 a[34:35], v32 offset:2304
v_mfma_f32_16x16x32_bf16 v[224:227], a[0:3], v[68:71], v[224:227]
s_waitcnt lgkmcnt(10)
ds_read_b64_tr_b16 a[36:37], v32 offset:16640
ds_read_b64_tr_b16 a[38:39], v32 offset:18688
v_mfma_f32_16x16x32_bf16 v[228:231], a[8:11], v[68:71], v[228:231]
ds_read_b64_tr_b16 a[40:41], v33 offset:256
ds_read_b64_tr_b16 a[42:43], v33 offset:2304
v_mfma_f32_16x16x32_bf16 v[228:231], a[12:15], v[76:79], v[228:231]
ds_read_b64_tr_b16 a[44:45], v33 offset:16640
ds_read_b64_tr_b16 a[46:47], v33 offset:18688
v_mfma_f32_16x16x32_bf16 v[164:167], a[12:15], v[72:75], v[164:167]
ds_read_b64_tr_b16 a[48:49], v34 offset:256
ds_read_b64_tr_b16 a[50:51], v34 offset:2304
v_mfma_f32_16x16x32_bf16 v[164:167], a[8:11], v[64:67], v[164:167]
s_waitcnt lgkmcnt(12)
ds_read_b64_tr_b16 a[52:53], v34 offset:16640
ds_read_b64_tr_b16 a[54:55], v34 offset:18688
v_mfma_f32_16x16x32_bf16 v[168:171], a[16:19], v[64:67], v[168:171]
ds_read_b64_tr_b16 a[56:57], v35 offset:256
ds_read_b64_tr_b16 a[58:59], v35 offset:2304
v_mfma_f32_16x16x32_bf16 v[168:171], a[20:23], v[72:75], v[168:171]
ds_read_b64_tr_b16 a[60:61], v35 offset:16640
ds_read_b64_tr_b16 a[62:63], v35 offset:18688
v_mfma_f32_16x16x32_bf16 v[232:235], a[20:23], v[76:79], v[232:235]
v_add_f32 v98, 0xf2000000, v16
v_min_f32 v98, 0, v98
v_mfma_f32_16x16x32_bf16 v[232:235], a[16:19], v[68:71], v[232:235]
v_add_f32 v99, 0xf2400000, v16
v_min_f32 v99, 0, v99
v_mfma_f32_16x16x32_bf16 v[236:239], a[24:27], v[68:71], v[236:239]
s_waitcnt lgkmcnt(8)
v_add_f32 v104, 0x74800000, v16
v_min_f32 v104, 0, v104
v_mfma_f32_16x16x32_bf16 v[236:239], a[28:31], v[76:79], v[236:239]
v_add_f32 v105, 0x747c0000, v16
v_min_f32 v105, 0, v105
v_mfma_f32_16x16x32_bf16 v[172:175], a[28:31], v[72:75], v[172:175]
v_add_f32 v106, 0x74780000, v16
v_min_f32 v106, 0, v106
v_mfma_f32_16x16x32_bf16 v[172:175], a[24:27], v[64:67], v[172:175]
v_add_f32 v107, 0x74740000, v16
v_min_f32 v107, 0, v107
v_mfma_f32_16x16x32_bf16 v[176:179], a[32:35], v[64:67], v[176:179]
v_add_f32 v100, 0xf3800000, v16
v_min_f32 v100, 0, v100
v_mfma_f32_16x16x32_bf16 v[176:179], a[36:39], v[72:75], v[176:179]
v_add_u32 v46, 0x10000, v1
v_add_f32 v101, 0xf3880000, v16
v_mfma_f32_16x16x32_bf16 v[240:243], a[36:39], v[76:79], v[240:243]
s_waitcnt vmcnt(18) lgkmcnt(0)
v_min_f32 v101, 0, v101
v_add_f32 v102, 0xf3900000, v16
v_mfma_f32_16x16x32_bf16 v[240:243], a[32:35], v[68:71], v[240:243]
s_barrier
v_min_f32 v102, 0, v102
v_add_f32 v103, 0xf3980000, v16
v_mfma_f32_16x16x32_bf16 v[244:247], a[40:43], v[68:71], v[244:247]
v_min_f32 v103, 0, v103
v_add_f32 v108, 0x74400000, v16
v_mfma_f32_16x16x32_bf16 v[244:247], a[44:47], v[76:79], v[244:247]
ds_read_b128 a[0:3], v46 offset:49152
v_min_f32 v108, 0, v108
v_mfma_f32_16x16x32_bf16 v[180:183], a[44:47], v[72:75], v[180:183]
ds_read_b128 a[4:7], v46 offset:50176
v_add_f32 v109, 0x743c0000, v16
v_mfma_f32_16x16x32_bf16 v[180:183], a[40:43], v[64:67], v[180:183]
v_mfma_f32_16x16x32_bf16 v[184:187], a[48:51], v[64:67], v[184:187]
ds_read_b128 a[8:11], v46 offset:51200
v_min_f32 v109, 0, v109
v_mfma_f32_16x16x32_bf16 v[184:187], a[52:55], v[72:75], v[184:187]
ds_read_b128 a[12:15], v46 offset:52224
v_add_f32 v110, 0x74380000, v16
v_mfma_f32_16x16x32_bf16 v[248:251], a[52:55], v[76:79], v[248:251]
v_min_f32 v110, 0, v110
v_add_f32 v111, 0x74340000, v16
v_mfma_f32_16x16x32_bf16 v[248:251], a[48:51], v[68:71], v[248:251]
ds_read_b128 a[16:19], v46 offset:53248
v_min_f32 v111, 0, v111
v_mfma_f32_16x16x32_bf16 v[252:255], a[56:59], v[68:71], v[252:255]
v_mfma_f32_16x16x32_bf16 v[252:255], a[60:63], v[76:79], v[252:255]
ds_read_b128 a[20:23], v46 offset:54272
v_mfma_f32_16x16x32_bf16 v[188:191], a[60:63], v[72:75], v[188:191]
v_mfma_f32_16x16x32_bf16 v[188:191], a[56:59], v[64:67], v[188:191]
ds_read_b128 a[24:27], v46 offset:55296
s_cmp_eq_u32 s62, 6
s_cbranch_scc1 BO
.p2align 3
ds_read_b128 a[28:31], v46 offset:56320
ds_read_b128 a[32:35], v46 offset:57344
ds_read_b128 a[36:39], v46 offset:58368
ds_read_b128 a[40:43], v46 offset:59392
ds_read_b128 a[44:47], v46 offset:60416
ds_read_b128 a[48:51], v46 offset:61440
ds_read_b128 a[52:55], v46 offset:62464
ds_read_b128 a[56:59], v46 offset:63488
ds_read_b128 a[60:63], v46 offset:64512
v_pk_mul_f32 v[128:129], v[128:129], v[22:23]
s_mov_b32 m0, s94
.p2align 3
v_pk_mul_f32 v[130:131], v[130:131], v[22:23]
v_pk_mul_f32 v[132:133], v[132:133], v[22:23]
v_pk_mul_f32 v[134:135], v[134:135], v[22:23]
v_pk_mul_f32 v[192:193], v[192:193], v[22:23]
buffer_load_dwordx4 v3, s[8:11], s93 offen offset:0 sc1 lds
v_pk_mul_f32 v[194:195], v[194:195], v[22:23]
v_pk_mul_f32 v[196:197], v[196:197], v[22:23]
v_pk_mul_f32 v[198:199], v[198:199], v[22:23]
v_pk_mul_f32 v[136:137], v[136:137], v[22:23]
v_pk_mul_f32 v[138:139], v[138:139], v[22:23]
buffer_load_dwordx4 v3, s[8:11], s93 offen offset:1024 sc1 lds
v_pk_mul_f32 v[140:141], v[140:141], v[22:23]
v_pk_mul_f32 v[142:143], v[142:143], v[22:23]
v_pk_mul_f32 v[200:201], v[200:201], v[22:23]
v_pk_mul_f32 v[202:203], v[202:203], v[22:23]
v_pk_mul_f32 v[204:205], v[204:205], v[22:23]
buffer_load_dwordx4 v3, s[8:11], s93 offen offset:2048 sc1 lds
v_pk_mul_f32 v[206:207], v[206:207], v[22:23]
v_pk_mul_f32 v[144:145], v[144:145], v[22:23]
v_pk_mul_f32 v[146:147], v[146:147], v[22:23]
v_pk_mul_f32 v[148:149], v[148:149], v[22:23]
v_pk_mul_f32 v[150:151], v[150:151], v[22:23]
buffer_load_dwordx4 v3, s[8:11], s93 offen offset:3072 sc1 lds
v_pk_mul_f32 v[208:209], v[208:209], v[22:23]
v_pk_mul_f32 v[210:211], v[210:211], v[22:23]
v_pk_mul_f32 v[212:213], v[212:213], v[22:23]
v_pk_mul_f32 v[214:215], v[214:215], v[22:23]
v_pk_mul_f32 v[152:153], v[152:153], v[22:23]
s_add_u32 m0, s94, 4096
v_pk_mul_f32 v[154:155], v[154:155], v[22:23]
v_pk_mul_f32 v[156:157], v[156:157], v[22:23]
v_pk_mul_f32 v[158:159], v[158:159], v[22:23]
v_pk_mul_f32 v[216:217], v[216:217], v[22:23]
v_pk_mul_f32 v[218:219], v[218:219], v[22:23]
buffer_load_dwordx4 v4, s[8:11], s93 offen offset:0 sc1 lds
v_pk_mul_f32 v[220:221], v[220:221], v[22:23]
v_pk_mul_f32 v[222:223], v[222:223], v[22:23]
v_pk_mul_f32 v[160:161], v[160:161], v[22:23]
v_pk_mul_f32 v[162:163], v[162:163], v[22:23]
v_pk_mul_f32 v[164:165], v[164:165], v[22:23]
buffer_load_dwordx4 v4, s[8:11], s93 offen offset:1024 sc1 lds
v_pk_mul_f32 v[166:167], v[166:167], v[22:23]
v_pk_mul_f32 v[224:225], v[224:225], v[22:23]
v_pk_mul_f32 v[226:227], v[226:227], v[22:23]
v_pk_mul_f32 v[228:229], v[228:229], v[22:23]
v_pk_mul_f32 v[230:231], v[230:231], v[22:23]
buffer_load_dwordx4 v4, s[8:11], s93 offen offset:2048 sc1 lds
v_pk_mul_f32 v[168:169], v[168:169], v[22:23]
v_pk_mul_f32 v[170:171], v[170:171], v[22:23]
v_pk_mul_f32 v[172:173], v[172:173], v[22:23]
v_pk_mul_f32 v[174:175], v[174:175], v[22:23]
v_pk_mul_f32 v[232:233], v[232:233], v[22:23]
buffer_load_dwordx4 v4, s[8:11], s93 offen offset:3072 sc1 lds
v_pk_mul_f32 v[234:235], v[234:235], v[22:23]
v_pk_mul_f32 v[236:237], v[236:237], v[22:23]
v_pk_mul_f32 v[238:239], v[238:239], v[22:23]
v_pk_mul_f32 v[176:177], v[176:177], v[22:23]
v_pk_mul_f32 v[178:179], v[178:179], v[22:23]
s_add_u32 s93, s93, 32768
v_pk_mul_f32 v[180:181], v[180:181], v[22:23]
v_pk_mul_f32 v[182:183], v[182:183], v[22:23]
v_pk_mul_f32 v[240:241], v[240:241], v[22:23]
v_pk_mul_f32 v[242:243], v[242:243], v[22:23]
v_pk_mul_f32 v[244:245], v[244:245], v[22:23]
s_add_u32 s94, s94, 32768
v_pk_mul_f32 v[246:247], v[246:247], v[22:23]
v_pk_mul_f32 v[184:185], v[184:185], v[22:23]
v_pk_mul_f32 v[186:187], v[186:187], v[22:23]
v_pk_mul_f32 v[188:189], v[188:189], v[22:23]
v_pk_mul_f32 v[190:191], v[190:191], v[22:23]
s_and_b32 s94, s94, 0x1ffff
v_pk_mul_f32 v[248:249], v[248:249], v[22:23]
v_pk_mul_f32 v[250:251], v[250:251], v[22:23]
v_pk_mul_f32 v[252:253], v[252:253], v[22:23]
v_pk_mul_f32 v[254:255], v[254:255], v[22:23]
v_cvt_pk_bf16_f32 v128, v128, v129
v_cvt_pk_bf16_f32 v129, v130, v131
v_cvt_pk_bf16_f32 v130, v132, v133
v_cvt_pk_bf16_f32 v131, v134, v135
v_cvt_pk_bf16_f32 v192, v192, v193
v_cvt_pk_bf16_f32 v193, v194, v195
v_cvt_pk_bf16_f32 v194, v196, v197
v_cvt_pk_bf16_f32 v195, v198, v199
s_waitcnt vmcnt(8) lgkmcnt(0)
s_barrier
v_mfma_f32_16x16x32_bf16 v[64:67], a[0:3], v[128:131], v[96:99]
s_mov_b32 s63, s72
.p2align 3
s_add_u32 s64, s72, 8192
buffer_store_dwordx4 v[128:131], v1, s[20:23], s63 offen offset:0 sc1
v_cvt_pk_bf16_f32 v136, v136, v137
v_cvt_pk_bf16_f32 v137, v138, v139
v_cvt_pk_bf16_f32 v138, v140, v141
v_cvt_pk_bf16_f32 v139, v142, v143
v_mfma_f32_16x16x32_bf16 v[68:71], a[32:35], v[128:131], v[100:103]
v_accvgpr_write_b32 a64, v128
v_accvgpr_write_b32 a65, v129
v_accvgpr_write_b32 a66, v130
v_accvgpr_write_b32 a67, v131
v_mfma_f32_16x16x32_bf16 v[76:79], a[32:35], v[192:195], v[108:111]
buffer_store_dwordx4 v[192:195], v1, s[20:23], s64 offen offset:0 sc1
v_cvt_pk_bf16_f32 v200, v200, v201
v_cvt_pk_bf16_f32 v201, v202, v203
v_cvt_pk_bf16_f32 v202, v204, v205
v_cvt_pk_bf16_f32 v203, v206, v207
v_mfma_f32_16x16x32_bf16 v[72:75], a[0:3], v[192:195], v[104:107]
v_accvgpr_write_b32 a96, v192
v_accvgpr_write_b32 a97, v193
v_accvgpr_write_b32 a98, v194
v_accvgpr_write_b32 a99, v195
v_mfma_f32_16x16x32_bf16 v[64:67], a[4:7], v[136:139], v[64:67]
buffer_store_dwordx4 v[136:139], v1, s[20:23], s63 offen offset:1024 sc1
v_cvt_pk_bf16_f32 v144, v144, v145
v_cvt_pk_bf16_f32 v145, v146, v147
v_cvt_pk_bf16_f32 v146, v148, v149
v_cvt_pk_bf16_f32 v147, v150, v151
v_mfma_f32_16x16x32_bf16 v[68:71], a[36:39], v[136:139], v[68:71]
v_accvgpr_write_b32 a68, v136
v_accvgpr_write_b32 a69, v137
v_accvgpr_write_b32 a70, v138
v_accvgpr_write_b32 a71, v139
v_mfma_f32_16x16x32_bf16 v[76:79], a[36:39], v[200:203], v[76:79]
buffer_store_dwordx4 v[200:203], v1, s[20:23], s64 offen offset:1024 sc1
v_cvt_pk_bf16_f32 v208, v208, v209
v_cvt_pk_bf16_f32 v209, v210, v211
v_cvt_pk_bf16_f32 v210, v212, v213
v_cvt_pk_bf16_f32 v211, v214, v215
v_mfma_f32_16x16x32_bf16 v[72:75], a[4:7], v[200:203], v[72:75]
v_accvgpr_write_b32 a100, v200
v_accvgpr_write_b32 a101, v201
v_accvgpr_write_b32 a102, v202
v_accvgpr_write_b32 a103, v203
v_mfma_f32_16x16x32_bf16 v[64:67], a[8:11], v[144:147], v[64:67]
buffer_store_dwordx4 v[144:147], v1, s[20:23], s63 offen offset:2048 sc1
v_cvt_pk_bf16_f32 v152, v152, v153
v_cvt_pk_bf16_f32 v153, v154, v155
v_cvt_pk_bf16_f32 v154, v156, v157
v_cvt_pk_bf16_f32 v155, v158, v159
v_mfma_f32_16x16x32_bf16 v[68:71], a[40:43], v[144:147], v[68:71]
v_accvgpr_write_b32 a72, v144
v_accvgpr_write_b32 a73, v145
v_accvgpr_write_b32 a74, v146
v_accvgpr_write_b32 a75, v147
v_mfma_f32_16x16x32_bf16 v[76:79], a[40:43], v[208:211], v[76:79]
buffer_store_dwordx4 v[208:211], v1, s[20:23], s64 offen offset:2048 sc1
v_cvt_pk_bf16_f32 v216, v216, v217
v_cvt_pk_bf16_f32 v217, v218, v219
v_cvt_pk_bf16_f32 v218, v220, v221
v_cvt_pk_bf16_f32 v219, v222, v223
v_mfma_f32_16x16x32_bf16 v[72:75], a[8:11], v[208:211], v[72:75]
v_accvgpr_write_b32 a104, v208
v_accvgpr_write_b32 a105, v209
v_accvgpr_write_b32 a106, v210
v_accvgpr_write_b32 a107, v211
v_mfma_f32_16x16x32_bf16 v[64:67], a[12:15], v[152:155], v[64:67]
buffer_store_dwordx4 v[152:155], v1, s[20:23], s63 offen offset:3072 sc1
v_cvt_pk_bf16_f32 v160, v160, v161
v_cvt_pk_bf16_f32 v161, v162, v163
v_cvt_pk_bf16_f32 v162, v164, v165
v_cvt_pk_bf16_f32 v163, v166, v167
v_mfma_f32_16x16x32_bf16 v[68:71], a[44:47], v[152:155], v[68:71]
v_accvgpr_write_b32 a76, v152
v_accvgpr_write_b32 a77, v153
v_accvgpr_write_b32 a78, v154
v_accvgpr_write_b32 a79, v155
v_mfma_f32_16x16x32_bf16 v[76:79], a[44:47], v[216:219], v[76:79]
buffer_store_dwordx4 v[216:219], v1, s[20:23], s64 offen offset:3072 sc1
v_cvt_pk_bf16_f32 v224, v224, v225
v_cvt_pk_bf16_f32 v225, v226, v227
v_cvt_pk_bf16_f32 v226, v228, v229
v_cvt_pk_bf16_f32 v227, v230, v231
v_mfma_f32_16x16x32_bf16 v[72:75], a[12:15], v[216:219], v[72:75]
v_accvgpr_write_b32 a108, v216
v_accvgpr_write_b32 a109, v217
v_accvgpr_write_b32 a110, v218
v_accvgpr_write_b32 a111, v219
v_mfma_f32_16x16x32_bf16 v[64:67], a[16:19], v[160:163], v[64:67]
.p2align 3
s_add_u32 s63, s63, 4096
s_add_u32 s64, s64, 4096
buffer_store_dwordx4 v[160:163], v1, s[20:23], s63 offen offset:0 sc1
v_cvt_pk_bf16_f32 v168, v168, v169
v_cvt_pk_bf16_f32 v169, v170, v171
v_cvt_pk_bf16_f32 v170, v172, v173
v_cvt_pk_bf16_f32 v171, v174, v175
v_mfma_f32_16x16x32_bf16 v[68:71], a[48:51], v[160:163], v[68:71]
v_accvgpr_write_b32 a80, v160
v_accvgpr_write_b32 a81, v161
v_accvgpr_write_b32 a82, v162
v_accvgpr_write_b32 a83, v163
v_mfma_f32_16x16x32_bf16 v[76:79], a[48:51], v[224:227], v[76:79]
buffer_store_dwordx4 v[224:227], v1, s[20:23], s64 offen offset:0 sc1
v_cvt_pk_bf16_f32 v232, v232, v233
v_cvt_pk_bf16_f32 v233, v234, v235
v_cvt_pk_bf16_f32 v234, v236, v237
v_cvt_pk_bf16_f32 v235, v238, v239
v_mfma_f32_16x16x32_bf16 v[72:75], a[16:19], v[224:227], v[72:75]
v_accvgpr_write_b32 a112, v224
v_accvgpr_write_b32 a113, v225
v_accvgpr_write_b32 a114, v226
v_accvgpr_write_b32 a115, v227
v_mfma_f32_16x16x32_bf16 v[64:67], a[20:23], v[168:171], v[64:67]
buffer_store_dwordx4 v[168:171], v1, s[20:23], s63 offen offset:1024 sc1
v_cvt_pk_bf16_f32 v176, v176, v177
v_cvt_pk_bf16_f32 v177, v178, v179
v_cvt_pk_bf16_f32 v178, v180, v181
v_cvt_pk_bf16_f32 v179, v182, v183
v_mfma_f32_16x16x32_bf16 v[68:71], a[52:55], v[168:171], v[68:71]
v_accvgpr_write_b32 a84, v168
v_accvgpr_write_b32 a85, v169
v_accvgpr_write_b32 a86, v170
v_accvgpr_write_b32 a87, v171
v_mfma_f32_16x16x32_bf16 v[76:79], a[52:55], v[232:235], v[76:79]
buffer_store_dwordx4 v[232:235], v1, s[20:23], s64 offen offset:1024 sc1
v_cvt_pk_bf16_f32 v240, v240, v241
v_cvt_pk_bf16_f32 v241, v242, v243
v_cvt_pk_bf16_f32 v242, v244, v245
v_cvt_pk_bf16_f32 v243, v246, v247
v_mfma_f32_16x16x32_bf16 v[72:75], a[20:23], v[232:235], v[72:75]
v_accvgpr_write_b32 a116, v232
v_accvgpr_write_b32 a117, v233
v_accvgpr_write_b32 a118, v234
v_accvgpr_write_b32 a119, v235
v_mfma_f32_16x16x32_bf16 v[64:67], a[24:27], v[176:179], v[64:67]
buffer_store_dwordx4 v[176:179], v1, s[20:23], s63 offen offset:2048 sc1
v_cvt_pk_bf16_f32 v184, v184, v185
v_cvt_pk_bf16_f32 v185, v186, v187
v_cvt_pk_bf16_f32 v186, v188, v189
v_cvt_pk_bf16_f32 v187, v190, v191
v_mfma_f32_16x16x32_bf16 v[68:71], a[56:59], v[176:179], v[68:71]
v_accvgpr_write_b32 a88, v176
v_accvgpr_write_b32 a89, v177
v_accvgpr_write_b32 a90, v178
v_accvgpr_write_b32 a91, v179
v_mfma_f32_16x16x32_bf16 v[76:79], a[56:59], v[240:243], v[76:79]
buffer_store_dwordx4 v[240:243], v1, s[20:23], s64 offen offset:2048 sc1
v_cvt_pk_bf16_f32 v248, v248, v249
v_cvt_pk_bf16_f32 v249, v250, v251
v_cvt_pk_bf16_f32 v250, v252, v253
v_cvt_pk_bf16_f32 v251, v254, v255
v_mfma_f32_16x16x32_bf16 v[72:75], a[24:27], v[240:243], v[72:75]
v_accvgpr_write_b32 a120, v240
v_accvgpr_write_b32 a121, v241
v_accvgpr_write_b32 a122, v242
v_accvgpr_write_b32 a123, v243
v_mfma_f32_16x16x32_bf16 v[64:67], a[28:31], v[184:187], v[64:67]
buffer_store_dwordx4 v[184:187], v1, s[20:23], s63 offen offset:3072 sc1
v_accvgpr_write_b32 a92, v184
v_accvgpr_write_b32 a93, v185
v_mfma_f32_16x16x32_bf16 v[68:71], a[60:63], v[184:187], v[68:71]
v_accvgpr_write_b32 a94, v186
v_accvgpr_write_b32 a95, v187
v_mfma_f32_16x16x32_bf16 v[76:79], a[60:63], v[248:251], v[76:79]
buffer_store_dwordx4 v[248:251], v1, s[20:23], s64 offen offset:3072 sc1
v_accvgpr_write_b32 a124, v248
v_accvgpr_write_b32 a125, v249
v_mfma_f32_16x16x32_bf16 v[72:75], a[28:31], v[248:251], v[72:75]
.p2align 3
v_accvgpr_write_b32 a126, v250
v_accvgpr_write_b32 a127, v251
v_xor_b32 v46, 0x10000, v46
ds_read_b128 a[0:3], v46 offset:16384
ds_read_b128 a[4:7], v46 offset:17408
ds_read_b128 a[8:11], v46 offset:18432
ds_read_b128 a[12:15], v46 offset:19456
ds_read_b128 a[16:19], v46 offset:20480
ds_read_b128 a[20:23], v46 offset:21504
ds_read_b128 a[24:27], v46 offset:22528
PRO_T:
v_cndmask_b32 v38, v8, v3, vcc
v_cndmask_b32 v39, v9, v3, vcc
v_cndmask_b32 v40, v10, v3, vcc
v_cndmask_b32 v41, v11, v3, vcc
v_cvt_f32_i32 v42, v17
v_add_f32 v42, 0.5, v42
v_mul_f32 v42, 0x71800000, v42
v_mov_b32 v18, 0
v_mov_b32 v19, 0
.p2align 3
v_max3_f32 v20, v64, v65, v20
v_max3_f32 v20, v66, v67, v20
v_max3_f32 v20, v68, v69, v20
v_max3_f32 v20, v70, v71, v20
v_max3_f32 v21, v72, v73, v21
v_max3_f32 v21, v74, v75, v21
v_max3_f32 v21, v76, v77, v21
v_max3_f32 v21, v78, v79, v21
v_mov_b32 v22, v20
v_mov_b32 v23, v21
s_nop 1
v_permlane32_swap_b32 v22, v20
v_permlane32_swap_b32 v23, v21
v_max_f32 v20, v22, v20
v_max_f32 v21, v23, v21
v_mov_b32 v22, v20
v_mov_b32 v23, v21
s_nop 1
v_permlane16_swap_b32 v22, v20
v_permlane16_swap_b32 v23, v21
v_max_f32 v20, v22, v20
v_max_f32 v21, v23, v21
.p2align 3
s_add_u32 s63, s72, 16384
buffer_store_dword v20, v5, s[20:23], s63 offen offset:0 sc1
buffer_store_dword v21, v5, s[20:23], s63 offen offset:256 sc1
v_sub_f32 v48, 0xc2c00000, v20
v_sub_f32 v49, 0xc2c00000, v20
v_sub_f32 v50, 0xc2c00000, v20
v_sub_f32 v51, 0xc2c00000, v20
v_pk_add_f32 v[64:65], v[64:65], v[48:49]
v_pk_add_f32 v[66:67], v[66:67], v[48:49]
v_pk_add_f32 v[68:69], v[68:69], v[48:49]
v_pk_add_f32 v[70:71], v[70:71], v[48:49]
v_sub_f32 v52, 0xc2c00000, v21
v_sub_f32 v53, 0xc2c00000, v21
v_sub_f32 v54, 0xc2c00000, v21
v_sub_f32 v55, 0xc2c00000, v21
v_pk_add_f32 v[72:73], v[72:73], v[52:53]
v_pk_add_f32 v[74:75], v[74:75], v[52:53]
v_pk_add_f32 v[76:77], v[76:77], v[52:53]
v_pk_add_f32 v[78:79], v[78:79], v[52:53]
PRO_S:
v_exp_f32 v64, v64
v_exp_f32 v65, v65
v_add_f32 v18, v64, v18
v_exp_f32 v66, v66
v_add_f32 v18, v65, v18
v_cvt_pk_bf16_f32 v64, v64, v65
v_exp_f32 v67, v67
v_add_f32 v18, v66, v18
v_exp_f32 v68, v68
v_add_f32 v18, v67, v18
v_cvt_pk_bf16_f32 v65, v66, v67
v_exp_f32 v69, v69
v_add_f32 v18, v68, v18
v_exp_f32 v70, v70
v_add_f32 v18, v69, v18
v_cvt_pk_bf16_f32 v66, v68, v69
v_exp_f32 v71, v71
v_add_f32 v18, v70, v18
s_nop 0
v_add_f32 v18, v71, v18
v_cvt_pk_bf16_f32 v67, v70, v71
s_mov_b32 s75, 0
s_mov_b32 s96, s90
s_mov_b32 s63, 2
s_cmp_eq_u32 s74, 0
s_cbranch_scc1 NOLATE
s_mov_b32 s74, 0
s_cmp_eq_u32 s90, 0
s_cbranch_scc1 REST0
s_waitcnt lgkmcnt(5)
v_mfma_f32_16x16x32_bf16 v[80:83], a[0:3], a[64:67], v[48:51]
v_exp_f32 v72, v72
v_mfma_f32_16x16x32_bf16 v[80:83], a[4:7], a[68:71], v[80:83]
s_mov_b32 m0, s94
ds_read_b128 a[28:31], v46 offset:23552
v_mfma_f32_16x16x32_bf16 v[88:91], a[4:7], a[100:103], v[52:55]
v_exp_f32 v73, v73
v_mfma_f32_16x16x32_bf16 v[88:91], a[0:3], a[96:99], v[88:91]
s_waitcnt lgkmcnt(3)
buffer_load_dwordx4 v3, s[8:11], s93 offen offset:0 sc1 lds
v_mfma_f32_16x16x32_bf16 v[88:91], a[8:11], a[104:107], v[88:91]
ds_read_b128 a[32:35], v46 offset:24576
v_add_f32 v19, v72, v19
v_mfma_f32_16x16x32_bf16 v[88:91], a[12:15], a[108:111], v[88:91]
ds_read_b128 a[36:39], v46 offset:25600
v_mfma_f32_16x16x32_bf16 v[80:83], a[12:15], a[76:79], v[80:83]
v_exp_f32 v74, v74
v_mfma_f32_16x16x32_bf16 v[80:83], a[8:11], a[72:75], v[80:83]
ds_read_b128 a[40:43], v46 offset:26624
v_add_f32 v19, v73, v19
v_mfma_f32_16x16x32_bf16 v[80:83], a[16:19], a[80:83], v[80:83]
s_waitcnt lgkmcnt(3)
ds_read_b128 a[44:47], v46 offset:27648
v_cvt_pk_bf16_f32 v72, v72, v73
v_mfma_f32_16x16x32_bf16 v[80:83], a[20:23], a[84:87], v[80:83]
buffer_load_dwordx4 v3, s[8:11], s93 offen offset:1024 sc1 lds
v_mfma_f32_16x16x32_bf16 v[88:91], a[20:23], a[116:119], v[88:91]
ds_read_b128 a[48:51], v46 offset:28672
v_mfma_f32_16x16x32_bf16 v[88:91], a[16:19], a[112:115], v[88:91]
v_exp_f32 v75, v75
v_mfma_f32_16x16x32_bf16 v[88:91], a[24:27], a[120:123], v[88:91]
ds_read_b128 a[52:55], v46 offset:29696
v_add_f32 v19, v74, v19
v_mfma_f32_16x16x32_bf16 v[88:91], a[28:31], a[124:127], v[88:91]
v_exp_f32 v76, v76
v_mfma_f32_16x16x32_bf16 v[80:83], a[28:31], a[92:95], v[80:83]
ds_read_b128 a[56:59], v46 offset:30720
v_add_f32 v19, v75, v19
v_mfma_f32_16x16x32_bf16 v[80:83], a[24:27], a[88:91], v[80:83]
s_waitcnt lgkmcnt(3)
ds_read_b128 a[60:63], v46 offset:31744
v_cvt_pk_bf16_f32 v73, v74, v75
v_mfma_f32_16x16x32_bf16 v[84:87], a[32:35], a[64:67], v[48:51]
buffer_load_dwordx4 v3, s[8:11], s93 offen offset:2048 sc1 lds
v_mfma_f32_16x16x32_bf16 v[84:87], a[36:39], a[68:71], v[84:87]
ds_read_b128 a[0:3], v46 offset:0
ds_read_b128 a[4:7], v46 offset:1024
v_mfma_f32_16x16x32_bf16 v[92:95], a[36:39], a[100:103], v[52:55]
v_exp_f32 v77, v77
v_mfma_f32_16x16x32_bf16 v[92:95], a[32:35], a[96:99], v[92:95]
ds_read_b128 a[8:11], v46 offset:2048
v_add_f32 v19, v76, v19
v_mfma_f32_16x16x32_bf16 v[92:95], a[40:43], a[104:107], v[92:95]
v_exp_f32 v78, v78
v_mfma_f32_16x16x32_bf16 v[92:95], a[44:47], a[108:111], v[92:95]
ds_read_b128 a[12:15], v46 offset:3072
v_add_f32 v19, v77, v19
v_mfma_f32_16x16x32_bf16 v[84:87], a[44:47], a[76:79], v[84:87]
buffer_load_dwordx4 v3, s[8:11], s93 offen offset:3072 sc1 lds
v_mfma_f32_16x16x32_bf16 v[84:87], a[40:43], a[72:75], v[84:87]
s_waitcnt lgkmcnt(4)
s_add_u32 m0, s94, 4096
ds_read_b128 a[16:19], v46 offset:4096
v_cvt_pk_bf16_f32 v74, v76, v77
v_mfma_f32_16x16x32_bf16 v[84:87], a[48:51], a[80:83], v[84:87]
ds_read_b128 a[20:23], v46 offset:5120
v_mfma_f32_16x16x32_bf16 v[84:87], a[52:55], a[84:87], v[84:87]
v_exp_f32 v79, v79
v_mfma_f32_16x16x32_bf16 v[92:95], a[52:55], a[116:119], v[92:95]
ds_read_b128 a[24:27], v46 offset:6144
v_add_f32 v19, v78, v19
v_mfma_f32_16x16x32_bf16 v[92:95], a[48:51], a[112:115], v[92:95]
ds_read_b128 a[28:31], v46 offset:7168
v_add_f32 v19, v79, v19
v_mfma_f32_16x16x32_bf16 v[92:95], a[56:59], a[120:123], v[92:95]
buffer_load_dwordx4 v4, s[8:11], s93 offen offset:0 sc1 lds
v_mfma_f32_16x16x32_bf16 v[92:95], a[60:63], a[124:127], v[92:95]
ds_read_b128 a[32:35], v46 offset:8192
v_cvt_pk_bf16_f32 v75, v78, v79
v_mfma_f32_16x16x32_bf16 v[84:87], a[60:63], a[92:95], v[84:87]
ds_read_b128 a[36:39], v46 offset:9216
v_mfma_f32_16x16x32_bf16 v[84:87], a[56:59], a[88:91], v[84:87]
s_waitcnt lgkmcnt(4)
ds_read_b128 a[40:43], v46 offset:10240
v_mfma_f32_16x16x32_bf16 v[128:131], a[0:3], v[64:67], 0
v_exp_f32 v80, v80
v_mfma_f32_16x16x32_bf16 v[192:195], a[0:3], v[72:75], 0
ds_read_b128 a[44:47], v46 offset:11264
v_mfma_f32_16x16x32_bf16 v[196:199], a[4:7], v[72:75], 0
buffer_load_dwordx4 v4, s[8:11], s93 offen offset:1024 sc1 lds
v_mfma_f32_16x16x32_bf16 v[132:135], a[4:7], v[64:67], 0
v_exp_f32 v81, v81
v_mfma_f32_16x16x32_bf16 v[136:139], a[8:11], v[64:67], 0
ds_read_b128 a[48:51], v46 offset:12288
v_add_f32 v18, v80, v18
v_mfma_f32_16x16x32_bf16 v[200:203], a[8:11], v[72:75], 0
ds_read_b128 a[52:55], v46 offset:13312
v_mfma_f32_16x16x32_bf16 v[204:207], a[12:15], v[72:75], 0
ds_read_b128 a[56:59], v46 offset:14336
v_mfma_f32_16x16x32_bf16 v[140:143], a[12:15], v[64:67], 0
ds_read_b128 a[60:63], v46 offset:15360
v_mfma_f32_16x16x32_bf16 v[144:147], a[16:19], v[64:67], 0
v_exp_f32 v82, v82
v_mfma_f32_16x16x32_bf16 v[208:211], a[16:19], v[72:75], 0
buffer_load_dwordx4 v4, s[8:11], s93 offen offset:2048 sc1 lds
v_mfma_f32_16x16x32_bf16 v[212:215], a[20:23], v[72:75], 0
v_add_f32 v18, v81, v18
v_cvt_pk_bf16_f32 v80, v80, v81
v_mfma_f32_16x16x32_bf16 v[148:151], a[20:23], v[64:67], 0
s_waitcnt lgkmcnt(3)
v_accvgpr_read_b32 v26, a180
v_accvgpr_read_b32 v27, a181
v_mfma_f32_16x16x32_bf16 v[152:155], a[24:27], v[64:67], 0
v_exp_f32 v83, v83
v_mfma_f32_16x16x32_bf16 v[216:219], a[24:27], v[72:75], 0
v_add_f32 v18, v82, v18
v_mfma_f32_16x16x32_bf16 v[220:223], a[28:31], v[72:75], 0
buffer_load_dwordx4 v4, s[8:11], s93 offen offset:3072 sc1 lds
v_mfma_f32_16x16x32_bf16 v[156:159], a[28:31], v[64:67], 0
s_add_u32 s93, s93, 32768
v_exp_f32 v84, v84
v_mfma_f32_16x16x32_bf16 v[160:163], a[32:35], v[64:67], 0
s_add_u32 s94, s94, 32768
v_add_f32 v18, v83, v18
v_accvgpr_read_b32 v28, a182
v_mfma_f32_16x16x32_bf16 v[224:227], a[32:35], v[72:75], 0
s_and_b32 s94, s94, 0x1ffff
v_cvt_pk_bf16_f32 v81, v82, v83
v_accvgpr_read_b32 v29, a183
v_mfma_f32_16x16x32_bf16 v[228:231], a[36:39], v[72:75], 0
s_waitcnt vmcnt(16) lgkmcnt(0)
v_exp_f32 v85, v85
v_mfma_f32_16x16x32_bf16 v[164:167], a[36:39], v[64:67], 0
s_barrier
v_mfma_f32_16x16x32_bf16 v[168:171], a[40:43], v[64:67], 0
ds_read_b128 a[0:3], v46 offset:49152
v_add_f32 v18, v84, v18
v_mfma_f32_16x16x32_bf16 v[232:235], a[40:43], v[72:75], 0
v_exp_f32 v86, v86
v_mfma_f32_16x16x32_bf16 v[236:239], a[44:47], v[72:75], 0
ds_read_b128 a[4:7], v46 offset:50176
v_accvgpr_read_b32 v22, a176
v_mfma_f32_16x16x32_bf16 v[172:175], a[44:47], v[64:67], 0
ds_read_b128 a[8:11], v46 offset:51200
v_add_f32 v18, v85, v18
v_mfma_f32_16x16x32_bf16 v[176:179], a[48:51], v[64:67], 0
ds_read_b128 a[12:15], v46 offset:52224
v_cvt_pk_bf16_f32 v82, v84, v85
v_mfma_f32_16x16x32_bf16 v[240:243], a[48:51], v[72:75], 0
v_mfma_f32_16x16x32_bf16 v[244:247], a[52:55], v[72:75], 0
v_exp_f32 v87, v87
v_mfma_f32_16x16x32_bf16 v[180:183], a[52:55], v[64:67], 0
ds_read_b128 a[16:19], v46 offset:53248
v_accvgpr_read_b32 v23, a177
v_mfma_f32_16x16x32_bf16 v[184:187], a[56:59], v[64:67], 0
ds_read_b128 a[20:23], v46 offset:54272
v_add_f32 v18, v86, v18
v_mfma_f32_16x16x32_bf16 v[248:251], a[56:59], v[72:75], 0
v_accvgpr_read_b32 v24, a178
v_add_f32 v18, v87, v18
v_mfma_f32_16x16x32_bf16 v[252:255], a[60:63], v[72:75], 0
ds_read_b128 a[24:27], v46 offset:55296
v_cvt_pk_bf16_f32 v83, v86, v87
v_mfma_f32_16x16x32_bf16 v[188:191], a[60:63], v[64:67], 0
s_waitcnt lgkmcnt(3)
v_mfma_f32_16x16x32_bf16 v[64:67], a[0:3], a[64:67], v[48:51]
v_exp_f32 v88, v88
v_mfma_f32_16x16x32_bf16 v[64:67], a[4:7], a[68:71], v[64:67]
s_mov_b32 m0, s94
ds_read_b128 a[28:31], v46 offset:56320
v_accvgpr_read_b32 v25, a179
v_mfma_f32_16x16x32_bf16 v[72:75], a[4:7], a[100:103], v[52:55]
v_exp_f32 v89, v89
v_mfma_f32_16x16x32_bf16 v[72:75], a[0:3], a[96:99], v[72:75]
ds_read_b128 a[32:35], v46 offset:57344
v_add_f32 v19, v88, v19
v_mfma_f32_16x16x32_bf16 v[72:75], a[8:11], a[104:107], v[72:75]
buffer_load_dwordx4 v3, s[8:11], s93 offen offset:0 sc1 lds
v_mfma_f32_16x16x32_bf16 v[72:75], a[12:15], a[108:111], v[72:75]
ds_read_b128 a[36:39], v46 offset:58368
v_cvt_pk_bf16_f32 v22, v22, v23
v_mfma_f32_16x16x32_bf16 v[64:67], a[12:15], a[76:79], v[64:67]
v_exp_f32 v90, v90
v_mfma_f32_16x16x32_bf16 v[64:67], a[8:11], a[72:75], v[64:67]
s_waitcnt lgkmcnt(3)
ds_read_b128 a[40:43], v46 offset:59392
v_add_f32 v19, v89, v19
v_mfma_f32_16x16x32_bf16 v[64:67], a[16:19], a[80:83], v[64:67]
ds_read_b128 a[44:47], v46 offset:60416
v_cvt_pk_bf16_f32 v23, v24, v25
v_mfma_f32_16x16x32_bf16 v[64:67], a[20:23], a[84:87], v[64:67]
ds_read_b128 a[48:51], v46 offset:61440
v_cvt_pk_bf16_f32 v88, v88, v89
v_mfma_f32_16x16x32_bf16 v[72:75], a[20:23], a[116:119], v[72:75]
buffer_load_dwordx4 v3, s[8:11], s93 offen offset:1024 sc1 lds
v_mfma_f32_16x16x32_bf16 v[72:75], a[16:19], a[112:115], v[72:75]
v_exp_f32 v91, v91
v_mfma_f32_16x16x32_bf16 v[72:75], a[24:27], a[120:123], v[72:75]
s_waitcnt lgkmcnt(3)
ds_read_b128 a[52:55], v46 offset:62464
v_cvt_pk_bf16_f32 v24, v26, v27
v_mfma_f32_16x16x32_bf16 v[72:75], a[28:31], a[124:127], v[72:75]
ds_read_b128 a[56:59], v46 offset:63488
v_add_f32 v19, v90, v19
v_mfma_f32_16x16x32_bf16 v[64:67], a[28:31], a[92:95], v[64:67]
v_exp_f32 v92, v92
v_mfma_f32_16x16x32_bf16 v[64:67], a[24:27], a[88:91], v[64:67]
ds_read_b128 a[60:63], v46 offset:64512
v_cvt_pk_bf16_f32 v25, v28, v29
v_mfma_f32_16x16x32_bf16 v[68:71], a[32:35], a[64:67], v[48:51]
ds_read_b128 a[0:3], v46 offset:32768
v_add_f32 v19, v91, v19
v_mfma_f32_16x16x32_bf16 v[68:71], a[36:39], a[68:71], v[68:71]
buffer_load_dwordx4 v3, s[8:11], s93 offen offset:2048 sc1 lds
v_mfma_f32_16x16x32_bf16 v[76:79], a[36:39], a[100:103], v[52:55]
ds_read_b128 a[4:7], v46 offset:33792
v_cvt_pk_bf16_f32 v89, v90, v91
v_mfma_f32_16x16x32_bf16 v[76:79], a[32:35], a[96:99], v[76:79]
s_waitcnt lgkmcnt(4)
v_exp_f32 v93, v93
v_mfma_f32_16x16x32_bf16 v[76:79], a[40:43], a[104:107], v[76:79]
buffer_store_dwordx4 v[22:25], v1, s[8:11], s76 offen offset:2048 sc1
v_mfma_f32_16x16x32_bf16 v[76:79], a[44:47], a[108:111], v[76:79]
ds_read_b128 a[8:11], v46 offset:34816
v_add_f32 v19, v92, v19
v_mfma_f32_16x16x32_bf16 v[68:71], a[44:47], a[76:79], v[68:71]
v_exp_f32 v94, v94
v_mfma_f32_16x16x32_bf16 v[68:71], a[40:43], a[72:75], v[68:71]
ds_read_b128 a[12:15], v46 offset:35840
v_accvgpr_read_b32 v26, a188
v_mfma_f32_16x16x32_bf16 v[68:71], a[48:51], a[80:83], v[68:71]
buffer_load_dwordx4 v3, s[8:11], s93 offen offset:3072 sc1 lds
v_mfma_f32_16x16x32_bf16 v[68:71], a[52:55], a[84:87], v[68:71]
s_add_u32 m0, s94, 4096
ds_read_b128 a[16:19], v46 offset:36864
v_add_f32 v19, v93, v19
v_mfma_f32_16x16x32_bf16 v[76:79], a[52:55], a[116:119], v[76:79]
ds_read_b128 a[20:23], v46 offset:37888
v_cvt_pk_bf16_f32 v90, v92, v93
v_mfma_f32_16x16x32_bf16 v[76:79], a[48:51], a[112:115], v[76:79]
s_waitcnt lgkmcnt(4)
v_exp_f32 v95, v95
v_mfma_f32_16x16x32_bf16 v[76:79], a[56:59], a[120:123], v[76:79]
v_add_f32 v19, v94, v19
v_accvgpr_read_b32 v27, a189
v_mfma_f32_16x16x32_bf16 v[76:79], a[60:63], a[124:127], v[76:79]
v_add_f32 v19, v95, v19
v_cvt_pk_bf16_f32 v91, v94, v95
v_mfma_f32_16x16x32_bf16 v[68:71], a[60:63], a[92:95], v[68:71]
ds_read_b128 a[24:27], v46 offset:38912
v_accvgpr_read_b32 v28, a190
v_mfma_f32_16x16x32_bf16 v[68:71], a[56:59], a[88:91], v[68:71]
ds_read_b128 a[28:31], v46 offset:39936
ds_read_b128 a[32:35], v46 offset:40960
v_mfma_f32_16x16x32_bf16 v[128:131], a[0:3], v[80:83], v[128:131]
buffer_load_dwordx4 v4, s[8:11], s93 offen offset:0 sc1 lds
v_mfma_f32_16x16x32_bf16 v[192:195], a[0:3], v[88:91], v[192:195]
ds_read_b128 a[36:39], v46 offset:41984
v_accvgpr_read_b32 v29, a191
v_mfma_f32_16x16x32_bf16 v[196:199], a[4:7], v[88:91], v[196:199]
ds_read_b128 a[40:43], v46 offset:43008
v_accvgpr_read_b32 v22, a184
v_mfma_f32_16x16x32_bf16 v[132:135], a[4:7], v[80:83], v[132:135]
s_waitcnt lgkmcnt(5)
v_exp_f32 v64, v64
v_mfma_f32_16x16x32_bf16 v[136:139], a[8:11], v[80:83], v[136:139]
ds_read_b128 a[44:47], v46 offset:44032
ds_read_b128 a[48:51], v46 offset:45056
v_mfma_f32_16x16x32_bf16 v[200:203], a[8:11], v[88:91], v[200:203]
buffer_load_dwordx4 v4, s[8:11], s93 offen offset:1024 sc1 lds
v_mfma_f32_16x16x32_bf16 v[204:207], a[12:15], v[88:91], v[204:207]
ds_read_b128 a[52:55], v46 offset:46080
v_accvgpr_read_b32 v23, a185
v_mfma_f32_16x16x32_bf16 v[140:143], a[12:15], v[80:83], v[140:143]
ds_read_b128 a[56:59], v46 offset:47104
ds_read_b128 a[60:63], v46 offset:48128
v_mfma_f32_16x16x32_bf16 v[144:147], a[16:19], v[80:83], v[144:147]
v_exp_f32 v65, v65
v_mfma_f32_16x16x32_bf16 v[208:211], a[16:19], v[88:91], v[208:211]
v_add_f32 v18, v64, v18
v_accvgpr_read_b32 v24, a186
v_mfma_f32_16x16x32_bf16 v[212:215], a[20:23], v[88:91], v[212:215]
v_exp_f32 v66, v66
v_mfma_f32_16x16x32_bf16 v[148:151], a[20:23], v[80:83], v[148:151]
s_waitcnt lgkmcnt(3)
v_add_f32 v18, v65, v18
v_cvt_pk_bf16_f32 v64, v64, v65
v_mfma_f32_16x16x32_bf16 v[152:155], a[24:27], v[80:83], v[152:155]
buffer_load_dwordx4 v4, s[8:11], s93 offen offset:2048 sc1 lds
v_mfma_f32_16x16x32_bf16 v[216:219], a[24:27], v[88:91], v[216:219]
v_exp_f32 v67, v67
v_mfma_f32_16x16x32_bf16 v[220:223], a[28:31], v[88:91], v[220:223]
buffer_load_dwordx4 v4, s[8:11], s93 offen offset:3072 sc1 lds
v_mfma_f32_16x16x32_bf16 v[156:159], a[28:31], v[80:83], v[156:159]
s_add_u32 s93, s93, 32768
v_add_f32 v18, v66, v18
v_accvgpr_read_b32 v25, a187
v_mfma_f32_16x16x32_bf16 v[160:163], a[32:35], v[80:83], v[160:163]
s_add_u32 s94, s94, 32768
v_exp_f32 v68, v68
v_mfma_f32_16x16x32_bf16 v[224:227], a[32:35], v[88:91], v[224:227]
s_and_b32 s94, s94, 0x1ffff
v_xor_b32 v46, 0x10000, v46
v_add_f32 v18, v67, v18
v_mfma_f32_16x16x32_bf16 v[228:231], a[36:39], v[88:91], v[228:231]
s_waitcnt vmcnt(17) lgkmcnt(0)
v_cvt_pk_bf16_f32 v22, v22, v23
v_cvt_pk_bf16_f32 v65, v66, v67
v_mfma_f32_16x16x32_bf16 v[164:167], a[36:39], v[80:83], v[164:167]
s_barrier
v_exp_f32 v69, v69
v_mfma_f32_16x16x32_bf16 v[168:171], a[40:43], v[80:83], v[168:171]
v_cvt_pk_bf16_f32 v23, v24, v25
v_add_f32 v18, v68, v18
v_mfma_f32_16x16x32_bf16 v[232:235], a[40:43], v[88:91], v[232:235]
v_exp_f32 v70, v70
v_mfma_f32_16x16x32_bf16 v[236:239], a[44:47], v[88:91], v[236:239]
ds_read_b128 a[0:3], v46 offset:16384
v_cvt_pk_bf16_f32 v24, v26, v27
v_mfma_f32_16x16x32_bf16 v[172:175], a[44:47], v[80:83], v[172:175]
ds_read_b128 a[4:7], v46 offset:17408
v_add_f32 v18, v69, v18
v_mfma_f32_16x16x32_bf16 v[176:179], a[48:51], v[80:83], v[176:179]
ds_read_b128 a[8:11], v46 offset:18432
v_cvt_pk_bf16_f32 v66, v68, v69
v_mfma_f32_16x16x32_bf16 v[240:243], a[48:51], v[88:91], v[240:243]
v_exp_f32 v71, v71
v_mfma_f32_16x16x32_bf16 v[244:247], a[52:55], v[88:91], v[244:247]
s_waitcnt vmcnt(17)
ds_read_b128 a[12:15], v46 offset:19456
v_cvt_pk_bf16_f32 v25, v28, v29
v_mfma_f32_16x16x32_bf16 v[180:183], a[52:55], v[80:83], v[180:183]
ds_read_b128 a[16:19], v46 offset:20480
v_mov_b32 v6, 2
v_mfma_f32_16x16x32_bf16 v[184:187], a[56:59], v[80:83], v[184:187]
ds_read_b128 a[20:23], v46 offset:21504
v_add_f32 v18, v70, v18
v_mfma_f32_16x16x32_bf16 v[248:251], a[56:59], v[88:91], v[248:251]
buffer_store_dwordx4 v[22:25], v1, s[8:11], s76 offen offset:3072 sc1
v_mfma_f32_16x16x32_bf16 v[252:255], a[60:63], v[88:91], v[252:255]
buffer_store_dword v6, off, s[8:11], s81 sc1
ds_read_b128 a[24:27], v46 offset:22528
v_add_f32 v18, v71, v18
v_cvt_pk_bf16_f32 v67, v70, v71
v_mfma_f32_16x16x32_bf16 v[188:191], a[60:63], v[80:83], v[188:191]
s_cmp_eq_u32 s90, 1
s_cbranch_scc1 REST1
s_waitcnt lgkmcnt(5)
v_mfma_f32_16x16x32_bf16 v[80:83], a[0:3], a[64:67], v[48:51]
s_add_u32 s76, s76, s78
v_exp_f32 v72, v72
v_mfma_f32_16x16x32_bf16 v[80:83], a[4:7], a[68:71], v[80:83]
s_mov_b32 m0, s94
ds_read_b128 a[28:31], v46 offset:23552
v_accvgpr_read_b32 v26, a196
v_mfma_f32_16x16x32_bf16 v[88:91], a[4:7], a[100:103], v[52:55]
v_exp_f32 v73, v73
v_mfma_f32_16x16x32_bf16 v[88:91], a[0:3], a[96:99], v[88:91]
s_waitcnt lgkmcnt(3)
buffer_load_dwordx4 v3, s[8:11], s93 offen offset:0 sc1 lds
v_mfma_f32_16x16x32_bf16 v[88:91], a[8:11], a[104:107], v[88:91]
ds_read_b128 a[32:35], v46 offset:24576
v_add_f32 v19, v72, v19
v_mfma_f32_16x16x32_bf16 v[88:91], a[12:15], a[108:111], v[88:91]
ds_read_b128 a[36:39], v46 offset:25600
v_accvgpr_read_b32 v27, a197
v_mfma_f32_16x16x32_bf16 v[80:83], a[12:15], a[76:79], v[80:83]
v_exp_f32 v74, v74
v_mfma_f32_16x16x32_bf16 v[80:83], a[8:11], a[72:75], v[80:83]
ds_read_b128 a[40:43], v46 offset:26624
v_add_f32 v19, v73, v19
v_mfma_f32_16x16x32_bf16 v[80:83], a[16:19], a[80:83], v[80:83]
s_waitcnt lgkmcnt(3)
ds_read_b128 a[44:47], v46 offset:27648
v_accvgpr_read_b32 v28, a198
v_mfma_f32_16x16x32_bf16 v[80:83], a[20:23], a[84:87], v[80:83]
ds_read_b128 a[48:51], v46 offset:28672
v_cvt_pk_bf16_f32 v72, v72, v73
v_mfma_f32_16x16x32_bf16 v[88:91], a[20:23], a[116:119], v[88:91]
buffer_load_dwordx4 v3, s[8:11], s93 offen offset:1024 sc1 lds
v_mfma_f32_16x16x32_bf16 v[88:91], a[16:19], a[112:115], v[88:91]
v_exp_f32 v75, v75
v_mfma_f32_16x16x32_bf16 v[88:91], a[24:27], a[120:123], v[88:91]
ds_read_b128 a[52:55], v46 offset:29696
v_accvgpr_read_b32 v29, a199
v_mfma_f32_16x16x32_bf16 v[88:91], a[28:31], a[124:127], v[88:91]
ds_read_b128 a[56:59], v46 offset:30720
v_add_f32 v19, v74, v19
v_mfma_f32_16x16x32_bf16 v[80:83], a[28:31], a[92:95], v[80:83]
v_exp_f32 v76, v76
v_mfma_f32_16x16x32_bf16 v[80:83], a[24:27], a[88:91], v[80:83]
s_waitcnt lgkmcnt(3)
ds_read_b128 a[60:63], v46 offset:31744
v_add_f32 v19, v75, v19
v_mfma_f32_16x16x32_bf16 v[84:87], a[32:35], a[64:67], v[48:51]
ds_read_b128 a[0:3], v46 offset:0
v_accvgpr_read_b32 v22, a192
v_mfma_f32_16x16x32_bf16 v[84:87], a[36:39], a[68:71], v[84:87]
buffer_load_dwordx4 v3, s[8:11], s93 offen offset:2048 sc1 lds
v_mfma_f32_16x16x32_bf16 v[92:95], a[36:39], a[100:103], v[52:55]
ds_read_b128 a[4:7], v46 offset:1024
v_cvt_pk_bf16_f32 v73, v74, v75
v_mfma_f32_16x16x32_bf16 v[92:95], a[32:35], a[96:99], v[92:95]
v_exp_f32 v77, v77
v_mfma_f32_16x16x32_bf16 v[92:95], a[40:43], a[104:107], v[92:95]
ds_read_b128 a[8:11], v46 offset:2048
v_accvgpr_read_b32 v23, a193
v_mfma_f32_16x16x32_bf16 v[92:95], a[44:47], a[108:111], v[92:95]
ds_read_b128 a[12:15], v46 offset:3072
v_add_f32 v19, v76, v19
v_mfma_f32_16x16x32_bf16 v[84:87], a[44:47], a[76:79], v[84:87]
v_exp_f32 v78, v78
v_mfma_f32_16x16x32_bf16 v[84:87], a[40:43], a[72:75], v[84:87]
s_waitcnt lgkmcnt(3)
buffer_load_dwordx4 v3, s[8:11], s93 offen offset:3072 sc1 lds
v_mfma_f32_16x16x32_bf16 v[84:87], a[48:51], a[80:83], v[84:87]
s_add_u32 m0, s94, 4096
ds_read_b128 a[16:19], v46 offset:4096
v_accvgpr_read_b32 v24, a194
v_mfma_f32_16x16x32_bf16 v[84:87], a[52:55], a[84:87], v[84:87]
ds_read_b128 a[20:23], v46 offset:5120
v_add_f32 v19, v77, v19
v_mfma_f32_16x16x32_bf16 v[92:95], a[52:55], a[116:119], v[92:95]
v_cvt_pk_bf16_f32 v74, v76, v77
v_accvgpr_read_b32 v25, a195
v_mfma_f32_16x16x32_bf16 v[92:95], a[48:51], a[112:115], v[92:95]
v_exp_f32 v79, v79
v_mfma_f32_16x16x32_bf16 v[92:95], a[56:59], a[120:123], v[92:95]
ds_read_b128 a[24:27], v46 offset:6144
v_add_f32 v19, v78, v19
v_mfma_f32_16x16x32_bf16 v[92:95], a[60:63], a[124:127], v[92:95]
v_add_f32 v19, v79, v19
v_cvt_pk_bf16_f32 v75, v78, v79
v_mfma_f32_16x16x32_bf16 v[84:87], a[60:63], a[92:95], v[84:87]
ds_read_b128 a[28:31], v46 offset:7168
v_cvt_pk_bf16_f32 v22, v22, v23
v_mfma_f32_16x16x32_bf16 v[84:87], a[56:59], a[88:91], v[84:87]
buffer_load_dwordx4 v4, s[8:11], s93 offen offset:0 sc1 lds
v_mfma_f32_16x16x32_bf16 v[128:131], a[0:3], v[64:67], v[128:131]
ds_read_b128 a[32:35], v46 offset:8192
v_cvt_pk_bf16_f32 v23, v24, v25
v_mfma_f32_16x16x32_bf16 v[192:195], a[0:3], v[72:75], v[192:195]
s_waitcnt lgkmcnt(3)
ds_read_b128 a[36:39], v46 offset:9216
v_cvt_pk_bf16_f32 v24, v26, v27
v_mfma_f32_16x16x32_bf16 v[196:199], a[4:7], v[72:75], v[196:199]
ds_read_b128 a[40:43], v46 offset:10240
ds_read_b128 a[44:47], v46 offset:11264
v_mfma_f32_16x16x32_bf16 v[132:135], a[4:7], v[64:67], v[132:135]
v_exp_f32 v80, v80
v_mfma_f32_16x16x32_bf16 v[136:139], a[8:11], v[64:67], v[136:139]
buffer_load_dwordx4 v4, s[8:11], s93 offen offset:1024 sc1 lds
v_mfma_f32_16x16x32_bf16 v[200:203], a[8:11], v[72:75], v[200:203]
ds_read_b128 a[48:51], v46 offset:12288
v_cvt_pk_bf16_f32 v25, v28, v29
v_mfma_f32_16x16x32_bf16 v[204:207], a[12:15], v[72:75], v[204:207]
ds_read_b128 a[52:55], v46 offset:13312
ds_read_b128 a[56:59], v46 offset:14336
v_mfma_f32_16x16x32_bf16 v[140:143], a[12:15], v[64:67], v[140:143]
ds_read_b128 a[60:63], v46 offset:15360
v_mfma_f32_16x16x32_bf16 v[144:147], a[16:19], v[64:67], v[144:147]
v_exp_f32 v81, v81
v_mfma_f32_16x16x32_bf16 v[208:211], a[16:19], v[72:75], v[208:211]
v_add_f32 v18, v80, v18
v_mfma_f32_16x16x32_bf16 v[212:215], a[20:23], v[72:75], v[212:215]
v_exp_f32 v82, v82
v_mfma_f32_16x16x32_bf16 v[148:151], a[20:23], v[64:67], v[148:151]
s_waitcnt lgkmcnt(4)
buffer_load_dwordx4 v4, s[8:11], s93 offen offset:2048 sc1 lds
v_mfma_f32_16x16x32_bf16 v[152:155], a[24:27], v[64:67], v[152:155]
v_add_f32 v18, v81, v18
v_cvt_pk_bf16_f32 v80, v80, v81
v_mfma_f32_16x16x32_bf16 v[216:219], a[24:27], v[72:75], v[216:219]
buffer_store_dwordx4 v[22:25], v1, s[8:11], s76 offen offset:0 sc1
v_mfma_f32_16x16x32_bf16 v[220:223], a[28:31], v[72:75], v[220:223]
buffer_load_dwordx4 v4, s[8:11], s93 offen offset:3072 sc1 lds
v_mfma_f32_16x16x32_bf16 v[156:159], a[28:31], v[64:67], v[156:159]
s_add_u32 s93, s93, 32768
v_exp_f32 v83, v83
v_mfma_f32_16x16x32_bf16 v[160:163], a[32:35], v[64:67], v[160:163]
s_add_u32 s94, s94, 32768
v_accvgpr_read_b32 v26, a204
v_add_f32 v18, v82, v18
v_mfma_f32_16x16x32_bf16 v[224:227], a[32:35], v[72:75], v[224:227]
s_and_b32 s94, s94, 0x1ffff
v_exp_f32 v84, v84
v_mfma_f32_16x16x32_bf16 v[228:231], a[36:39], v[72:75], v[228:231]
s_waitcnt vmcnt(17) lgkmcnt(0)
v_accvgpr_read_b32 v27, a205
v_add_f32 v18, v83, v18
v_mfma_f32_16x16x32_bf16 v[164:167], a[36:39], v[64:67], v[164:167]
s_barrier
v_cvt_pk_bf16_f32 v81, v82, v83
v_accvgpr_read_b32 v28, a206
v_mfma_f32_16x16x32_bf16 v[168:171], a[40:43], v[64:67], v[168:171]
v_exp_f32 v85, v85
v_mfma_f32_16x16x32_bf16 v[232:235], a[40:43], v[72:75], v[232:235]
ds_read_b128 a[0:3], v46 offset:49152
v_add_f32 v18, v84, v18
v_mfma_f32_16x16x32_bf16 v[236:239], a[44:47], v[72:75], v[236:239]
v_exp_f32 v86, v86
v_mfma_f32_16x16x32_bf16 v[172:175], a[44:47], v[64:67], v[172:175]
ds_read_b128 a[4:7], v46 offset:50176
v_accvgpr_read_b32 v29, a207
v_mfma_f32_16x16x32_bf16 v[176:179], a[48:51], v[64:67], v[176:179]
ds_read_b128 a[8:11], v46 offset:51200
v_add_f32 v18, v85, v18
v_mfma_f32_16x16x32_bf16 v[240:243], a[48:51], v[72:75], v[240:243]
v_accvgpr_read_b32 v22, a200
v_cvt_pk_bf16_f32 v82, v84, v85
v_mfma_f32_16x16x32_bf16 v[244:247], a[52:55], v[72:75], v[244:247]
v_exp_f32 v87, v87
v_mfma_f32_16x16x32_bf16 v[180:183], a[52:55], v[64:67], v[180:183]
ds_read_b128 a[12:15], v46 offset:52224
v_accvgpr_read_b32 v23, a201
v_mfma_f32_16x16x32_bf16 v[184:187], a[56:59], v[64:67], v[184:187]
ds_read_b128 a[16:19], v46 offset:53248
v_add_f32 v18, v86, v18
v_mfma_f32_16x16x32_bf16 v[248:251], a[56:59], v[72:75], v[248:251]
ds_read_b128 a[20:23], v46 offset:54272
v_add_f32 v18, v87, v18
v_mfma_f32_16x16x32_bf16 v[252:255], a[60:63], v[72:75], v[252:255]
ds_read_b128 a[24:27], v46 offset:55296
v_cvt_pk_bf16_f32 v83, v86, v87
v_mfma_f32_16x16x32_bf16 v[188:191], a[60:63], v[64:67], v[188:191]
s_waitcnt lgkmcnt(4)
ds_read_b128 a[28:31], v46 offset:56320
v_accvgpr_read_b32 v24, a202
v_mfma_f32_16x16x32_bf16 v[64:67], a[0:3], a[64:67], v[48:51]
v_exp_f32 v88, v88
v_mfma_f32_16x16x32_bf16 v[64:67], a[4:7], a[68:71], v[64:67]
s_mov_b32 m0, s94
ds_read_b128 a[32:35], v46 offset:57344
v_accvgpr_read_b32 v25, a203
v_mfma_f32_16x16x32_bf16 v[72:75], a[4:7], a[100:103], v[52:55]
v_exp_f32 v89, v89
v_mfma_f32_16x16x32_bf16 v[72:75], a[0:3], a[96:99], v[72:75]
buffer_load_dwordx4 v3, s[8:11], s93 offen offset:0 sc1 lds
v_mfma_f32_16x16x32_bf16 v[72:75], a[8:11], a[104:107], v[72:75]
s_waitcnt lgkmcnt(3)
ds_read_b128 a[36:39], v46 offset:58368
v_add_f32 v19, v88, v19
v_mfma_f32_16x16x32_bf16 v[72:75], a[12:15], a[108:111], v[72:75]
v_exp_f32 v90, v90
v_mfma_f32_16x16x32_bf16 v[64:67], a[12:15], a[76:79], v[64:67]
ds_read_b128 a[40:43], v46 offset:59392
v_cvt_pk_bf16_f32 v22, v22, v23
v_mfma_f32_16x16x32_bf16 v[64:67], a[8:11], a[72:75], v[64:67]
ds_read_b128 a[44:47], v46 offset:60416
v_add_f32 v19, v89, v19
v_mfma_f32_16x16x32_bf16 v[64:67], a[16:19], a[80:83], v[64:67]
ds_read_b128 a[48:51], v46 offset:61440
v_cvt_pk_bf16_f32 v88, v88, v89
v_mfma_f32_16x16x32_bf16 v[64:67], a[20:23], a[84:87], v[64:67]
buffer_load_dwordx4 v3, s[8:11], s93 offen offset:1024 sc1 lds
v_mfma_f32_16x16x32_bf16 v[72:75], a[20:23], a[116:119], v[72:75]
v_exp_f32 v91, v91
v_mfma_f32_16x16x32_bf16 v[72:75], a[16:19], a[112:115], v[72:75]
s_waitcnt lgkmcnt(3)
ds_read_b128 a[52:55], v46 offset:62464
v_cvt_pk_bf16_f32 v23, v24, v25
v_mfma_f32_16x16x32_bf16 v[72:75], a[24:27], a[120:123], v[72:75]
ds_read_b128 a[56:59], v46 offset:63488
v_add_f32 v19, v90, v19
v_mfma_f32_16x16x32_bf16 v[72:75], a[28:31], a[124:127], v[72:75]
v_exp_f32 v92, v92
v_mfma_f32_16x16x32_bf16 v[64:67], a[28:31], a[92:95], v[64:67]
ds_read_b128 a[60:63], v46 offset:64512
v_cvt_pk_bf16_f32 v24, v26, v27
v_mfma_f32_16x16x32_bf16 v[64:67], a[24:27], a[88:91], v[64:67]
ds_read_b128 a[0:3], v46 offset:32768
v_add_f32 v19, v91, v19
v_mfma_f32_16x16x32_bf16 v[68:71], a[32:35], a[64:67], v[48:51]
buffer_load_dwordx4 v3, s[8:11], s93 offen offset:2048 sc1 lds
v_mfma_f32_16x16x32_bf16 v[68:71], a[36:39], a[68:71], v[68:71]
v_cvt_pk_bf16_f32 v25, v28, v29
v_cvt_pk_bf16_f32 v89, v90, v91
v_mfma_f32_16x16x32_bf16 v[76:79], a[36:39], a[100:103], v[52:55]
v_exp_f32 v93, v93
v_mfma_f32_16x16x32_bf16 v[76:79], a[32:35], a[96:99], v[76:79]
s_waitcnt lgkmcnt(2)
ds_read_b128 a[4:7], v46 offset:33792
v_add_f32 v19, v92, v19
v_mfma_f32_16x16x32_bf16 v[76:79], a[40:43], a[104:107], v[76:79]
buffer_store_dwordx4 v[22:25], v1, s[8:11], s76 offen offset:1024 sc1
v_mfma_f32_16x16x32_bf16 v[76:79], a[44:47], a[108:111], v[76:79]
ds_read_b128 a[8:11], v46 offset:34816
v_accvgpr_read_b32 v26, a212
v_mfma_f32_16x16x32_bf16 v[68:71], a[44:47], a[76:79], v[68:71]
v_exp_f32 v94, v94
v_mfma_f32_16x16x32_bf16 v[68:71], a[40:43], a[72:75], v[68:71]
ds_read_b128 a[12:15], v46 offset:35840
v_add_f32 v19, v93, v19
v_mfma_f32_16x16x32_bf16 v[68:71], a[48:51], a[80:83], v[68:71]
buffer_load_dwordx4 v3, s[8:11], s93 offen offset:3072 sc1 lds
v_mfma_f32_16x16x32_bf16 v[68:71], a[52:55], a[84:87], v[68:71]
s_add_u32 m0, s94, 4096
ds_read_b128 a[16:19], v46 offset:36864
v_cvt_pk_bf16_f32 v90, v92, v93
v_mfma_f32_16x16x32_bf16 v[76:79], a[52:55], a[116:119], v[76:79]
ds_read_b128 a[20:23], v46 offset:37888
v_accvgpr_read_b32 v27, a213
v_mfma_f32_16x16x32_bf16 v[76:79], a[48:51], a[112:115], v[76:79]
v_exp_f32 v95, v95
v_mfma_f32_16x16x32_bf16 v[76:79], a[56:59], a[120:123], v[76:79]
s_waitcnt lgkmcnt(3)
ds_read_b128 a[24:27], v46 offset:38912
v_add_f32 v19, v94, v19
v_mfma_f32_16x16x32_bf16 v[76:79], a[60:63], a[124:127], v[76:79]
v_add_f32 v19, v95, v19
v_cvt_pk_bf16_f32 v91, v94, v95
v_mfma_f32_16x16x32_bf16 v[68:71], a[60:63], a[92:95], v[68:71]
ds_read_b128 a[28:31], v46 offset:39936
v_accvgpr_read_b32 v28, a214
v_mfma_f32_16x16x32_bf16 v[68:71], a[56:59], a[88:91], v[68:71]
buffer_load_dwordx4 v4, s[8:11], s93 offen offset:0 sc1 lds
v_mfma_f32_16x16x32_bf16 v[128:131], a[0:3], v[80:83], v[128:131]
ds_read_b128 a[32:35], v46 offset:40960
v_accvgpr_read_b32 v29, a215
v_mfma_f32_16x16x32_bf16 v[192:195], a[0:3], v[88:91], v[192:195]
ds_read_b128 a[36:39], v46 offset:41984
ds_read_b128 a[40:43], v46 offset:43008
v_mfma_f32_16x16x32_bf16 v[196:199], a[4:7], v[88:91], v[196:199]
v_exp_f32 v64, v64
v_mfma_f32_16x16x32_bf16 v[132:135], a[4:7], v[80:83], v[132:135]
ds_read_b128 a[44:47], v46 offset:44032
v_accvgpr_read_b32 v22, a208
v_mfma_f32_16x16x32_bf16 v[136:139], a[8:11], v[80:83], v[136:139]
buffer_load_dwordx4 v4, s[8:11], s93 offen offset:1024 sc1 lds
v_mfma_f32_16x16x32_bf16 v[200:203], a[8:11], v[88:91], v[200:203]
s_waitcnt lgkmcnt(4)
v_exp_f32 v65, v65
v_mfma_f32_16x16x32_bf16 v[204:207], a[12:15], v[88:91], v[204:207]
ds_read_b128 a[48:51], v46 offset:45056
ds_read_b128 a[52:55], v46 offset:46080
v_mfma_f32_16x16x32_bf16 v[140:143], a[12:15], v[80:83], v[140:143]
ds_read_b128 a[56:59], v46 offset:47104
ds_read_b128 a[60:63], v46 offset:48128
v_mfma_f32_16x16x32_bf16 v[144:147], a[16:19], v[80:83], v[144:147]
v_add_f32 v18, v64, v18
v_accvgpr_read_b32 v23, a209
v_mfma_f32_16x16x32_bf16 v[208:211], a[16:19], v[88:91], v[208:211]
v_exp_f32 v66, v66
v_mfma_f32_16x16x32_bf16 v[212:215], a[20:23], v[88:91], v[212:215]
v_add_f32 v18, v65, v18
v_cvt_pk_bf16_f32 v64, v64, v65
v_mfma_f32_16x16x32_bf16 v[148:151], a[20:23], v[80:83], v[148:151]
buffer_load_dwordx4 v4, s[8:11], s93 offen offset:2048 sc1 lds
v_mfma_f32_16x16x32_bf16 v[152:155], a[24:27], v[80:83], v[152:155]
v_exp_f32 v67, v67
v_mfma_f32_16x16x32_bf16 v[216:219], a[24:27], v[88:91], v[216:219]
v_accvgpr_read_b32 v24, a210
v_add_f32 v18, v66, v18
v_mfma_f32_16x16x32_bf16 v[220:223], a[28:31], v[88:91], v[220:223]
buffer_load_dwordx4 v4, s[8:11], s93 offen offset:3072 sc1 lds
v_mfma_f32_16x16x32_bf16 v[156:159], a[28:31], v[80:83], v[156:159]
s_waitcnt lgkmcnt(0)
s_add_u32 s93, s93, 32768
v_exp_f32 v68, v68
v_mfma_f32_16x16x32_bf16 v[160:163], a[32:35], v[80:83], v[160:163]
s_add_u32 s94, s94, 32768
v_accvgpr_read_b32 v25, a211
v_add_f32 v18, v67, v18
v_mfma_f32_16x16x32_bf16 v[224:227], a[32:35], v[88:91], v[224:227]
s_and_b32 s94, s94, 0x1ffff
v_xor_b32 v46, 0x10000, v46
v_cvt_pk_bf16_f32 v22, v22, v23
v_mfma_f32_16x16x32_bf16 v[228:231], a[36:39], v[88:91], v[228:231]
s_waitcnt vmcnt(18) lgkmcnt(0)
v_cvt_pk_bf16_f32 v65, v66, v67
v_cvt_pk_bf16_f32 v23, v24, v25
v_mfma_f32_16x16x32_bf16 v[164:167], a[36:39], v[80:83], v[164:167]
s_barrier
v_exp_f32 v69, v69
v_mfma_f32_16x16x32_bf16 v[168:171], a[40:43], v[80:83], v[168:171]
ds_read_b128 a[0:3], v46 offset:16384
v_add_f32 v18, v68, v18
v_mfma_f32_16x16x32_bf16 v[232:235], a[40:43], v[88:91], v[232:235]
v_exp_f32 v70, v70
v_mfma_f32_16x16x32_bf16 v[236:239], a[44:47], v[88:91], v[236:239]
ds_read_b128 a[4:7], v46 offset:17408
v_add_f32 v18, v69, v18
v_mfma_f32_16x16x32_bf16 v[172:175], a[44:47], v[80:83], v[172:175]
ds_read_b128 a[8:11], v46 offset:18432
v_cvt_pk_bf16_f32 v24, v26, v27
v_mfma_f32_16x16x32_bf16 v[176:179], a[48:51], v[80:83], v[176:179]
ds_read_b128 a[12:15], v46 offset:19456
v_cvt_pk_bf16_f32 v66, v68, v69
v_mfma_f32_16x16x32_bf16 v[240:243], a[48:51], v[88:91], v[240:243]
v_exp_f32 v71, v71
v_mfma_f32_16x16x32_bf16 v[244:247], a[52:55], v[88:91], v[244:247]
ds_read_b128 a[16:19], v46 offset:20480
v_cvt_pk_bf16_f32 v25, v28, v29
v_mfma_f32_16x16x32_bf16 v[180:183], a[52:55], v[80:83], v[180:183]
ds_read_b128 a[20:23], v46 offset:21504
v_add_f32 v18, v70, v18
v_mfma_f32_16x16x32_bf16 v[184:187], a[56:59], v[80:83], v[184:187]
ds_read_b128 a[24:27], v46 offset:22528
v_add_f32 v18, v71, v18
v_mfma_f32_16x16x32_bf16 v[248:251], a[56:59], v[88:91], v[248:251]
buffer_store_dwordx4 v[22:25], v1, s[8:11], s76 offen offset:2048 sc1
v_mfma_f32_16x16x32_bf16 v[252:255], a[60:63], v[88:91], v[252:255]
v_cvt_pk_bf16_f32 v67, v70, v71
v_mfma_f32_16x16x32_bf16 v[188:191], a[60:63], v[80:83], v[188:191]
s_cmp_eq_u32 s90, 2
s_cbranch_scc1 REST2
s_waitcnt lgkmcnt(5)
v_mfma_f32_16x16x32_bf16 v[80:83], a[0:3], a[64:67], v[48:51]
v_exp_f32 v72, v72
v_mfma_f32_16x16x32_bf16 v[80:83], a[4:7], a[68:71], v[80:83]
s_mov_b32 m0, s94
ds_read_b128 a[28:31], v46 offset:23552
v_accvgpr_read_b32 v26, a220
v_mfma_f32_16x16x32_bf16 v[88:91], a[4:7], a[100:103], v[52:55]
v_exp_f32 v73, v73
v_mfma_f32_16x16x32_bf16 v[88:91], a[0:3], a[96:99], v[88:91]
s_waitcnt lgkmcnt(3)
buffer_load_dwordx4 v3, s[8:11], s93 offen offset:0 sc1 lds
v_mfma_f32_16x16x32_bf16 v[88:91], a[8:11], a[104:107], v[88:91]
ds_read_b128 a[32:35], v46 offset:24576
v_add_f32 v19, v72, v19
v_mfma_f32_16x16x32_bf16 v[88:91], a[12:15], a[108:111], v[88:91]
ds_read_b128 a[36:39], v46 offset:25600
v_accvgpr_read_b32 v27, a221
v_mfma_f32_16x16x32_bf16 v[80:83], a[12:15], a[76:79], v[80:83]
v_exp_f32 v74, v74
v_mfma_f32_16x16x32_bf16 v[80:83], a[8:11], a[72:75], v[80:83]
ds_read_b128 a[40:43], v46 offset:26624
v_add_f32 v19, v73, v19
v_mfma_f32_16x16x32_bf16 v[80:83], a[16:19], a[80:83], v[80:83]
s_waitcnt lgkmcnt(3)
ds_read_b128 a[44:47], v46 offset:27648
v_accvgpr_read_b32 v28, a222
v_mfma_f32_16x16x32_bf16 v[80:83], a[20:23], a[84:87], v[80:83]
ds_read_b128 a[48:51], v46 offset:28672
v_cvt_pk_bf16_f32 v72, v72, v73
v_mfma_f32_16x16x32_bf16 v[88:91], a[20:23], a[116:119], v[88:91]
buffer_load_dwordx4 v3, s[8:11], s93 offen offset:1024 sc1 lds
v_mfma_f32_16x16x32_bf16 v[88:91], a[16:19], a[112:115], v[88:91]
v_exp_f32 v75, v75
v_mfma_f32_16x16x32_bf16 v[88:91], a[24:27], a[120:123], v[88:91]
ds_read_b128 a[52:55], v46 offset:29696
v_accvgpr_read_b32 v29, a223
v_mfma_f32_16x16x32_bf16 v[88:91], a[28:31], a[124:127], v[88:91]
ds_read_b128 a[56:59], v46 offset:30720
v_add_f32 v19, v74, v19
v_mfma_f32_16x16x32_bf16 v[80:83], a[28:31], a[92:95], v[80:83]
v_exp_f32 v76, v76
v_mfma_f32_16x16x32_bf16 v[80:83], a[24:27], a[88:91], v[80:83]
s_waitcnt lgkmcnt(3)
ds_read_b128 a[60:63], v46 offset:31744
v_add_f32 v19, v75, v19
v_mfma_f32_16x16x32_bf16 v[84:87], a[32:35], a[64:67], v[48:51]
ds_read_b128 a[0:3], v46 offset:0
v_accvgpr_read_b32 v22, a216
v_mfma_f32_16x16x32_bf16 v[84:87], a[36:39], a[68:71], v[84:87]
buffer_load_dwordx4 v3, s[8:11], s93 offen offset:2048 sc1 lds
v_mfma_f32_16x16x32_bf16 v[92:95], a[36:39], a[100:103], v[52:55]
ds_read_b128 a[4:7], v46 offset:1024
v_cvt_pk_bf16_f32 v73, v74, v75
v_mfma_f32_16x16x32_bf16 v[92:95], a[32:35], a[96:99], v[92:95]
v_exp_f32 v77, v77
v_mfma_f32_16x16x32_bf16 v[92:95], a[40:43], a[104:107], v[92:95]
ds_read_b128 a[8:11], v46 offset:2048
v_accvgpr_read_b32 v23, a217
v_mfma_f32_16x16x32_bf16 v[92:95], a[44:47], a[108:111], v[92:95]
ds_read_b128 a[12:15], v46 offset:3072
v_add_f32 v19, v76, v19
v_mfma_f32_16x16x32_bf16 v[84:87], a[44:47], a[76:79], v[84:87]
v_exp_f32 v78, v78
v_mfma_f32_16x16x32_bf16 v[84:87], a[40:43], a[72:75], v[84:87]
s_waitcnt lgkmcnt(3)
buffer_load_dwordx4 v3, s[8:11], s93 offen offset:3072 sc1 lds
v_mfma_f32_16x16x32_bf16 v[84:87], a[48:51], a[80:83], v[84:87]
s_add_u32 m0, s94, 4096
ds_read_b128 a[16:19], v46 offset:4096
v_accvgpr_read_b32 v24, a218
v_mfma_f32_16x16x32_bf16 v[84:87], a[52:55], a[84:87], v[84:87]
ds_read_b128 a[20:23], v46 offset:5120
v_add_f32 v19, v77, v19
v_mfma_f32_16x16x32_bf16 v[92:95], a[52:55], a[116:119], v[92:95]
v_cvt_pk_bf16_f32 v74, v76, v77
v_accvgpr_read_b32 v25, a219
v_mfma_f32_16x16x32_bf16 v[92:95], a[48:51], a[112:115], v[92:95]
v_exp_f32 v79, v79
v_mfma_f32_16x16x32_bf16 v[92:95], a[56:59], a[120:123], v[92:95]
ds_read_b128 a[24:27], v46 offset:6144
v_add_f32 v19, v78, v19
v_mfma_f32_16x16x32_bf16 v[92:95], a[60:63], a[124:127], v[92:95]
v_add_f32 v19, v79, v19
v_cvt_pk_bf16_f32 v75, v78, v79
v_mfma_f32_16x16x32_bf16 v[84:87], a[60:63], a[92:95], v[84:87]
ds_read_b128 a[28:31], v46 offset:7168
v_cvt_pk_bf16_f32 v22, v22, v23
v_mfma_f32_16x16x32_bf16 v[84:87], a[56:59], a[88:91], v[84:87]
buffer_load_dwordx4 v4, s[8:11], s93 offen offset:0 sc1 lds
v_mfma_f32_16x16x32_bf16 v[128:131], a[0:3], v[64:67], v[128:131]
ds_read_b128 a[32:35], v46 offset:8192
v_cvt_pk_bf16_f32 v23, v24, v25
v_mfma_f32_16x16x32_bf16 v[192:195], a[0:3], v[72:75], v[192:195]
s_waitcnt lgkmcnt(3)
ds_read_b128 a[36:39], v46 offset:9216
v_cvt_pk_bf16_f32 v24, v26, v27
v_mfma_f32_16x16x32_bf16 v[196:199], a[4:7], v[72:75], v[196:199]
ds_read_b128 a[40:43], v46 offset:10240
ds_read_b128 a[44:47], v46 offset:11264
v_mfma_f32_16x16x32_bf16 v[132:135], a[4:7], v[64:67], v[132:135]
v_exp_f32 v80, v80
v_mfma_f32_16x16x32_bf16 v[136:139], a[8:11], v[64:67], v[136:139]
buffer_load_dwordx4 v4, s[8:11], s93 offen offset:1024 sc1 lds
v_mfma_f32_16x16x32_bf16 v[200:203], a[8:11], v[72:75], v[200:203]
ds_read_b128 a[48:51], v46 offset:12288
v_cvt_pk_bf16_f32 v25, v28, v29
v_mfma_f32_16x16x32_bf16 v[204:207], a[12:15], v[72:75], v[204:207]
ds_read_b128 a[52:55], v46 offset:13312
ds_read_b128 a[56:59], v46 offset:14336
v_mfma_f32_16x16x32_bf16 v[140:143], a[12:15], v[64:67], v[140:143]
ds_read_b128 a[60:63], v46 offset:15360
v_mfma_f32_16x16x32_bf16 v[144:147], a[16:19], v[64:67], v[144:147]
v_exp_f32 v81, v81
v_mfma_f32_16x16x32_bf16 v[208:211], a[16:19], v[72:75], v[208:211]
v_add_f32 v18, v80, v18
v_mfma_f32_16x16x32_bf16 v[212:215], a[20:23], v[72:75], v[212:215]
v_exp_f32 v82, v82
v_mfma_f32_16x16x32_bf16 v[148:151], a[20:23], v[64:67], v[148:151]
s_waitcnt lgkmcnt(4)
buffer_load_dwordx4 v4, s[8:11], s93 offen offset:2048 sc1 lds
v_mfma_f32_16x16x32_bf16 v[152:155], a[24:27], v[64:67], v[152:155]
v_add_f32 v18, v81, v18
v_cvt_pk_bf16_f32 v80, v80, v81
v_mfma_f32_16x16x32_bf16 v[216:219], a[24:27], v[72:75], v[216:219]
buffer_store_dwordx4 v[22:25], v1, s[8:11], s76 offen offset:3072 sc1
v_mfma_f32_16x16x32_bf16 v[220:223], a[28:31], v[72:75], v[220:223]
s_add_u32 s76, s76, s77
buffer_load_dwordx4 v4, s[8:11], s93 offen offset:3072 sc1 lds
v_mfma_f32_16x16x32_bf16 v[156:159], a[28:31], v[64:67], v[156:159]
s_add_u32 s93, s93, 32768
v_exp_f32 v83, v83
v_mfma_f32_16x16x32_bf16 v[160:163], a[32:35], v[64:67], v[160:163]
s_add_u32 s94, s94, 32768
v_accvgpr_read_b32 v26, a228
v_add_f32 v18, v82, v18
v_mfma_f32_16x16x32_bf16 v[224:227], a[32:35], v[72:75], v[224:227]
s_and_b32 s94, s94, 0x1ffff
v_exp_f32 v84, v84
v_mfma_f32_16x16x32_bf16 v[228:231], a[36:39], v[72:75], v[228:231]
s_waitcnt vmcnt(17) lgkmcnt(0)
v_accvgpr_read_b32 v27, a229
v_add_f32 v18, v83, v18
v_mfma_f32_16x16x32_bf16 v[164:167], a[36:39], v[64:67], v[164:167]
s_barrier
v_cvt_pk_bf16_f32 v81, v82, v83
v_accvgpr_read_b32 v28, a230
v_mfma_f32_16x16x32_bf16 v[168:171], a[40:43], v[64:67], v[168:171]
v_exp_f32 v85, v85
v_mfma_f32_16x16x32_bf16 v[232:235], a[40:43], v[72:75], v[232:235]
ds_read_b128 a[0:3], v46 offset:49152
v_add_f32 v18, v84, v18
v_mfma_f32_16x16x32_bf16 v[236:239], a[44:47], v[72:75], v[236:239]
v_exp_f32 v86, v86
v_mfma_f32_16x16x32_bf16 v[172:175], a[44:47], v[64:67], v[172:175]
ds_read_b128 a[4:7], v46 offset:50176
v_accvgpr_read_b32 v29, a231
v_mfma_f32_16x16x32_bf16 v[176:179], a[48:51], v[64:67], v[176:179]
ds_read_b128 a[8:11], v46 offset:51200
v_add_f32 v18, v85, v18
v_mfma_f32_16x16x32_bf16 v[240:243], a[48:51], v[72:75], v[240:243]
v_accvgpr_read_b32 v22, a224
v_cvt_pk_bf16_f32 v82, v84, v85
v_mfma_f32_16x16x32_bf16 v[244:247], a[52:55], v[72:75], v[244:247]
v_exp_f32 v87, v87
v_mfma_f32_16x16x32_bf16 v[180:183], a[52:55], v[64:67], v[180:183]
ds_read_b128 a[12:15], v46 offset:52224
v_accvgpr_read_b32 v23, a225
v_mfma_f32_16x16x32_bf16 v[184:187], a[56:59], v[64:67], v[184:187]
ds_read_b128 a[16:19], v46 offset:53248
v_add_f32 v18, v86, v18
v_mfma_f32_16x16x32_bf16 v[248:251], a[56:59], v[72:75], v[248:251]
ds_read_b128 a[20:23], v46 offset:54272
v_add_f32 v18, v87, v18
v_mfma_f32_16x16x32_bf16 v[252:255], a[60:63], v[72:75], v[252:255]
ds_read_b128 a[24:27], v46 offset:55296
v_cvt_pk_bf16_f32 v83, v86, v87
v_mfma_f32_16x16x32_bf16 v[188:191], a[60:63], v[64:67], v[188:191]
s_waitcnt lgkmcnt(4)
ds_read_b128 a[28:31], v46 offset:56320
v_accvgpr_read_b32 v24, a226
v_mfma_f32_16x16x32_bf16 v[64:67], a[0:3], a[64:67], v[48:51]
v_exp_f32 v88, v88
v_mfma_f32_16x16x32_bf16 v[64:67], a[4:7], a[68:71], v[64:67]
s_mov_b32 m0, s94
ds_read_b128 a[32:35], v46 offset:57344
v_accvgpr_read_b32 v25, a227
v_mfma_f32_16x16x32_bf16 v[72:75], a[4:7], a[100:103], v[52:55]
v_exp_f32 v89, v89
v_mfma_f32_16x16x32_bf16 v[72:75], a[0:3], a[96:99], v[72:75]
buffer_load_dwordx4 v3, s[8:11], s93 offen offset:0 sc1 lds
v_mfma_f32_16x16x32_bf16 v[72:75], a[8:11], a[104:107], v[72:75]
s_waitcnt lgkmcnt(3)
ds_read_b128 a[36:39], v46 offset:58368
v_add_f32 v19, v88, v19
v_mfma_f32_16x16x32_bf16 v[72:75], a[12:15], a[108:111], v[72:75]
v_exp_f32 v90, v90
v_mfma_f32_16x16x32_bf16 v[64:67], a[12:15], a[76:79], v[64:67]
ds_read_b128 a[40:43], v46 offset:59392
v_cvt_pk_bf16_f32 v22, v22, v23
v_mfma_f32_16x16x32_bf16 v[64:67], a[8:11], a[72:75], v[64:67]
ds_read_b128 a[44:47], v46 offset:60416
v_add_f32 v19, v89, v19
v_mfma_f32_16x16x32_bf16 v[64:67], a[16:19], a[80:83], v[64:67]
ds_read_b128 a[48:51], v46 offset:61440
v_cvt_pk_bf16_f32 v88, v88, v89
v_mfma_f32_16x16x32_bf16 v[64:67], a[20:23], a[84:87], v[64:67]
buffer_load_dwordx4 v3, s[8:11], s93 offen offset:1024 sc1 lds
v_mfma_f32_16x16x32_bf16 v[72:75], a[20:23], a[116:119], v[72:75]
v_exp_f32 v91, v91
v_mfma_f32_16x16x32_bf16 v[72:75], a[16:19], a[112:115], v[72:75]
s_waitcnt lgkmcnt(3)
ds_read_b128 a[52:55], v46 offset:62464
v_cvt_pk_bf16_f32 v23, v24, v25
v_mfma_f32_16x16x32_bf16 v[72:75], a[24:27], a[120:123], v[72:75]
ds_read_b128 a[56:59], v46 offset:63488
v_add_f32 v19, v90, v19
v_mfma_f32_16x16x32_bf16 v[72:75], a[28:31], a[124:127], v[72:75]
v_exp_f32 v92, v92
v_mfma_f32_16x16x32_bf16 v[64:67], a[28:31], a[92:95], v[64:67]
ds_read_b128 a[60:63], v46 offset:64512
v_cvt_pk_bf16_f32 v24, v26, v27
v_mfma_f32_16x16x32_bf16 v[64:67], a[24:27], a[88:91], v[64:67]
ds_read_b128 a[0:3], v46 offset:32768
v_add_f32 v19, v91, v19
v_mfma_f32_16x16x32_bf16 v[68:71], a[32:35], a[64:67], v[48:51]
buffer_load_dwordx4 v3, s[8:11], s93 offen offset:2048 sc1 lds
v_mfma_f32_16x16x32_bf16 v[68:71], a[36:39], a[68:71], v[68:71]
v_cvt_pk_bf16_f32 v25, v28, v29
v_cvt_pk_bf16_f32 v89, v90, v91
v_mfma_f32_16x16x32_bf16 v[76:79], a[36:39], a[100:103], v[52:55]
v_exp_f32 v93, v93
v_mfma_f32_16x16x32_bf16 v[76:79], a[32:35], a[96:99], v[76:79]
s_waitcnt lgkmcnt(2)
ds_read_b128 a[4:7], v46 offset:33792
v_add_f32 v19, v92, v19
v_mfma_f32_16x16x32_bf16 v[76:79], a[40:43], a[104:107], v[76:79]
buffer_store_dwordx4 v[22:25], v1, s[8:11], s76 offen offset:0 sc1
v_mfma_f32_16x16x32_bf16 v[76:79], a[44:47], a[108:111], v[76:79]
ds_read_b128 a[8:11], v46 offset:34816
v_accvgpr_read_b32 v26, a236
v_mfma_f32_16x16x32_bf16 v[68:71], a[44:47], a[76:79], v[68:71]
v_exp_f32 v94, v94
v_mfma_f32_16x16x32_bf16 v[68:71], a[40:43], a[72:75], v[68:71]
ds_read_b128 a[12:15], v46 offset:35840
v_add_f32 v19, v93, v19
v_mfma_f32_16x16x32_bf16 v[68:71], a[48:51], a[80:83], v[68:71]
buffer_load_dwordx4 v3, s[8:11], s93 offen offset:3072 sc1 lds
v_mfma_f32_16x16x32_bf16 v[68:71], a[52:55], a[84:87], v[68:71]
s_add_u32 m0, s94, 4096
ds_read_b128 a[16:19], v46 offset:36864
v_cvt_pk_bf16_f32 v90, v92, v93
v_mfma_f32_16x16x32_bf16 v[76:79], a[52:55], a[116:119], v[76:79]
ds_read_b128 a[20:23], v46 offset:37888
v_accvgpr_read_b32 v27, a237
v_mfma_f32_16x16x32_bf16 v[76:79], a[48:51], a[112:115], v[76:79]
v_exp_f32 v95, v95
v_mfma_f32_16x16x32_bf16 v[76:79], a[56:59], a[120:123], v[76:79]
s_waitcnt lgkmcnt(3)
ds_read_b128 a[24:27], v46 offset:38912
v_add_f32 v19, v94, v19
v_mfma_f32_16x16x32_bf16 v[76:79], a[60:63], a[124:127], v[76:79]
v_add_f32 v19, v95, v19
v_cvt_pk_bf16_f32 v91, v94, v95
v_mfma_f32_16x16x32_bf16 v[68:71], a[60:63], a[92:95], v[68:71]
ds_read_b128 a[28:31], v46 offset:39936
v_accvgpr_read_b32 v28, a238
v_mfma_f32_16x16x32_bf16 v[68:71], a[56:59], a[88:91], v[68:71]
buffer_load_dwordx4 v4, s[8:11], s93 offen offset:0 sc1 lds
v_mfma_f32_16x16x32_bf16 v[128:131], a[0:3], v[80:83], v[128:131]
ds_read_b128 a[32:35], v46 offset:40960
v_accvgpr_read_b32 v29, a239
v_mfma_f32_16x16x32_bf16 v[192:195], a[0:3], v[88:91], v[192:195]
ds_read_b128 a[36:39], v46 offset:41984
ds_read_b128 a[40:43], v46 offset:43008
v_mfma_f32_16x16x32_bf16 v[196:199], a[4:7], v[88:91], v[196:199]
v_exp_f32 v64, v64
v_mfma_f32_16x16x32_bf16 v[132:135], a[4:7], v[80:83], v[132:135]
ds_read_b128 a[44:47], v46 offset:44032
v_accvgpr_read_b32 v22, a232
v_mfma_f32_16x16x32_bf16 v[136:139], a[8:11], v[80:83], v[136:139]
buffer_load_dwordx4 v4, s[8:11], s93 offen offset:1024 sc1 lds
v_mfma_f32_16x16x32_bf16 v[200:203], a[8:11], v[88:91], v[200:203]
s_waitcnt lgkmcnt(4)
v_exp_f32 v65, v65
v_mfma_f32_16x16x32_bf16 v[204:207], a[12:15], v[88:91], v[204:207]
ds_read_b128 a[48:51], v46 offset:45056
ds_read_b128 a[52:55], v46 offset:46080
v_mfma_f32_16x16x32_bf16 v[140:143], a[12:15], v[80:83], v[140:143]
ds_read_b128 a[56:59], v46 offset:47104
ds_read_b128 a[60:63], v46 offset:48128
v_mfma_f32_16x16x32_bf16 v[144:147], a[16:19], v[80:83], v[144:147]
v_add_f32 v18, v64, v18
v_accvgpr_read_b32 v23, a233
v_mfma_f32_16x16x32_bf16 v[208:211], a[16:19], v[88:91], v[208:211]
v_exp_f32 v66, v66
v_mfma_f32_16x16x32_bf16 v[212:215], a[20:23], v[88:91], v[212:215]
v_add_f32 v18, v65, v18
v_cvt_pk_bf16_f32 v64, v64, v65
v_mfma_f32_16x16x32_bf16 v[148:151], a[20:23], v[80:83], v[148:151]
buffer_load_dwordx4 v4, s[8:11], s93 offen offset:2048 sc1 lds
v_mfma_f32_16x16x32_bf16 v[152:155], a[24:27], v[80:83], v[152:155]
v_exp_f32 v67, v67
v_mfma_f32_16x16x32_bf16 v[216:219], a[24:27], v[88:91], v[216:219]
v_accvgpr_read_b32 v24, a234
v_add_f32 v18, v66, v18
v_mfma_f32_16x16x32_bf16 v[220:223], a[28:31], v[88:91], v[220:223]
buffer_load_dwordx4 v4, s[8:11], s93 offen offset:3072 sc1 lds
v_mfma_f32_16x16x32_bf16 v[156:159], a[28:31], v[80:83], v[156:159]
s_waitcnt lgkmcnt(0)
s_add_u32 s93, s93, 32768
v_exp_f32 v68, v68
v_mfma_f32_16x16x32_bf16 v[160:163], a[32:35], v[80:83], v[160:163]
s_add_u32 s94, s94, 32768
v_accvgpr_read_b32 v25, a235
v_add_f32 v18, v67, v18
v_mfma_f32_16x16x32_bf16 v[224:227], a[32:35], v[88:91], v[224:227]
s_and_b32 s94, s94, 0x1ffff
v_xor_b32 v46, 0x10000, v46
v_cvt_pk_bf16_f32 v22, v22, v23
v_mfma_f32_16x16x32_bf16 v[228:231], a[36:39], v[88:91], v[228:231]
s_waitcnt vmcnt(18) lgkmcnt(0)
v_cvt_pk_bf16_f32 v65, v66, v67
v_cvt_pk_bf16_f32 v23, v24, v25
v_mfma_f32_16x16x32_bf16 v[164:167], a[36:39], v[80:83], v[164:167]
s_barrier
v_exp_f32 v69, v69
v_mfma_f32_16x16x32_bf16 v[168:171], a[40:43], v[80:83], v[168:171]
ds_read_b128 a[0:3], v46 offset:16384
v_add_f32 v18, v68, v18
v_mfma_f32_16x16x32_bf16 v[232:235], a[40:43], v[88:91], v[232:235]
v_exp_f32 v70, v70
v_mfma_f32_16x16x32_bf16 v[236:239], a[44:47], v[88:91], v[236:239]
ds_read_b128 a[4:7], v46 offset:17408
v_add_f32 v18, v69, v18
v_mfma_f32_16x16x32_bf16 v[172:175], a[44:47], v[80:83], v[172:175]
ds_read_b128 a[8:11], v46 offset:18432
v_cvt_pk_bf16_f32 v24, v26, v27
v_mfma_f32_16x16x32_bf16 v[176:179], a[48:51], v[80:83], v[176:179]
ds_read_b128 a[12:15], v46 offset:19456
v_cvt_pk_bf16_f32 v66, v68, v69
v_mfma_f32_16x16x32_bf16 v[240:243], a[48:51], v[88:91], v[240:243]
v_exp_f32 v71, v71
v_mfma_f32_16x16x32_bf16 v[244:247], a[52:55], v[88:91], v[244:247]
ds_read_b128 a[16:19], v46 offset:20480
v_cvt_pk_bf16_f32 v25, v28, v29
v_mfma_f32_16x16x32_bf16 v[180:183], a[52:55], v[80:83], v[180:183]
ds_read_b128 a[20:23], v46 offset:21504
v_add_f32 v18, v70, v18
v_mfma_f32_16x16x32_bf16 v[184:187], a[56:59], v[80:83], v[184:187]
ds_read_b128 a[24:27], v46 offset:22528
v_add_f32 v18, v71, v18
v_mfma_f32_16x16x32_bf16 v[248:251], a[56:59], v[88:91], v[248:251]
buffer_store_dwordx4 v[22:25], v1, s[8:11], s76 offen offset:1024 sc1
v_mfma_f32_16x16x32_bf16 v[252:255], a[60:63], v[88:91], v[252:255]
v_cvt_pk_bf16_f32 v67, v70, v71
v_mfma_f32_16x16x32_bf16 v[188:191], a[60:63], v[80:83], v[188:191]
s_cmp_eq_u32 s90, 3
s_cbranch_scc1 REST3
s_waitcnt lgkmcnt(5)
v_mfma_f32_16x16x32_bf16 v[80:83], a[0:3], a[64:67], v[48:51]
v_exp_f32 v72, v72
v_mfma_f32_16x16x32_bf16 v[80:83], a[4:7], a[68:71], v[80:83]
s_mov_b32 m0, s94
ds_read_b128 a[28:31], v46 offset:23552
v_accvgpr_read_b32 v26, a244
v_mfma_f32_16x16x32_bf16 v[88:91], a[4:7], a[100:103], v[52:55]
v_exp_f32 v73, v73
v_mfma_f32_16x16x32_bf16 v[88:91], a[0:3], a[96:99], v[88:91]
s_waitcnt lgkmcnt(3)
buffer_load_dwordx4 v3, s[8:11], s93 offen offset:0 sc1 lds
v_mfma_f32_16x16x32_bf16 v[88:91], a[8:11], a[104:107], v[88:91]
ds_read_b128 a[32:35], v46 offset:24576
v_accvgpr_read_b32 v27, a245
v_mfma_f32_16x16x32_bf16 v[88:91], a[12:15], a[108:111], v[88:91]
ds_read_b128 a[36:39], v46 offset:25600
v_add_f32 v19, v72, v19
v_mfma_f32_16x16x32_bf16 v[80:83], a[12:15], a[76:79], v[80:83]
v_exp_f32 v74, v74
v_mfma_f32_16x16x32_bf16 v[80:83], a[8:11], a[72:75], v[80:83]
ds_read_b128 a[40:43], v46 offset:26624
v_accvgpr_read_b32 v28, a246
v_mfma_f32_16x16x32_bf16 v[80:83], a[16:19], a[80:83], v[80:83]
s_waitcnt lgkmcnt(3)
ds_read_b128 a[44:47], v46 offset:27648
v_add_f32 v19, v73, v19
v_mfma_f32_16x16x32_bf16 v[80:83], a[20:23], a[84:87], v[80:83]
v_cvt_pk_bf16_f32 v72, v72, v73
v_accvgpr_read_b32 v29, a247
v_mfma_f32_16x16x32_bf16 v[88:91], a[20:23], a[116:119], v[88:91]
buffer_load_dwordx4 v3, s[8:11], s93 offen offset:1024 sc1 lds
v_mfma_f32_16x16x32_bf16 v[88:91], a[16:19], a[112:115], v[88:91]
ds_read_b128 a[48:51], v46 offset:28672
v_accvgpr_read_b32 v22, a240
v_mfma_f32_16x16x32_bf16 v[88:91], a[24:27], a[120:123], v[88:91]
v_exp_f32 v75, v75
v_mfma_f32_16x16x32_bf16 v[88:91], a[28:31], a[124:127], v[88:91]
ds_read_b128 a[52:55], v46 offset:29696
v_add_f32 v19, v74, v19
v_mfma_f32_16x16x32_bf16 v[80:83], a[28:31], a[92:95], v[80:83]
v_exp_f32 v76, v76
v_mfma_f32_16x16x32_bf16 v[80:83], a[24:27], a[88:91], v[80:83]
s_waitcnt lgkmcnt(2)
ds_read_b128 a[56:59], v46 offset:30720
v_accvgpr_read_b32 v23, a241
v_mfma_f32_16x16x32_bf16 v[84:87], a[32:35], a[64:67], v[48:51]
ds_read_b128 a[60:63], v46 offset:31744
v_add_f32 v19, v75, v19
v_mfma_f32_16x16x32_bf16 v[84:87], a[36:39], a[68:71], v[84:87]
buffer_load_dwordx4 v3, s[8:11], s93 offen offset:2048 sc1 lds
v_mfma_f32_16x16x32_bf16 v[92:95], a[36:39], a[100:103], v[52:55]
ds_read_b128 a[0:3], v46 offset:0
v_cvt_pk_bf16_f32 v73, v74, v75
v_mfma_f32_16x16x32_bf16 v[92:95], a[32:35], a[96:99], v[92:95]
ds_read_b128 a[4:7], v46 offset:1024
v_accvgpr_read_b32 v24, a242
v_mfma_f32_16x16x32_bf16 v[92:95], a[40:43], a[104:107], v[92:95]
v_exp_f32 v77, v77
v_mfma_f32_16x16x32_bf16 v[92:95], a[44:47], a[108:111], v[92:95]
ds_read_b128 a[8:11], v46 offset:2048
v_accvgpr_read_b32 v25, a243
v_mfma_f32_16x16x32_bf16 v[84:87], a[44:47], a[76:79], v[84:87]
ds_read_b128 a[12:15], v46 offset:3072
v_add_f32 v19, v76, v19
v_mfma_f32_16x16x32_bf16 v[84:87], a[40:43], a[72:75], v[84:87]
s_waitcnt lgkmcnt(4)
v_exp_f32 v78, v78
v_mfma_f32_16x16x32_bf16 v[84:87], a[48:51], a[80:83], v[84:87]
buffer_load_dwordx4 v3, s[8:11], s93 offen offset:3072 sc1 lds
v_mfma_f32_16x16x32_bf16 v[84:87], a[52:55], a[84:87], v[84:87]
s_add_u32 m0, s94, 4096
ds_read_b128 a[16:19], v46 offset:4096
v_cvt_pk_bf16_f32 v22, v22, v23
v_mfma_f32_16x16x32_bf16 v[92:95], a[52:55], a[116:119], v[92:95]
v_add_f32 v19, v77, v19
v_cvt_pk_bf16_f32 v74, v76, v77
v_mfma_f32_16x16x32_bf16 v[92:95], a[48:51], a[112:115], v[92:95]
v_exp_f32 v79, v79
v_mfma_f32_16x16x32_bf16 v[92:95], a[56:59], a[120:123], v[92:95]
ds_read_b128 a[20:23], v46 offset:5120
v_add_f32 v19, v78, v19
v_mfma_f32_16x16x32_bf16 v[92:95], a[60:63], a[124:127], v[92:95]
v_add_f32 v19, v79, v19
v_cvt_pk_bf16_f32 v75, v78, v79
v_mfma_f32_16x16x32_bf16 v[84:87], a[60:63], a[92:95], v[84:87]
ds_read_b128 a[24:27], v46 offset:6144
v_cvt_pk_bf16_f32 v23, v24, v25
v_mfma_f32_16x16x32_bf16 v[84:87], a[56:59], a[88:91], v[84:87]
s_waitcnt lgkmcnt(3)
ds_read_b128 a[28:31], v46 offset:7168
v_cvt_pk_bf16_f32 v24, v26, v27
v_mfma_f32_16x16x32_bf16 v[128:131], a[0:3], v[64:67], v[128:131]
buffer_load_dwordx4 v4, s[8:11], s93 offen offset:0 sc1 lds
v_mfma_f32_16x16x32_bf16 v[192:195], a[0:3], v[72:75], v[192:195]
ds_read_b128 a[32:35], v46 offset:8192
v_cvt_pk_bf16_f32 v25, v28, v29
v_mfma_f32_16x16x32_bf16 v[196:199], a[4:7], v[72:75], v[196:199]
ds_read_b128 a[36:39], v46 offset:9216
ds_read_b128 a[40:43], v46 offset:10240
v_mfma_f32_16x16x32_bf16 v[132:135], a[4:7], v[64:67], v[132:135]
buffer_store_dwordx4 v[22:25], v1, s[8:11], s76 offen offset:2048 sc1
v_mfma_f32_16x16x32_bf16 v[136:139], a[8:11], v[64:67], v[136:139]
v_exp_f32 v80, v80
v_mfma_f32_16x16x32_bf16 v[200:203], a[8:11], v[72:75], v[200:203]
ds_read_b128 a[44:47], v46 offset:11264
ds_read_b128 a[48:51], v46 offset:12288
v_mfma_f32_16x16x32_bf16 v[204:207], a[12:15], v[72:75], v[204:207]
ds_read_b128 a[52:55], v46 offset:13312
ds_read_b128 a[56:59], v46 offset:14336
v_mfma_f32_16x16x32_bf16 v[140:143], a[12:15], v[64:67], v[140:143]
s_waitcnt lgkmcnt(7)
ds_read_b128 a[60:63], v46 offset:15360
v_accvgpr_read_b32 v26, a252
v_mfma_f32_16x16x32_bf16 v[144:147], a[16:19], v[64:67], v[144:147]
buffer_load_dwordx4 v4, s[8:11], s93 offen offset:1024 sc1 lds
v_mfma_f32_16x16x32_bf16 v[208:211], a[16:19], v[72:75], v[208:211]
v_exp_f32 v81, v81
v_mfma_f32_16x16x32_bf16 v[212:215], a[20:23], v[72:75], v[212:215]
v_accvgpr_read_b32 v27, a253
v_add_f32 v18, v80, v18
v_mfma_f32_16x16x32_bf16 v[148:151], a[20:23], v[64:67], v[148:151]
v_exp_f32 v82, v82
v_mfma_f32_16x16x32_bf16 v[152:155], a[24:27], v[64:67], v[152:155]
v_accvgpr_read_b32 v28, a254
v_add_f32 v18, v81, v18
v_mfma_f32_16x16x32_bf16 v[216:219], a[24:27], v[72:75], v[216:219]
buffer_load_dwordx4 v4, s[8:11], s93 offen offset:2048 sc1 lds
v_mfma_f32_16x16x32_bf16 v[220:223], a[28:31], v[72:75], v[220:223]
buffer_load_dwordx4 v4, s[8:11], s93 offen offset:3072 sc1 lds
v_mfma_f32_16x16x32_bf16 v[156:159], a[28:31], v[64:67], v[156:159]
s_waitcnt lgkmcnt(0)
s_add_u32 s93, s93, 32768
v_accvgpr_read_b32 v29, a255
v_cvt_pk_bf16_f32 v80, v80, v81
v_mfma_f32_16x16x32_bf16 v[160:163], a[32:35], v[64:67], v[160:163]
s_add_u32 s94, s94, 32768
v_exp_f32 v83, v83
v_mfma_f32_16x16x32_bf16 v[224:227], a[32:35], v[72:75], v[224:227]
s_and_b32 s94, s94, 0x1ffff
v_accvgpr_read_b32 v22, a248
v_add_f32 v18, v82, v18
v_mfma_f32_16x16x32_bf16 v[228:231], a[36:39], v[72:75], v[228:231]
s_waitcnt vmcnt(17) lgkmcnt(0)
v_exp_f32 v84, v84
v_mfma_f32_16x16x32_bf16 v[164:167], a[36:39], v[64:67], v[164:167]
s_barrier
v_accvgpr_read_b32 v23, a249
v_add_f32 v18, v83, v18
v_mfma_f32_16x16x32_bf16 v[168:171], a[40:43], v[64:67], v[168:171]
v_accvgpr_read_b32 v24, a250
v_cvt_pk_bf16_f32 v81, v82, v83
v_mfma_f32_16x16x32_bf16 v[232:235], a[40:43], v[72:75], v[232:235]
v_exp_f32 v85, v85
v_mfma_f32_16x16x32_bf16 v[236:239], a[44:47], v[72:75], v[236:239]
v_accvgpr_read_b32 v25, a251
v_add_f32 v18, v84, v18
v_mfma_f32_16x16x32_bf16 v[172:175], a[44:47], v[64:67], v[172:175]
ds_read_b128 a[0:3], v46 offset:49152
v_cvt_pk_bf16_f32 v22, v22, v23
v_mfma_f32_16x16x32_bf16 v[176:179], a[48:51], v[64:67], v[176:179]
ds_read_b128 a[4:7], v46 offset:50176
v_cvt_pk_bf16_f32 v23, v24, v25
v_mfma_f32_16x16x32_bf16 v[240:243], a[48:51], v[72:75], v[240:243]
v_exp_f32 v86, v86
v_mfma_f32_16x16x32_bf16 v[244:247], a[52:55], v[72:75], v[244:247]
ds_read_b128 a[8:11], v46 offset:51200
v_add_f32 v18, v85, v18
v_mfma_f32_16x16x32_bf16 v[180:183], a[52:55], v[64:67], v[180:183]
v_cvt_pk_bf16_f32 v82, v84, v85
v_cvt_pk_bf16_f32 v24, v26, v27
v_mfma_f32_16x16x32_bf16 v[184:187], a[56:59], v[64:67], v[184:187]
ds_read_b128 a[12:15], v46 offset:52224
v_cvt_pk_bf16_f32 v25, v28, v29
v_mfma_f32_16x16x32_bf16 v[248:251], a[56:59], v[72:75], v[248:251]
v_exp_f32 v87, v87
v_mfma_f32_16x16x32_bf16 v[252:255], a[60:63], v[72:75], v[252:255]
ds_read_b128 a[16:19], v46 offset:53248
v_add_f32 v18, v86, v18
v_mfma_f32_16x16x32_bf16 v[188:191], a[60:63], v[64:67], v[188:191]
s_waitcnt lgkmcnt(3)
buffer_store_dwordx4 v[22:25], v1, s[8:11], s76 offen offset:3072 sc1
v_add_f32 v18, v87, v18
v_cvt_pk_bf16_f32 v83, v86, v87
v_mfma_f32_16x16x32_bf16 v[64:67], a[0:3], a[64:67], v[48:51]
ds_read_b128 a[20:23], v46 offset:54272
ds_read_b128 a[24:27], v46 offset:55296
v_mfma_f32_16x16x32_bf16 v[64:67], a[4:7], a[68:71], v[64:67]
s_mov_b32 m0, s94
v_exp_f32 v88, v88
v_mfma_f32_16x16x32_bf16 v[72:75], a[4:7], a[100:103], v[52:55]
ds_read_b128 a[28:31], v46 offset:56320
ds_read_b128 a[32:35], v46 offset:57344
v_mfma_f32_16x16x32_bf16 v[72:75], a[0:3], a[96:99], v[72:75]
s_waitcnt lgkmcnt(5)
v_exp_f32 v89, v89
v_mfma_f32_16x16x32_bf16 v[72:75], a[8:11], a[104:107], v[72:75]
buffer_load_dwordx4 v3, s[8:11], s93 offen offset:0 sc1 lds
v_mfma_f32_16x16x32_bf16 v[72:75], a[12:15], a[108:111], v[72:75]
ds_read_b128 a[36:39], v46 offset:58368
v_add_f32 v19, v88, v19
v_mfma_f32_16x16x32_bf16 v[64:67], a[12:15], a[76:79], v[64:67]
v_exp_f32 v90, v90
v_mfma_f32_16x16x32_bf16 v[64:67], a[8:11], a[72:75], v[64:67]
s_waitcnt lgkmcnt(3)
ds_read_b128 a[40:43], v46 offset:59392
v_add_f32 v19, v89, v19
v_mfma_f32_16x16x32_bf16 v[64:67], a[16:19], a[80:83], v[64:67]
ds_read_b128 a[44:47], v46 offset:60416
v_cvt_pk_bf16_f32 v88, v88, v89
v_mfma_f32_16x16x32_bf16 v[64:67], a[20:23], a[84:87], v[64:67]
ds_read_b128 a[48:51], v46 offset:61440
v_mfma_f32_16x16x32_bf16 v[72:75], a[20:23], a[116:119], v[72:75]
buffer_load_dwordx4 v3, s[8:11], s93 offen offset:1024 sc1 lds
v_mfma_f32_16x16x32_bf16 v[72:75], a[16:19], a[112:115], v[72:75]
v_exp_f32 v91, v91
v_mfma_f32_16x16x32_bf16 v[72:75], a[24:27], a[120:123], v[72:75]
s_waitcnt lgkmcnt(3)
ds_read_b128 a[52:55], v46 offset:62464
v_add_f32 v19, v90, v19
v_mfma_f32_16x16x32_bf16 v[72:75], a[28:31], a[124:127], v[72:75]
ds_read_b128 a[56:59], v46 offset:63488
ds_read_b128 a[60:63], v46 offset:64512
v_mfma_f32_16x16x32_bf16 v[64:67], a[28:31], a[92:95], v[64:67]
v_exp_f32 v92, v92
v_mfma_f32_16x16x32_bf16 v[64:67], a[24:27], a[88:91], v[64:67]
ds_read_b128 a[0:3], v46 offset:32768
v_add_f32 v19, v91, v19
v_mfma_f32_16x16x32_bf16 v[68:71], a[32:35], a[64:67], v[48:51]
buffer_load_dwordx4 v3, s[8:11], s93 offen offset:2048 sc1 lds
v_mfma_f32_16x16x32_bf16 v[68:71], a[36:39], a[68:71], v[68:71]
ds_read_b128 a[4:7], v46 offset:33792
v_cvt_pk_bf16_f32 v89, v90, v91
v_mfma_f32_16x16x32_bf16 v[76:79], a[36:39], a[100:103], v[52:55]
v_exp_f32 v93, v93
v_mfma_f32_16x16x32_bf16 v[76:79], a[32:35], a[96:99], v[76:79]
s_waitcnt lgkmcnt(4)
ds_read_b128 a[8:11], v46 offset:34816
v_add_f32 v19, v92, v19
v_mfma_f32_16x16x32_bf16 v[76:79], a[40:43], a[104:107], v[76:79]
v_exp_f32 v94, v94
v_mfma_f32_16x16x32_bf16 v[76:79], a[44:47], a[108:111], v[76:79]
ds_read_b128 a[12:15], v46 offset:35840
v_add_f32 v19, v93, v19
v_mfma_f32_16x16x32_bf16 v[68:71], a[44:47], a[76:79], v[68:71]
buffer_load_dwordx4 v3, s[8:11], s93 offen offset:3072 sc1 lds
v_mfma_f32_16x16x32_bf16 v[68:71], a[40:43], a[72:75], v[68:71]
s_add_u32 m0, s94, 4096
ds_read_b128 a[16:19], v46 offset:36864
v_cvt_pk_bf16_f32 v90, v92, v93
v_mfma_f32_16x16x32_bf16 v[68:71], a[48:51], a[80:83], v[68:71]
ds_read_b128 a[20:23], v46 offset:37888
v_mfma_f32_16x16x32_bf16 v[68:71], a[52:55], a[84:87], v[68:71]
v_exp_f32 v95, v95
v_mfma_f32_16x16x32_bf16 v[76:79], a[52:55], a[116:119], v[76:79]
ds_read_b128 a[24:27], v46 offset:38912
v_add_f32 v19, v94, v19
v_mfma_f32_16x16x32_bf16 v[76:79], a[48:51], a[112:115], v[76:79]
s_waitcnt lgkmcnt(4)
ds_read_b128 a[28:31], v46 offset:39936
v_add_f32 v19, v95, v19
v_mfma_f32_16x16x32_bf16 v[76:79], a[56:59], a[120:123], v[76:79]
buffer_load_dwordx4 v4, s[8:11], s93 offen offset:0 sc1 lds
v_mfma_f32_16x16x32_bf16 v[76:79], a[60:63], a[124:127], v[76:79]
ds_read_b128 a[32:35], v46 offset:40960
v_cvt_pk_bf16_f32 v91, v94, v95
v_mfma_f32_16x16x32_bf16 v[68:71], a[60:63], a[92:95], v[68:71]
ds_read_b128 a[36:39], v46 offset:41984
v_mfma_f32_16x16x32_bf16 v[68:71], a[56:59], a[88:91], v[68:71]
ds_read_b128 a[40:43], v46 offset:43008
v_mfma_f32_16x16x32_bf16 v[128:131], a[0:3], v[80:83], v[128:131]
v_exp_f32 v64, v64
v_mfma_f32_16x16x32_bf16 v[192:195], a[0:3], v[88:91], v[192:195]
ds_read_b128 a[44:47], v46 offset:44032
v_mfma_f32_16x16x32_bf16 v[196:199], a[4:7], v[88:91], v[196:199]
buffer_load_dwordx4 v4, s[8:11], s93 offen offset:1024 sc1 lds
v_mfma_f32_16x16x32_bf16 v[132:135], a[4:7], v[80:83], v[132:135]
v_exp_f32 v65, v65
v_mfma_f32_16x16x32_bf16 v[136:139], a[8:11], v[80:83], v[136:139]
ds_read_b128 a[48:51], v46 offset:45056
v_add_f32 v18, v64, v18
v_mfma_f32_16x16x32_bf16 v[200:203], a[8:11], v[88:91], v[200:203]
s_waitcnt lgkmcnt(3)
ds_read_b128 a[52:55], v46 offset:46080
v_mfma_f32_16x16x32_bf16 v[204:207], a[12:15], v[88:91], v[204:207]
v_exp_f32 v66, v66
v_mfma_f32_16x16x32_bf16 v[140:143], a[12:15], v[80:83], v[140:143]
ds_read_b128 a[56:59], v46 offset:47104
ds_read_b128 a[60:63], v46 offset:48128
v_mfma_f32_16x16x32_bf16 v[144:147], a[16:19], v[80:83], v[144:147]
v_add_f32 v18, v65, v18
v_cvt_pk_bf16_f32 v64, v64, v65
v_mfma_f32_16x16x32_bf16 v[208:211], a[16:19], v[88:91], v[208:211]
buffer_load_dwordx4 v4, s[8:11], s93 offen offset:2048 sc1 lds
v_mfma_f32_16x16x32_bf16 v[212:215], a[20:23], v[88:91], v[212:215]
v_exp_f32 v67, v67
v_mfma_f32_16x16x32_bf16 v[148:151], a[20:23], v[80:83], v[148:151]
v_add_f32 v18, v66, v18
v_mfma_f32_16x16x32_bf16 v[152:155], a[24:27], v[80:83], v[152:155]
v_mfma_f32_16x16x32_bf16 v[216:219], a[24:27], v[88:91], v[216:219]
v_exp_f32 v68, v68
v_mfma_f32_16x16x32_bf16 v[220:223], a[28:31], v[88:91], v[220:223]
buffer_load_dwordx4 v4, s[8:11], s93 offen offset:3072 sc1 lds
v_mfma_f32_16x16x32_bf16 v[156:159], a[28:31], v[80:83], v[156:159]
s_add_u32 s93, s93, 32768
v_add_f32 v18, v67, v18
v_cvt_pk_bf16_f32 v65, v66, v67
v_mfma_f32_16x16x32_bf16 v[160:163], a[32:35], v[80:83], v[160:163]
s_add_u32 s94, s94, 32768
v_mfma_f32_16x16x32_bf16 v[224:227], a[32:35], v[88:91], v[224:227]
s_and_b32 s94, s94, 0x1ffff
v_xor_b32 v46, 0x10000, v46
v_mfma_f32_16x16x32_bf16 v[228:231], a[36:39], v[88:91], v[228:231]
s_waitcnt vmcnt(18) lgkmcnt(0)
v_exp_f32 v69, v69
v_mfma_f32_16x16x32_bf16 v[164:167], a[36:39], v[80:83], v[164:167]
s_barrier
v_add_f32 v18, v68, v18
v_mfma_f32_16x16x32_bf16 v[168:171], a[40:43], v[80:83], v[168:171]
s_waitcnt vmcnt(8)
ds_read_b128 a[0:3], v46 offset:16384
v_mov_b32 v6, 3
v_mfma_f32_16x16x32_bf16 v[232:235], a[40:43], v[88:91], v[232:235]
v_exp_f32 v70, v70
v_mfma_f32_16x16x32_bf16 v[236:239], a[44:47], v[88:91], v[236:239]
ds_read_b128 a[4:7], v46 offset:17408
v_add_f32 v18, v69, v18
v_mfma_f32_16x16x32_bf16 v[172:175], a[44:47], v[80:83], v[172:175]
v_mfma_f32_16x16x32_bf16 v[176:179], a[48:51], v[80:83], v[176:179]
ds_read_b128 a[8:11], v46 offset:18432
v_cvt_pk_bf16_f32 v66, v68, v69
v_mfma_f32_16x16x32_bf16 v[240:243], a[48:51], v[88:91], v[240:243]
v_exp_f32 v71, v71
v_mfma_f32_16x16x32_bf16 v[244:247], a[52:55], v[88:91], v[244:247]
ds_read_b128 a[12:15], v46 offset:19456
v_add_f32 v18, v70, v18
v_mfma_f32_16x16x32_bf16 v[180:183], a[52:55], v[80:83], v[180:183]
buffer_store_dword v6, off, s[8:11], s81 sc1
v_mfma_f32_16x16x32_bf16 v[184:187], a[56:59], v[80:83], v[184:187]
ds_read_b128 a[16:19], v46 offset:20480
v_add_f32 v18, v71, v18
v_mfma_f32_16x16x32_bf16 v[248:251], a[56:59], v[88:91], v[248:251]
ds_read_b128 a[20:23], v46 offset:21504
v_cvt_pk_bf16_f32 v67, v70, v71
v_mfma_f32_16x16x32_bf16 v[252:255], a[60:63], v[88:91], v[252:255]
ds_read_b128 a[24:27], v46 offset:22528
v_mfma_f32_16x16x32_bf16 v[188:191], a[60:63], v[80:83], v[188:191]
s_sub_u32 s96, s90, 4
s_mov_b32 s63, 1
NOLATE:
s_min_u32 s66, s96, s63
s_sub_u32 s96, s96, s66
s_sub_u32 s66, s66, 1
s_cbranch_scc0 PLAIN
s_cmp_eq_u32 s89, 2
s_cbranch_scc1 NOANTE
s_branch ONDIAG
ONCE8:
s_waitcnt vmcnt(8)
v_mov_b32 v6, s98
buffer_store_dword v6, off, s[8:11], s79 sc1
s_mov_b32 s98, 0
s_branch BACK8
SEG2:
s_cmp_lg_u32 s75, 0
s_cbranch_scc1 SEG3
s_mov_b32 s75, 1
s_lshl_b32 s65, s61, 8
buffer_load_dword v7, v5, s[8:11], s65 offen sc1
s_min_u32 s66, s96, 1
s_sub_u32 s96, s96, s66
s_sub_u32 s66, s66, 1
s_branch PLAIN
SEG3:
s_lshl_b32 s65, s61, 8
v_cmp_gt_u32 vcc, 3, v7
s_nop 0
s_cmp_lg_u64 vcc, 0
s_cbranch_scc1 SPIN12_0
OK12_0:
s_min_u32 s66, s96, 99
s_sub_u32 s96, s96, s66
s_sub_u32 s66, s66, 1
.p2align 5
PLAIN:
s_waitcnt lgkmcnt(5)
v_mfma_f32_16x16x32_bf16 v[80:83], a[0:3], a[64:67], v[48:51]
v_exp_f32 v72, v72
v_mfma_f32_16x16x32_bf16 v[80:83], a[4:7], a[68:71], v[80:83]
s_mov_b32 m0, s94
ds_read_b128 a[28:31], v46 offset:23552
v_mfma_f32_16x16x32_bf16 v[88:91], a[4:7], a[100:103], v[52:55]
v_exp_f32 v73, v73
v_mfma_f32_16x16x32_bf16 v[88:91], a[0:3], a[96:99], v[88:91]
s_waitcnt lgkmcnt(3)
buffer_load_dwordx4 v3, s[8:11], s93 offen offset:0 sc1 lds
v_mfma_f32_16x16x32_bf16 v[88:91], a[8:11], a[104:107], v[88:91]
ds_read_b128 a[32:35], v46 offset:24576
v_add_f32 v19, v72, v19
v_mfma_f32_16x16x32_bf16 v[88:91], a[12:15], a[108:111], v[88:91]
ds_read_b128 a[36:39], v46 offset:25600
v_mfma_f32_16x16x32_bf16 v[80:83], a[12:15], a[76:79], v[80:83]
v_exp_f32 v74, v74
v_mfma_f32_16x16x32_bf16 v[80:83], a[8:11], a[72:75], v[80:83]
ds_read_b128 a[40:43], v46 offset:26624
v_add_f32 v19, v73, v19
v_mfma_f32_16x16x32_bf16 v[80:83], a[16:19], a[80:83], v[80:83]
s_waitcnt lgkmcnt(3)
ds_read_b128 a[44:47], v46 offset:27648
v_cvt_pk_bf16_f32 v72, v72, v73
v_mfma_f32_16x16x32_bf16 v[80:83], a[20:23], a[84:87], v[80:83]
buffer_load_dwordx4 v3, s[8:11], s93 offen offset:1024 sc1 lds
v_mfma_f32_16x16x32_bf16 v[88:91], a[20:23], a[116:119], v[88:91]
ds_read_b128 a[48:51], v46 offset:28672
v_mfma_f32_16x16x32_bf16 v[88:91], a[16:19], a[112:115], v[88:91]
v_exp_f32 v75, v75
v_mfma_f32_16x16x32_bf16 v[88:91], a[24:27], a[120:123], v[88:91]
ds_read_b128 a[52:55], v46 offset:29696
v_add_f32 v19, v74, v19
v_mfma_f32_16x16x32_bf16 v[88:91], a[28:31], a[124:127], v[88:91]
v_exp_f32 v76, v76
v_mfma_f32_16x16x32_bf16 v[80:83], a[28:31], a[92:95], v[80:83]
ds_read_b128 a[56:59], v46 offset:30720
v_add_f32 v19, v75, v19
v_mfma_f32_16x16x32_bf16 v[80:83], a[24:27], a[88:91], v[80:83]
s_waitcnt lgkmcnt(3)
ds_read_b128 a[60:63], v46 offset:31744
v_cvt_pk_bf16_f32 v73, v74, v75
v_mfma_f32_16x16x32_bf16 v[84:87], a[32:35], a[64:67], v[48:51]
buffer_load_dwordx4 v3, s[8:11], s93 offen offset:2048 sc1 lds
v_mfma_f32_16x16x32_bf16 v[84:87], a[36:39], a[68:71], v[84:87]
ds_read_b128 a[0:3], v46 offset:0
ds_read_b128 a[4:7], v46 offset:1024
v_mfma_f32_16x16x32_bf16 v[92:95], a[36:39], a[100:103], v[52:55]
v_exp_f32 v77, v77
v_mfma_f32_16x16x32_bf16 v[92:95], a[32:35], a[96:99], v[92:95]
ds_read_b128 a[8:11], v46 offset:2048
v_add_f32 v19, v76, v19
v_mfma_f32_16x16x32_bf16 v[92:95], a[40:43], a[104:107], v[92:95]
v_exp_f32 v78, v78
v_mfma_f32_16x16x32_bf16 v[92:95], a[44:47], a[108:111], v[92:95]
ds_read_b128 a[12:15], v46 offset:3072
v_add_f32 v19, v77, v19
v_mfma_f32_16x16x32_bf16 v[84:87], a[44:47], a[76:79], v[84:87]
buffer_load_dwordx4 v3, s[8:11], s93 offen offset:3072 sc1 lds
v_mfma_f32_16x16x32_bf16 v[84:87], a[40:43], a[72:75], v[84:87]
s_waitcnt lgkmcnt(4)
s_add_u32 m0, s94, 4096
ds_read_b128 a[16:19], v46 offset:4096
v_cvt_pk_bf16_f32 v74, v76, v77
v_mfma_f32_16x16x32_bf16 v[84:87], a[48:51], a[80:83], v[84:87]
ds_read_b128 a[20:23], v46 offset:5120
v_mfma_f32_16x16x32_bf16 v[84:87], a[52:55], a[84:87], v[84:87]
v_exp_f32 v79, v79
v_mfma_f32_16x16x32_bf16 v[92:95], a[52:55], a[116:119], v[92:95]
ds_read_b128 a[24:27], v46 offset:6144
v_add_f32 v19, v78, v19
v_mfma_f32_16x16x32_bf16 v[92:95], a[48:51], a[112:115], v[92:95]
ds_read_b128 a[28:31], v46 offset:7168
v_add_f32 v19, v79, v19
v_mfma_f32_16x16x32_bf16 v[92:95], a[56:59], a[120:123], v[92:95]
buffer_load_dwordx4 v4, s[8:11], s93 offen offset:0 sc1 lds
v_mfma_f32_16x16x32_bf16 v[92:95], a[60:63], a[124:127], v[92:95]
ds_read_b128 a[32:35], v46 offset:8192
v_cvt_pk_bf16_f32 v75, v78, v79
v_mfma_f32_16x16x32_bf16 v[84:87], a[60:63], a[92:95], v[84:87]
ds_read_b128 a[36:39], v46 offset:9216
v_mfma_f32_16x16x32_bf16 v[84:87], a[56:59], a[88:91], v[84:87]
s_waitcnt lgkmcnt(4)
ds_read_b128 a[40:43], v46 offset:10240
v_mfma_f32_16x16x32_bf16 v[128:131], a[0:3], v[64:67], v[128:131]
v_exp_f32 v80, v80
v_mfma_f32_16x16x32_bf16 v[192:195], a[0:3], v[72:75], v[192:195]
ds_read_b128 a[44:47], v46 offset:11264
v_mfma_f32_16x16x32_bf16 v[196:199], a[4:7], v[72:75], v[196:199]
buffer_load_dwordx4 v4, s[8:11], s93 offen offset:1024 sc1 lds
v_mfma_f32_16x16x32_bf16 v[132:135], a[4:7], v[64:67], v[132:135]
v_exp_f32 v81, v81
v_mfma_f32_16x16x32_bf16 v[136:139], a[8:11], v[64:67], v[136:139]
ds_read_b128 a[48:51], v46 offset:12288
v_add_f32 v18, v80, v18
v_mfma_f32_16x16x32_bf16 v[200:203], a[8:11], v[72:75], v[200:203]
ds_read_b128 a[52:55], v46 offset:13312
v_mfma_f32_16x16x32_bf16 v[204:207], a[12:15], v[72:75], v[204:207]
ds_read_b128 a[56:59], v46 offset:14336
v_mfma_f32_16x16x32_bf16 v[140:143], a[12:15], v[64:67], v[140:143]
ds_read_b128 a[60:63], v46 offset:15360
v_mfma_f32_16x16x32_bf16 v[144:147], a[16:19], v[64:67], v[144:147]
v_exp_f32 v82, v82
v_mfma_f32_16x16x32_bf16 v[208:211], a[16:19], v[72:75], v[208:211]
buffer_load_dwordx4 v4, s[8:11], s93 offen offset:2048 sc1 lds
v_mfma_f32_16x16x32_bf16 v[212:215], a[20:23], v[72:75], v[212:215]
v_add_f32 v18, v81, v18
v_cvt_pk_bf16_f32 v80, v80, v81
v_mfma_f32_16x16x32_bf16 v[148:151], a[20:23], v[64:67], v[148:151]
s_waitcnt lgkmcnt(3)
v_exp_f32 v83, v83
v_mfma_f32_16x16x32_bf16 v[152:155], a[24:27], v[64:67], v[152:155]
v_add_f32 v18, v82, v18
v_mfma_f32_16x16x32_bf16 v[216:219], a[24:27], v[72:75], v[216:219]
v_exp_f32 v84, v84
v_mfma_f32_16x16x32_bf16 v[220:223], a[28:31], v[72:75], v[220:223]
buffer_load_dwordx4 v4, s[8:11], s93 offen offset:3072 sc1 lds
v_mfma_f32_16x16x32_bf16 v[156:159], a[28:31], v[64:67], v[156:159]
s_add_u32 s93, s93, 32768
v_add_f32 v18, v83, v18
v_cvt_pk_bf16_f32 v81, v82, v83
v_mfma_f32_16x16x32_bf16 v[160:163], a[32:35], v[64:67], v[160:163]
s_add_u32 s94, s94, 32768
v_mfma_f32_16x16x32_bf16 v[224:227], a[32:35], v[72:75], v[224:227]
s_and_b32 s94, s94, 0x1ffff
v_mfma_f32_16x16x32_bf16 v[228:231], a[36:39], v[72:75], v[228:231]
s_waitcnt vmcnt(16) lgkmcnt(0)
v_exp_f32 v85, v85
v_mfma_f32_16x16x32_bf16 v[164:167], a[36:39], v[64:67], v[164:167]
s_barrier
v_mfma_f32_16x16x32_bf16 v[168:171], a[40:43], v[64:67], v[168:171]
s_cmp_lg_u32 s98, 0
ds_read_b128 a[0:3], v46 offset:49152
v_add_f32 v18, v84, v18
v_mfma_f32_16x16x32_bf16 v[232:235], a[40:43], v[72:75], v[232:235]
s_cbranch_scc1 ONCE8
BACK8:
v_exp_f32 v86, v86
v_mfma_f32_16x16x32_bf16 v[236:239], a[44:47], v[72:75], v[236:239]
ds_read_b128 a[4:7], v46 offset:50176
v_add_f32 v18, v85, v18
v_mfma_f32_16x16x32_bf16 v[172:175], a[44:47], v[64:67], v[172:175]
v_mfma_f32_16x16x32_bf16 v[176:179], a[48:51], v[64:67], v[176:179]
ds_read_b128 a[8:11], v46 offset:51200
v_cvt_pk_bf16_f32 v82, v84, v85
v_mfma_f32_16x16x32_bf16 v[240:243], a[48:51], v[72:75], v[240:243]
ds_read_b128 a[12:15], v46 offset:52224
v_mfma_f32_16x16x32_bf16 v[244:247], a[52:55], v[72:75], v[244:247]
v_exp_f32 v87, v87
v_mfma_f32_16x16x32_bf16 v[180:183], a[52:55], v[64:67], v[180:183]
ds_read_b128 a[16:19], v46 offset:53248
v_add_f32 v18, v86, v18
v_mfma_f32_16x16x32_bf16 v[184:187], a[56:59], v[64:67], v[184:187]
v_mfma_f32_16x16x32_bf16 v[248:251], a[56:59], v[72:75], v[248:251]
ds_read_b128 a[20:23], v46 offset:54272
v_add_f32 v18, v87, v18
v_mfma_f32_16x16x32_bf16 v[252:255], a[60:63], v[72:75], v[252:255]
ds_read_b128 a[24:27], v46 offset:55296
v_cvt_pk_bf16_f32 v83, v86, v87
v_mfma_f32_16x16x32_bf16 v[188:191], a[60:63], v[64:67], v[188:191]
s_waitcnt lgkmcnt(4)
v_mfma_f32_16x16x32_bf16 v[64:67], a[0:3], a[64:67], v[48:51]
v_exp_f32 v88, v88
v_mfma_f32_16x16x32_bf16 v[64:67], a[4:7], a[68:71], v[64:67]
s_mov_b32 m0, s94
ds_read_b128 a[28:31], v46 offset:56320
v_mfma_f32_16x16x32_bf16 v[72:75], a[4:7], a[100:103], v[52:55]
v_exp_f32 v89, v89
v_mfma_f32_16x16x32_bf16 v[72:75], a[0:3], a[96:99], v[72:75]
ds_read_b128 a[32:35], v46 offset:57344
v_add_f32 v19, v88, v19
v_mfma_f32_16x16x32_bf16 v[72:75], a[8:11], a[104:107], v[72:75]
s_waitcnt lgkmcnt(3)
buffer_load_dwordx4 v3, s[8:11], s93 offen offset:0 sc1 lds
v_mfma_f32_16x16x32_bf16 v[72:75], a[12:15], a[108:111], v[72:75]
ds_read_b128 a[36:39], v46 offset:58368
ds_read_b128 a[40:43], v46 offset:59392
v_mfma_f32_16x16x32_bf16 v[64:67], a[12:15], a[76:79], v[64:67]
v_exp_f32 v90, v90
v_mfma_f32_16x16x32_bf16 v[64:67], a[8:11], a[72:75], v[64:67]
ds_read_b128 a[44:47], v46 offset:60416
v_add_f32 v19, v89, v19
v_mfma_f32_16x16x32_bf16 v[64:67], a[16:19], a[80:83], v[64:67]
ds_read_b128 a[48:51], v46 offset:61440
v_cvt_pk_bf16_f32 v88, v88, v89
v_mfma_f32_16x16x32_bf16 v[64:67], a[20:23], a[84:87], v[64:67]
buffer_load_dwordx4 v3, s[8:11], s93 offen offset:1024 sc1 lds
v_mfma_f32_16x16x32_bf16 v[72:75], a[20:23], a[116:119], v[72:75]
v_exp_f32 v91, v91
v_mfma_f32_16x16x32_bf16 v[72:75], a[16:19], a[112:115], v[72:75]
s_waitcnt lgkmcnt(4)
ds_read_b128 a[52:55], v46 offset:62464
v_add_f32 v19, v90, v19
v_mfma_f32_16x16x32_bf16 v[72:75], a[24:27], a[120:123], v[72:75]
ds_read_b128 a[56:59], v46 offset:63488
v_mfma_f32_16x16x32_bf16 v[72:75], a[28:31], a[124:127], v[72:75]
v_exp_f32 v92, v92
v_mfma_f32_16x16x32_bf16 v[64:67], a[28:31], a[92:95], v[64:67]
ds_read_b128 a[60:63], v46 offset:64512
v_add_f32 v19, v91, v19
v_mfma_f32_16x16x32_bf16 v[64:67], a[24:27], a[88:91], v[64:67]
buffer_load_dwordx4 v3, s[8:11], s93 offen offset:2048 sc1 lds
v_mfma_f32_16x16x32_bf16 v[68:71], a[32:35], a[64:67], v[48:51]
s_waitcnt lgkmcnt(3)
ds_read_b128 a[0:3], v46 offset:32768
v_cvt_pk_bf16_f32 v89, v90, v91
v_mfma_f32_16x16x32_bf16 v[68:71], a[36:39], a[68:71], v[68:71]
v_exp_f32 v93, v93
v_mfma_f32_16x16x32_bf16 v[76:79], a[36:39], a[100:103], v[52:55]
ds_read_b128 a[4:7], v46 offset:33792
v_add_f32 v19, v92, v19
v_mfma_f32_16x16x32_bf16 v[76:79], a[32:35], a[96:99], v[76:79]
ds_read_b128 a[8:11], v46 offset:34816
v_mfma_f32_16x16x32_bf16 v[76:79], a[40:43], a[104:107], v[76:79]
v_exp_f32 v94, v94
v_mfma_f32_16x16x32_bf16 v[76:79], a[44:47], a[108:111], v[76:79]
ds_read_b128 a[12:15], v46 offset:35840
v_add_f32 v19, v93, v19
v_mfma_f32_16x16x32_bf16 v[68:71], a[44:47], a[76:79], v[68:71]
buffer_load_dwordx4 v3, s[8:11], s93 offen offset:3072 sc1 lds
v_mfma_f32_16x16x32_bf16 v[68:71], a[40:43], a[72:75], v[68:71]
s_add_u32 m0, s94, 4096
ds_read_b128 a[16:19], v46 offset:36864
v_cvt_pk_bf16_f32 v90, v92, v93
v_mfma_f32_16x16x32_bf16 v[68:71], a[48:51], a[80:83], v[68:71]
s_waitcnt lgkmcnt(4)
ds_read_b128 a[20:23], v46 offset:37888
v_mfma_f32_16x16x32_bf16 v[68:71], a[52:55], a[84:87], v[68:71]
v_exp_f32 v95, v95
v_mfma_f32_16x16x32_bf16 v[76:79], a[52:55], a[116:119], v[76:79]
ds_read_b128 a[24:27], v46 offset:38912
v_add_f32 v19, v94, v19
v_mfma_f32_16x16x32_bf16 v[76:79], a[48:51], a[112:115], v[76:79]
ds_read_b128 a[28:31], v46 offset:39936
v_add_f32 v19, v95, v19
v_mfma_f32_16x16x32_bf16 v[76:79], a[56:59], a[120:123], v[76:79]
buffer_load_dwordx4 v4, s[8:11], s93 offen offset:0 sc1 lds
v_mfma_f32_16x16x32_bf16 v[76:79], a[60:63], a[124:127], v[76:79]
ds_read_b128 a[32:35], v46 offset:40960
v_cvt_pk_bf16_f32 v91, v94, v95
v_mfma_f32_16x16x32_bf16 v[68:71], a[60:63], a[92:95], v[68:71]
ds_read_b128 a[36:39], v46 offset:41984
v_mfma_f32_16x16x32_bf16 v[68:71], a[56:59], a[88:91], v[68:71]
ds_read_b128 a[40:43], v46 offset:43008
v_mfma_f32_16x16x32_bf16 v[128:131], a[0:3], v[80:83], v[128:131]
v_exp_f32 v64, v64
v_mfma_f32_16x16x32_bf16 v[192:195], a[0:3], v[88:91], v[192:195]
s_waitcnt lgkmcnt(4)
ds_read_b128 a[44:47], v46 offset:44032
v_mfma_f32_16x16x32_bf16 v[196:199], a[4:7], v[88:91], v[196:199]
buffer_load_dwordx4 v4, s[8:11], s93 offen offset:1024 sc1 lds
v_mfma_f32_16x16x32_bf16 v[132:135], a[4:7], v[80:83], v[132:135]
v_exp_f32 v65, v65
v_mfma_f32_16x16x32_bf16 v[136:139], a[8:11], v[80:83], v[136:139]
ds_read_b128 a[48:51], v46 offset:45056
v_add_f32 v18, v64, v18
v_mfma_f32_16x16x32_bf16 v[200:203], a[8:11], v[88:91], v[200:203]
ds_read_b128 a[52:55], v46 offset:46080
v_mfma_f32_16x16x32_bf16 v[204:207], a[12:15], v[88:91], v[204:207]
v_exp_f32 v66, v66
v_mfma_f32_16x16x32_bf16 v[140:143], a[12:15], v[80:83], v[140:143]
ds_read_b128 a[56:59], v46 offset:47104
ds_read_b128 a[60:63], v46 offset:48128
v_mfma_f32_16x16x32_bf16 v[144:147], a[16:19], v[80:83], v[144:147]
v_add_f32 v18, v65, v18
v_cvt_pk_bf16_f32 v64, v64, v65
v_mfma_f32_16x16x32_bf16 v[208:211], a[16:19], v[88:91], v[208:211]
buffer_load_dwordx4 v4, s[8:11], s93 offen offset:2048 sc1 lds
v_mfma_f32_16x16x32_bf16 v[212:215], a[20:23], v[88:91], v[212:215]
v_exp_f32 v67, v67
v_mfma_f32_16x16x32_bf16 v[148:151], a[20:23], v[80:83], v[148:151]
v_add_f32 v18, v66, v18
v_mfma_f32_16x16x32_bf16 v[152:155], a[24:27], v[80:83], v[152:155]
v_mfma_f32_16x16x32_bf16 v[216:219], a[24:27], v[88:91], v[216:219]
s_waitcnt lgkmcnt(2)
v_exp_f32 v68, v68
v_mfma_f32_16x16x32_bf16 v[220:223], a[28:31], v[88:91], v[220:223]
buffer_load_dwordx4 v4, s[8:11], s93 offen offset:3072 sc1 lds
v_mfma_f32_16x16x32_bf16 v[156:159], a[28:31], v[80:83], v[156:159]
s_add_u32 s93, s93, 32768
v_add_f32 v18, v67, v18
v_cvt_pk_bf16_f32 v65, v66, v67
v_mfma_f32_16x16x32_bf16 v[160:163], a[32:35], v[80:83], v[160:163]
s_add_u32 s94, s94, 32768
v_mfma_f32_16x16x32_bf16 v[224:227], a[32:35], v[88:91], v[224:227]
s_and_b32 s94, s94, 0x1ffff
v_xor_b32 v46, 0x10000, v46
v_mfma_f32_16x16x32_bf16 v[228:231], a[36:39], v[88:91], v[228:231]
s_waitcnt vmcnt(16) lgkmcnt(0)
v_exp_f32 v69, v69
v_mfma_f32_16x16x32_bf16 v[164:167], a[36:39], v[80:83], v[164:167]
s_barrier
v_add_f32 v18, v68, v18
v_mfma_f32_16x16x32_bf16 v[168:171], a[40:43], v[80:83], v[168:171]
ds_read_b128 a[0:3], v46 offset:16384
v_mfma_f32_16x16x32_bf16 v[232:235], a[40:43], v[88:91], v[232:235]
v_exp_f32 v70, v70
v_mfma_f32_16x16x32_bf16 v[236:239], a[44:47], v[88:91], v[236:239]
ds_read_b128 a[4:7], v46 offset:17408
v_add_f32 v18, v69, v18
v_mfma_f32_16x16x32_bf16 v[172:175], a[44:47], v[80:83], v[172:175]
v_mfma_f32_16x16x32_bf16 v[176:179], a[48:51], v[80:83], v[176:179]
ds_read_b128 a[8:11], v46 offset:18432
v_cvt_pk_bf16_f32 v66, v68, v69
v_mfma_f32_16x16x32_bf16 v[240:243], a[48:51], v[88:91], v[240:243]
v_exp_f32 v71, v71
v_mfma_f32_16x16x32_bf16 v[244:247], a[52:55], v[88:91], v[244:247]
ds_read_b128 a[12:15], v46 offset:19456
v_add_f32 v18, v70, v18
v_mfma_f32_16x16x32_bf16 v[180:183], a[52:55], v[80:83], v[180:183]
ds_read_b128 a[16:19], v46 offset:20480
v_add_f32 v18, v71, v18
v_mfma_f32_16x16x32_bf16 v[184:187], a[56:59], v[80:83], v[184:187]
ds_read_b128 a[20:23], v46 offset:21504
v_cvt_pk_bf16_f32 v67, v70, v71
v_mfma_f32_16x16x32_bf16 v[248:251], a[56:59], v[88:91], v[248:251]
v_mfma_f32_16x16x32_bf16 v[252:255], a[60:63], v[88:91], v[252:255]
ds_read_b128 a[24:27], v46 offset:22528
v_mfma_f32_16x16x32_bf16 v[188:191], a[60:63], v[80:83], v[188:191]
s_sub_u32 s66, s66, 1
s_cbranch_scc0 PLAIN
s_cmp_lg_u32 s96, 0
s_cbranch_scc1 SEG2
NOPLAIN:
s_cmp_lg_u32 s92, 2
s_cbranch_scc1 ONDIAG
s_waitcnt lgkmcnt(5)
v_mfma_f32_16x16x32_bf16 v[80:83], a[0:3], a[64:67], v[48:51]
v_exp_f32 v72, v72
v_mfma_f32_16x16x32_bf16 v[80:83], a[4:7], a[68:71], v[80:83]
s_mov_b32 m0, s94
ds_read_b128 a[28:31], v46 offset:23552
v_mfma_f32_16x16x32_bf16 v[88:91], a[4:7], a[100:103], v[52:55]
v_exp_f32 v73, v73
v_mfma_f32_16x16x32_bf16 v[88:91], a[0:3], a[96:99], v[88:91]
s_waitcnt lgkmcnt(3)
buffer_load_dwordx4 v3, s[8:11], s93 offen offset:0 sc1 lds
v_mfma_f32_16x16x32_bf16 v[88:91], a[8:11], a[104:107], v[88:91]
ds_read_b128 a[32:35], v46 offset:24576
v_add_f32 v19, v72, v19
v_mfma_f32_16x16x32_bf16 v[88:91], a[12:15], a[108:111], v[88:91]
ds_read_b128 a[36:39], v46 offset:25600
v_mfma_f32_16x16x32_bf16 v[80:83], a[12:15], a[76:79], v[80:83]
v_exp_f32 v74, v74
v_mfma_f32_16x16x32_bf16 v[80:83], a[8:11], a[72:75], v[80:83]
ds_read_b128 a[40:43], v46 offset:26624
v_add_f32 v19, v73, v19
v_mfma_f32_16x16x32_bf16 v[80:83], a[16:19], a[80:83], v[80:83]
s_waitcnt lgkmcnt(3)
ds_read_b128 a[44:47], v46 offset:27648
v_cvt_pk_bf16_f32 v72, v72, v73
v_mfma_f32_16x16x32_bf16 v[80:83], a[20:23], a[84:87], v[80:83]
buffer_load_dwordx4 v3, s[8:11], s93 offen offset:1024 sc1 lds
v_mfma_f32_16x16x32_bf16 v[88:91], a[20:23], a[116:119], v[88:91]
ds_read_b128 a[48:51], v46 offset:28672
v_mfma_f32_16x16x32_bf16 v[88:91], a[16:19], a[112:115], v[88:91]
v_exp_f32 v75, v75
v_mfma_f32_16x16x32_bf16 v[88:91], a[24:27], a[120:123], v[88:91]
ds_read_b128 a[52:55], v46 offset:29696
v_add_f32 v19, v74, v19
v_mfma_f32_16x16x32_bf16 v[88:91], a[28:31], a[124:127], v[88:91]
v_exp_f32 v76, v76
v_mfma_f32_16x16x32_bf16 v[80:83], a[28:31], a[92:95], v[80:83]
ds_read_b128 a[56:59], v46 offset:30720
v_add_f32 v19, v75, v19
v_mfma_f32_16x16x32_bf16 v[80:83], a[24:27], a[88:91], v[80:83]
s_waitcnt lgkmcnt(3)
ds_read_b128 a[60:63], v46 offset:31744
v_cvt_pk_bf16_f32 v73, v74, v75
v_mfma_f32_16x16x32_bf16 v[84:87], a[32:35], a[64:67], v[48:51]
buffer_load_dwordx4 v3, s[8:11], s93 offen offset:2048 sc1 lds
v_mfma_f32_16x16x32_bf16 v[84:87], a[36:39], a[68:71], v[84:87]
ds_read_b128 a[0:3], v46 offset:0
ds_read_b128 a[4:7], v46 offset:1024
v_mfma_f32_16x16x32_bf16 v[92:95], a[36:39], a[100:103], v[52:55]
v_exp_f32 v77, v77
v_mfma_f32_16x16x32_bf16 v[92:95], a[32:35], a[96:99], v[92:95]
ds_read_b128 a[8:11], v46 offset:2048
v_add_f32 v19, v76, v19
v_mfma_f32_16x16x32_bf16 v[92:95], a[40:43], a[104:107], v[92:95]
v_exp_f32 v78, v78
v_mfma_f32_16x16x32_bf16 v[92:95], a[44:47], a[108:111], v[92:95]
ds_read_b128 a[12:15], v46 offset:3072
v_add_f32 v19, v77, v19
v_mfma_f32_16x16x32_bf16 v[84:87], a[44:47], a[76:79], v[84:87]
buffer_load_dwordx4 v3, s[8:11], s93 offen offset:3072 sc1 lds
v_mfma_f32_16x16x32_bf16 v[84:87], a[40:43], a[72:75], v[84:87]
s_waitcnt lgkmcnt(4)
s_add_u32 m0, s94, 4096
ds_read_b128 a[16:19], v46 offset:4096
v_cvt_pk_bf16_f32 v74, v76, v77
v_mfma_f32_16x16x32_bf16 v[84:87], a[48:51], a[80:83], v[84:87]
ds_read_b128 a[20:23], v46 offset:5120
v_mfma_f32_16x16x32_bf16 v[84:87], a[52:55], a[84:87], v[84:87]
v_exp_f32 v79, v79
v_mfma_f32_16x16x32_bf16 v[92:95], a[52:55], a[116:119], v[92:95]
ds_read_b128 a[24:27], v46 offset:6144
v_add_f32 v19, v78, v19
v_mfma_f32_16x16x32_bf16 v[92:95], a[48:51], a[112:115], v[92:95]
ds_read_b128 a[28:31], v46 offset:7168
v_add_f32 v19, v79, v19
v_mfma_f32_16x16x32_bf16 v[92:95], a[56:59], a[120:123], v[92:95]
buffer_load_dwordx4 v4, s[8:11], s93 offen offset:0 sc1 lds
v_mfma_f32_16x16x32_bf16 v[92:95], a[60:63], a[124:127], v[92:95]
ds_read_b128 a[32:35], v46 offset:8192
v_cvt_pk_bf16_f32 v75, v78, v79
v_mfma_f32_16x16x32_bf16 v[84:87], a[60:63], a[92:95], v[84:87]
ds_read_b128 a[36:39], v46 offset:9216
v_mfma_f32_16x16x32_bf16 v[84:87], a[56:59], a[88:91], v[84:87]
s_waitcnt lgkmcnt(4)
ds_read_b128 a[40:43], v46 offset:10240
v_mfma_f32_16x16x32_bf16 v[128:131], a[0:3], v[64:67], v[128:131]
v_exp_f32 v80, v80
v_mfma_f32_16x16x32_bf16 v[192:195], a[0:3], v[72:75], v[192:195]
ds_read_b128 a[44:47], v46 offset:11264
v_mfma_f32_16x16x32_bf16 v[196:199], a[4:7], v[72:75], v[196:199]
buffer_load_dwordx4 v4, s[8:11], s93 offen offset:1024 sc1 lds
v_mfma_f32_16x16x32_bf16 v[132:135], a[4:7], v[64:67], v[132:135]
v_exp_f32 v81, v81
v_mfma_f32_16x16x32_bf16 v[136:139], a[8:11], v[64:67], v[136:139]
ds_read_b128 a[48:51], v46 offset:12288
v_add_f32 v18, v80, v18
v_mfma_f32_16x16x32_bf16 v[200:203], a[8:11], v[72:75], v[200:203]
ds_read_b128 a[52:55], v46 offset:13312
v_mfma_f32_16x16x32_bf16 v[204:207], a[12:15], v[72:75], v[204:207]
ds_read_b128 a[56:59], v46 offset:14336
v_mfma_f32_16x16x32_bf16 v[140:143], a[12:15], v[64:67], v[140:143]
ds_read_b128 a[60:63], v46 offset:15360
v_mfma_f32_16x16x32_bf16 v[144:147], a[16:19], v[64:67], v[144:147]
v_exp_f32 v82, v82
v_mfma_f32_16x16x32_bf16 v[208:211], a[16:19], v[72:75], v[208:211]
buffer_load_dwordx4 v4, s[8:11], s93 offen offset:2048 sc1 lds
v_mfma_f32_16x16x32_bf16 v[212:215], a[20:23], v[72:75], v[212:215]
v_add_f32 v18, v81, v18
v_cvt_pk_bf16_f32 v80, v80, v81
v_mfma_f32_16x16x32_bf16 v[148:151], a[20:23], v[64:67], v[148:151]
s_waitcnt lgkmcnt(3)
v_exp_f32 v83, v83
v_mfma_f32_16x16x32_bf16 v[152:155], a[24:27], v[64:67], v[152:155]
v_add_f32 v18, v82, v18
v_mfma_f32_16x16x32_bf16 v[216:219], a[24:27], v[72:75], v[216:219]
v_exp_f32 v84, v84
v_mfma_f32_16x16x32_bf16 v[220:223], a[28:31], v[72:75], v[220:223]
buffer_load_dwordx4 v4, s[8:11], s93 offen offset:3072 sc1 lds
v_mfma_f32_16x16x32_bf16 v[156:159], a[28:31], v[64:67], v[156:159]
s_add_u32 s93, s93, 32768
v_add_f32 v18, v83, v18
v_cvt_pk_bf16_f32 v81, v82, v83
v_mfma_f32_16x16x32_bf16 v[160:163], a[32:35], v[64:67], v[160:163]
s_add_u32 s94, s94, 32768
v_mfma_f32_16x16x32_bf16 v[224:227], a[32:35], v[72:75], v[224:227]
s_and_b32 s94, s94, 0x1ffff
v_mfma_f32_16x16x32_bf16 v[228:231], a[36:39], v[72:75], v[228:231]
s_waitcnt vmcnt(16) lgkmcnt(0)
v_exp_f32 v85, v85
v_mfma_f32_16x16x32_bf16 v[164:167], a[36:39], v[64:67], v[164:167]
s_barrier
v_mfma_f32_16x16x32_bf16 v[168:171], a[40:43], v[64:67], v[168:171]
ds_read_b128 a[0:3], v46 offset:49152
v_add_f32 v18, v84, v18
v_mfma_f32_16x16x32_bf16 v[232:235], a[40:43], v[72:75], v[232:235]
s_mov_b32 m0, s94
v_exp_f32 v86, v86
v_mfma_f32_16x16x32_bf16 v[236:239], a[44:47], v[72:75], v[236:239]
ds_read_b128 a[4:7], v46 offset:50176
v_add_f32 v18, v85, v18
v_mfma_f32_16x16x32_bf16 v[172:175], a[44:47], v[64:67], v[172:175]
v_mfma_f32_16x16x32_bf16 v[176:179], a[48:51], v[64:67], v[176:179]
buffer_load_dwordx4 v38, s[16:19], s101 offen offset:0 sc1 lds
v_mfma_f32_16x16x32_bf16 v[240:243], a[48:51], v[72:75], v[240:243]
ds_read_b128 a[8:11], v46 offset:51200
v_cvt_pk_bf16_f32 v82, v84, v85
v_mfma_f32_16x16x32_bf16 v[244:247], a[52:55], v[72:75], v[244:247]
v_exp_f32 v87, v87
v_mfma_f32_16x16x32_bf16 v[180:183], a[52:55], v[64:67], v[180:183]
ds_read_b128 a[12:15], v46 offset:52224
v_add_f32 v18, v86, v18
v_mfma_f32_16x16x32_bf16 v[184:187], a[56:59], v[64:67], v[184:187]
ds_read_b128 a[16:19], v46 offset:53248
v_add_f32 v18, v87, v18
v_mfma_f32_16x16x32_bf16 v[248:251], a[56:59], v[72:75], v[248:251]
ds_read_b128 a[20:23], v46 offset:54272
v_cvt_pk_bf16_f32 v83, v86, v87
v_mfma_f32_16x16x32_bf16 v[252:255], a[60:63], v[72:75], v[252:255]
ds_read_b128 a[24:27], v46 offset:55296
v_mfma_f32_16x16x32_bf16 v[188:191], a[60:63], v[64:67], v[188:191]
s_waitcnt lgkmcnt(5)
v_mfma_f32_16x16x32_bf16 v[64:67], a[0:3], a[64:67], v[48:51]
v_exp_f32 v88, v88
v_mfma_f32_16x16x32_bf16 v[64:67], a[4:7], a[68:71], v[64:67]
ds_read_b128 a[28:31], v46 offset:56320
v_mfma_f32_16x16x32_bf16 v[72:75], a[4:7], a[100:103], v[52:55]
v_exp_f32 v89, v89
v_mfma_f32_16x16x32_bf16 v[72:75], a[0:3], a[96:99], v[72:75]
s_waitcnt lgkmcnt(3)
ds_read_b128 a[32:35], v46 offset:57344
v_add_f32 v19, v88, v19
v_mfma_f32_16x16x32_bf16 v[72:75], a[8:11], a[104:107], v[72:75]
buffer_load_dwordx4 v39, s[16:19], s101 offen offset:1024 sc1 lds
v_mfma_f32_16x16x32_bf16 v[72:75], a[12:15], a[108:111], v[72:75]
ds_read_b128 a[36:39], v46 offset:58368
ds_read_b128 a[40:43], v46 offset:59392
v_mfma_f32_16x16x32_bf16 v[64:67], a[12:15], a[76:79], v[64:67]
v_exp_f32 v90, v90
v_mfma_f32_16x16x32_bf16 v[64:67], a[8:11], a[72:75], v[64:67]
ds_read_b128 a[44:47], v46 offset:60416
v_add_f32 v19, v89, v19
v_mfma_f32_16x16x32_bf16 v[64:67], a[16:19], a[80:83], v[64:67]
s_waitcnt lgkmcnt(4)
ds_read_b128 a[48:51], v46 offset:61440
v_cvt_pk_bf16_f32 v88, v88, v89
v_mfma_f32_16x16x32_bf16 v[64:67], a[20:23], a[84:87], v[64:67]
v_exp_f32 v91, v91
v_mfma_f32_16x16x32_bf16 v[72:75], a[20:23], a[116:119], v[72:75]
ds_read_b128 a[52:55], v46 offset:62464
v_add_f32 v19, v90, v19
v_mfma_f32_16x16x32_bf16 v[72:75], a[16:19], a[112:115], v[72:75]
ds_read_b128 a[56:59], v46 offset:63488
v_mfma_f32_16x16x32_bf16 v[72:75], a[24:27], a[120:123], v[72:75]
v_exp_f32 v92, v92
v_mfma_f32_16x16x32_bf16 v[72:75], a[28:31], a[124:127], v[72:75]
ds_read_b128 a[60:63], v46 offset:64512
v_add_f32 v19, v91, v19
v_mfma_f32_16x16x32_bf16 v[64:67], a[28:31], a[92:95], v[64:67]
buffer_load_dwordx4 v40, s[16:19], s101 offen offset:2048 sc1 lds
v_mfma_f32_16x16x32_bf16 v[64:67], a[24:27], a[88:91], v[64:67]
s_waitcnt lgkmcnt(3)
ds_read_b128 a[0:3], v46 offset:32768
v_cvt_pk_bf16_f32 v89, v90, v91
v_mfma_f32_16x16x32_bf16 v[68:71], a[32:35], a[64:67], v[48:51]
ds_read_b128 a[4:7], v46 offset:33792
v_mfma_f32_16x16x32_bf16 v[68:71], a[36:39], a[68:71], v[68:71]
v_exp_f32 v93, v93
v_mfma_f32_16x16x32_bf16 v[76:79], a[36:39], a[100:103], v[52:55]
ds_read_b128 a[8:11], v46 offset:34816
v_add_f32 v19, v92, v19
v_mfma_f32_16x16x32_bf16 v[76:79], a[32:35], a[96:99], v[76:79]
ds_read_b128 a[12:15], v46 offset:35840
v_mfma_f32_16x16x32_bf16 v[76:79], a[40:43], a[104:107], v[76:79]
v_exp_f32 v94, v94
v_mfma_f32_16x16x32_bf16 v[76:79], a[44:47], a[108:111], v[76:79]
ds_read_b128 a[16:19], v46 offset:36864
v_add_f32 v19, v93, v19
v_mfma_f32_16x16x32_bf16 v[68:71], a[44:47], a[76:79], v[68:71]
v_mfma_f32_16x16x32_bf16 v[68:71], a[40:43], a[72:75], v[68:71]
ds_read_b128 a[20:23], v46 offset:37888
v_cvt_pk_bf16_f32 v90, v92, v93
v_mfma_f32_16x16x32_bf16 v[68:71], a[48:51], a[80:83], v[68:71]
s_waitcnt lgkmcnt(4)
v_exp_f32 v95, v95
v_mfma_f32_16x16x32_bf16 v[68:71], a[52:55], a[84:87], v[68:71]
buffer_load_dwordx4 v41, s[16:19], s101 offen offset:3072 sc1 lds
v_mfma_f32_16x16x32_bf16 v[76:79], a[52:55], a[116:119], v[76:79]
s_add_u32 m0, s94, 4096
ds_read_b128 a[24:27], v46 offset:38912
v_add_f32 v19, v94, v19
v_mfma_f32_16x16x32_bf16 v[76:79], a[48:51], a[112:115], v[76:79]
ds_read_b128 a[28:31], v46 offset:39936
v_add_f32 v19, v95, v19
v_mfma_f32_16x16x32_bf16 v[76:79], a[56:59], a[120:123], v[76:79]
ds_read_b128 a[32:35], v46 offset:40960
v_cvt_pk_bf16_f32 v91, v94, v95
v_mfma_f32_16x16x32_bf16 v[76:79], a[60:63], a[124:127], v[76:79]
ds_read_b128 a[36:39], v46 offset:41984
v_mfma_f32_16x16x32_bf16 v[68:71], a[60:63], a[92:95], v[68:71]
v_mfma_f32_16x16x32_bf16 v[68:71], a[56:59], a[88:91], v[68:71]
ds_read_b128 a[40:43], v46 offset:43008
v_mfma_f32_16x16x32_bf16 v[128:131], a[0:3], v[80:83], v[128:131]
v_exp_f32 v64, v64
v_mfma_f32_16x16x32_bf16 v[192:195], a[0:3], v[88:91], v[192:195]
ds_read_b128 a[44:47], v46 offset:44032
v_mfma_f32_16x16x32_bf16 v[196:199], a[4:7], v[88:91], v[196:199]
v_exp_f32 v65, v65
v_mfma_f32_16x16x32_bf16 v[132:135], a[4:7], v[80:83], v[132:135]
s_waitcnt lgkmcnt(3)
ds_read_b128 a[48:51], v46 offset:45056
v_add_f32 v18, v64, v18
v_mfma_f32_16x16x32_bf16 v[136:139], a[8:11], v[80:83], v[136:139]
buffer_load_dword v7, off, s[8:11], s80 sc1
v_mfma_f32_16x16x32_bf16 v[200:203], a[8:11], v[88:91], v[200:203]
buffer_load_dwordx4 v38, s[16:19], s70 offen offset:0 sc1 lds
v_mfma_f32_16x16x32_bf16 v[204:207], a[12:15], v[88:91], v[204:207]
ds_read_b128 a[52:55], v46 offset:46080
ds_read_b128 a[56:59], v46 offset:47104
v_mfma_f32_16x16x32_bf16 v[140:143], a[12:15], v[80:83], v[140:143]
ds_read_b128 a[60:63], v46 offset:48128
v_mfma_f32_16x16x32_bf16 v[144:147], a[16:19], v[80:83], v[144:147]
v_exp_f32 v66, v66
v_mfma_f32_16x16x32_bf16 v[208:211], a[16:19], v[88:91], v[208:211]
v_add_f32 v18, v65, v18
v_cvt_pk_bf16_f32 v64, v64, v65
v_mfma_f32_16x16x32_bf16 v[212:215], a[20:23], v[88:91], v[212:215]
v_exp_f32 v67, v67
v_mfma_f32_16x16x32_bf16 v[148:151], a[20:23], v[80:83], v[148:151]
v_add_f32 v18, v66, v18
v_mfma_f32_16x16x32_bf16 v[152:155], a[24:27], v[80:83], v[152:155]
v_exp_f32 v68, v68
v_mfma_f32_16x16x32_bf16 v[216:219], a[24:27], v[88:91], v[216:219]
v_add_f32 v18, v67, v18
v_cvt_pk_bf16_f32 v65, v66, v67
v_mfma_f32_16x16x32_bf16 v[220:223], a[28:31], v[88:91], v[220:223]
v_mfma_f32_16x16x32_bf16 v[156:159], a[28:31], v[80:83], v[156:159]
buffer_load_dwordx4 v39, s[16:19], s70 offen offset:1024 sc1 lds
v_mfma_f32_16x16x32_bf16 v[160:163], a[32:35], v[80:83], v[160:163]
v_exp_f32 v69, v69
v_mfma_f32_16x16x32_bf16 v[224:227], a[32:35], v[88:91], v[224:227]
s_waitcnt lgkmcnt(0)
v_xor_b32 v46, 0x10000, v46
v_add_f32 v18, v68, v18
v_mfma_f32_16x16x32_bf16 v[228:231], a[36:39], v[88:91], v[228:231]
s_waitcnt vmcnt(15) lgkmcnt(0)
v_mfma_f32_16x16x32_bf16 v[164:167], a[36:39], v[80:83], v[164:167]
s_barrier
v_exp_f32 v70, v70
v_mfma_f32_16x16x32_bf16 v[168:171], a[40:43], v[80:83], v[168:171]
ds_read_b128 a[0:3], v46 offset:16384
v_add_f32 v18, v69, v18
v_mfma_f32_16x16x32_bf16 v[232:235], a[40:43], v[88:91], v[232:235]
ds_read_b128 a[4:7], v46 offset:17408
v_cvt_pk_bf16_f32 v66, v68, v69
v_mfma_f32_16x16x32_bf16 v[236:239], a[44:47], v[88:91], v[236:239]
v_mfma_f32_16x16x32_bf16 v[172:175], a[44:47], v[80:83], v[172:175]
v_exp_f32 v71, v71
v_mfma_f32_16x16x32_bf16 v[176:179], a[48:51], v[80:83], v[176:179]
ds_read_b128 a[8:11], v46 offset:18432
v_add_f32 v18, v70, v18
v_mfma_f32_16x16x32_bf16 v[240:243], a[48:51], v[88:91], v[240:243]
ds_read_b128 a[12:15], v46 offset:19456
v_add_f32 v18, v71, v18
v_mfma_f32_16x16x32_bf16 v[244:247], a[52:55], v[88:91], v[244:247]
buffer_load_dwordx4 v40, s[16:19], s70 offen offset:2048 sc1 lds
v_mfma_f32_16x16x32_bf16 v[180:183], a[52:55], v[80:83], v[180:183]
ds_read_b128 a[16:19], v46 offset:20480
v_cvt_pk_bf16_f32 v67, v70, v71
v_mfma_f32_16x16x32_bf16 v[184:187], a[56:59], v[80:83], v[184:187]
v_exp_f32 v72, v72
v_mfma_f32_16x16x32_bf16 v[248:251], a[56:59], v[88:91], v[248:251]
ds_read_b128 a[20:23], v46 offset:21504
v_mfma_f32_16x16x32_bf16 v[252:255], a[60:63], v[88:91], v[252:255]
v_exp_f32 v73, v73
v_mfma_f32_16x16x32_bf16 v[188:191], a[60:63], v[80:83], v[188:191]
s_waitcnt lgkmcnt(3)
ds_read_b128 a[24:27], v46 offset:22528
v_add_f32 v19, v72, v19
v_mfma_f32_16x16x32_bf16 v[80:83], a[0:3], a[64:67], v[48:51]
ds_read_b128 a[28:31], v46 offset:23552
v_mfma_f32_16x16x32_bf16 v[80:83], a[4:7], a[68:71], v[80:83]
v_exp_f32 v74, v74
v_mfma_f32_16x16x32_bf16 v[88:91], a[4:7], a[100:103], v[52:55]
ds_read_b128 a[32:35], v46 offset:24576
v_add_f32 v19, v73, v19
v_mfma_f32_16x16x32_bf16 v[88:91], a[0:3], a[96:99], v[88:91]
ds_read_b128 a[36:39], v46 offset:25600
v_cvt_pk_bf16_f32 v72, v72, v73
v_mfma_f32_16x16x32_bf16 v[88:91], a[8:11], a[104:107], v[88:91]
s_waitcnt lgkmcnt(4)
buffer_load_dwordx4 v41, s[16:19], s70 offen offset:3072 sc1 lds
v_mfma_f32_16x16x32_bf16 v[88:91], a[12:15], a[108:111], v[88:91]
s_add_u32 s101, s101, s71
v_exp_f32 v75, v75
v_mfma_f32_16x16x32_bf16 v[80:83], a[12:15], a[76:79], v[80:83]
s_add_u32 s70, s70, s71
ds_read_b128 a[40:43], v46 offset:26624
v_add_f32 v19, v74, v19
v_mfma_f32_16x16x32_bf16 v[80:83], a[8:11], a[72:75], v[80:83]
s_add_u32 s94, s94, 32768
ds_read_b128 a[44:47], v46 offset:27648
v_mfma_f32_16x16x32_bf16 v[80:83], a[16:19], a[80:83], v[80:83]
s_and_b32 s94, s94, 0x1ffff
v_exp_f32 v76, v76
v_mfma_f32_16x16x32_bf16 v[80:83], a[20:23], a[84:87], v[80:83]
ds_read_b128 a[48:51], v46 offset:28672
v_add_f32 v19, v75, v19
v_mfma_f32_16x16x32_bf16 v[88:91], a[20:23], a[116:119], v[88:91]
ds_read_b128 a[52:55], v46 offset:29696
v_cvt_pk_bf16_f32 v73, v74, v75
v_mfma_f32_16x16x32_bf16 v[88:91], a[16:19], a[112:115], v[88:91]
s_waitcnt lgkmcnt(4)
ds_read_b128 a[56:59], v46 offset:30720
v_mfma_f32_16x16x32_bf16 v[88:91], a[24:27], a[120:123], v[88:91]
s_waitcnt vmcnt(4)
v_cmp_eq_u32 vcc, 0, v7
s_nop 0
s_cmp_lg_u64 vcc, 0
s_cbranch_scc1 SPIN10_0
OK10_0:
v_mfma_f32_16x16x32_bf16 v[88:91], a[28:31], a[124:127], v[88:91]
s_add_u32 s63, s99, 16384
v_exp_f32 v77, v77
v_mfma_f32_16x16x32_bf16 v[80:83], a[28:31], a[92:95], v[80:83]
ds_read_b128 a[60:63], v46 offset:31744
v_add_f32 v19, v76, v19
v_mfma_f32_16x16x32_bf16 v[80:83], a[24:27], a[88:91], v[80:83]
buffer_load_dwordx4 v[30:33], v1, s[8:11], s63 offen sc1
v_mfma_f32_16x16x32_bf16 v[84:87], a[32:35], a[64:67], v[48:51]
s_add_u32 s63, s99, 0
v_exp_f32 v78, v78
v_mfma_f32_16x16x32_bf16 v[84:87], a[36:39], a[68:71], v[84:87]
ds_read_b128 a[0:3], v46 offset:0
v_add_f32 v19, v77, v19
v_mfma_f32_16x16x32_bf16 v[92:95], a[36:39], a[100:103], v[52:55]
ds_read_b128 a[4:7], v46 offset:1024
v_cvt_pk_bf16_f32 v74, v76, v77
v_mfma_f32_16x16x32_bf16 v[92:95], a[32:35], a[96:99], v[92:95]
s_waitcnt lgkmcnt(3)
buffer_load_dwordx4 a[128:131], v1, s[8:11], s63 offen offset:0 sc1
v_mfma_f32_16x16x32_bf16 v[92:95], a[40:43], a[104:107], v[92:95]
ds_read_b128 a[8:11], v46 offset:2048
ds_read_b128 a[12:15], v46 offset:3072
v_mfma_f32_16x16x32_bf16 v[92:95], a[44:47], a[108:111], v[92:95]
v_exp_f32 v79, v79
v_mfma_f32_16x16x32_bf16 v[84:87], a[44:47], a[76:79], v[84:87]
ds_read_b128 a[16:19], v46 offset:4096
v_add_f32 v19, v78, v19
v_mfma_f32_16x16x32_bf16 v[84:87], a[40:43], a[72:75], v[84:87]
v_add_f32 v19, v79, v19
v_cvt_pk_bf16_f32 v75, v78, v79
v_mfma_f32_16x16x32_bf16 v[84:87], a[48:51], a[80:83], v[84:87]
buffer_load_dwordx4 a[132:135], v1, s[8:11], s63 offen offset:1024 sc1
v_mfma_f32_16x16x32_bf16 v[84:87], a[52:55], a[84:87], v[84:87]
ds_read_b128 a[20:23], v46 offset:5120
ds_read_b128 a[24:27], v46 offset:6144
v_mfma_f32_16x16x32_bf16 v[92:95], a[52:55], a[116:119], v[92:95]
v_exp_f32 v80, v80
v_mfma_f32_16x16x32_bf16 v[92:95], a[48:51], a[112:115], v[92:95]
buffer_load_dwordx4 a[136:139], v1, s[8:11], s63 offen offset:2048 sc1
v_mfma_f32_16x16x32_bf16 v[92:95], a[56:59], a[120:123], v[92:95]
s_waitcnt lgkmcnt(3)
v_exp_f32 v81, v81
v_mfma_f32_16x16x32_bf16 v[92:95], a[60:63], a[124:127], v[92:95]
ds_read_b128 a[28:31], v46 offset:7168
v_add_f32 v18, v80, v18
v_mfma_f32_16x16x32_bf16 v[84:87], a[60:63], a[92:95], v[84:87]
v_exp_f32 v82, v82
v_mfma_f32_16x16x32_bf16 v[84:87], a[56:59], a[88:91], v[84:87]
ds_read_b128 a[32:35], v46 offset:8192
v_add_f32 v18, v81, v18
v_mfma_f32_16x16x32_bf16 v[128:131], a[0:3], v[64:67], v[128:131]
ds_read_b128 a[36:39], v46 offset:9216
v_cvt_pk_bf16_f32 v80, v80, v81
v_mfma_f32_16x16x32_bf16 v[192:195], a[0:3], v[72:75], v[192:195]
v_exp_f32 v83, v83
v_mfma_f32_16x16x32_bf16 v[196:199], a[4:7], v[72:75], v[196:199]
ds_read_b128 a[40:43], v46 offset:10240
v_add_f32 v18, v82, v18
v_mfma_f32_16x16x32_bf16 v[132:135], a[4:7], v[64:67], v[132:135]
v_exp_f32 v84, v84
v_mfma_f32_16x16x32_bf16 v[136:139], a[8:11], v[64:67], v[136:139]
ds_read_b128 a[44:47], v46 offset:11264
v_add_f32 v18, v83, v18
v_mfma_f32_16x16x32_bf16 v[200:203], a[8:11], v[72:75], v[200:203]
ds_read_b128 a[48:51], v46 offset:12288
v_cvt_pk_bf16_f32 v81, v82, v83
v_mfma_f32_16x16x32_bf16 v[204:207], a[12:15], v[72:75], v[204:207]
ds_read_b128 a[52:55], v46 offset:13312
v_exp_f32 v85, v85
v_mfma_f32_16x16x32_bf16 v[140:143], a[12:15], v[64:67], v[140:143]
s_waitcnt lgkmcnt(4)
ds_read_b128 a[56:59], v46 offset:14336
ds_read_b128 a[60:63], v46 offset:15360
v_add_f32 v18, v84, v18
v_mfma_f32_16x16x32_bf16 v[144:147], a[16:19], v[64:67], v[144:147]
v_exp_f32 v86, v86
v_mfma_f32_16x16x32_bf16 v[208:211], a[16:19], v[72:75], v[208:211]
v_add_f32 v18, v85, v18
v_cvt_pk_bf16_f32 v82, v84, v85
v_mfma_f32_16x16x32_bf16 v[212:215], a[20:23], v[72:75], v[212:215]
v_exp_f32 v87, v87
v_mfma_f32_16x16x32_bf16 v[148:151], a[20:23], v[64:67], v[148:151]
v_add_f32 v18, v86, v18
v_add_f32 v18, v87, v18
v_mfma_f32_16x16x32_bf16 v[152:155], a[24:27], v[64:67], v[152:155]
v_cvt_pk_bf16_f32 v83, v86, v87
v_mfma_f32_16x16x32_bf16 v[216:219], a[24:27], v[72:75], v[216:219]
v_exp_f32 v88, v88
v_mfma_f32_16x16x32_bf16 v[220:223], a[28:31], v[72:75], v[220:223]
v_exp_f32 v89, v89
v_mfma_f32_16x16x32_bf16 v[156:159], a[28:31], v[64:67], v[156:159]
v_add_f32 v19, v88, v19
v_mfma_f32_16x16x32_bf16 v[160:163], a[32:35], v[64:67], v[160:163]
v_exp_f32 v90, v90
v_mfma_f32_16x16x32_bf16 v[224:227], a[32:35], v[72:75], v[224:227]
v_add_f32 v19, v89, v19
v_cvt_pk_bf16_f32 v88, v88, v89
v_mfma_f32_16x16x32_bf16 v[228:231], a[36:39], v[72:75], v[228:231]
s_waitcnt vmcnt(13) lgkmcnt(0)
v_exp_f32 v91, v91
v_mfma_f32_16x16x32_bf16 v[164:167], a[36:39], v[64:67], v[164:167]
s_barrier
v_add_f32 v19, v90, v19
v_mfma_f32_16x16x32_bf16 v[168:171], a[40:43], v[64:67], v[168:171]
v_exp_f32 v92, v92
v_mfma_f32_16x16x32_bf16 v[232:235], a[40:43], v[72:75], v[232:235]
ds_read_b128 a[0:3], v46 offset:32768
v_add_f32 v19, v91, v19
v_mfma_f32_16x16x32_bf16 v[236:239], a[44:47], v[72:75], v[236:239]
ds_read_b128 a[4:7], v46 offset:33792
v_cvt_pk_bf16_f32 v89, v90, v91
v_mfma_f32_16x16x32_bf16 v[172:175], a[44:47], v[64:67], v[172:175]
v_exp_f32 v93, v93
v_mfma_f32_16x16x32_bf16 v[176:179], a[48:51], v[64:67], v[176:179]
ds_read_b128 a[8:11], v46 offset:34816
v_add_f32 v19, v92, v19
v_mfma_f32_16x16x32_bf16 v[240:243], a[48:51], v[72:75], v[240:243]
v_exp_f32 v94, v94
v_mfma_f32_16x16x32_bf16 v[244:247], a[52:55], v[72:75], v[244:247]
v_add_f32 v19, v93, v19
v_cvt_pk_bf16_f32 v90, v92, v93
v_mfma_f32_16x16x32_bf16 v[180:183], a[52:55], v[64:67], v[180:183]
v_exp_f32 v95, v95
v_mfma_f32_16x16x32_bf16 v[184:187], a[56:59], v[64:67], v[184:187]
buffer_load_dwordx4 a[140:143], v1, s[8:11], s63 offen offset:3072 sc1
v_add_f32 v19, v94, v19
v_mfma_f32_16x16x32_bf16 v[248:251], a[56:59], v[72:75], v[248:251]
s_add_u32 s63, s99, 4096
ds_read_b128 a[12:15], v46 offset:35840
v_add_f32 v19, v95, v19
v_cvt_pk_bf16_f32 v91, v94, v95
v_mfma_f32_16x16x32_bf16 v[252:255], a[60:63], v[72:75], v[252:255]
buffer_load_dwordx4 a[144:147], v1, s[8:11], s63 offen offset:0 sc1
v_mfma_f32_16x16x32_bf16 v[188:191], a[60:63], v[64:67], v[188:191]
s_waitcnt lgkmcnt(1)
buffer_load_dwordx4 a[148:151], v1, s[8:11], s63 offen offset:1024 sc1
ds_read_b128 a[16:19], v46 offset:36864
v_mfma_f32_16x16x32_bf16 v[128:131], a[0:3], v[80:83], v[128:131]
buffer_load_dwordx4 a[152:155], v1, s[8:11], s63 offen offset:2048 sc1
v_mfma_f32_16x16x32_bf16 v[192:195], a[0:3], v[88:91], v[192:195]
buffer_load_dwordx4 a[156:159], v1, s[8:11], s63 offen offset:3072 sc1
ds_read_b128 a[20:23], v46 offset:37888
v_mfma_f32_16x16x32_bf16 v[196:199], a[4:7], v[88:91], v[196:199]
s_add_u32 s63, s99, 8192
ds_read_b128 a[24:27], v46 offset:38912
v_mov_b32 v22, v18
v_mfma_f32_16x16x32_bf16 v[132:135], a[4:7], v[80:83], v[132:135]
buffer_load_dwordx4 a[160:163], v1, s[8:11], s63 offen offset:0 sc1
v_mfma_f32_16x16x32_bf16 v[136:139], a[8:11], v[80:83], v[136:139]
buffer_load_dwordx4 a[164:167], v1, s[8:11], s63 offen offset:1024 sc1
v_mfma_f32_16x16x32_bf16 v[200:203], a[8:11], v[88:91], v[200:203]
s_waitcnt lgkmcnt(3)
buffer_load_dwordx4 a[168:171], v1, s[8:11], s63 offen offset:2048 sc1
ds_read_b128 a[28:31], v46 offset:39936
v_mfma_f32_16x16x32_bf16 v[204:207], a[12:15], v[88:91], v[204:207]
buffer_load_dwordx4 a[172:175], v1, s[8:11], s63 offen offset:3072 sc1
v_mfma_f32_16x16x32_bf16 v[140:143], a[12:15], v[80:83], v[140:143]
s_waitcnt lgkmcnt(3)
s_add_u32 s63, s99, 12288
ds_read_b128 a[32:35], v46 offset:40960
v_mov_b32 v23, v19
v_mfma_f32_16x16x32_bf16 v[144:147], a[16:19], v[80:83], v[144:147]
buffer_load_dwordx4 a[176:179], v1, s[8:11], s63 offen offset:0 sc1
v_permlane32_swap_b32 v22, v18
v_mfma_f32_16x16x32_bf16 v[208:211], a[16:19], v[88:91], v[208:211]
s_waitcnt lgkmcnt(2)
buffer_load_dwordx4 a[180:183], v1, s[8:11], s63 offen offset:1024 sc1
ds_read_b128 a[36:39], v46 offset:41984
v_permlane32_swap_b32 v23, v19
v_mfma_f32_16x16x32_bf16 v[212:215], a[20:23], v[88:91], v[212:215]
buffer_load_dwordx4 a[184:187], v1, s[8:11], s63 offen offset:2048 sc1
v_add_f32 v18, v22, v18
v_mfma_f32_16x16x32_bf16 v[148:151], a[20:23], v[80:83], v[148:151]
buffer_load_dwordx4 a[188:191], v1, s[8:11], s63 offen offset:3072 sc1
ds_read_b128 a[40:43], v46 offset:43008
ds_read_b128 a[44:47], v46 offset:44032
v_add_f32 v19, v23, v19
v_mfma_f32_16x16x32_bf16 v[152:155], a[24:27], v[80:83], v[152:155]
s_mov_b32 m0, s94
ds_read_b128 a[48:51], v46 offset:45056
ds_read_b128 a[52:55], v46 offset:46080
v_mov_b32 v22, v18
v_mfma_f32_16x16x32_bf16 v[216:219], a[24:27], v[88:91], v[216:219]
s_waitcnt lgkmcnt(6)
ds_read_b128 a[56:59], v46 offset:47104
ds_read_b128 a[60:63], v46 offset:48128
v_mov_b32 v23, v19
v_mfma_f32_16x16x32_bf16 v[220:223], a[28:31], v[88:91], v[220:223]
v_permlane16_swap_b32 v22, v18
v_mfma_f32_16x16x32_bf16 v[156:159], a[28:31], v[80:83], v[156:159]
s_waitcnt lgkmcnt(7)
v_permlane16_swap_b32 v23, v19
v_mfma_f32_16x16x32_bf16 v[160:163], a[32:35], v[80:83], v[160:163]
v_add_f32 v18, v22, v18
v_mfma_f32_16x16x32_bf16 v[224:227], a[32:35], v[88:91], v[224:227]
s_waitcnt lgkmcnt(6)
buffer_load_dwordx4 v38, s[16:19], s101 offen offset:0 sc1 lds
v_add_f32 v19, v23, v19
v_mfma_f32_16x16x32_bf16 v[228:231], a[36:39], v[88:91], v[228:231]
buffer_load_dwordx4 v39, s[16:19], s101 offen offset:1024 sc1 lds
v_add_f32 v23, v18, v19
v_mfma_f32_16x16x32_bf16 v[164:167], a[36:39], v[80:83], v[164:167]
s_waitcnt lgkmcnt(2)
buffer_load_dwordx4 v40, s[16:19], s101 offen offset:2048 sc1 lds
v_cmp_nge_f32 vcc, 0x5f800000, v23
v_mfma_f32_16x16x32_bf16 v[168:171], a[40:43], v[80:83], v[168:171]
buffer_load_dwordx4 v41, s[16:19], s101 offen offset:3072 sc1 lds
v_mfma_f32_16x16x32_bf16 v[232:235], a[40:43], v[88:91], v[232:235]
s_lshl_b32 s63, s60, 2
s_add_u32 s63, s63, 131072
s_cmp_lg_u64 vcc, 0
s_cselect_b32 s64, 1, 0
s_add_u32 m0, s94, 4096
v_mfma_f32_16x16x32_bf16 v[236:239], a[44:47], v[88:91], v[236:239]
buffer_load_dwordx4 v38, s[16:19], s70 offen offset:0 sc1 lds
v_mfma_f32_16x16x32_bf16 v[172:175], a[44:47], v[80:83], v[172:175]
buffer_load_dwordx4 v39, s[16:19], s70 offen offset:1024 sc1 lds
v_mfma_f32_16x16x32_bf16 v[176:179], a[48:51], v[80:83], v[176:179]
buffer_load_dwordx4 v40, s[16:19], s70 offen offset:2048 sc1 lds
v_mfma_f32_16x16x32_bf16 v[240:243], a[48:51], v[88:91], v[240:243]
buffer_load_dwordx4 v41, s[16:19], s70 offen offset:3072 sc1 lds
v_mov_b32 v24, s63
v_mov_b32 v25, s64
v_mfma_f32_16x16x32_bf16 v[244:247], a[52:55], v[88:91], v[244:247]
s_add_u32 s101, s101, s71
ds_write_b32 v24, v25
v_mov_b32 v24, 131072
v_mfma_f32_16x16x32_bf16 v[180:183], a[52:55], v[80:83], v[180:183]
s_waitcnt lgkmcnt(1)
s_add_u32 s70, s70, s71
v_not_b32 v25, v46
v_mov_b32 v34, 0x10000
v_mfma_f32_16x16x32_bf16 v[184:187], a[56:59], v[80:83], v[184:187]
s_add_u32 s94, s94, 32768
v_bfi_b32 v12, v34, v25, v12
v_bfi_b32 v13, v34, v25, v13
v_mfma_f32_16x16x32_bf16 v[248:251], a[56:59], v[88:91], v[248:251]
s_and_b32 s94, s94, 0x1ffff
v_bfi_b32 v14, v34, v25, v14
v_bfi_b32 v15, v34, v25, v15
v_mfma_f32_16x16x32_bf16 v[252:255], a[60:63], v[88:91], v[252:255]
v_mfma_f32_16x16x32_bf16 v[188:191], a[60:63], v[80:83], v[188:191]
s_waitcnt vmcnt(8)
v_cmp_neq_f32 vcc, v32, v48
v_cmp_neq_f32 s[86:87], v33, v52
v_add_f32 v26, v30, v18
v_add_f32 v28, v31, v19
s_or_b64 vcc, vcc, s[86:87]
s_cbranch_scc1 SLOWMERGE
v_mfma_f32_16x16x32_bf16 v[128:131], v[56:59], a[128:131], v[128:131]
s_waitcnt lgkmcnt(0)
v_rcp_f32 v26, v26
v_mfma_f32_16x16x32_bf16 v[132:135], v[60:63], a[128:131], v[132:135]
s_barrier
v_rcp_f32 v28, v28
v_mfma_f32_16x16x32_bf16 v[136:139], v[56:59], a[132:135], v[136:139]
ds_read_b128 v[34:37], v24
v_mov_b32 v27, v26
v_mfma_f32_16x16x32_bf16 v[140:143], v[60:63], a[132:135], v[140:143]
s_mov_b32 m0, s94
ds_read_b64_tr_b16 a[0:1], v12 offset:0
v_mov_b32 v29, v28
v_mfma_f32_16x16x32_bf16 v[144:147], v[56:59], a[136:139], v[144:147]
buffer_load_dwordx4 v38, s[16:19], s101 offen offset:0 sc1 lds
v_mfma_f32_16x16x32_bf16 v[148:151], v[60:63], a[136:139], v[148:151]
ds_read_b64_tr_b16 a[2:3], v12 offset:2048
ds_read_b64_tr_b16 a[4:5], v12 offset:4096
v_mfma_f32_16x16x32_bf16 v[152:155], v[56:59], a[140:143], v[152:155]
ds_read_b64_tr_b16 a[6:7], v12 offset:6144
v_mfma_f32_16x16x32_bf16 v[156:159], v[60:63], a[140:143], v[156:159]
ds_read_b64_tr_b16 a[8:9], v12 offset:16384
ds_read_b64_tr_b16 a[10:11], v12 offset:18432
v_mfma_f32_16x16x32_bf16 v[160:163], v[56:59], a[144:147], v[160:163]
buffer_load_dwordx4 v39, s[16:19], s101 offen offset:1024 sc1 lds
v_mfma_f32_16x16x32_bf16 v[164:167], v[60:63], a[144:147], v[164:167]
ds_read_b64_tr_b16 a[12:13], v12 offset:20480
ds_read_b64_tr_b16 a[14:15], v12 offset:22528
v_mfma_f32_16x16x32_bf16 v[168:171], v[56:59], a[148:151], v[168:171]
ds_read_b64_tr_b16 a[16:17], v12 offset:8192
ds_read_b64_tr_b16 a[18:19], v12 offset:10240
v_mfma_f32_16x16x32_bf16 v[172:175], v[60:63], a[148:151], v[172:175]
ds_read_b64_tr_b16 a[20:21], v12 offset:12288
ds_read_b64_tr_b16 a[22:23], v12 offset:14336
v_mfma_f32_16x16x32_bf16 v[176:179], v[56:59], a[152:155], v[176:179]
ds_read_b64_tr_b16 a[24:25], v12 offset:24576
ds_read_b64_tr_b16 a[26:27], v12 offset:26624
v_mfma_f32_16x16x32_bf16 v[180:183], v[60:63], a[152:155], v[180:183]
buffer_load_dwordx4 v40, s[16:19], s101 offen offset:2048 sc1 lds
v_mfma_f32_16x16x32_bf16 v[184:187], v[56:59], a[156:159], v[184:187]
v_mul_f32 v128, v26, v128
v_mul_f32 v129, v26, v129
v_mfma_f32_16x16x32_bf16 v[188:191], v[60:63], a[156:159], v[188:191]
v_mul_f32 v130, v26, v130
v_mul_f32 v131, v26, v131
v_mfma_f32_16x16x32_bf16 v[192:195], v[56:59], a[160:163], v[192:195]
buffer_load_dwordx4 v41, s[16:19], s101 offen offset:3072 sc1 lds
v_mfma_f32_16x16x32_bf16 v[196:199], v[60:63], a[160:163], v[196:199]
s_add_u32 m0, s94, 4096
v_cvt_pk_bf16_f32 v64, v128, v129
v_cvt_pk_bf16_f32 v65, v130, v131
v_mfma_f32_16x16x32_bf16 v[200:203], v[56:59], a[164:167], v[200:203]
v_mul_f32 v132, v26, v132
v_mul_f32 v133, v26, v133
v_mfma_f32_16x16x32_bf16 v[204:207], v[60:63], a[164:167], v[204:207]
v_mul_f32 v134, v26, v134
v_mul_f32 v135, v26, v135
v_mfma_f32_16x16x32_bf16 v[208:211], v[56:59], a[168:171], v[208:211]
buffer_load_dwordx4 v38, s[16:19], s70 offen offset:0 sc1 lds
v_mfma_f32_16x16x32_bf16 v[212:215], v[60:63], a[168:171], v[212:215]
v_cvt_pk_bf16_f32 v66, v132, v133
v_cvt_pk_bf16_f32 v67, v134, v135
v_mfma_f32_16x16x32_bf16 v[216:219], v[56:59], a[172:175], v[216:219]
v_mul_f32 v136, v26, v136
v_mul_f32 v137, v26, v137
v_mfma_f32_16x16x32_bf16 v[220:223], v[60:63], a[172:175], v[220:223]
buffer_load_dwordx4 v39, s[16:19], s70 offen offset:1024 sc1 lds
v_mfma_f32_16x16x32_bf16 v[224:227], v[56:59], a[176:179], v[224:227]
v_mul_f32 v138, v26, v138
v_mul_f32 v139, v26, v139
v_mfma_f32_16x16x32_bf16 v[228:231], v[60:63], a[176:179], v[228:231]
v_cvt_pk_bf16_f32 v68, v136, v137
v_cvt_pk_bf16_f32 v69, v138, v139
v_mfma_f32_16x16x32_bf16 v[232:235], v[56:59], a[180:183], v[232:235]
buffer_load_dwordx4 v40, s[16:19], s70 offen offset:2048 sc1 lds
v_mul_f32 v140, v26, v140
v_mul_f32 v141, v26, v141
v_mfma_f32_16x16x32_bf16 v[236:239], v[60:63], a[180:183], v[236:239]
buffer_load_dwordx4 v41, s[16:19], s70 offen offset:3072 sc1 lds
v_mul_f32 v142, v26, v142
v_mul_f32 v143, v26, v143
v_mfma_f32_16x16x32_bf16 v[240:243], v[56:59], a[184:187], v[240:243]
s_add_u32 s101, s101, s71
v_cvt_pk_bf16_f32 v70, v140, v141
v_cvt_pk_bf16_f32 v71, v142, v143
v_mfma_f32_16x16x32_bf16 v[244:247], v[60:63], a[184:187], v[244:247]
s_add_u32 s70, s70, s71
v_mul_f32 v144, v26, v144
v_mul_f32 v145, v26, v145
v_mfma_f32_16x16x32_bf16 v[248:251], v[56:59], a[188:191], v[248:251]
s_add_u32 s94, s94, 32768
v_mul_f32 v146, v26, v146
v_mul_f32 v147, v26, v147
v_mfma_f32_16x16x32_bf16 v[252:255], v[60:63], a[188:191], v[252:255]
s_and_b32 s94, s94, 0x1ffff
v_cvt_pk_bf16_f32 v72, v144, v145
v_cvt_pk_bf16_f32 v73, v146, v147
PACK:
.p2align 3
v_pk_mul_f32 v[148:149], v[148:149], v[26:27]
v_cvt_pk_bf16_f32 v74, v148, v149
v_pk_mul_f32 v[150:151], v[150:151], v[26:27]
v_cvt_pk_bf16_f32 v75, v150, v151
v_pk_mul_f32 v[152:153], v[152:153], v[26:27]
v_cvt_pk_bf16_f32 v76, v152, v153
v_pk_mul_f32 v[154:155], v[154:155], v[26:27]
v_cvt_pk_bf16_f32 v77, v154, v155
v_pk_mul_f32 v[156:157], v[156:157], v[26:27]
v_cvt_pk_bf16_f32 v78, v156, v157
v_pk_mul_f32 v[158:159], v[158:159], v[26:27]
v_cvt_pk_bf16_f32 v79, v158, v159
v_pk_mul_f32 v[160:161], v[160:161], v[26:27]
v_cvt_pk_bf16_f32 v80, v160, v161
v_pk_mul_f32 v[162:163], v[162:163], v[26:27]
v_cvt_pk_bf16_f32 v81, v162, v163
v_pk_mul_f32 v[164:165], v[164:165], v[26:27]
v_cvt_pk_bf16_f32 v82, v164, v165
v_pk_mul_f32 v[166:167], v[166:167], v[26:27]
v_cvt_pk_bf16_f32 v83, v166, v167
v_pk_mul_f32 v[168:169], v[168:169], v[26:27]
v_cvt_pk_bf16_f32 v84, v168, v169
v_pk_mul_f32 v[170:171], v[170:171], v[26:27]
v_cvt_pk_bf16_f32 v85, v170, v171
v_pk_mul_f32 v[172:173], v[172:173], v[26:27]
v_cvt_pk_bf16_f32 v86, v172, v173
v_pk_mul_f32 v[174:175], v[174:175], v[26:27]
v_cvt_pk_bf16_f32 v87, v174, v175
v_pk_mul_f32 v[176:177], v[176:177], v[26:27]
v_cvt_pk_bf16_f32 v88, v176, v177
v_pk_mul_f32 v[178:179], v[178:179], v[26:27]
v_cvt_pk_bf16_f32 v89, v178, v179
v_pk_mul_f32 v[180:181], v[180:181], v[26:27]
v_cvt_pk_bf16_f32 v90, v180, v181
v_pk_mul_f32 v[182:183], v[182:183], v[26:27]
v_cvt_pk_bf16_f32 v91, v182, v183
v_pk_mul_f32 v[184:185], v[184:185], v[26:27]
v_cvt_pk_bf16_f32 v92, v184, v185
v_pk_mul_f32 v[186:187], v[186:187], v[26:27]
v_cvt_pk_bf16_f32 v93, v186, v187
v_pk_mul_f32 v[188:189], v[188:189], v[26:27]
v_cvt_pk_bf16_f32 v94, v188, v189
v_pk_mul_f32 v[190:191], v[190:191], v[26:27]
v_cvt_pk_bf16_f32 v95, v190, v191
v_pk_mul_f32 v[192:193], v[192:193], v[28:29]
v_cvt_pk_bf16_f32 v96, v192, v193
v_pk_mul_f32 v[194:195], v[194:195], v[28:29]
v_cvt_pk_bf16_f32 v97, v194, v195
v_pk_mul_f32 v[196:197], v[196:197], v[28:29]
v_cvt_pk_bf16_f32 v98, v196, v197
v_pk_mul_f32 v[198:199], v[198:199], v[28:29]
v_cvt_pk_bf16_f32 v99, v198, v199
v_pk_mul_f32 v[200:201], v[200:201], v[28:29]
v_cvt_pk_bf16_f32 v100, v200, v201
v_pk_mul_f32 v[202:203], v[202:203], v[28:29]
v_cvt_pk_bf16_f32 v101, v202, v203
v_pk_mul_f32 v[204:205], v[204:205], v[28:29]
v_cvt_pk_bf16_f32 v102, v204, v205
v_pk_mul_f32 v[206:207], v[206:207], v[28:29]
v_cvt_pk_bf16_f32 v103, v206, v207
v_pk_mul_f32 v[208:209], v[208:209], v[28:29]
v_cvt_pk_bf16_f32 v104, v208, v209
v_pk_mul_f32 v[210:211], v[210:211], v[28:29]
v_cvt_pk_bf16_f32 v105, v210, v211
v_pk_mul_f32 v[212:213], v[212:213], v[28:29]
v_cvt_pk_bf16_f32 v106, v212, v213
v_pk_mul_f32 v[214:215], v[214:215], v[28:29]
v_cvt_pk_bf16_f32 v107, v214, v215
v_pk_mul_f32 v[216:217], v[216:217], v[28:29]
v_cvt_pk_bf16_f32 v108, v216, v217
v_pk_mul_f32 v[218:219], v[218:219], v[28:29]
v_cvt_pk_bf16_f32 v109, v218, v219
v_pk_mul_f32 v[220:221], v[220:221], v[28:29]
v_cvt_pk_bf16_f32 v110, v220, v221
v_pk_mul_f32 v[222:223], v[222:223], v[28:29]
v_cvt_pk_bf16_f32 v111, v222, v223
v_pk_mul_f32 v[224:225], v[224:225], v[28:29]
v_cvt_pk_bf16_f32 v112, v224, v225
v_pk_mul_f32 v[226:227], v[226:227], v[28:29]
v_cvt_pk_bf16_f32 v113, v226, v227
v_pk_mul_f32 v[228:229], v[228:229], v[28:29]
v_cvt_pk_bf16_f32 v114, v228, v229
v_pk_mul_f32 v[230:231], v[230:231], v[28:29]
v_cvt_pk_bf16_f32 v115, v230, v231
v_pk_mul_f32 v[232:233], v[232:233], v[28:29]
v_cvt_pk_bf16_f32 v116, v232, v233
v_pk_mul_f32 v[234:235], v[234:235], v[28:29]
v_cvt_pk_bf16_f32 v117, v234, v235
v_pk_mul_f32 v[236:237], v[236:237], v[28:29]
v_cvt_pk_bf16_f32 v118, v236, v237
v_pk_mul_f32 v[238:239], v[238:239], v[28:29]
v_cvt_pk_bf16_f32 v119, v238, v239
v_pk_mul_f32 v[240:241], v[240:241], v[28:29]
v_cvt_pk_bf16_f32 v120, v240, v241
v_pk_mul_f32 v[242:243], v[242:243], v[28:29]
v_cvt_pk_bf16_f32 v121, v242, v243
v_pk_mul_f32 v[244:245], v[244:245], v[28:29]
v_cvt_pk_bf16_f32 v122, v244, v245
v_pk_mul_f32 v[246:247], v[246:247], v[28:29]
v_cvt_pk_bf16_f32 v123, v246, v247
v_pk_mul_f32 v[248:249], v[248:249], v[28:29]
v_cvt_pk_bf16_f32 v124, v248, v249
v_pk_mul_f32 v[250:251], v[250:251], v[28:29]
v_cvt_pk_bf16_f32 v125, v250, v251
v_pk_mul_f32 v[252:253], v[252:253], v[28:29]
v_cvt_pk_bf16_f32 v126, v252, v253
v_pk_mul_f32 v[254:255], v[254:255], v[28:29]
v_cvt_pk_bf16_f32 v127, v254, v255
PACKED:
s_waitcnt lgkmcnt(0)
v_or3_b32 v34, v34, v35, v36
v_or_b32 v34, v34, v37
s_nop 0
v_readfirstlane_b32 s63, v34
s_andn2_b32 s63, s63, s97
s_cbranch_scc1 REDO
OPROJ:
v_mfma_f32_16x16x32_bf16 v[128:131], a[0:3], v[64:67], 0
ds_read_b64_tr_b16 a[28:29], v12 offset:28672
v_mfma_f32_16x16x32_bf16 v[128:131], a[4:7], v[68:71], v[128:131]
s_mov_b32 m0, s94
ds_read_b64_tr_b16 a[30:31], v12 offset:30720
v_mfma_f32_16x16x32_bf16 v[136:139], a[4:7], v[100:103], 0
ds_read_b64_tr_b16 a[32:33], v13 offset:0
v_mfma_f32_16x16x32_bf16 v[136:139], a[0:3], v[96:99], v[136:139]
buffer_load_dwordx4 v38, s[16:19], s101 offen offset:0 sc1 lds
v_mfma_f32_16x16x32_bf16 v[136:139], a[8:11], v[104:107], v[136:139]
ds_read_b64_tr_b16 a[34:35], v13 offset:2048
ds_read_b64_tr_b16 a[36:37], v13 offset:4096
v_mfma_f32_16x16x32_bf16 v[136:139], a[12:15], v[108:111], v[136:139]
ds_read_b64_tr_b16 a[38:39], v13 offset:6144
v_mfma_f32_16x16x32_bf16 v[128:131], a[12:15], v[76:79], v[128:131]
ds_read_b64_tr_b16 a[40:41], v13 offset:16384
v_mfma_f32_16x16x32_bf16 v[128:131], a[8:11], v[72:75], v[128:131]
ds_read_b64_tr_b16 a[42:43], v13 offset:18432
ds_read_b64_tr_b16 a[44:45], v13 offset:20480
v_mfma_f32_16x16x32_bf16 v[128:131], a[16:19], v[80:83], v[128:131]
ds_read_b64_tr_b16 a[46:47], v13 offset:22528
v_mfma_f32_16x16x32_bf16 v[128:131], a[20:23], v[84:87], v[128:131]
buffer_load_dwordx4 v39, s[16:19], s101 offen offset:1024 sc1 lds
v_mfma_f32_16x16x32_bf16 v[136:139], a[20:23], v[116:119], v[136:139]
ds_read_b64_tr_b16 a[48:49], v13 offset:8192
ds_read_b64_tr_b16 a[50:51], v13 offset:10240
v_mfma_f32_16x16x32_bf16 v[136:139], a[16:19], v[112:115], v[136:139]
ds_read_b64_tr_b16 a[52:53], v13 offset:12288
v_mfma_f32_16x16x32_bf16 v[136:139], a[24:27], v[120:123], v[136:139]
s_waitcnt lgkmcnt(7)
ds_read_b64_tr_b16 a[54:55], v13 offset:14336
v_mfma_f32_16x16x32_bf16 v[136:139], a[28:31], v[124:127], v[136:139]
ds_read_b64_tr_b16 a[56:57], v13 offset:24576
ds_read_b64_tr_b16 a[58:59], v13 offset:26624
v_mfma_f32_16x16x32_bf16 v[128:131], a[28:31], v[92:95], v[128:131]
ds_read_b64_tr_b16 a[60:61], v13 offset:28672
v_mfma_f32_16x16x32_bf16 v[128:131], a[24:27], v[88:91], v[128:131]
buffer_load_dwordx4 v40, s[16:19], s101 offen offset:2048 sc1 lds
v_mfma_f32_16x16x32_bf16 v[132:135], a[32:35], v[64:67], 0
ds_read_b64_tr_b16 a[62:63], v13 offset:30720
ds_read_b64_tr_b16 a[0:1], v14 offset:0
v_mfma_f32_16x16x32_bf16 v[132:135], a[36:39], v[68:71], v[132:135]
ds_read_b64_tr_b16 a[2:3], v14 offset:2048
v_mfma_f32_16x16x32_bf16 v[140:143], a[36:39], v[100:103], 0
ds_read_b64_tr_b16 a[4:5], v14 offset:4096
ds_read_b64_tr_b16 a[6:7], v14 offset:6144
v_mfma_f32_16x16x32_bf16 v[140:143], a[32:35], v[96:99], v[140:143]
s_waitcnt lgkmcnt(8)
ds_read_b64_tr_b16 a[8:9], v14 offset:16384
v_mfma_f32_16x16x32_bf16 v[140:143], a[40:43], v[104:107], v[140:143]
ds_read_b64_tr_b16 a[10:11], v14 offset:18432
v_mfma_f32_16x16x32_bf16 v[140:143], a[44:47], v[108:111], v[140:143]
buffer_load_dwordx4 v41, s[16:19], s101 offen offset:3072 sc1 lds
v_mfma_f32_16x16x32_bf16 v[132:135], a[44:47], v[76:79], v[132:135]
s_add_u32 m0, s94, 4096
ds_read_b64_tr_b16 a[12:13], v14 offset:20480
ds_read_b64_tr_b16 a[14:15], v14 offset:22528
v_mfma_f32_16x16x32_bf16 v[132:135], a[40:43], v[72:75], v[132:135]
ds_read_b64_tr_b16 a[16:17], v14 offset:8192
ds_read_b64_tr_b16 a[18:19], v14 offset:10240
v_mfma_f32_16x16x32_bf16 v[132:135], a[48:51], v[80:83], v[132:135]
ds_read_b64_tr_b16 a[20:21], v14 offset:12288
v_mfma_f32_16x16x32_bf16 v[132:135], a[52:55], v[84:87], v[132:135]
ds_read_b64_tr_b16 a[22:23], v14 offset:14336
v_mfma_f32_16x16x32_bf16 v[140:143], a[52:55], v[116:119], v[140:143]
ds_read_b64_tr_b16 a[24:25], v14 offset:24576
v_mfma_f32_16x16x32_bf16 v[140:143], a[48:51], v[112:115], v[140:143]
s_waitcnt lgkmcnt(7)
buffer_load_dwordx4 v38, s[16:19], s70 offen offset:0 sc1 lds
v_mfma_f32_16x16x32_bf16 v[140:143], a[56:59], v[120:123], v[140:143]
ds_read_b64_tr_b16 a[26:27], v14 offset:26624
ds_read_b64_tr_b16 a[28:29], v14 offset:28672
v_mfma_f32_16x16x32_bf16 v[140:143], a[60:63], v[124:127], v[140:143]
ds_read_b64_tr_b16 a[30:31], v14 offset:30720
ds_read_b64_tr_b16 a[32:33], v15 offset:0
v_mfma_f32_16x16x32_bf16 v[132:135], a[60:63], v[92:95], v[132:135]
ds_read_b64_tr_b16 a[34:35], v15 offset:2048
v_mfma_f32_16x16x32_bf16 v[132:135], a[56:59], v[88:91], v[132:135]
ds_read_b64_tr_b16 a[36:37], v15 offset:4096
v_mfma_f32_16x16x32_bf16 v[144:147], a[0:3], v[64:67], 0
ds_read_b64_tr_b16 a[38:39], v15 offset:6144
v_mfma_f32_16x16x32_bf16 v[144:147], a[4:7], v[68:71], v[144:147]
buffer_load_dwordx4 v39, s[16:19], s70 offen offset:1024 sc1 lds
v_mfma_f32_16x16x32_bf16 v[152:155], a[4:7], v[100:103], 0
ds_read_b64_tr_b16 a[40:41], v15 offset:16384
ds_read_b64_tr_b16 a[42:43], v15 offset:18432
v_mfma_f32_16x16x32_bf16 v[152:155], a[0:3], v[96:99], v[152:155]
ds_read_b64_tr_b16 a[44:45], v15 offset:20480
ds_read_b64_tr_b16 a[46:47], v15 offset:22528
v_mfma_f32_16x16x32_bf16 v[152:155], a[8:11], v[104:107], v[152:155]
s_waitcnt lgkmcnt(7)
ds_read_b64_tr_b16 a[48:49], v15 offset:8192
v_mfma_f32_16x16x32_bf16 v[152:155], a[12:15], v[108:111], v[152:155]
ds_read_b64_tr_b16 a[50:51], v15 offset:10240
v_cvt_pk_bf16_f32 v160, v128, v129
v_mfma_f32_16x16x32_bf16 v[144:147], a[12:15], v[76:79], v[144:147]
ds_read_b64_tr_b16 a[52:53], v15 offset:12288
v_mfma_f32_16x16x32_bf16 v[144:147], a[8:11], v[72:75], v[144:147]
ds_read_b64_tr_b16 a[54:55], v15 offset:14336
v_cvt_pk_bf16_f32 v161, v130, v131
v_mfma_f32_16x16x32_bf16 v[144:147], a[16:19], v[80:83], v[144:147]
ds_read_b64_tr_b16 a[56:57], v15 offset:24576
ds_read_b64_tr_b16 a[58:59], v15 offset:26624
v_mfma_f32_16x16x32_bf16 v[144:147], a[20:23], v[84:87], v[144:147]
ds_read_b64_tr_b16 a[60:61], v15 offset:28672
ds_read_b64_tr_b16 a[62:63], v15 offset:30720
v_mfma_f32_16x16x32_bf16 v[152:155], a[20:23], v[116:119], v[152:155]
buffer_load_dwordx4 v40, s[16:19], s70 offen offset:2048 sc1 lds
v_mfma_f32_16x16x32_bf16 v[152:155], a[16:19], v[112:115], v[152:155]
v_cvt_pk_bf16_f32 v162, v132, v133
v_mfma_f32_16x16x32_bf16 v[152:155], a[24:27], v[120:123], v[152:155]
buffer_load_dwordx4 v41, s[16:19], s70 offen offset:3072 sc1 lds
v_mfma_f32_16x16x32_bf16 v[152:155], a[28:31], v[124:127], v[152:155]
s_add_u32 s101, s101, s71
v_mfma_f32_16x16x32_bf16 v[144:147], a[28:31], v[92:95], v[144:147]
s_add_u32 s70, s70, s71
v_cvt_pk_bf16_f32 v163, v134, v135
v_mfma_f32_16x16x32_bf16 v[144:147], a[24:27], v[88:91], v[144:147]
s_waitcnt lgkmcnt(2)
s_add_u32 s94, s94, 32768
v_mfma_f32_16x16x32_bf16 v[148:151], a[32:35], v[64:67], 0
s_and_b32 s94, s94, 0x1ffff
v_mfma_f32_16x16x32_bf16 v[148:151], a[36:39], v[68:71], v[148:151]
v_cvt_pk_bf16_f32 v164, v136, v137
v_cvt_pk_bf16_f32 v165, v138, v139
v_mfma_f32_16x16x32_bf16 v[156:159], a[36:39], v[100:103], 0
s_waitcnt vmcnt(16) lgkmcnt(0)
v_mfma_f32_16x16x32_bf16 v[156:159], a[32:35], v[96:99], v[156:159]
s_barrier
v_mfma_f32_16x16x32_bf16 v[156:159], a[40:43], v[104:107], v[156:159]
ds_read_b64_tr_b16 a[0:1], v12 offset:32768
v_cvt_pk_bf16_f32 v166, v140, v141
v_mfma_f32_16x16x32_bf16 v[156:159], a[44:47], v[108:111], v[156:159]
ds_read_b64_tr_b16 a[2:3], v12 offset:34816
v_mfma_f32_16x16x32_bf16 v[148:151], a[44:47], v[76:79], v[148:151]
ds_read_b64_tr_b16 a[4:5], v12 offset:36864
v_mfma_f32_16x16x32_bf16 v[148:151], a[40:43], v[72:75], v[148:151]
ds_read_b64_tr_b16 a[6:7], v12 offset:38912
v_cvt_pk_bf16_f32 v167, v142, v143
v_mfma_f32_16x16x32_bf16 v[148:151], a[48:51], v[80:83], v[148:151]
s_add_u32 s63, s100, 0
ds_read_b64_tr_b16 a[8:9], v12 offset:49152
v_mfma_f32_16x16x32_bf16 v[148:151], a[52:55], v[84:87], v[148:151]
ds_read_b64_tr_b16 a[10:11], v12 offset:51200
v_mfma_f32_16x16x32_bf16 v[156:159], a[52:55], v[116:119], v[156:159]
ds_read_b64_tr_b16 a[12:13], v12 offset:53248
v_mfma_f32_16x16x32_bf16 v[156:159], a[48:51], v[112:115], v[156:159]
ds_read_b64_tr_b16 a[14:15], v12 offset:55296
v_mfma_f32_16x16x32_bf16 v[156:159], a[56:59], v[120:123], v[156:159]
buffer_store_dwordx4 v[160:163], v1, s[8:11], s63 offen sc1
v_mfma_f32_16x16x32_bf16 v[156:159], a[60:63], v[124:127], v[156:159]
s_add_u32 s63, s63, 917504
ds_read_b64_tr_b16 a[16:17], v12 offset:40960
ds_read_b64_tr_b16 a[18:19], v12 offset:43008
v_mfma_f32_16x16x32_bf16 v[148:151], a[60:63], v[92:95], v[148:151]
buffer_store_dwordx4 v[164:167], v1, s[8:11], s63 offen sc1
v_mfma_f32_16x16x32_bf16 v[148:151], a[56:59], v[88:91], v[148:151]
s_waitcnt lgkmcnt(5)
ds_read_b64_tr_b16 a[20:21], v12 offset:45056
ds_read_b64_tr_b16 a[22:23], v12 offset:47104
v_mfma_f32_16x16x32_bf16 v[128:131], a[0:3], v[64:67], 0
ds_read_b64_tr_b16 a[24:25], v12 offset:57344
ds_read_b64_tr_b16 a[26:27], v12 offset:59392
v_mfma_f32_16x16x32_bf16 v[128:131], a[4:7], v[68:71], v[128:131]
s_mov_b32 m0, s94
ds_read_b64_tr_b16 a[28:29], v12 offset:61440
ds_read_b64_tr_b16 a[30:31], v12 offset:63488
v_mfma_f32_16x16x32_bf16 v[136:139], a[4:7], v[100:103], 0
ds_read_b64_tr_b16 a[32:33], v13 offset:32768
v_mfma_f32_16x16x32_bf16 v[136:139], a[0:3], v[96:99], v[136:139]
s_waitcnt lgkmcnt(9)
buffer_load_dwordx4 v38, s[16:19], s101 offen offset:0 sc1 lds
v_mfma_f32_16x16x32_bf16 v[136:139], a[8:11], v[104:107], v[136:139]
ds_read_b64_tr_b16 a[34:35], v13 offset:34816
v_cvt_pk_bf16_f32 v168, v144, v145
v_mfma_f32_16x16x32_bf16 v[136:139], a[12:15], v[108:111], v[136:139]
ds_read_b64_tr_b16 a[36:37], v13 offset:36864
ds_read_b64_tr_b16 a[38:39], v13 offset:38912
v_mfma_f32_16x16x32_bf16 v[128:131], a[12:15], v[76:79], v[128:131]
ds_read_b64_tr_b16 a[40:41], v13 offset:49152
v_cvt_pk_bf16_f32 v169, v146, v147
v_mfma_f32_16x16x32_bf16 v[128:131], a[8:11], v[72:75], v[128:131]
s_waitcnt lgkmcnt(7)
ds_read_b64_tr_b16 a[42:43], v13 offset:51200
ds_read_b64_tr_b16 a[44:45], v13 offset:53248
v_mfma_f32_16x16x32_bf16 v[128:131], a[16:19], v[80:83], v[128:131]
ds_read_b64_tr_b16 a[46:47], v13 offset:55296
v_mfma_f32_16x16x32_bf16 v[128:131], a[20:23], v[84:87], v[128:131]
buffer_load_dwordx4 v39, s[16:19], s101 offen offset:1024 sc1 lds
v_mfma_f32_16x16x32_bf16 v[136:139], a[20:23], v[116:119], v[136:139]
ds_read_b64_tr_b16 a[48:49], v13 offset:40960
v_cvt_pk_bf16_f32 v170, v148, v149
v_mfma_f32_16x16x32_bf16 v[136:139], a[16:19], v[112:115], v[136:139]
ds_read_b64_tr_b16 a[50:51], v13 offset:43008
ds_read_b64_tr_b16 a[52:53], v13 offset:45056
v_mfma_f32_16x16x32_bf16 v[136:139], a[24:27], v[120:123], v[136:139]
s_waitcnt lgkmcnt(7)
ds_read_b64_tr_b16 a[54:55], v13 offset:47104
ds_read_b64_tr_b16 a[56:57], v13 offset:57344
v_mfma_f32_16x16x32_bf16 v[136:139], a[28:31], v[124:127], v[136:139]
ds_read_b64_tr_b16 a[58:59], v13 offset:59392
v_cvt_pk_bf16_f32 v171, v150, v151
v_mfma_f32_16x16x32_bf16 v[128:131], a[28:31], v[92:95], v[128:131]
ds_read_b64_tr_b16 a[60:61], v13 offset:61440
v_mfma_f32_16x16x32_bf16 v[128:131], a[24:27], v[88:91], v[128:131]
buffer_load_dwordx4 v40, s[16:19], s101 offen offset:2048 sc1 lds
v_mfma_f32_16x16x32_bf16 v[132:135], a[32:35], v[64:67], 0
ds_read_b64_tr_b16 a[62:63], v13 offset:63488
v_cvt_pk_bf16_f32 v172, v152, v153
v_mfma_f32_16x16x32_bf16 v[132:135], a[36:39], v[68:71], v[132:135]
ds_read_b64_tr_b16 a[0:1], v14 offset:32768
ds_read_b64_tr_b16 a[2:3], v14 offset:34816
v_mfma_f32_16x16x32_bf16 v[140:143], a[36:39], v[100:103], 0
ds_read_b64_tr_b16 a[4:5], v14 offset:36864
ds_read_b64_tr_b16 a[6:7], v14 offset:38912
v_mfma_f32_16x16x32_bf16 v[140:143], a[32:35], v[96:99], v[140:143]
s_waitcnt lgkmcnt(7)
ds_read_b64_tr_b16 a[8:9], v14 offset:49152
v_cvt_pk_bf16_f32 v173, v154, v155
v_mfma_f32_16x16x32_bf16 v[140:143], a[40:43], v[104:107], v[140:143]
ds_read_b64_tr_b16 a[10:11], v14 offset:51200
v_mfma_f32_16x16x32_bf16 v[140:143], a[44:47], v[108:111], v[140:143]
buffer_load_dwordx4 v41, s[16:19], s101 offen offset:3072 sc1 lds
v_mfma_f32_16x16x32_bf16 v[132:135], a[44:47], v[76:79], v[132:135]
s_add_u32 m0, s94, 4096
ds_read_b64_tr_b16 a[12:13], v14 offset:53248
ds_read_b64_tr_b16 a[14:15], v14 offset:55296
v_mfma_f32_16x16x32_bf16 v[132:135], a[40:43], v[72:75], v[132:135]
ds_read_b64_tr_b16 a[16:17], v14 offset:40960
v_cvt_pk_bf16_f32 v174, v156, v157
v_mfma_f32_16x16x32_bf16 v[132:135], a[48:51], v[80:83], v[132:135]
ds_read_b64_tr_b16 a[18:19], v14 offset:43008
ds_read_b64_tr_b16 a[20:21], v14 offset:45056
v_mfma_f32_16x16x32_bf16 v[132:135], a[52:55], v[84:87], v[132:135]
ds_read_b64_tr_b16 a[22:23], v14 offset:47104
v_cvt_pk_bf16_f32 v175, v158, v159
v_mfma_f32_16x16x32_bf16 v[140:143], a[52:55], v[116:119], v[140:143]
s_add_u32 s63, s100, 16384
ds_read_b64_tr_b16 a[24:25], v14 offset:57344
v_mfma_f32_16x16x32_bf16 v[140:143], a[48:51], v[112:115], v[140:143]
s_waitcnt lgkmcnt(7)
buffer_load_dwordx4 v38, s[16:19], s70 offen offset:0 sc1 lds
v_mfma_f32_16x16x32_bf16 v[140:143], a[56:59], v[120:123], v[140:143]
ds_read_b64_tr_b16 a[26:27], v14 offset:59392
ds_read_b64_tr_b16 a[28:29], v14 offset:61440
v_mfma_f32_16x16x32_bf16 v[140:143], a[60:63], v[124:127], v[140:143]
ds_read_b64_tr_b16 a[30:31], v14 offset:63488
ds_read_b64_tr_b16 a[32:33], v15 offset:32768
v_mfma_f32_16x16x32_bf16 v[132:135], a[60:63], v[92:95], v[132:135]
ds_read_b64_tr_b16 a[34:35], v15 offset:34816
v_mfma_f32_16x16x32_bf16 v[132:135], a[56:59], v[88:91], v[132:135]
buffer_store_dwordx4 v[168:171], v1, s[8:11], s63 offen sc1
v_mfma_f32_16x16x32_bf16 v[144:147], a[0:3], v[64:67], 0
s_add_u32 s63, s63, 917504
ds_read_b64_tr_b16 a[36:37], v15 offset:36864
ds_read_b64_tr_b16 a[38:39], v15 offset:38912
v_mfma_f32_16x16x32_bf16 v[144:147], a[4:7], v[68:71], v[144:147]
buffer_load_dwordx4 v39, s[16:19], s70 offen offset:1024 sc1 lds
v_mfma_f32_16x16x32_bf16 v[152:155], a[4:7], v[100:103], 0
ds_read_b64_tr_b16 a[40:41], v15 offset:49152
ds_read_b64_tr_b16 a[42:43], v15 offset:51200
v_mfma_f32_16x16x32_bf16 v[152:155], a[0:3], v[96:99], v[152:155]
buffer_store_dwordx4 v[172:175], v1, s[8:11], s63 offen sc1
v_mfma_f32_16x16x32_bf16 v[152:155], a[8:11], v[104:107], v[152:155]
s_waitcnt lgkmcnt(5)
ds_read_b64_tr_b16 a[44:45], v15 offset:53248
ds_read_b64_tr_b16 a[46:47], v15 offset:55296
v_mfma_f32_16x16x32_bf16 v[152:155], a[12:15], v[108:111], v[152:155]
ds_read_b64_tr_b16 a[48:49], v15 offset:40960
v_cvt_pk_bf16_f32 v176, v128, v129
v_mfma_f32_16x16x32_bf16 v[144:147], a[12:15], v[76:79], v[144:147]
ds_read_b64_tr_b16 a[50:51], v15 offset:43008
ds_read_b64_tr_b16 a[52:53], v15 offset:45056
v_mfma_f32_16x16x32_bf16 v[144:147], a[8:11], v[72:75], v[144:147]
ds_read_b64_tr_b16 a[54:55], v15 offset:47104
v_cvt_pk_bf16_f32 v177, v130, v131
v_mfma_f32_16x16x32_bf16 v[144:147], a[16:19], v[80:83], v[144:147]
ds_read_b64_tr_b16 a[56:57], v15 offset:57344
ds_read_b64_tr_b16 a[58:59], v15 offset:59392
v_mfma_f32_16x16x32_bf16 v[144:147], a[20:23], v[84:87], v[144:147]
ds_read_b64_tr_b16 a[60:61], v15 offset:61440
ds_read_b64_tr_b16 a[62:63], v15 offset:63488
v_mfma_f32_16x16x32_bf16 v[152:155], a[20:23], v[116:119], v[152:155]
buffer_load_dwordx4 v40, s[16:19], s70 offen offset:2048 sc1 lds
v_mfma_f32_16x16x32_bf16 v[152:155], a[16:19], v[112:115], v[152:155]
v_xor_b32 v12, 0x10000, v12
v_cvt_pk_bf16_f32 v178, v132, v133
v_mfma_f32_16x16x32_bf16 v[152:155], a[24:27], v[120:123], v[152:155]
buffer_load_dwordx4 v41, s[16:19], s70 offen offset:3072 sc1 lds
v_mfma_f32_16x16x32_bf16 v[152:155], a[28:31], v[124:127], v[152:155]
s_add_u32 s101, s101, s71
v_xor_b32 v13, 0x10000, v13
v_cvt_pk_bf16_f32 v179, v134, v135
v_mfma_f32_16x16x32_bf16 v[144:147], a[28:31], v[92:95], v[144:147]
s_add_u32 s70, s70, s71
v_mfma_f32_16x16x32_bf16 v[144:147], a[24:27], v[88:91], v[144:147]
s_waitcnt lgkmcnt(2)
s_add_u32 s94, s94, 32768
v_xor_b32 v14, 0x10000, v14
v_xor_b32 v15, 0x10000, v15
v_mfma_f32_16x16x32_bf16 v[148:151], a[32:35], v[64:67], 0
s_and_b32 s94, s94, 0x1ffff
v_mfma_f32_16x16x32_bf16 v[148:151], a[36:39], v[68:71], v[148:151]
v_cvt_pk_bf16_f32 v180, v136, v137
v_cvt_pk_bf16_f32 v181, v138, v139
v_mfma_f32_16x16x32_bf16 v[156:159], a[36:39], v[100:103], 0
s_waitcnt vmcnt(20) lgkmcnt(0)
v_mfma_f32_16x16x32_bf16 v[156:159], a[32:35], v[96:99], v[156:159]
s_barrier
v_mfma_f32_16x16x32_bf16 v[156:159], a[40:43], v[104:107], v[156:159]
ds_read_b64_tr_b16 a[0:1], v12 offset:0
v_cvt_pk_bf16_f32 v182, v140, v141
v_mfma_f32_16x16x32_bf16 v[156:159], a[44:47], v[108:111], v[156:159]
ds_read_b64_tr_b16 a[2:3], v12 offset:2048
v_mfma_f32_16x16x32_bf16 v[148:151], a[44:47], v[76:79], v[148:151]
ds_read_b64_tr_b16 a[4:5], v12 offset:4096
v_mfma_f32_16x16x32_bf16 v[148:151], a[40:43], v[72:75], v[148:151]
ds_read_b64_tr_b16 a[6:7], v12 offset:6144
v_cvt_pk_bf16_f32 v183, v142, v143
v_mfma_f32_16x16x32_bf16 v[148:151], a[48:51], v[80:83], v[148:151]
s_add_u32 s63, s100, 32768
ds_read_b64_tr_b16 a[8:9], v12 offset:16384
v_mfma_f32_16x16x32_bf16 v[148:151], a[52:55], v[84:87], v[148:151]
ds_read_b64_tr_b16 a[10:11], v12 offset:18432
v_mfma_f32_16x16x32_bf16 v[156:159], a[52:55], v[116:119], v[156:159]
ds_read_b64_tr_b16 a[12:13], v12 offset:20480
v_mfma_f32_16x16x32_bf16 v[156:159], a[48:51], v[112:115], v[156:159]
ds_read_b64_tr_b16 a[14:15], v12 offset:22528
v_mfma_f32_16x16x32_bf16 v[156:159], a[56:59], v[120:123], v[156:159]
buffer_store_dwordx4 v[176:179], v1, s[8:11], s63 offen sc1
v_mfma_f32_16x16x32_bf16 v[156:159], a[60:63], v[124:127], v[156:159]
s_add_u32 s63, s63, 917504
ds_read_b64_tr_b16 a[16:17], v12 offset:8192
ds_read_b64_tr_b16 a[18:19], v12 offset:10240
v_mfma_f32_16x16x32_bf16 v[148:151], a[60:63], v[92:95], v[148:151]
buffer_store_dwordx4 v[180:183], v1, s[8:11], s63 offen sc1
v_mfma_f32_16x16x32_bf16 v[148:151], a[56:59], v[88:91], v[148:151]
s_waitcnt lgkmcnt(5)
ds_read_b64_tr_b16 a[20:21], v12 offset:12288
ds_read_b64_tr_b16 a[22:23], v12 offset:14336
v_mfma_f32_16x16x32_bf16 v[128:131], a[0:3], v[64:67], 0
ds_read_b64_tr_b16 a[24:25], v12 offset:24576
ds_read_b64_tr_b16 a[26:27], v12 offset:26624
v_mfma_f32_16x16x32_bf16 v[128:131], a[4:7], v[68:71], v[128:131]
s_mov_b32 m0, s94
ds_read_b64_tr_b16 a[28:29], v12 offset:28672
ds_read_b64_tr_b16 a[30:31], v12 offset:30720
v_mfma_f32_16x16x32_bf16 v[136:139], a[4:7], v[100:103], 0
ds_read_b64_tr_b16 a[32:33], v13 offset:0
v_mfma_f32_16x16x32_bf16 v[136:139], a[0:3], v[96:99], v[136:139]
s_waitcnt lgkmcnt(9)
buffer_load_dwordx4 v38, s[16:19], s101 offen offset:0 sc1 lds
v_mfma_f32_16x16x32_bf16 v[136:139], a[8:11], v[104:107], v[136:139]
ds_read_b64_tr_b16 a[34:35], v13 offset:2048
v_cvt_pk_bf16_f32 v184, v144, v145
v_mfma_f32_16x16x32_bf16 v[136:139], a[12:15], v[108:111], v[136:139]
ds_read_b64_tr_b16 a[36:37], v13 offset:4096
ds_read_b64_tr_b16 a[38:39], v13 offset:6144
v_mfma_f32_16x16x32_bf16 v[128:131], a[12:15], v[76:79], v[128:131]
ds_read_b64_tr_b16 a[40:41], v13 offset:16384
v_cvt_pk_bf16_f32 v185, v146, v147
v_mfma_f32_16x16x32_bf16 v[128:131], a[8:11], v[72:75], v[128:131]
s_waitcnt lgkmcnt(7)
ds_read_b64_tr_b16 a[42:43], v13 offset:18432
ds_read_b64_tr_b16 a[44:45], v13 offset:20480
v_mfma_f32_16x16x32_bf16 v[128:131], a[16:19], v[80:83], v[128:131]
ds_read_b64_tr_b16 a[46:47], v13 offset:22528
v_mfma_f32_16x16x32_bf16 v[128:131], a[20:23], v[84:87], v[128:131]
buffer_load_dwordx4 v39, s[16:19], s101 offen offset:1024 sc1 lds
v_mfma_f32_16x16x32_bf16 v[136:139], a[20:23], v[116:119], v[136:139]
ds_read_b64_tr_b16 a[48:49], v13 offset:8192
v_cvt_pk_bf16_f32 v186, v148, v149
v_mfma_f32_16x16x32_bf16 v[136:139], a[16:19], v[112:115], v[136:139]
ds_read_b64_tr_b16 a[50:51], v13 offset:10240
ds_read_b64_tr_b16 a[52:53], v13 offset:12288
v_mfma_f32_16x16x32_bf16 v[136:139], a[24:27], v[120:123], v[136:139]
s_waitcnt lgkmcnt(7)
ds_read_b64_tr_b16 a[54:55], v13 offset:14336
ds_read_b64_tr_b16 a[56:57], v13 offset:24576
v_mfma_f32_16x16x32_bf16 v[136:139], a[28:31], v[124:127], v[136:139]
ds_read_b64_tr_b16 a[58:59], v13 offset:26624
v_cvt_pk_bf16_f32 v187, v150, v151
v_mfma_f32_16x16x32_bf16 v[128:131], a[28:31], v[92:95], v[128:131]
ds_read_b64_tr_b16 a[60:61], v13 offset:28672
v_mfma_f32_16x16x32_bf16 v[128:131], a[24:27], v[88:91], v[128:131]
buffer_load_dwordx4 v40, s[16:19], s101 offen offset:2048 sc1 lds
v_mfma_f32_16x16x32_bf16 v[132:135], a[32:35], v[64:67], 0
ds_read_b64_tr_b16 a[62:63], v13 offset:30720
v_cvt_pk_bf16_f32 v188, v152, v153
v_mfma_f32_16x16x32_bf16 v[132:135], a[36:39], v[68:71], v[132:135]
ds_read_b64_tr_b16 a[0:1], v14 offset:0
ds_read_b64_tr_b16 a[2:3], v14 offset:2048
v_mfma_f32_16x16x32_bf16 v[140:143], a[36:39], v[100:103], 0
ds_read_b64_tr_b16 a[4:5], v14 offset:4096
ds_read_b64_tr_b16 a[6:7], v14 offset:6144
v_mfma_f32_16x16x32_bf16 v[140:143], a[32:35], v[96:99], v[140:143]
s_waitcnt lgkmcnt(7)
ds_read_b64_tr_b16 a[8:9], v14 offset:16384
v_cvt_pk_bf16_f32 v189, v154, v155
v_mfma_f32_16x16x32_bf16 v[140:143], a[40:43], v[104:107], v[140:143]
ds_read_b64_tr_b16 a[10:11], v14 offset:18432
v_mfma_f32_16x16x32_bf16 v[140:143], a[44:47], v[108:111], v[140:143]
buffer_load_dwordx4 v41, s[16:19], s101 offen offset:3072 sc1 lds
v_mfma_f32_16x16x32_bf16 v[132:135], a[44:47], v[76:79], v[132:135]
s_add_u32 m0, s94, 4096
ds_read_b64_tr_b16 a[12:13], v14 offset:20480
ds_read_b64_tr_b16 a[14:15], v14 offset:22528
v_mfma_f32_16x16x32_bf16 v[132:135], a[40:43], v[72:75], v[132:135]
ds_read_b64_tr_b16 a[16:17], v14 offset:8192
v_cvt_pk_bf16_f32 v190, v156, v157
v_mfma_f32_16x16x32_bf16 v[132:135], a[48:51], v[80:83], v[132:135]
ds_read_b64_tr_b16 a[18:19], v14 offset:10240
ds_read_b64_tr_b16 a[20:21], v14 offset:12288
v_mfma_f32_16x16x32_bf16 v[132:135], a[52:55], v[84:87], v[132:135]
ds_read_b64_tr_b16 a[22:23], v14 offset:14336
v_cvt_pk_bf16_f32 v191, v158, v159
v_mfma_f32_16x16x32_bf16 v[140:143], a[52:55], v[116:119], v[140:143]
s_add_u32 s63, s100, 49152
ds_read_b64_tr_b16 a[24:25], v14 offset:24576
v_mfma_f32_16x16x32_bf16 v[140:143], a[48:51], v[112:115], v[140:143]
s_waitcnt lgkmcnt(7)
buffer_load_dwordx4 v38, s[16:19], s70 offen offset:0 sc1 lds
v_mfma_f32_16x16x32_bf16 v[140:143], a[56:59], v[120:123], v[140:143]
ds_read_b64_tr_b16 a[26:27], v14 offset:26624
ds_read_b64_tr_b16 a[28:29], v14 offset:28672
v_mfma_f32_16x16x32_bf16 v[140:143], a[60:63], v[124:127], v[140:143]
ds_read_b64_tr_b16 a[30:31], v14 offset:30720
ds_read_b64_tr_b16 a[32:33], v15 offset:0
v_mfma_f32_16x16x32_bf16 v[132:135], a[60:63], v[92:95], v[132:135]
ds_read_b64_tr_b16 a[34:35], v15 offset:2048
v_mfma_f32_16x16x32_bf16 v[132:135], a[56:59], v[88:91], v[132:135]
buffer_store_dwordx4 v[184:187], v1, s[8:11], s63 offen sc1
v_mfma_f32_16x16x32_bf16 v[144:147], a[0:3], v[64:67], 0
s_add_u32 s63, s63, 917504
ds_read_b64_tr_b16 a[36:37], v15 offset:4096
ds_read_b64_tr_b16 a[38:39], v15 offset:6144
v_mfma_f32_16x16x32_bf16 v[144:147], a[4:7], v[68:71], v[144:147]
buffer_load_dwordx4 v39, s[16:19], s70 offen offset:1024 sc1 lds
v_mfma_f32_16x16x32_bf16 v[152:155], a[4:7], v[100:103], 0
ds_read_b64_tr_b16 a[40:41], v15 offset:16384
ds_read_b64_tr_b16 a[42:43], v15 offset:18432
v_mfma_f32_16x16x32_bf16 v[152:155], a[0:3], v[96:99], v[152:155]
buffer_store_dwordx4 v[188:191], v1, s[8:11], s63 offen sc1
v_mfma_f32_16x16x32_bf16 v[152:155], a[8:11], v[104:107], v[152:155]
s_waitcnt lgkmcnt(5)
ds_read_b64_tr_b16 a[44:45], v15 offset:20480
ds_read_b64_tr_b16 a[46:47], v15 offset:22528
v_mfma_f32_16x16x32_bf16 v[152:155], a[12:15], v[108:111], v[152:155]
ds_read_b64_tr_b16 a[48:49], v15 offset:8192
v_cvt_pk_bf16_f32 v192, v128, v129
v_mfma_f32_16x16x32_bf16 v[144:147], a[12:15], v[76:79], v[144:147]
ds_read_b64_tr_b16 a[50:51], v15 offset:10240
ds_read_b64_tr_b16 a[52:53], v15 offset:12288
v_mfma_f32_16x16x32_bf16 v[144:147], a[8:11], v[72:75], v[144:147]
ds_read_b64_tr_b16 a[54:55], v15 offset:14336
v_cvt_pk_bf16_f32 v193, v130, v131
v_mfma_f32_16x16x32_bf16 v[144:147], a[16:19], v[80:83], v[144:147]
ds_read_b64_tr_b16 a[56:57], v15 offset:24576
ds_read_b64_tr_b16 a[58:59], v15 offset:26624
v_mfma_f32_16x16x32_bf16 v[144:147], a[20:23], v[84:87], v[144:147]
ds_read_b64_tr_b16 a[60:61], v15 offset:28672
ds_read_b64_tr_b16 a[62:63], v15 offset:30720
v_mfma_f32_16x16x32_bf16 v[152:155], a[20:23], v[116:119], v[152:155]
buffer_load_dwordx4 v40, s[16:19], s70 offen offset:2048 sc1 lds
v_mfma_f32_16x16x32_bf16 v[152:155], a[16:19], v[112:115], v[152:155]
v_cvt_pk_bf16_f32 v194, v132, v133
v_mfma_f32_16x16x32_bf16 v[152:155], a[24:27], v[120:123], v[152:155]
buffer_load_dwordx4 v41, s[16:19], s70 offen offset:3072 sc1 lds
v_mfma_f32_16x16x32_bf16 v[152:155], a[28:31], v[124:127], v[152:155]
s_add_u32 s101, s101, s71
v_mfma_f32_16x16x32_bf16 v[144:147], a[28:31], v[92:95], v[144:147]
s_add_u32 s70, s70, s71
v_cvt_pk_bf16_f32 v195, v134, v135
v_mfma_f32_16x16x32_bf16 v[144:147], a[24:27], v[88:91], v[144:147]
s_waitcnt lgkmcnt(2)
s_add_u32 s94, s94, 32768
v_mfma_f32_16x16x32_bf16 v[148:151], a[32:35], v[64:67], 0
s_and_b32 s94, s94, 0x1ffff
v_mfma_f32_16x16x32_bf16 v[148:151], a[36:39], v[68:71], v[148:151]
v_cvt_pk_bf16_f32 v196, v136, v137
v_cvt_pk_bf16_f32 v197, v138, v139
v_mfma_f32_16x16x32_bf16 v[156:159], a[36:39], v[100:103], 0
s_waitcnt vmcnt(24) lgkmcnt(0)
v_mfma_f32_16x16x32_bf16 v[156:159], a[32:35], v[96:99], v[156:159]
s_barrier
v_mfma_f32_16x16x32_bf16 v[156:159], a[40:43], v[104:107], v[156:159]
ds_read_b64_tr_b16 a[0:1], v12 offset:32768
v_cvt_pk_bf16_f32 v198, v140, v141
v_mfma_f32_16x16x32_bf16 v[156:159], a[44:47], v[108:111], v[156:159]
ds_read_b64_tr_b16 a[2:3], v12 offset:34816
v_mfma_f32_16x16x32_bf16 v[148:151], a[44:47], v[76:79], v[148:151]
ds_read_b64_tr_b16 a[4:5], v12 offset:36864
v_mfma_f32_16x16x32_bf16 v[148:151], a[40:43], v[72:75], v[148:151]
ds_read_b64_tr_b16 a[6:7], v12 offset:38912
v_cvt_pk_bf16_f32 v199, v142, v143
v_mfma_f32_16x16x32_bf16 v[148:151], a[48:51], v[80:83], v[148:151]
s_add_u32 s63, s100, 65536
ds_read_b64_tr_b16 a[8:9], v12 offset:49152
v_mfma_f32_16x16x32_bf16 v[148:151], a[52:55], v[84:87], v[148:151]
ds_read_b64_tr_b16 a[10:11], v12 offset:51200
v_mfma_f32_16x16x32_bf16 v[156:159], a[52:55], v[116:119], v[156:159]
ds_read_b64_tr_b16 a[12:13], v12 offset:53248
v_mfma_f32_16x16x32_bf16 v[156:159], a[48:51], v[112:115], v[156:159]
ds_read_b64_tr_b16 a[14:15], v12 offset:55296
v_mfma_f32_16x16x32_bf16 v[156:159], a[56:59], v[120:123], v[156:159]
buffer_store_dwordx4 v[192:195], v1, s[8:11], s63 offen sc1
v_mfma_f32_16x16x32_bf16 v[156:159], a[60:63], v[124:127], v[156:159]
s_add_u32 s63, s63, 917504
ds_read_b64_tr_b16 a[16:17], v12 offset:40960
ds_read_b64_tr_b16 a[18:19], v12 offset:43008
v_mfma_f32_16x16x32_bf16 v[148:151], a[60:63], v[92:95], v[148:151]
buffer_store_dwordx4 v[196:199], v1, s[8:11], s63 offen sc1
v_mfma_f32_16x16x32_bf16 v[148:151], a[56:59], v[88:91], v[148:151]
s_waitcnt lgkmcnt(5)
ds_read_b64_tr_b16 a[20:21], v12 offset:45056
ds_read_b64_tr_b16 a[22:23], v12 offset:47104
v_mfma_f32_16x16x32_bf16 v[128:131], a[0:3], v[64:67], 0
ds_read_b64_tr_b16 a[24:25], v12 offset:57344
ds_read_b64_tr_b16 a[26:27], v12 offset:59392
v_mfma_f32_16x16x32_bf16 v[128:131], a[4:7], v[68:71], v[128:131]
s_mov_b32 m0, s94
ds_read_b64_tr_b16 a[28:29], v12 offset:61440
ds_read_b64_tr_b16 a[30:31], v12 offset:63488
v_mfma_f32_16x16x32_bf16 v[136:139], a[4:7], v[100:103], 0
ds_read_b64_tr_b16 a[32:33], v13 offset:32768
v_mfma_f32_16x16x32_bf16 v[136:139], a[0:3], v[96:99], v[136:139]
s_waitcnt lgkmcnt(9)
buffer_load_dwordx4 v38, s[16:19], s101 offen offset:0 sc1 lds
v_mfma_f32_16x16x32_bf16 v[136:139], a[8:11], v[104:107], v[136:139]
ds_read_b64_tr_b16 a[34:35], v13 offset:34816
v_cvt_pk_bf16_f32 v200, v144, v145
v_mfma_f32_16x16x32_bf16 v[136:139], a[12:15], v[108:111], v[136:139]
ds_read_b64_tr_b16 a[36:37], v13 offset:36864
ds_read_b64_tr_b16 a[38:39], v13 offset:38912
v_mfma_f32_16x16x32_bf16 v[128:131], a[12:15], v[76:79], v[128:131]
ds_read_b64_tr_b16 a[40:41], v13 offset:49152
v_cvt_pk_bf16_f32 v201, v146, v147
v_mfma_f32_16x16x32_bf16 v[128:131], a[8:11], v[72:75], v[128:131]
s_waitcnt lgkmcnt(7)
ds_read_b64_tr_b16 a[42:43], v13 offset:51200
ds_read_b64_tr_b16 a[44:45], v13 offset:53248
v_mfma_f32_16x16x32_bf16 v[128:131], a[16:19], v[80:83], v[128:131]
ds_read_b64_tr_b16 a[46:47], v13 offset:55296
v_mfma_f32_16x16x32_bf16 v[128:131], a[20:23], v[84:87], v[128:131]
buffer_load_dwordx4 v39, s[16:19], s101 offen offset:1024 sc1 lds
v_mfma_f32_16x16x32_bf16 v[136:139], a[20:23], v[116:119], v[136:139]
ds_read_b64_tr_b16 a[48:49], v13 offset:40960
v_cvt_pk_bf16_f32 v202, v148, v149
v_mfma_f32_16x16x32_bf16 v[136:139], a[16:19], v[112:115], v[136:139]
ds_read_b64_tr_b16 a[50:51], v13 offset:43008
ds_read_b64_tr_b16 a[52:53], v13 offset:45056
v_mfma_f32_16x16x32_bf16 v[136:139], a[24:27], v[120:123], v[136:139]
s_waitcnt lgkmcnt(7)
ds_read_b64_tr_b16 a[54:55], v13 offset:47104
ds_read_b64_tr_b16 a[56:57], v13 offset:57344
v_mfma_f32_16x16x32_bf16 v[136:139], a[28:31], v[124:127], v[136:139]
ds_read_b64_tr_b16 a[58:59], v13 offset:59392
v_cvt_pk_bf16_f32 v203, v150, v151
v_mfma_f32_16x16x32_bf16 v[128:131], a[28:31], v[92:95], v[128:131]
ds_read_b64_tr_b16 a[60:61], v13 offset:61440
v_mfma_f32_16x16x32_bf16 v[128:131], a[24:27], v[88:91], v[128:131]
buffer_load_dwordx4 v40, s[16:19], s101 offen offset:2048 sc1 lds
v_mfma_f32_16x16x32_bf16 v[132:135], a[32:35], v[64:67], 0
ds_read_b64_tr_b16 a[62:63], v13 offset:63488
v_cvt_pk_bf16_f32 v204, v152, v153
v_mfma_f32_16x16x32_bf16 v[132:135], a[36:39], v[68:71], v[132:135]
ds_read_b64_tr_b16 a[0:1], v14 offset:32768
ds_read_b64_tr_b16 a[2:3], v14 offset:34816
v_mfma_f32_16x16x32_bf16 v[140:143], a[36:39], v[100:103], 0
ds_read_b64_tr_b16 a[4:5], v14 offset:36864
ds_read_b64_tr_b16 a[6:7], v14 offset:38912
v_mfma_f32_16x16x32_bf16 v[140:143], a[32:35], v[96:99], v[140:143]
s_waitcnt lgkmcnt(7)
ds_read_b64_tr_b16 a[8:9], v14 offset:49152
v_cvt_pk_bf16_f32 v205, v154, v155
v_mfma_f32_16x16x32_bf16 v[140:143], a[40:43], v[104:107], v[140:143]
ds_read_b64_tr_b16 a[10:11], v14 offset:51200
v_mfma_f32_16x16x32_bf16 v[140:143], a[44:47], v[108:111], v[140:143]
buffer_load_dwordx4 v41, s[16:19], s101 offen offset:3072 sc1 lds
v_mfma_f32_16x16x32_bf16 v[132:135], a[44:47], v[76:79], v[132:135]
s_add_u32 m0, s94, 4096
ds_read_b64_tr_b16 a[12:13], v14 offset:53248
ds_read_b64_tr_b16 a[14:15], v14 offset:55296
v_mfma_f32_16x16x32_bf16 v[132:135], a[40:43], v[72:75], v[132:135]
ds_read_b64_tr_b16 a[16:17], v14 offset:40960
v_cvt_pk_bf16_f32 v206, v156, v157
v_mfma_f32_16x16x32_bf16 v[132:135], a[48:51], v[80:83], v[132:135]
ds_read_b64_tr_b16 a[18:19], v14 offset:43008
ds_read_b64_tr_b16 a[20:21], v14 offset:45056
v_mfma_f32_16x16x32_bf16 v[132:135], a[52:55], v[84:87], v[132:135]
ds_read_b64_tr_b16 a[22:23], v14 offset:47104
v_cvt_pk_bf16_f32 v207, v158, v159
v_mfma_f32_16x16x32_bf16 v[140:143], a[52:55], v[116:119], v[140:143]
s_add_u32 s63, s100, 81920
ds_read_b64_tr_b16 a[24:25], v14 offset:57344
v_mfma_f32_16x16x32_bf16 v[140:143], a[48:51], v[112:115], v[140:143]
s_waitcnt lgkmcnt(7)
buffer_load_dwordx4 v38, s[16:19], s70 offen offset:0 sc1 lds
v_mfma_f32_16x16x32_bf16 v[140:143], a[56:59], v[120:123], v[140:143]
ds_read_b64_tr_b16 a[26:27], v14 offset:59392
ds_read_b64_tr_b16 a[28:29], v14 offset:61440
v_mfma_f32_16x16x32_bf16 v[140:143], a[60:63], v[124:127], v[140:143]
ds_read_b64_tr_b16 a[30:31], v14 offset:63488
ds_read_b64_tr_b16 a[32:33], v15 offset:32768
v_mfma_f32_16x16x32_bf16 v[132:135], a[60:63], v[92:95], v[132:135]
ds_read_b64_tr_b16 a[34:35], v15 offset:34816
v_mfma_f32_16x16x32_bf16 v[132:135], a[56:59], v[88:91], v[132:135]
buffer_store_dwordx4 v[200:203], v1, s[8:11], s63 offen sc1
v_mfma_f32_16x16x32_bf16 v[144:147], a[0:3], v[64:67], 0
s_add_u32 s63, s63, 917504
ds_read_b64_tr_b16 a[36:37], v15 offset:36864
ds_read_b64_tr_b16 a[38:39], v15 offset:38912
v_mfma_f32_16x16x32_bf16 v[144:147], a[4:7], v[68:71], v[144:147]
buffer_load_dwordx4 v39, s[16:19], s70 offen offset:1024 sc1 lds
v_mfma_f32_16x16x32_bf16 v[152:155], a[4:7], v[100:103], 0
ds_read_b64_tr_b16 a[40:41], v15 offset:49152
ds_read_b64_tr_b16 a[42:43], v15 offset:51200
v_mfma_f32_16x16x32_bf16 v[152:155], a[0:3], v[96:99], v[152:155]
buffer_store_dwordx4 v[204:207], v1, s[8:11], s63 offen sc1
v_mfma_f32_16x16x32_bf16 v[152:155], a[8:11], v[104:107], v[152:155]
s_waitcnt lgkmcnt(5)
ds_read_b64_tr_b16 a[44:45], v15 offset:53248
ds_read_b64_tr_b16 a[46:47], v15 offset:55296
v_mfma_f32_16x16x32_bf16 v[152:155], a[12:15], v[108:111], v[152:155]
ds_read_b64_tr_b16 a[48:49], v15 offset:40960
v_cvt_pk_bf16_f32 v208, v128, v129
v_mfma_f32_16x16x32_bf16 v[144:147], a[12:15], v[76:79], v[144:147]
ds_read_b64_tr_b16 a[50:51], v15 offset:43008
ds_read_b64_tr_b16 a[52:53], v15 offset:45056
v_mfma_f32_16x16x32_bf16 v[144:147], a[8:11], v[72:75], v[144:147]
ds_read_b64_tr_b16 a[54:55], v15 offset:47104
v_cvt_pk_bf16_f32 v209, v130, v131
v_mfma_f32_16x16x32_bf16 v[144:147], a[16:19], v[80:83], v[144:147]
ds_read_b64_tr_b16 a[56:57], v15 offset:57344
ds_read_b64_tr_b16 a[58:59], v15 offset:59392
v_mfma_f32_16x16x32_bf16 v[144:147], a[20:23], v[84:87], v[144:147]
ds_read_b64_tr_b16 a[60:61], v15 offset:61440
ds_read_b64_tr_b16 a[62:63], v15 offset:63488
v_mfma_f32_16x16x32_bf16 v[152:155], a[20:23], v[116:119], v[152:155]
buffer_load_dwordx4 v40, s[16:19], s70 offen offset:2048 sc1 lds
v_mfma_f32_16x16x32_bf16 v[152:155], a[16:19], v[112:115], v[152:155]
v_xor_b32 v12, 0x10000, v12
v_cvt_pk_bf16_f32 v210, v132, v133
v_mfma_f32_16x16x32_bf16 v[152:155], a[24:27], v[120:123], v[152:155]
buffer_load_dwordx4 v41, s[16:19], s70 offen offset:3072 sc1 lds
v_mfma_f32_16x16x32_bf16 v[152:155], a[28:31], v[124:127], v[152:155]
s_add_u32 s101, s101, s71
v_xor_b32 v13, 0x10000, v13
v_cvt_pk_bf16_f32 v211, v134, v135
v_mfma_f32_16x16x32_bf16 v[144:147], a[28:31], v[92:95], v[144:147]
s_add_u32 s70, s70, s71
v_mfma_f32_16x16x32_bf16 v[144:147], a[24:27], v[88:91], v[144:147]
s_waitcnt lgkmcnt(2)
s_add_u32 s94, s94, 32768
v_xor_b32 v14, 0x10000, v14
v_xor_b32 v15, 0x10000, v15
v_mfma_f32_16x16x32_bf16 v[148:151], a[32:35], v[64:67], 0
s_and_b32 s94, s94, 0x1ffff
v_mfma_f32_16x16x32_bf16 v[148:151], a[36:39], v[68:71], v[148:151]
v_cvt_pk_bf16_f32 v212, v136, v137
v_cvt_pk_bf16_f32 v213, v138, v139
v_mfma_f32_16x16x32_bf16 v[156:159], a[36:39], v[100:103], 0
s_waitcnt vmcnt(24) lgkmcnt(0)
v_mfma_f32_16x16x32_bf16 v[156:159], a[32:35], v[96:99], v[156:159]
s_barrier
v_mfma_f32_16x16x32_bf16 v[156:159], a[40:43], v[104:107], v[156:159]
ds_read_b64_tr_b16 a[0:1], v12 offset:0
v_cvt_pk_bf16_f32 v214, v140, v141
v_mfma_f32_16x16x32_bf16 v[156:159], a[44:47], v[108:111], v[156:159]
ds_read_b64_tr_b16 a[2:3], v12 offset:2048
v_mfma_f32_16x16x32_bf16 v[148:151], a[44:47], v[76:79], v[148:151]
ds_read_b64_tr_b16 a[4:5], v12 offset:4096
v_mfma_f32_16x16x32_bf16 v[148:151], a[40:43], v[72:75], v[148:151]
ds_read_b64_tr_b16 a[6:7], v12 offset:6144
v_cvt_pk_bf16_f32 v215, v142, v143
v_mfma_f32_16x16x32_bf16 v[148:151], a[48:51], v[80:83], v[148:151]
s_add_u32 s63, s100, 98304
ds_read_b64_tr_b16 a[8:9], v12 offset:16384
v_mfma_f32_16x16x32_bf16 v[148:151], a[52:55], v[84:87], v[148:151]
ds_read_b64_tr_b16 a[10:11], v12 offset:18432
v_mfma_f32_16x16x32_bf16 v[156:159], a[52:55], v[116:119], v[156:159]
ds_read_b64_tr_b16 a[12:13], v12 offset:20480
v_mfma_f32_16x16x32_bf16 v[156:159], a[48:51], v[112:115], v[156:159]
ds_read_b64_tr_b16 a[14:15], v12 offset:22528
v_mfma_f32_16x16x32_bf16 v[156:159], a[56:59], v[120:123], v[156:159]
buffer_store_dwordx4 v[208:211], v1, s[8:11], s63 offen sc1
v_mfma_f32_16x16x32_bf16 v[156:159], a[60:63], v[124:127], v[156:159]
s_add_u32 s63, s63, 917504
ds_read_b64_tr_b16 a[16:17], v12 offset:8192
ds_read_b64_tr_b16 a[18:19], v12 offset:10240
v_mfma_f32_16x16x32_bf16 v[148:151], a[60:63], v[92:95], v[148:151]
buffer_store_dwordx4 v[212:215], v1, s[8:11], s63 offen sc1
v_mfma_f32_16x16x32_bf16 v[148:151], a[56:59], v[88:91], v[148:151]
s_waitcnt lgkmcnt(5)
ds_read_b64_tr_b16 a[20:21], v12 offset:12288
ds_read_b64_tr_b16 a[22:23], v12 offset:14336
v_mfma_f32_16x16x32_bf16 v[128:131], a[0:3], v[64:67], 0
ds_read_b64_tr_b16 a[24:25], v12 offset:24576
ds_read_b64_tr_b16 a[26:27], v12 offset:26624
v_mfma_f32_16x16x32_bf16 v[128:131], a[4:7], v[68:71], v[128:131]
ds_read_b64_tr_b16 a[28:29], v12 offset:28672
ds_read_b64_tr_b16 a[30:31], v12 offset:30720
v_mfma_f32_16x16x32_bf16 v[136:139], a[4:7], v[100:103], 0
ds_read_b64_tr_b16 a[32:33], v13 offset:0
v_mfma_f32_16x16x32_bf16 v[136:139], a[0:3], v[96:99], v[136:139]
s_waitcnt lgkmcnt(9)
ds_read_b64_tr_b16 a[34:35], v13 offset:2048
v_mfma_f32_16x16x32_bf16 v[136:139], a[8:11], v[104:107], v[136:139]
ds_read_b64_tr_b16 a[36:37], v13 offset:4096
v_cvt_pk_bf16_f32 v216, v144, v145
v_mfma_f32_16x16x32_bf16 v[136:139], a[12:15], v[108:111], v[136:139]
ds_read_b64_tr_b16 a[38:39], v13 offset:6144
v_mfma_f32_16x16x32_bf16 v[128:131], a[12:15], v[76:79], v[128:131]
ds_read_b64_tr_b16 a[40:41], v13 offset:16384
v_cvt_pk_bf16_f32 v217, v146, v147
v_mfma_f32_16x16x32_bf16 v[128:131], a[8:11], v[72:75], v[128:131]
s_waitcnt lgkmcnt(7)
ds_read_b64_tr_b16 a[42:43], v13 offset:18432
ds_read_b64_tr_b16 a[44:45], v13 offset:20480
v_mfma_f32_16x16x32_bf16 v[128:131], a[16:19], v[80:83], v[128:131]
ds_read_b64_tr_b16 a[46:47], v13 offset:22528
v_mfma_f32_16x16x32_bf16 v[128:131], a[20:23], v[84:87], v[128:131]
ds_read_b64_tr_b16 a[48:49], v13 offset:8192
v_cvt_pk_bf16_f32 v218, v148, v149
v_mfma_f32_16x16x32_bf16 v[136:139], a[20:23], v[116:119], v[136:139]
ds_read_b64_tr_b16 a[50:51], v13 offset:10240
v_mfma_f32_16x16x32_bf16 v[136:139], a[16:19], v[112:115], v[136:139]
ds_read_b64_tr_b16 a[52:53], v13 offset:12288
v_mfma_f32_16x16x32_bf16 v[136:139], a[24:27], v[120:123], v[136:139]
s_waitcnt lgkmcnt(7)
ds_read_b64_tr_b16 a[54:55], v13 offset:14336
ds_read_b64_tr_b16 a[56:57], v13 offset:24576
v_mfma_f32_16x16x32_bf16 v[136:139], a[28:31], v[124:127], v[136:139]
ds_read_b64_tr_b16 a[58:59], v13 offset:26624
v_cvt_pk_bf16_f32 v219, v150, v151
v_mfma_f32_16x16x32_bf16 v[128:131], a[28:31], v[92:95], v[128:131]
ds_read_b64_tr_b16 a[60:61], v13 offset:28672
v_mfma_f32_16x16x32_bf16 v[128:131], a[24:27], v[88:91], v[128:131]
ds_read_b64_tr_b16 a[62:63], v13 offset:30720
v_mfma_f32_16x16x32_bf16 v[132:135], a[32:35], v[64:67], 0
ds_read_b64_tr_b16 a[0:1], v14 offset:0
v_cvt_pk_bf16_f32 v220, v152, v153
v_mfma_f32_16x16x32_bf16 v[132:135], a[36:39], v[68:71], v[132:135]
ds_read_b64_tr_b16 a[2:3], v14 offset:2048
ds_read_b64_tr_b16 a[4:5], v14 offset:4096
v_mfma_f32_16x16x32_bf16 v[140:143], a[36:39], v[100:103], 0
ds_read_b64_tr_b16 a[6:7], v14 offset:6144
v_mfma_f32_16x16x32_bf16 v[140:143], a[32:35], v[96:99], v[140:143]
s_waitcnt lgkmcnt(7)
ds_read_b64_tr_b16 a[8:9], v14 offset:16384
v_cvt_pk_bf16_f32 v221, v154, v155
v_mfma_f32_16x16x32_bf16 v[140:143], a[40:43], v[104:107], v[140:143]
ds_read_b64_tr_b16 a[10:11], v14 offset:18432
v_mfma_f32_16x16x32_bf16 v[140:143], a[44:47], v[108:111], v[140:143]
ds_read_b64_tr_b16 a[12:13], v14 offset:20480
v_mfma_f32_16x16x32_bf16 v[132:135], a[44:47], v[76:79], v[132:135]
ds_read_b64_tr_b16 a[14:15], v14 offset:22528
v_cvt_pk_bf16_f32 v222, v156, v157
v_mfma_f32_16x16x32_bf16 v[132:135], a[40:43], v[72:75], v[132:135]
ds_read_b64_tr_b16 a[16:17], v14 offset:8192
ds_read_b64_tr_b16 a[18:19], v14 offset:10240
v_mfma_f32_16x16x32_bf16 v[132:135], a[48:51], v[80:83], v[132:135]
ds_read_b64_tr_b16 a[20:21], v14 offset:12288
v_mfma_f32_16x16x32_bf16 v[132:135], a[52:55], v[84:87], v[132:135]
ds_read_b64_tr_b16 a[22:23], v14 offset:14336
v_cvt_pk_bf16_f32 v223, v158, v159
v_mfma_f32_16x16x32_bf16 v[140:143], a[52:55], v[116:119], v[140:143]
s_add_u32 s63, s100, 114688
ds_read_b64_tr_b16 a[24:25], v14 offset:24576
v_mfma_f32_16x16x32_bf16 v[140:143], a[48:51], v[112:115], v[140:143]
s_waitcnt lgkmcnt(7)
ds_read_b64_tr_b16 a[26:27], v14 offset:26624
v_mfma_f32_16x16x32_bf16 v[140:143], a[56:59], v[120:123], v[140:143]
ds_read_b64_tr_b16 a[28:29], v14 offset:28672
ds_read_b64_tr_b16 a[30:31], v14 offset:30720
v_mfma_f32_16x16x32_bf16 v[140:143], a[60:63], v[124:127], v[140:143]
ds_read_b64_tr_b16 a[32:33], v15 offset:0
v_mfma_f32_16x16x32_bf16 v[132:135], a[60:63], v[92:95], v[132:135]
s_mov_b64 s[16:17], s[50:51]
s_cmp_lt_u32 s62, 8
s_cselect_b64 vcc, -1, 0
s_cselect_b32 s18, 401408, 0
v_mfma_f32_16x16x32_bf16 v[132:135], a[56:59], v[88:91], v[132:135]
ds_read_b64_tr_b16 a[34:35], v15 offset:2048
ds_read_b64_tr_b16 a[36:37], v15 offset:4096
v_mfma_f32_16x16x32_bf16 v[144:147], a[0:3], v[64:67], 0
s_cmp_gt_u32 s84, 6
s_subb_u32 s101, s84, 0
s_lshl_b32 s101, s101, 7
v_mfma_f32_16x16x32_bf16 v[144:147], a[4:7], v[68:71], v[144:147]
buffer_store_dwordx4 v[216:219], v1, s[8:11], s63 offen sc1
v_mfma_f32_16x16x32_bf16 v[152:155], a[4:7], v[100:103], 0
s_add_u32 s70, s101, 28672
s_mov_b32 s71, 229376
s_add_u32 s94, s94, 32768
s_and_b32 s94, s94, 0x1ffff
s_add_u32 s63, s63, 917504
v_mfma_f32_16x16x32_bf16 v[152:155], a[0:3], v[96:99], v[152:155]
buffer_store_dwordx4 v[220:223], v1, s[8:11], s63 offen sc1
ds_read_b64_tr_b16 a[38:39], v15 offset:6144
v_mfma_f32_16x16x32_bf16 v[152:155], a[8:11], v[104:107], v[152:155]
s_waitcnt lgkmcnt(3)
ds_read_b64_tr_b16 a[40:41], v15 offset:16384
ds_read_b64_tr_b16 a[42:43], v15 offset:18432
v_mfma_f32_16x16x32_bf16 v[152:155], a[12:15], v[108:111], v[152:155]
ds_read_b64_tr_b16 a[44:45], v15 offset:20480
ds_read_b64_tr_b16 a[46:47], v15 offset:22528
v_mfma_f32_16x16x32_bf16 v[144:147], a[12:15], v[76:79], v[144:147]
ds_read_b64_tr_b16 a[48:49], v15 offset:8192
ds_read_b64_tr_b16 a[50:51], v15 offset:10240
v_mfma_f32_16x16x32_bf16 v[144:147], a[8:11], v[72:75], v[144:147]
ds_read_b64_tr_b16 a[52:53], v15 offset:12288
ds_read_b64_tr_b16 a[54:55], v15 offset:14336
v_mfma_f32_16x16x32_bf16 v[144:147], a[16:19], v[80:83], v[144:147]
ds_read_b64_tr_b16 a[56:57], v15 offset:24576
ds_read_b64_tr_b16 a[58:59], v15 offset:26624
v_mfma_f32_16x16x32_bf16 v[144:147], a[20:23], v[84:87], v[144:147]
ds_read_b64_tr_b16 a[60:61], v15 offset:28672
ds_read_b64_tr_b16 a[62:63], v15 offset:30720
v_mfma_f32_16x16x32_bf16 v[152:155], a[20:23], v[116:119], v[152:155]
v_cvt_pk_bf16_f32 v224, v128, v129
v_cvt_pk_bf16_f32 v225, v130, v131
v_mfma_f32_16x16x32_bf16 v[152:155], a[16:19], v[112:115], v[152:155]
v_cvt_pk_bf16_f32 v226, v132, v133
v_mfma_f32_16x16x32_bf16 v[152:155], a[24:27], v[120:123], v[152:155]
v_mfma_f32_16x16x32_bf16 v[152:155], a[28:31], v[124:127], v[152:155]
v_mfma_f32_16x16x32_bf16 v[144:147], a[28:31], v[92:95], v[144:147]
v_cvt_pk_bf16_f32 v227, v134, v135
v_mfma_f32_16x16x32_bf16 v[144:147], a[24:27], v[88:91], v[144:147]
s_waitcnt lgkmcnt(2)
v_mfma_f32_16x16x32_bf16 v[148:151], a[32:35], v[64:67], 0
v_mfma_f32_16x16x32_bf16 v[148:151], a[36:39], v[68:71], v[148:151]
v_cvt_pk_bf16_f32 v228, v136, v137
v_cvt_pk_bf16_f32 v229, v138, v139
v_mfma_f32_16x16x32_bf16 v[156:159], a[36:39], v[100:103], 0
s_waitcnt vmcnt(16) lgkmcnt(0)
v_mfma_f32_16x16x32_bf16 v[156:159], a[32:35], v[96:99], v[156:159]
s_barrier
v_mfma_f32_16x16x32_bf16 v[156:159], a[40:43], v[104:107], v[156:159]
ds_read_b64_tr_b16 a[0:1], v12 offset:32768
v_cvt_pk_bf16_f32 v230, v140, v141
v_mfma_f32_16x16x32_bf16 v[156:159], a[44:47], v[108:111], v[156:159]
ds_read_b64_tr_b16 a[2:3], v12 offset:34816
v_mfma_f32_16x16x32_bf16 v[148:151], a[44:47], v[76:79], v[148:151]
ds_read_b64_tr_b16 a[4:5], v12 offset:36864
v_mfma_f32_16x16x32_bf16 v[148:151], a[40:43], v[72:75], v[148:151]
ds_read_b64_tr_b16 a[6:7], v12 offset:38912
v_cvt_pk_bf16_f32 v231, v142, v143
v_mfma_f32_16x16x32_bf16 v[148:151], a[48:51], v[80:83], v[148:151]
s_add_u32 s63, s100, 131072
ds_read_b64_tr_b16 a[8:9], v12 offset:49152
v_mfma_f32_16x16x32_bf16 v[148:151], a[52:55], v[84:87], v[148:151]
ds_read_b64_tr_b16 a[10:11], v12 offset:51200
v_mfma_f32_16x16x32_bf16 v[156:159], a[52:55], v[116:119], v[156:159]
ds_read_b64_tr_b16 a[12:13], v12 offset:53248
v_mfma_f32_16x16x32_bf16 v[156:159], a[48:51], v[112:115], v[156:159]
ds_read_b64_tr_b16 a[14:15], v12 offset:55296
v_mfma_f32_16x16x32_bf16 v[156:159], a[56:59], v[120:123], v[156:159]
buffer_store_dwordx4 v[224:227], v1, s[8:11], s63 offen sc1
v_mfma_f32_16x16x32_bf16 v[156:159], a[60:63], v[124:127], v[156:159]
s_add_u32 s63, s63, 917504
ds_read_b64_tr_b16 a[16:17], v12 offset:40960
ds_read_b64_tr_b16 a[18:19], v12 offset:43008
v_mfma_f32_16x16x32_bf16 v[148:151], a[60:63], v[92:95], v[148:151]
buffer_store_dwordx4 v[228:231], v1, s[8:11], s63 offen sc1
v_mfma_f32_16x16x32_bf16 v[148:151], a[56:59], v[88:91], v[148:151]
s_waitcnt lgkmcnt(5)
ds_read_b64_tr_b16 a[20:21], v12 offset:45056
ds_read_b64_tr_b16 a[22:23], v12 offset:47104
v_mfma_f32_16x16x32_bf16 v[128:131], a[0:3], v[64:67], 0
ds_read_b64_tr_b16 a[24:25], v12 offset:57344
ds_read_b64_tr_b16 a[26:27], v12 offset:59392
v_mfma_f32_16x16x32_bf16 v[128:131], a[4:7], v[68:71], v[128:131]
s_mov_b32 m0, s94
ds_read_b64_tr_b16 a[28:29], v12 offset:61440
ds_read_b64_tr_b16 a[30:31], v12 offset:63488
v_mfma_f32_16x16x32_bf16 v[136:139], a[4:7], v[100:103], 0
ds_read_b64_tr_b16 a[32:33], v13 offset:32768
v_mfma_f32_16x16x32_bf16 v[136:139], a[0:3], v[96:99], v[136:139]
s_waitcnt lgkmcnt(9)
buffer_load_dwordx4 v38, s[16:19], s101 offen offset:0 sc1 lds
v_mfma_f32_16x16x32_bf16 v[136:139], a[8:11], v[104:107], v[136:139]
ds_read_b64_tr_b16 a[34:35], v13 offset:34816
v_cvt_pk_bf16_f32 v232, v144, v145
v_mfma_f32_16x16x32_bf16 v[136:139], a[12:15], v[108:111], v[136:139]
ds_read_b64_tr_b16 a[36:37], v13 offset:36864
ds_read_b64_tr_b16 a[38:39], v13 offset:38912
v_mfma_f32_16x16x32_bf16 v[128:131], a[12:15], v[76:79], v[128:131]
ds_read_b64_tr_b16 a[40:41], v13 offset:49152
v_cvt_pk_bf16_f32 v233, v146, v147
v_mfma_f32_16x16x32_bf16 v[128:131], a[8:11], v[72:75], v[128:131]
s_waitcnt lgkmcnt(7)
ds_read_b64_tr_b16 a[42:43], v13 offset:51200
ds_read_b64_tr_b16 a[44:45], v13 offset:53248
v_mfma_f32_16x16x32_bf16 v[128:131], a[16:19], v[80:83], v[128:131]
ds_read_b64_tr_b16 a[46:47], v13 offset:55296
v_mfma_f32_16x16x32_bf16 v[128:131], a[20:23], v[84:87], v[128:131]
buffer_load_dwordx4 v39, s[16:19], s101 offen offset:1024 sc1 lds
v_mfma_f32_16x16x32_bf16 v[136:139], a[20:23], v[116:119], v[136:139]
ds_read_b64_tr_b16 a[48:49], v13 offset:40960
v_cvt_pk_bf16_f32 v234, v148, v149
v_mfma_f32_16x16x32_bf16 v[136:139], a[16:19], v[112:115], v[136:139]
ds_read_b64_tr_b16 a[50:51], v13 offset:43008
ds_read_b64_tr_b16 a[52:53], v13 offset:45056
v_mfma_f32_16x16x32_bf16 v[136:139], a[24:27], v[120:123], v[136:139]
s_waitcnt lgkmcnt(7)
ds_read_b64_tr_b16 a[54:55], v13 offset:47104
ds_read_b64_tr_b16 a[56:57], v13 offset:57344
v_mfma_f32_16x16x32_bf16 v[136:139], a[28:31], v[124:127], v[136:139]
ds_read_b64_tr_b16 a[58:59], v13 offset:59392
v_cvt_pk_bf16_f32 v235, v150, v151
v_mfma_f32_16x16x32_bf16 v[128:131], a[28:31], v[92:95], v[128:131]
ds_read_b64_tr_b16 a[60:61], v13 offset:61440
v_mfma_f32_16x16x32_bf16 v[128:131], a[24:27], v[88:91], v[128:131]
buffer_load_dwordx4 v40, s[16:19], s101 offen offset:2048 sc1 lds
v_mfma_f32_16x16x32_bf16 v[132:135], a[32:35], v[64:67], 0
ds_read_b64_tr_b16 a[62:63], v13 offset:63488
v_cvt_pk_bf16_f32 v236, v152, v153
v_mfma_f32_16x16x32_bf16 v[132:135], a[36:39], v[68:71], v[132:135]
ds_read_b64_tr_b16 a[0:1], v14 offset:32768
ds_read_b64_tr_b16 a[2:3], v14 offset:34816
v_mfma_f32_16x16x32_bf16 v[140:143], a[36:39], v[100:103], 0
ds_read_b64_tr_b16 a[4:5], v14 offset:36864
ds_read_b64_tr_b16 a[6:7], v14 offset:38912
v_mfma_f32_16x16x32_bf16 v[140:143], a[32:35], v[96:99], v[140:143]
s_waitcnt lgkmcnt(7)
ds_read_b64_tr_b16 a[8:9], v14 offset:49152
v_cvt_pk_bf16_f32 v237, v154, v155
v_mfma_f32_16x16x32_bf16 v[140:143], a[40:43], v[104:107], v[140:143]
ds_read_b64_tr_b16 a[10:11], v14 offset:51200
v_mfma_f32_16x16x32_bf16 v[140:143], a[44:47], v[108:111], v[140:143]
buffer_load_dwordx4 v41, s[16:19], s101 offen offset:3072 sc1 lds
v_mfma_f32_16x16x32_bf16 v[132:135], a[44:47], v[76:79], v[132:135]
s_add_u32 m0, s94, 4096
ds_read_b64_tr_b16 a[12:13], v14 offset:53248
ds_read_b64_tr_b16 a[14:15], v14 offset:55296
v_mfma_f32_16x16x32_bf16 v[132:135], a[40:43], v[72:75], v[132:135]
ds_read_b64_tr_b16 a[16:17], v14 offset:40960
v_cvt_pk_bf16_f32 v238, v156, v157
v_mfma_f32_16x16x32_bf16 v[132:135], a[48:51], v[80:83], v[132:135]
ds_read_b64_tr_b16 a[18:19], v14 offset:43008
ds_read_b64_tr_b16 a[20:21], v14 offset:45056
v_mfma_f32_16x16x32_bf16 v[132:135], a[52:55], v[84:87], v[132:135]
ds_read_b64_tr_b16 a[22:23], v14 offset:47104
v_cvt_pk_bf16_f32 v239, v158, v159
v_mfma_f32_16x16x32_bf16 v[140:143], a[52:55], v[116:119], v[140:143]
s_add_u32 s63, s100, 147456
ds_read_b64_tr_b16 a[24:25], v14 offset:57344
v_mfma_f32_16x16x32_bf16 v[140:143], a[48:51], v[112:115], v[140:143]
s_waitcnt lgkmcnt(7)
buffer_load_dwordx4 v38, s[16:19], s70 offen offset:0 sc1 lds
v_mfma_f32_16x16x32_bf16 v[140:143], a[56:59], v[120:123], v[140:143]
ds_read_b64_tr_b16 a[26:27], v14 offset:59392
ds_read_b64_tr_b16 a[28:29], v14 offset:61440
v_mfma_f32_16x16x32_bf16 v[140:143], a[60:63], v[124:127], v[140:143]
ds_read_b64_tr_b16 a[30:31], v14 offset:63488
ds_read_b64_tr_b16 a[32:33], v15 offset:32768
v_mfma_f32_16x16x32_bf16 v[132:135], a[60:63], v[92:95], v[132:135]
s_mov_b32 s92, s62
s_lshl_b32 s95, s92, 2
s_add_u32 s95, s95, s60
s_lshl_b32 s95, s95, 7
s_add_u32 s95, s95, 12288
v_mfma_f32_16x16x32_bf16 v[132:135], a[56:59], v[88:91], v[132:135]
ds_read_b64_tr_b16 a[34:35], v15 offset:34816
ds_read_b64_tr_b16 a[36:37], v15 offset:36864
v_mfma_f32_16x16x32_bf16 v[144:147], a[0:3], v[64:67], 0
v_mov_b32 v34, 1
s_mov_b64 exec, 1
buffer_atomic_add v34, off, s[8:11], s95 sc0 sc1
s_mov_b64 exec, -1
v_mfma_f32_16x16x32_bf16 v[144:147], a[4:7], v[68:71], v[144:147]
buffer_store_dwordx4 v[232:235], v1, s[8:11], s63 offen sc1
v_mfma_f32_16x16x32_bf16 v[152:155], a[4:7], v[100:103], 0
s_add_u32 s63, s63, 917504
ds_read_b64_tr_b16 a[38:39], v15 offset:38912
ds_read_b64_tr_b16 a[40:41], v15 offset:49152
v_mfma_f32_16x16x32_bf16 v[152:155], a[0:3], v[96:99], v[152:155]
buffer_store_dwordx4 v[236:239], v1, s[8:11], s63 offen sc1
v_mfma_f32_16x16x32_bf16 v[152:155], a[8:11], v[104:107], v[152:155]
s_waitcnt lgkmcnt(4)
ds_read_b64_tr_b16 a[42:43], v15 offset:51200
ds_read_b64_tr_b16 a[44:45], v15 offset:53248
v_mfma_f32_16x16x32_bf16 v[152:155], a[12:15], v[108:111], v[152:155]
ds_read_b64_tr_b16 a[46:47], v15 offset:55296
v_cvt_pk_bf16_f32 v240, v128, v129
v_mfma_f32_16x16x32_bf16 v[144:147], a[12:15], v[76:79], v[144:147]
ds_read_b64_tr_b16 a[48:49], v15 offset:40960
ds_read_b64_tr_b16 a[50:51], v15 offset:43008
v_mfma_f32_16x16x32_bf16 v[144:147], a[8:11], v[72:75], v[144:147]
ds_read_b64_tr_b16 a[52:53], v15 offset:45056
ds_read_b64_tr_b16 a[54:55], v15 offset:47104
v_mfma_f32_16x16x32_bf16 v[144:147], a[16:19], v[80:83], v[144:147]
ds_read_b64_tr_b16 a[56:57], v15 offset:57344
ds_read_b64_tr_b16 a[58:59], v15 offset:59392
v_mfma_f32_16x16x32_bf16 v[144:147], a[20:23], v[84:87], v[144:147]
ds_read_b64_tr_b16 a[60:61], v15 offset:61440
ds_read_b64_tr_b16 a[62:63], v15 offset:63488
v_mfma_f32_16x16x32_bf16 v[152:155], a[20:23], v[116:119], v[152:155]
buffer_load_dwordx4 v39, s[16:19], s70 offen offset:1024 sc1 lds
v_mfma_f32_16x16x32_bf16 v[152:155], a[16:19], v[112:115], v[152:155]
buffer_load_dwordx4 v40, s[16:19], s70 offen offset:2048 sc1 lds
v_mfma_f32_16x16x32_bf16 v[152:155], a[24:27], v[120:123], v[152:155]
buffer_load_dwordx4 v41, s[16:19], s70 offen offset:3072 sc1 lds
v_mfma_f32_16x16x32_bf16 v[152:155], a[28:31], v[124:127], v[152:155]
s_add_u32 s101, s101, s71
v_cvt_pk_bf16_f32 v241, v130, v131
v_xor_b32 v12, 0x10000, v12
v_mfma_f32_16x16x32_bf16 v[144:147], a[28:31], v[92:95], v[144:147]
s_add_u32 s70, s70, s71
v_cvt_pk_bf16_f32 v242, v132, v133
v_xor_b32 v13, 0x10000, v13
v_mfma_f32_16x16x32_bf16 v[144:147], a[24:27], v[88:91], v[144:147]
s_waitcnt lgkmcnt(2)
s_add_u32 s94, s94, 32768
v_cvt_pk_bf16_f32 v243, v134, v135
v_xor_b32 v14, 0x10000, v14
v_mfma_f32_16x16x32_bf16 v[148:151], a[32:35], v[64:67], 0
s_and_b32 s94, s94, 0x1ffff
v_mfma_f32_16x16x32_bf16 v[148:151], a[36:39], v[68:71], v[148:151]
v_xor_b32 v15, 0x10000, v15
v_cvt_pk_bf16_f32 v244, v136, v137
v_mfma_f32_16x16x32_bf16 v[156:159], a[36:39], v[100:103], 0
s_waitcnt vmcnt(17) lgkmcnt(0)
v_mfma_f32_16x16x32_bf16 v[156:159], a[32:35], v[96:99], v[156:159]
s_barrier
v_cvt_pk_bf16_f32 v245, v138, v139
v_mfma_f32_16x16x32_bf16 v[156:159], a[40:43], v[104:107], v[156:159]
ds_read_b64_tr_b16 a[0:1], v12 offset:0
v_cvt_pk_bf16_f32 v246, v140, v141
v_mfma_f32_16x16x32_bf16 v[156:159], a[44:47], v[108:111], v[156:159]
ds_read_b64_tr_b16 a[2:3], v12 offset:2048
v_mfma_f32_16x16x32_bf16 v[148:151], a[44:47], v[76:79], v[148:151]
ds_read_b64_tr_b16 a[4:5], v12 offset:4096
v_mfma_f32_16x16x32_bf16 v[148:151], a[40:43], v[72:75], v[148:151]
ds_read_b64_tr_b16 a[6:7], v12 offset:6144
v_cvt_pk_bf16_f32 v247, v142, v143
v_mfma_f32_16x16x32_bf16 v[148:151], a[48:51], v[80:83], v[148:151]
s_add_u32 s63, s100, 163840
ds_read_b64_tr_b16 a[8:9], v12 offset:16384
v_mfma_f32_16x16x32_bf16 v[148:151], a[52:55], v[84:87], v[148:151]
ds_read_b64_tr_b16 a[10:11], v12 offset:18432
v_mfma_f32_16x16x32_bf16 v[156:159], a[52:55], v[116:119], v[156:159]
ds_read_b64_tr_b16 a[12:13], v12 offset:20480
v_mfma_f32_16x16x32_bf16 v[156:159], a[48:51], v[112:115], v[156:159]
ds_read_b64_tr_b16 a[14:15], v12 offset:22528
v_mfma_f32_16x16x32_bf16 v[156:159], a[56:59], v[120:123], v[156:159]
buffer_store_dwordx4 v[240:243], v1, s[8:11], s63 offen sc1
v_mfma_f32_16x16x32_bf16 v[156:159], a[60:63], v[124:127], v[156:159]
s_add_u32 s63, s63, 917504
ds_read_b64_tr_b16 a[16:17], v12 offset:8192
ds_read_b64_tr_b16 a[18:19], v12 offset:10240
v_mfma_f32_16x16x32_bf16 v[148:151], a[60:63], v[92:95], v[148:151]
buffer_store_dwordx4 v[244:247], v1, s[8:11], s63 offen sc1
v_mfma_f32_16x16x32_bf16 v[148:151], a[56:59], v[88:91], v[148:151]
s_waitcnt lgkmcnt(5)
ds_read_b64_tr_b16 a[20:21], v12 offset:12288
ds_read_b64_tr_b16 a[22:23], v12 offset:14336
v_mfma_f32_16x16x32_bf16 v[128:131], a[0:3], v[64:67], 0
ds_read_b64_tr_b16 a[24:25], v12 offset:24576
ds_read_b64_tr_b16 a[26:27], v12 offset:26624
v_mfma_f32_16x16x32_bf16 v[128:131], a[4:7], v[68:71], v[128:131]
s_mov_b32 m0, s94
ds_read_b64_tr_b16 a[28:29], v12 offset:28672
ds_read_b64_tr_b16 a[30:31], v12 offset:30720
v_mfma_f32_16x16x32_bf16 v[136:139], a[4:7], v[100:103], 0
ds_read_b64_tr_b16 a[32:33], v13 offset:0
v_mfma_f32_16x16x32_bf16 v[136:139], a[0:3], v[96:99], v[136:139]
s_waitcnt lgkmcnt(9)
buffer_load_dwordx4 v38, s[16:19], s101 offen offset:0 sc1 lds
v_mfma_f32_16x16x32_bf16 v[136:139], a[8:11], v[104:107], v[136:139]
ds_read_b64_tr_b16 a[34:35], v13 offset:2048
v_cvt_pk_bf16_f32 v248, v144, v145
v_mfma_f32_16x16x32_bf16 v[136:139], a[12:15], v[108:111], v[136:139]
ds_read_b64_tr_b16 a[36:37], v13 offset:4096
ds_read_b64_tr_b16 a[38:39], v13 offset:6144
v_mfma_f32_16x16x32_bf16 v[128:131], a[12:15], v[76:79], v[128:131]
ds_read_b64_tr_b16 a[40:41], v13 offset:16384
v_cvt_pk_bf16_f32 v249, v146, v147
v_mfma_f32_16x16x32_bf16 v[128:131], a[8:11], v[72:75], v[128:131]
s_waitcnt lgkmcnt(7)
ds_read_b64_tr_b16 a[42:43], v13 offset:18432
ds_read_b64_tr_b16 a[44:45], v13 offset:20480
v_mfma_f32_16x16x32_bf16 v[128:131], a[16:19], v[80:83], v[128:131]
ds_read_b64_tr_b16 a[46:47], v13 offset:22528
v_mfma_f32_16x16x32_bf16 v[128:131], a[20:23], v[84:87], v[128:131]
buffer_load_dwordx4 v39, s[16:19], s101 offen offset:1024 sc1 lds
v_mfma_f32_16x16x32_bf16 v[136:139], a[20:23], v[116:119], v[136:139]
ds_read_b64_tr_b16 a[48:49], v13 offset:8192
v_cvt_pk_bf16_f32 v250, v148, v149
v_mfma_f32_16x16x32_bf16 v[136:139], a[16:19], v[112:115], v[136:139]
ds_read_b64_tr_b16 a[50:51], v13 offset:10240
ds_read_b64_tr_b16 a[52:53], v13 offset:12288
v_mfma_f32_16x16x32_bf16 v[136:139], a[24:27], v[120:123], v[136:139]
s_waitcnt lgkmcnt(7)
ds_read_b64_tr_b16 a[54:55], v13 offset:14336
ds_read_b64_tr_b16 a[56:57], v13 offset:24576
v_mfma_f32_16x16x32_bf16 v[136:139], a[28:31], v[124:127], v[136:139]
ds_read_b64_tr_b16 a[58:59], v13 offset:26624
v_cvt_pk_bf16_f32 v251, v150, v151
v_mfma_f32_16x16x32_bf16 v[128:131], a[28:31], v[92:95], v[128:131]
ds_read_b64_tr_b16 a[60:61], v13 offset:28672
v_mfma_f32_16x16x32_bf16 v[128:131], a[24:27], v[88:91], v[128:131]
buffer_load_dwordx4 v40, s[16:19], s101 offen offset:2048 sc1 lds
v_mfma_f32_16x16x32_bf16 v[132:135], a[32:35], v[64:67], 0
ds_read_b64_tr_b16 a[62:63], v13 offset:30720
v_cvt_pk_bf16_f32 v252, v152, v153
v_mfma_f32_16x16x32_bf16 v[132:135], a[36:39], v[68:71], v[132:135]
ds_read_b64_tr_b16 a[0:1], v14 offset:0
ds_read_b64_tr_b16 a[2:3], v14 offset:2048
v_mfma_f32_16x16x32_bf16 v[140:143], a[36:39], v[100:103], 0
ds_read_b64_tr_b16 a[4:5], v14 offset:4096
ds_read_b64_tr_b16 a[6:7], v14 offset:6144
v_mfma_f32_16x16x32_bf16 v[140:143], a[32:35], v[96:99], v[140:143]
s_waitcnt lgkmcnt(7)
ds_read_b64_tr_b16 a[8:9], v14 offset:16384
v_cvt_pk_bf16_f32 v253, v154, v155
v_mfma_f32_16x16x32_bf16 v[140:143], a[40:43], v[104:107], v[140:143]
ds_read_b64_tr_b16 a[10:11], v14 offset:18432
v_mfma_f32_16x16x32_bf16 v[140:143], a[44:47], v[108:111], v[140:143]
buffer_load_dwordx4 v41, s[16:19], s101 offen offset:3072 sc1 lds
v_mfma_f32_16x16x32_bf16 v[132:135], a[44:47], v[76:79], v[132:135]
s_add_u32 m0, s94, 4096
ds_read_b64_tr_b16 a[12:13], v14 offset:20480
ds_read_b64_tr_b16 a[14:15], v14 offset:22528
v_mfma_f32_16x16x32_bf16 v[132:135], a[40:43], v[72:75], v[132:135]
ds_read_b64_tr_b16 a[16:17], v14 offset:8192
v_cvt_pk_bf16_f32 v254, v156, v157
v_mfma_f32_16x16x32_bf16 v[132:135], a[48:51], v[80:83], v[132:135]
ds_read_b64_tr_b16 a[18:19], v14 offset:10240
ds_read_b64_tr_b16 a[20:21], v14 offset:12288
v_mfma_f32_16x16x32_bf16 v[132:135], a[52:55], v[84:87], v[132:135]
ds_read_b64_tr_b16 a[22:23], v14 offset:14336
v_cvt_pk_bf16_f32 v255, v158, v159
v_mfma_f32_16x16x32_bf16 v[140:143], a[52:55], v[116:119], v[140:143]
s_add_u32 s63, s100, 180224
ds_read_b64_tr_b16 a[24:25], v14 offset:24576
v_mfma_f32_16x16x32_bf16 v[140:143], a[48:51], v[112:115], v[140:143]
s_waitcnt lgkmcnt(7)
buffer_load_dwordx4 v38, s[16:19], s70 offen offset:0 sc1 lds
v_mfma_f32_16x16x32_bf16 v[140:143], a[56:59], v[120:123], v[140:143]
ds_read_b64_tr_b16 a[26:27], v14 offset:26624
ds_read_b64_tr_b16 a[28:29], v14 offset:28672
v_mfma_f32_16x16x32_bf16 v[140:143], a[60:63], v[124:127], v[140:143]
ds_read_b64_tr_b16 a[30:31], v14 offset:30720
ds_read_b64_tr_b16 a[32:33], v15 offset:0
v_mfma_f32_16x16x32_bf16 v[132:135], a[60:63], v[92:95], v[132:135]
ds_read_b64_tr_b16 a[34:35], v15 offset:2048
v_mfma_f32_16x16x32_bf16 v[132:135], a[56:59], v[88:91], v[132:135]
buffer_store_dwordx4 v[248:251], v1, s[8:11], s63 offen sc1
v_mfma_f32_16x16x32_bf16 v[144:147], a[0:3], v[64:67], 0
s_add_u32 s63, s63, 917504
ds_read_b64_tr_b16 a[36:37], v15 offset:4096
ds_read_b64_tr_b16 a[38:39], v15 offset:6144
v_mfma_f32_16x16x32_bf16 v[144:147], a[4:7], v[68:71], v[144:147]
buffer_load_dwordx4 v39, s[16:19], s70 offen offset:1024 sc1 lds
v_mfma_f32_16x16x32_bf16 v[152:155], a[4:7], v[100:103], 0
ds_read_b64_tr_b16 a[40:41], v15 offset:16384
ds_read_b64_tr_b16 a[42:43], v15 offset:18432
v_mfma_f32_16x16x32_bf16 v[152:155], a[0:3], v[96:99], v[152:155]
buffer_store_dwordx4 v[252:255], v1, s[8:11], s63 offen sc1
v_mfma_f32_16x16x32_bf16 v[152:155], a[8:11], v[104:107], v[152:155]
s_waitcnt lgkmcnt(5)
ds_read_b64_tr_b16 a[44:45], v15 offset:20480
ds_read_b64_tr_b16 a[46:47], v15 offset:22528
v_mfma_f32_16x16x32_bf16 v[152:155], a[12:15], v[108:111], v[152:155]
ds_read_b64_tr_b16 a[48:49], v15 offset:8192
v_cvt_pk_bf16_f32 v160, v128, v129
v_mfma_f32_16x16x32_bf16 v[144:147], a[12:15], v[76:79], v[144:147]
ds_read_b64_tr_b16 a[50:51], v15 offset:10240
ds_read_b64_tr_b16 a[52:53], v15 offset:12288
v_mfma_f32_16x16x32_bf16 v[144:147], a[8:11], v[72:75], v[144:147]
ds_read_b64_tr_b16 a[54:55], v15 offset:14336
v_cvt_pk_bf16_f32 v161, v130, v131
v_mfma_f32_16x16x32_bf16 v[144:147], a[16:19], v[80:83], v[144:147]
ds_read_b64_tr_b16 a[56:57], v15 offset:24576
ds_read_b64_tr_b16 a[58:59], v15 offset:26624
v_mfma_f32_16x16x32_bf16 v[144:147], a[20:23], v[84:87], v[144:147]
ds_read_b64_tr_b16 a[60:61], v15 offset:28672
ds_read_b64_tr_b16 a[62:63], v15 offset:30720
v_mfma_f32_16x16x32_bf16 v[152:155], a[20:23], v[116:119], v[152:155]
buffer_load_dwordx4 v40, s[16:19], s70 offen offset:2048 sc1 lds
v_mfma_f32_16x16x32_bf16 v[152:155], a[16:19], v[112:115], v[152:155]
v_xor_b32 v12, 0x10000, v12
v_cvt_pk_bf16_f32 v162, v132, v133
v_mfma_f32_16x16x32_bf16 v[152:155], a[24:27], v[120:123], v[152:155]
buffer_load_dwordx4 v41, s[16:19], s70 offen offset:3072 sc1 lds
v_mfma_f32_16x16x32_bf16 v[152:155], a[28:31], v[124:127], v[152:155]
s_add_u32 s101, s101, s71
v_xor_b32 v13, 0x10000, v13
v_cvt_pk_bf16_f32 v163, v134, v135
v_mfma_f32_16x16x32_bf16 v[144:147], a[28:31], v[92:95], v[144:147]
s_add_u32 s70, s70, s71
v_mfma_f32_16x16x32_bf16 v[144:147], a[24:27], v[88:91], v[144:147]
s_waitcnt lgkmcnt(2)
s_add_u32 s94, s94, 32768
v_xor_b32 v14, 0x10000, v14
v_xor_b32 v15, 0x10000, v15
v_mfma_f32_16x16x32_bf16 v[148:151], a[32:35], v[64:67], 0
s_and_b32 s94, s94, 0x1ffff
v_mfma_f32_16x16x32_bf16 v[148:151], a[36:39], v[68:71], v[148:151]
v_cvt_pk_bf16_f32 v164, v136, v137
v_cvt_pk_bf16_f32 v165, v138, v139
v_mfma_f32_16x16x32_bf16 v[156:159], a[36:39], v[100:103], 0
v_mfma_f32_16x16x32_bf16 v[156:159], a[32:35], v[96:99], v[156:159]
v_mfma_f32_16x16x32_bf16 v[156:159], a[40:43], v[104:107], v[156:159]
v_mfma_f32_16x16x32_bf16 v[156:159], a[44:47], v[108:111], v[156:159]
v_mfma_f32_16x16x32_bf16 v[148:151], a[44:47], v[76:79], v[148:151]
v_cvt_pk_bf16_f32 v166, v140, v141
v_mfma_f32_16x16x32_bf16 v[148:151], a[40:43], v[72:75], v[148:151]
v_mfma_f32_16x16x32_bf16 v[148:151], a[48:51], v[80:83], v[148:151]
v_mfma_f32_16x16x32_bf16 v[148:151], a[52:55], v[84:87], v[148:151]
v_cvt_pk_bf16_f32 v167, v142, v143
v_mfma_f32_16x16x32_bf16 v[156:159], a[52:55], v[116:119], v[156:159]
s_add_u32 s63, s100, 196608
v_mfma_f32_16x16x32_bf16 v[156:159], a[48:51], v[112:115], v[156:159]
buffer_store_dwordx4 v[160:163], v1, s[8:11], s63 offen sc1
v_mfma_f32_16x16x32_bf16 v[156:159], a[56:59], v[120:123], v[156:159]
s_waitcnt lgkmcnt(0)
s_add_u32 s63, s63, 917504
v_mfma_f32_16x16x32_bf16 v[156:159], a[60:63], v[124:127], v[156:159]
v_mfma_f32_16x16x32_bf16 v[148:151], a[60:63], v[92:95], v[148:151]
buffer_store_dwordx4 v[164:167], v1, s[8:11], s63 offen sc1
v_mfma_f32_16x16x32_bf16 v[148:151], a[56:59], v[88:91], v[148:151]
s_nop 7
.p2align 3
v_cvt_pk_bf16_f32 v168, v144, v145
v_cvt_pk_bf16_f32 v169, v146, v147
v_cvt_pk_bf16_f32 v170, v148, v149
v_cvt_pk_bf16_f32 v171, v150, v151
v_cvt_pk_bf16_f32 v172, v152, v153
v_cvt_pk_bf16_f32 v173, v154, v155
v_cvt_pk_bf16_f32 v174, v156, v157
v_cvt_pk_bf16_f32 v175, v158, v159
s_add_u32 s63, s100, 212992
buffer_store_dwordx4 v[168:171], v1, s[8:11], s63 offen sc1
s_add_u32 s63, s63, 917504
buffer_store_dwordx4 v[172:175], v1, s[8:11], s63 offen sc1
s_waitcnt vmcnt(21)
s_mov_b64 s[24:25], s[52:53]
s_mov_b32 s26, 3670016
s_mov_b32 s27, 0x20000
v_bfe_u32 v22, v1, 4, 4
v_lshlrev_b32 v37, 2, v22
v_mul_u32_u24 v36, 1792, v22
v_bfe_u32 v22, v1, 8, 1
v_lshl_add_u32 v36, v22, 5, v36
v_bfe_u32 v22, v1, 9, 1
v_lshl_add_u32 v36, v22, 4, v36
v_readfirstlane_b32 s91, v34
s_mov_b32 s90, 0
s_cmp_ge_u32 s92, 8
s_cselect_b32 s63, 56, 56
s_lshl_b32 s64, s91, 2
s_add_u32 s64, s64, s60
s_cmp_lt_u32 s64, s63
s_cselect_b32 s30, s10, 0
s_cselect_b32 s63, s64, s63
s_add_u32 s91, s64, s63
s_mul_i32 s93, s92, 112
s_add_u32 s93, s93, s91
s_lshl_b32 s93, s93, 14
s_add_u32 s93, s93, 67108864
s_mul_i32 s65, s91, 147
s_lshr_b32 s65, s65, 11
s_mul_i32 s100, s92, 229376
s_lshl_b32 s64, s91, 6
s_add_u32 s100, s100, s64
s_mul_i32 s64, s65, 27776
s_add_u32 s100, s100, s64
s_and_b32 s65, s65, 3
s_lshl_b32 s63, s92, 2
s_add_u32 s63, s63, s65
s_lshl_b32 s63, s63, 7
.p2align 3
s_add_u32 s96, s63, 32768
s_cmp_lt_u32 s91, 112
s_cselect_b32 s89, 0, 0x5555
buffer_load_dword v7, v37, s[8:11], s96 offen sc1
s_mov_b32 s65, 8192
buffer_load_dword v35, v5, s[8:11], s65 offen sc1
s_waitcnt vmcnt(2)
v_mov_b32 v6, 7
buffer_store_dword v6, off, s[8:11], s82 sc1
s_cmp_lt_u32 s62, 8
s_cselect_b32 s63, s62, 6
s_cmp_lg_u32 s63, 6
s_waitcnt vmcnt(1)
s_cbranch_scc1 RED_B2
s_cmp_lg_u32 s89, 0
s_cbranch_scc1 RED_X
s_branch RED_K
RED:
v_readfirstlane_b32 s91, v34
s_mov_b32 s90, 0
s_cmp_ge_u32 s92, 8
s_cselect_b32 s63, 56, 56
s_lshl_b32 s64, s91, 2
s_add_u32 s64, s64, s60
s_cmp_lt_u32 s64, s63
s_cselect_b32 s30, s10, 0
s_cselect_b32 s63, s64, s63
s_add_u32 s91, s64, s63
s_mul_i32 s93, s92, 112
s_add_u32 s93, s93, s91
s_lshl_b32 s93, s93, 14
s_add_u32 s93, s93, 67108864
s_mul_i32 s65, s91, 147
s_lshr_b32 s65, s65, 11
s_mul_i32 s100, s92, 229376
s_lshl_b32 s64, s91, 6
s_add_u32 s100, s100, s64
s_mul_i32 s64, s65, 27776
s_add_u32 s100, s100, s64
s_and_b32 s65, s65, 3
s_lshl_b32 s63, s92, 2
s_add_u32 s63, s63, s65
s_lshl_b32 s63, s63, 7
s_add_u32 s96, s63, 32768
s_cmp_lt_u32 s91, 112
s_cselect_b32 s89, 0, 0x5555
s_cmp_lg_u32 s89, 0
s_cbranch_scc1 RED_X
RED_L:
buffer_load_dword v7, v37, s[8:11], s96 offen sc1
s_waitcnt vmcnt(0)
RED_K:
v_cmp_le_u32 vcc, 7, v7
s_sub_u32 s83, s83, 1
s_cselect_b32 s64, -1, 0
s_andn2_b32 s83, s83, s64
s_lshr_b32 s63, vcc_lo, 1
s_and_b32 s63, s63, vcc_lo
s_or_b32 s63, s63, s64
s_and_b32 s63, s63, 0x5555
s_andn2_b32 s88, s63, s89
s_or_b32 s89, s89, s88
s_or_b32 s63, s88, s90
s_cbranch_scc1 RED_G
s_sleep 8
s_branch RED_L
RED_B2:
v_cmp_le_u32 vcc, 7, v7
s_sub_u32 s83, s83, 1
s_cselect_b32 s64, -1, 0
s_andn2_b32 s83, s83, s64
s_lshr_b32 s63, vcc_lo, 1
s_and_b32 s63, s63, vcc_lo
s_or_b32 s63, s63, s64
s_and_b32 s63, s63, 0x5555
s_andn2_b32 s88, s63, s89
s_or_b32 s89, s89, s88
s_bitcmp1_b32 s88, 0
s_cbranch_scc0 RED_F0
s_add_u32 s63, s93, 0
s_add_u32 s64, s63, 16384
buffer_load_dwordx4 a[64:67], v1, s[8:11], s63 offen offset:0 sc1
buffer_load_dwordx4 a[68:71], v1, s[8:11], s63 offen offset:1024 sc1
buffer_load_dwordx4 v[64:67], v1, s[28:31], s64 offen offset:0 sc1
buffer_load_dwordx4 v[68:71], v1, s[28:31], s64 offen offset:1024 sc1
RED_F0:
s_bitcmp1_b32 s88, 2
s_cbranch_scc0 RED_F1
.p2align 3
s_add_u32 s63, s93, 2048
s_add_u32 s64, s63, 16384
buffer_load_dwordx4 a[72:75], v1, s[8:11], s63 offen offset:0 sc1
buffer_load_dwordx4 a[76:79], v1, s[8:11], s63 offen offset:1024 sc1
buffer_load_dwordx4 v[72:75], v1, s[28:31], s64 offen offset:0 sc1
buffer_load_dwordx4 v[76:79], v1, s[28:31], s64 offen offset:1024 sc1
RED_F1:
s_bitcmp1_b32 s88, 4
s_cbranch_scc0 RED_F2
.p2align 3
s_add_u32 s63, s93, 4096
s_add_u32 s64, s63, 16384
buffer_load_dwordx4 a[80:83], v1, s[8:11], s63 offen offset:0 sc1
buffer_load_dwordx4 a[84:87], v1, s[8:11], s63 offen offset:1024 sc1
buffer_load_dwordx4 v[80:83], v1, s[28:31], s64 offen offset:0 sc1
buffer_load_dwordx4 v[84:87], v1, s[28:31], s64 offen offset:1024 sc1
RED_F2:
s_bitcmp1_b32 s88, 6
s_cbranch_scc0 RED_F3
.p2align 3
s_add_u32 s63, s93, 6144
s_add_u32 s64, s63, 16384
buffer_load_dwordx4 a[88:91], v1, s[8:11], s63 offen offset:0 sc1
buffer_load_dwordx4 a[92:95], v1, s[8:11], s63 offen offset:1024 sc1
buffer_load_dwordx4 v[88:91], v1, s[28:31], s64 offen offset:0 sc1
buffer_load_dwordx4 v[92:95], v1, s[28:31], s64 offen offset:1024 sc1
RED_F3:
s_bitcmp1_b32 s88, 8
s_cbranch_scc0 RED_F4
.p2align 3
s_add_u32 s63, s93, 8192
s_add_u32 s64, s63, 16384
buffer_load_dwordx4 a[96:99], v1, s[8:11], s63 offen offset:0 sc1
buffer_load_dwordx4 a[100:103], v1, s[8:11], s63 offen offset:1024 sc1
buffer_load_dwordx4 v[96:99], v1, s[28:31], s64 offen offset:0 sc1
buffer_load_dwordx4 v[100:103], v1, s[28:31], s64 offen offset:1024 sc1
RED_F4:
s_bitcmp1_b32 s88, 10
s_cbranch_scc0 RED_F5
.p2align 3
s_add_u32 s63, s93, 10240
s_add_u32 s64, s63, 16384
buffer_load_dwordx4 a[104:107], v1, s[8:11], s63 offen offset:0 sc1
buffer_load_dwordx4 a[108:111], v1, s[8:11], s63 offen offset:1024 sc1
buffer_load_dwordx4 v[104:107], v1, s[28:31], s64 offen offset:0 sc1
buffer_load_dwordx4 v[108:111], v1, s[28:31], s64 offen offset:1024 sc1
RED_F5:
s_bitcmp1_b32 s88, 12
s_cbranch_scc0 RED_F6
.p2align 3
s_add_u32 s63, s93, 12288
s_add_u32 s64, s63, 16384
buffer_load_dwordx4 a[112:115], v1, s[8:11], s63 offen offset:0 sc1
buffer_load_dwordx4 a[116:119], v1, s[8:11], s63 offen offset:1024 sc1
buffer_load_dwordx4 v[112:115], v1, s[28:31], s64 offen offset:0 sc1
buffer_load_dwordx4 v[116:119], v1, s[28:31], s64 offen offset:1024 sc1
RED_F6:
s_bitcmp1_b32 s88, 14
s_cbranch_scc0 RED_F7
.p2align 3
s_add_u32 s63, s93, 14336
s_add_u32 s64, s63, 16384
buffer_load_dwordx4 a[120:123], v1, s[8:11], s63 offen offset:0 sc1
buffer_load_dwordx4 a[124:127], v1, s[8:11], s63 offen offset:1024 sc1
buffer_load_dwordx4 v[120:123], v1, s[28:31], s64 offen offset:0 sc1
buffer_load_dwordx4 v[124:127], v1, s[28:31], s64 offen offset:1024 sc1
RED_F7:
s_mov_b32 s90, s88
s_waitcnt vmcnt(30)
s_mov_b32 s65, 8192
v_cmp_eq_u32 vcc, 0, v35
s_nop 0
s_cmp_lg_u64 vcc, 0
s_cbranch_scc1 SPIN14_0
OK14_0:
s_lshl_b32 s101, s61, 17
s_lshl_b32 s70, s60, 15
s_add_u32 s101, s101, s70
.p2align 3
s_add_u32 s101, s101, 130023424
s_add_u32 s70, s101, 16384
buffer_load_dwordx4 a[128:131], v1, s[8:11], s101 offen offset:0 sc1
buffer_load_dwordx4 a[192:195], v1, s[8:11], s70 offen offset:0 sc1
buffer_load_dwordx4 a[132:135], v1, s[8:11], s101 offen offset:1024 sc1
buffer_load_dwordx4 a[196:199], v1, s[8:11], s70 offen offset:1024 sc1
buffer_load_dwordx4 a[136:139], v1, s[8:11], s101 offen offset:2048 sc1
buffer_load_dwordx4 a[200:203], v1, s[8:11], s70 offen offset:2048 sc1
buffer_load_dwordx4 a[140:143], v1, s[8:11], s101 offen offset:3072 sc1
buffer_load_dwordx4 a[204:207], v1, s[8:11], s70 offen offset:3072 sc1
s_add_u32 s101, s101, 4096
s_add_u32 s70, s70, 4096
buffer_load_dwordx4 a[144:147], v1, s[8:11], s101 offen offset:0 sc1
buffer_load_dwordx4 a[208:211], v1, s[8:11], s70 offen offset:0 sc1
buffer_load_dwordx4 a[148:151], v1, s[8:11], s101 offen offset:1024 sc1
buffer_load_dwordx4 a[212:215], v1, s[8:11], s70 offen offset:1024 sc1
buffer_load_dwordx4 a[152:155], v1, s[8:11], s101 offen offset:2048 sc1
buffer_load_dwordx4 a[216:219], v1, s[8:11], s70 offen offset:2048 sc1
buffer_load_dwordx4 a[156:159], v1, s[8:11], s101 offen offset:3072 sc1
buffer_load_dwordx4 a[220:223], v1, s[8:11], s70 offen offset:3072 sc1
s_add_u32 s101, s101, 4096
s_add_u32 s70, s70, 4096
buffer_load_dwordx4 a[160:163], v1, s[8:11], s101 offen offset:0 sc1
buffer_load_dwordx4 a[224:227], v1, s[8:11], s70 offen offset:0 sc1
buffer_load_dwordx4 a[164:167], v1, s[8:11], s101 offen offset:1024 sc1
buffer_load_dwordx4 a[228:231], v1, s[8:11], s70 offen offset:1024 sc1
buffer_load_dwordx4 a[168:171], v1, s[8:11], s101 offen offset:2048 sc1
buffer_load_dwordx4 a[232:235], v1, s[8:11], s70 offen offset:2048 sc1
buffer_load_dwordx4 a[172:175], v1, s[8:11], s101 offen offset:3072 sc1
buffer_load_dwordx4 a[236:239], v1, s[8:11], s70 offen offset:3072 sc1
s_add_u32 s101, s101, 4096
s_add_u32 s70, s70, 4096
buffer_load_dwordx4 a[176:179], v1, s[8:11], s101 offen offset:0 sc1
buffer_load_dwordx4 a[240:243], v1, s[8:11], s70 offen offset:0 sc1
buffer_load_dwordx4 a[180:183], v1, s[8:11], s101 offen offset:1024 sc1
buffer_load_dwordx4 a[244:247], v1, s[8:11], s70 offen offset:1024 sc1
buffer_load_dwordx4 a[184:187], v1, s[8:11], s101 offen offset:2048 sc1
buffer_load_dwordx4 a[248:251], v1, s[8:11], s70 offen offset:2048 sc1
buffer_load_dwordx4 a[188:191], v1, s[8:11], s101 offen offset:3072 sc1
buffer_load_dwordx4 a[252:255], v1, s[8:11], s70 offen offset:3072 sc1
s_add_u32 s101, s101, 4096
s_add_u32 s70, s70, 4096
buffer_load_dword v7, v37, s[8:11], s96 offen sc1
s_barrier
.p2align 3
ds_read_b64_tr_b16 a[0:1], v12 offset:0
ds_read_b64_tr_b16 a[2:3], v12 offset:2048
ds_read_b64_tr_b16 a[4:5], v13 offset:0
ds_read_b64_tr_b16 a[6:7], v13 offset:2048
ds_read_b64_tr_b16 a[8:9], v14 offset:0
ds_read_b64_tr_b16 a[10:11], v14 offset:2048
ds_read_b64_tr_b16 a[12:13], v15 offset:0
ds_read_b64_tr_b16 a[14:15], v15 offset:2048
ds_read_b64_tr_b16 a[16:17], v14 offset:3584
ds_read_b64_tr_b16 a[18:19], v14 offset:5632
ds_read_b64_tr_b16 a[20:21], v15 offset:3584
ds_read_b64_tr_b16 a[22:23], v15 offset:5632
ds_read_b64_tr_b16 a[24:25], v12 offset:3584
ds_read_b64_tr_b16 a[26:27], v12 offset:5632
s_cmp_gt_u32 s84, 6
s_subb_u32 s101, s84, 0
s_lshl_b32 s101, s101, 7
s_lshl_b32 s70, s61, 2
s_add_u32 s70, s70, s60
s_mul_i32 s70, s70, 57344
s_add_u32 s101, s101, s70
s_add_u32 s101, s101, 896
s_add_u32 s70, s101, 28672
s_waitcnt vmcnt(31)
s_waitcnt lgkmcnt(5)
v_mfma_f32_16x16x32_bf16 v[128:131], a[0:3], a[128:131], 0
ds_read_b64_tr_b16 a[28:29], v13 offset:3584
v_mfma_f32_16x16x32_bf16 v[144:147], a[0:3], a[192:195], 0
ds_read_b64_tr_b16 a[30:31], v13 offset:5632
v_mfma_f32_16x16x32_bf16 v[148:151], a[4:7], a[192:195], 0
ds_read_b64_tr_b16 a[32:33], v12 offset:7168
v_mfma_f32_16x16x32_bf16 v[132:135], a[4:7], a[128:131], 0
ds_read_b64_tr_b16 a[34:35], v12 offset:9216
v_mfma_f32_16x16x32_bf16 v[136:139], a[8:11], a[128:131], 0
ds_read_b64_tr_b16 a[36:37], v13 offset:7168
v_mfma_f32_16x16x32_bf16 v[152:155], a[8:11], a[192:195], 0
ds_read_b64_tr_b16 a[38:39], v13 offset:9216
v_mfma_f32_16x16x32_bf16 v[156:159], a[12:15], a[192:195], 0
s_waitcnt vmcnt(29)
ds_read_b64_tr_b16 a[40:41], v14 offset:7168
v_mfma_f32_16x16x32_bf16 v[140:143], a[12:15], a[128:131], 0
s_waitcnt lgkmcnt(6)
ds_read_b64_tr_b16 a[42:43], v14 offset:9216
v_mfma_f32_16x16x32_bf16 v[128:131], a[16:19], a[132:135], v[128:131]
ds_read_b64_tr_b16 a[44:45], v15 offset:7168
v_mfma_f32_16x16x32_bf16 v[144:147], a[16:19], a[196:199], v[144:147]
ds_read_b64_tr_b16 a[46:47], v15 offset:9216
v_mfma_f32_16x16x32_bf16 v[148:151], a[20:23], a[196:199], v[148:151]
ds_read_b64_tr_b16 a[48:49], v14 offset:10752
v_mfma_f32_16x16x32_bf16 v[132:135], a[20:23], a[132:135], v[132:135]
ds_read_b64_tr_b16 a[50:51], v14 offset:12800
v_mfma_f32_16x16x32_bf16 v[136:139], a[24:27], a[132:135], v[136:139]
ds_read_b64_tr_b16 a[52:53], v15 offset:10752
v_mfma_f32_16x16x32_bf16 v[152:155], a[24:27], a[196:199], v[152:155]
s_waitcnt lgkmcnt(6)
ds_read_b64_tr_b16 a[54:55], v15 offset:12800
v_mfma_f32_16x16x32_bf16 v[156:159], a[28:31], a[196:199], v[156:159]
s_waitcnt vmcnt(27)
ds_read_b64_tr_b16 a[56:57], v12 offset:10752
v_mfma_f32_16x16x32_bf16 v[140:143], a[28:31], a[132:135], v[140:143]
ds_read_b64_tr_b16 a[58:59], v12 offset:12800
v_mfma_f32_16x16x32_bf16 v[128:131], a[32:35], a[136:139], v[128:131]
ds_read_b64_tr_b16 a[60:61], v13 offset:10752
v_mfma_f32_16x16x32_bf16 v[144:147], a[32:35], a[200:203], v[144:147]
ds_read_b64_tr_b16 a[62:63], v13 offset:12800
v_mfma_f32_16x16x32_bf16 v[148:151], a[36:39], a[200:203], v[148:151]
ds_read_b64_tr_b16 a[0:1], v12 offset:14336
v_mfma_f32_16x16x32_bf16 v[132:135], a[36:39], a[136:139], v[132:135]
s_waitcnt lgkmcnt(6)
ds_read_b64_tr_b16 a[2:3], v12 offset:16384
v_mfma_f32_16x16x32_bf16 v[136:139], a[40:43], a[136:139], v[136:139]
ds_read_b64_tr_b16 a[4:5], v13 offset:14336
v_mfma_f32_16x16x32_bf16 v[152:155], a[40:43], a[200:203], v[152:155]
ds_read_b64_tr_b16 a[6:7], v13 offset:16384
v_mfma_f32_16x16x32_bf16 v[156:159], a[44:47], a[200:203], v[156:159]
s_waitcnt vmcnt(25)
ds_read_b64_tr_b16 a[8:9], v14 offset:14336
v_mfma_f32_16x16x32_bf16 v[140:143], a[44:47], a[136:139], v[140:143]
ds_read_b64_tr_b16 a[10:11], v14 offset:16384
v_mfma_f32_16x16x32_bf16 v[128:131], a[48:51], a[140:143], v[128:131]
ds_read_b64_tr_b16 a[12:13], v15 offset:14336
v_mfma_f32_16x16x32_bf16 v[144:147], a[48:51], a[204:207], v[144:147]
s_waitcnt lgkmcnt(6)
ds_read_b64_tr_b16 a[14:15], v15 offset:16384
v_mfma_f32_16x16x32_bf16 v[148:151], a[52:55], a[204:207], v[148:151]
ds_read_b64_tr_b16 a[16:17], v14 offset:17920
v_mfma_f32_16x16x32_bf16 v[132:135], a[52:55], a[140:143], v[132:135]
ds_read_b64_tr_b16 a[18:19], v14 offset:19968
v_mfma_f32_16x16x32_bf16 v[136:139], a[56:59], a[140:143], v[136:139]
ds_read_b64_tr_b16 a[20:21], v15 offset:17920
v_mfma_f32_16x16x32_bf16 v[152:155], a[56:59], a[204:207], v[152:155]
ds_read_b64_tr_b16 a[22:23], v15 offset:19968
v_mfma_f32_16x16x32_bf16 v[156:159], a[60:63], a[204:207], v[156:159]
s_waitcnt vmcnt(23)
ds_read_b64_tr_b16 a[24:25], v12 offset:17920
v_mfma_f32_16x16x32_bf16 v[140:143], a[60:63], a[140:143], v[140:143]
s_waitcnt lgkmcnt(6)
ds_read_b64_tr_b16 a[26:27], v12 offset:19968
v_mfma_f32_16x16x32_bf16 v[128:131], a[0:3], a[144:147], v[128:131]
ds_read_b64_tr_b16 a[28:29], v13 offset:17920
v_mfma_f32_16x16x32_bf16 v[144:147], a[0:3], a[208:211], v[144:147]
ds_read_b64_tr_b16 a[30:31], v13 offset:19968
v_mfma_f32_16x16x32_bf16 v[148:151], a[4:7], a[208:211], v[148:151]
ds_read_b64_tr_b16 a[32:33], v12 offset:21504
v_mfma_f32_16x16x32_bf16 v[132:135], a[4:7], a[144:147], v[132:135]
ds_read_b64_tr_b16 a[34:35], v12 offset:23552
v_mfma_f32_16x16x32_bf16 v[136:139], a[8:11], a[144:147], v[136:139]
ds_read_b64_tr_b16 a[36:37], v13 offset:21504
v_mfma_f32_16x16x32_bf16 v[152:155], a[8:11], a[208:211], v[152:155]
s_waitcnt lgkmcnt(6)
ds_read_b64_tr_b16 a[38:39], v13 offset:23552
v_mfma_f32_16x16x32_bf16 v[156:159], a[12:15], a[208:211], v[156:159]
s_waitcnt vmcnt(0)
v_cmp_le_u32 vcc, 7, v7
s_sub_u32 s83, s83, 1
s_cselect_b32 s64, -1, 0
s_andn2_b32 s83, s83, s64
s_lshr_b32 s63, vcc_lo, 1
s_and_b32 s63, s63, vcc_lo
s_or_b32 s63, s63, s64
s_and_b32 s63, s63, 0x5555
s_andn2_b32 s88, s63, s89
s_or_b32 s89, s89, s88
ds_read_b64_tr_b16 a[40:41], v14 offset:21504
v_mfma_f32_16x16x32_bf16 v[140:143], a[12:15], a[144:147], v[140:143]
ds_read_b64_tr_b16 a[42:43], v14 offset:23552
v_mfma_f32_16x16x32_bf16 v[128:131], a[16:19], a[148:151], v[128:131]
s_bitcmp1_b32 s88, 0
s_cbranch_scc0 RED_H0
s_add_u32 s63, s93, 0
s_add_u32 s64, s63, 16384
buffer_load_dwordx4 a[64:67], v1, s[8:11], s63 offen offset:0 sc1
buffer_load_dwordx4 a[68:71], v1, s[8:11], s63 offen offset:1024 sc1
buffer_load_dwordx4 v[64:67], v1, s[28:31], s64 offen offset:0 sc1
buffer_load_dwordx4 v[68:71], v1, s[28:31], s64 offen offset:1024 sc1
RED_H0:
ds_read_b64_tr_b16 a[44:45], v15 offset:21504
v_mfma_f32_16x16x32_bf16 v[144:147], a[16:19], a[212:215], v[144:147]
ds_read_b64_tr_b16 a[46:47], v15 offset:23552
v_mfma_f32_16x16x32_bf16 v[148:151], a[20:23], a[212:215], v[148:151]
ds_read_b64_tr_b16 a[48:49], v14 offset:25088
v_mfma_f32_16x16x32_bf16 v[132:135], a[20:23], a[148:151], v[132:135]
s_waitcnt lgkmcnt(6)
ds_read_b64_tr_b16 a[50:51], v14 offset:27136
v_mfma_f32_16x16x32_bf16 v[136:139], a[24:27], a[148:151], v[136:139]
ds_read_b64_tr_b16 a[52:53], v15 offset:25088
v_mfma_f32_16x16x32_bf16 v[152:155], a[24:27], a[212:215], v[152:155]
ds_read_b64_tr_b16 a[54:55], v15 offset:27136
v_mfma_f32_16x16x32_bf16 v[156:159], a[28:31], a[212:215], v[156:159]
ds_read_b64_tr_b16 a[56:57], v12 offset:25088
v_mfma_f32_16x16x32_bf16 v[140:143], a[28:31], a[148:151], v[140:143]
ds_read_b64_tr_b16 a[58:59], v12 offset:27136
v_mfma_f32_16x16x32_bf16 v[128:131], a[32:35], a[152:155], v[128:131]
ds_read_b64_tr_b16 a[60:61], v13 offset:25088
v_mfma_f32_16x16x32_bf16 v[144:147], a[32:35], a[216:219], v[144:147]
s_waitcnt lgkmcnt(6)
ds_read_b64_tr_b16 a[62:63], v13 offset:27136
v_mfma_f32_16x16x32_bf16 v[148:151], a[36:39], a[216:219], v[148:151]
ds_read_b64_tr_b16 a[0:1], v12 offset:28672
v_mfma_f32_16x16x32_bf16 v[132:135], a[36:39], a[152:155], v[132:135]
s_bitcmp1_b32 s88, 2
s_cbranch_scc0 RED_H1
.p2align 3
s_add_u32 s63, s93, 2048
s_add_u32 s64, s63, 16384
buffer_load_dwordx4 a[72:75], v1, s[8:11], s63 offen offset:0 sc1
buffer_load_dwordx4 a[76:79], v1, s[8:11], s63 offen offset:1024 sc1
buffer_load_dwordx4 v[72:75], v1, s[28:31], s64 offen offset:0 sc1
buffer_load_dwordx4 v[76:79], v1, s[28:31], s64 offen offset:1024 sc1
RED_H1:
ds_read_b64_tr_b16 a[2:3], v12 offset:30720
v_mfma_f32_16x16x32_bf16 v[136:139], a[40:43], a[152:155], v[136:139]
ds_read_b64_tr_b16 a[4:5], v13 offset:28672
v_mfma_f32_16x16x32_bf16 v[152:155], a[40:43], a[216:219], v[152:155]
ds_read_b64_tr_b16 a[6:7], v13 offset:30720
v_mfma_f32_16x16x32_bf16 v[156:159], a[44:47], a[216:219], v[156:159]
ds_read_b64_tr_b16 a[8:9], v14 offset:28672
v_mfma_f32_16x16x32_bf16 v[140:143], a[44:47], a[152:155], v[140:143]
s_waitcnt lgkmcnt(6)
ds_read_b64_tr_b16 a[10:11], v14 offset:30720
v_mfma_f32_16x16x32_bf16 v[128:131], a[48:51], a[156:159], v[128:131]
ds_read_b64_tr_b16 a[12:13], v15 offset:28672
v_mfma_f32_16x16x32_bf16 v[144:147], a[48:51], a[220:223], v[144:147]
ds_read_b64_tr_b16 a[14:15], v15 offset:30720
v_mfma_f32_16x16x32_bf16 v[148:151], a[52:55], a[220:223], v[148:151]
ds_read_b64_tr_b16 a[16:17], v14 offset:32256
v_mfma_f32_16x16x32_bf16 v[132:135], a[52:55], a[156:159], v[132:135]
ds_read_b64_tr_b16 a[18:19], v14 offset:34304
v_mfma_f32_16x16x32_bf16 v[136:139], a[56:59], a[156:159], v[136:139]
ds_read_b64_tr_b16 a[20:21], v15 offset:32256
v_mfma_f32_16x16x32_bf16 v[152:155], a[56:59], a[220:223], v[152:155]
s_waitcnt lgkmcnt(6)
ds_read_b64_tr_b16 a[22:23], v15 offset:34304
v_mfma_f32_16x16x32_bf16 v[156:159], a[60:63], a[220:223], v[156:159]
s_bitcmp1_b32 s88, 4
s_cbranch_scc0 RED_H2
.p2align 3
s_add_u32 s63, s93, 4096
s_add_u32 s64, s63, 16384
buffer_load_dwordx4 a[80:83], v1, s[8:11], s63 offen offset:0 sc1
buffer_load_dwordx4 a[84:87], v1, s[8:11], s63 offen offset:1024 sc1
buffer_load_dwordx4 v[80:83], v1, s[28:31], s64 offen offset:0 sc1
buffer_load_dwordx4 v[84:87], v1, s[28:31], s64 offen offset:1024 sc1
RED_H2:
ds_read_b64_tr_b16 a[24:25], v12 offset:32256
v_mfma_f32_16x16x32_bf16 v[140:143], a[60:63], a[156:159], v[140:143]
ds_read_b64_tr_b16 a[26:27], v12 offset:34304
v_mfma_f32_16x16x32_bf16 v[128:131], a[0:3], a[160:163], v[128:131]
ds_read_b64_tr_b16 a[28:29], v13 offset:32256
v_mfma_f32_16x16x32_bf16 v[144:147], a[0:3], a[224:227], v[144:147]
ds_read_b64_tr_b16 a[30:31], v13 offset:34304
v_mfma_f32_16x16x32_bf16 v[148:151], a[4:7], a[224:227], v[148:151]
ds_read_b64_tr_b16 a[32:33], v12 offset:35840
v_mfma_f32_16x16x32_bf16 v[132:135], a[4:7], a[160:163], v[132:135]
s_waitcnt lgkmcnt(6)
ds_read_b64_tr_b16 a[34:35], v12 offset:37888
v_mfma_f32_16x16x32_bf16 v[136:139], a[8:11], a[160:163], v[136:139]
ds_read_b64_tr_b16 a[36:37], v13 offset:35840
v_mfma_f32_16x16x32_bf16 v[152:155], a[8:11], a[224:227], v[152:155]
ds_read_b64_tr_b16 a[38:39], v13 offset:37888
v_mfma_f32_16x16x32_bf16 v[156:159], a[12:15], a[224:227], v[156:159]
ds_read_b64_tr_b16 a[40:41], v14 offset:35840
v_mfma_f32_16x16x32_bf16 v[140:143], a[12:15], a[160:163], v[140:143]
ds_read_b64_tr_b16 a[42:43], v14 offset:37888
v_mfma_f32_16x16x32_bf16 v[128:131], a[16:19], a[164:167], v[128:131]
ds_read_b64_tr_b16 a[44:45], v15 offset:35840
v_mfma_f32_16x16x32_bf16 v[144:147], a[16:19], a[228:231], v[144:147]
s_waitcnt lgkmcnt(6)
s_bitcmp1_b32 s88, 6
s_cbranch_scc0 RED_H3
.p2align 3
s_add_u32 s63, s93, 6144
s_add_u32 s64, s63, 16384
buffer_load_dwordx4 a[88:91], v1, s[8:11], s63 offen offset:0 sc1
buffer_load_dwordx4 a[92:95], v1, s[8:11], s63 offen offset:1024 sc1
buffer_load_dwordx4 v[88:91], v1, s[28:31], s64 offen offset:0 sc1
buffer_load_dwordx4 v[92:95], v1, s[28:31], s64 offen offset:1024 sc1
RED_H3:
ds_read_b64_tr_b16 a[46:47], v15 offset:37888
v_mfma_f32_16x16x32_bf16 v[148:151], a[20:23], a[228:231], v[148:151]
ds_read_b64_tr_b16 a[48:49], v14 offset:39424
v_mfma_f32_16x16x32_bf16 v[132:135], a[20:23], a[164:167], v[132:135]
ds_read_b64_tr_b16 a[50:51], v14 offset:41472
v_mfma_f32_16x16x32_bf16 v[136:139], a[24:27], a[164:167], v[136:139]
ds_read_b64_tr_b16 a[52:53], v15 offset:39424
v_mfma_f32_16x16x32_bf16 v[152:155], a[24:27], a[228:231], v[152:155]
ds_read_b64_tr_b16 a[54:55], v15 offset:41472
v_mfma_f32_16x16x32_bf16 v[156:159], a[28:31], a[228:231], v[156:159]
ds_read_b64_tr_b16 a[56:57], v12 offset:39424
v_mfma_f32_16x16x32_bf16 v[140:143], a[28:31], a[164:167], v[140:143]
s_waitcnt lgkmcnt(6)
ds_read_b64_tr_b16 a[58:59], v12 offset:41472
v_mfma_f32_16x16x32_bf16 v[128:131], a[32:35], a[168:171], v[128:131]
ds_read_b64_tr_b16 a[60:61], v13 offset:39424
v_mfma_f32_16x16x32_bf16 v[144:147], a[32:35], a[232:235], v[144:147]
ds_read_b64_tr_b16 a[62:63], v13 offset:41472
v_mfma_f32_16x16x32_bf16 v[148:151], a[36:39], a[232:235], v[148:151]
ds_read_b64_tr_b16 a[0:1], v12 offset:43008
v_mfma_f32_16x16x32_bf16 v[132:135], a[36:39], a[168:171], v[132:135]
ds_read_b64_tr_b16 a[2:3], v12 offset:45056
v_mfma_f32_16x16x32_bf16 v[136:139], a[40:43], a[168:171], v[136:139]
s_bitcmp1_b32 s88, 8
s_cbranch_scc0 RED_H4
.p2align 3
s_add_u32 s63, s93, 8192
s_add_u32 s64, s63, 16384
buffer_load_dwordx4 a[96:99], v1, s[8:11], s63 offen offset:0 sc1
buffer_load_dwordx4 a[100:103], v1, s[8:11], s63 offen offset:1024 sc1
buffer_load_dwordx4 v[96:99], v1, s[28:31], s64 offen offset:0 sc1
buffer_load_dwordx4 v[100:103], v1, s[28:31], s64 offen offset:1024 sc1
RED_H4:
ds_read_b64_tr_b16 a[4:5], v13 offset:43008
v_mfma_f32_16x16x32_bf16 v[152:155], a[40:43], a[232:235], v[152:155]
s_waitcnt lgkmcnt(6)
ds_read_b64_tr_b16 a[6:7], v13 offset:45056
v_mfma_f32_16x16x32_bf16 v[156:159], a[44:47], a[232:235], v[156:159]
ds_read_b64_tr_b16 a[8:9], v14 offset:43008
v_mfma_f32_16x16x32_bf16 v[140:143], a[44:47], a[168:171], v[140:143]
ds_read_b64_tr_b16 a[10:11], v14 offset:45056
v_mfma_f32_16x16x32_bf16 v[128:131], a[48:51], a[172:175], v[128:131]
ds_read_b64_tr_b16 a[12:13], v15 offset:43008
v_mfma_f32_16x16x32_bf16 v[144:147], a[48:51], a[236:239], v[144:147]
ds_read_b64_tr_b16 a[14:15], v15 offset:45056
v_mfma_f32_16x16x32_bf16 v[148:151], a[52:55], a[236:239], v[148:151]
ds_read_b64_tr_b16 a[16:17], v14 offset:46592
v_mfma_f32_16x16x32_bf16 v[132:135], a[52:55], a[172:175], v[132:135]
s_waitcnt lgkmcnt(6)
ds_read_b64_tr_b16 a[18:19], v14 offset:48640
v_mfma_f32_16x16x32_bf16 v[136:139], a[56:59], a[172:175], v[136:139]
ds_read_b64_tr_b16 a[20:21], v15 offset:46592
v_mfma_f32_16x16x32_bf16 v[152:155], a[56:59], a[236:239], v[152:155]
ds_read_b64_tr_b16 a[22:23], v15 offset:48640
v_mfma_f32_16x16x32_bf16 v[156:159], a[60:63], a[236:239], v[156:159]
ds_read_b64_tr_b16 a[24:25], v12 offset:46592
v_mfma_f32_16x16x32_bf16 v[140:143], a[60:63], a[172:175], v[140:143]
s_bitcmp1_b32 s88, 10
s_cbranch_scc0 RED_H5
.p2align 3
s_add_u32 s63, s93, 10240
s_add_u32 s64, s63, 16384
buffer_load_dwordx4 a[104:107], v1, s[8:11], s63 offen offset:0 sc1
buffer_load_dwordx4 a[108:111], v1, s[8:11], s63 offen offset:1024 sc1
buffer_load_dwordx4 v[104:107], v1, s[28:31], s64 offen offset:0 sc1
buffer_load_dwordx4 v[108:111], v1, s[28:31], s64 offen offset:1024 sc1
RED_H5:
ds_read_b64_tr_b16 a[26:27], v12 offset:48640
v_mfma_f32_16x16x32_bf16 v[128:131], a[0:3], a[176:179], v[128:131]
ds_read_b64_tr_b16 a[28:29], v13 offset:46592
v_mfma_f32_16x16x32_bf16 v[144:147], a[0:3], a[240:243], v[144:147]
s_waitcnt lgkmcnt(6)
ds_read_b64_tr_b16 a[30:31], v13 offset:48640
v_mfma_f32_16x16x32_bf16 v[148:151], a[4:7], a[240:243], v[148:151]
ds_read_b64_tr_b16 a[32:33], v12 offset:50176
v_mfma_f32_16x16x32_bf16 v[132:135], a[4:7], a[176:179], v[132:135]
ds_read_b64_tr_b16 a[34:35], v12 offset:52224
v_mfma_f32_16x16x32_bf16 v[136:139], a[8:11], a[176:179], v[136:139]
ds_read_b64_tr_b16 a[36:37], v13 offset:50176
v_mfma_f32_16x16x32_bf16 v[152:155], a[8:11], a[240:243], v[152:155]
ds_read_b64_tr_b16 a[38:39], v13 offset:52224
v_mfma_f32_16x16x32_bf16 v[156:159], a[12:15], a[240:243], v[156:159]
ds_read_b64_tr_b16 a[40:41], v14 offset:50176
v_mfma_f32_16x16x32_bf16 v[140:143], a[12:15], a[176:179], v[140:143]
s_waitcnt lgkmcnt(6)
ds_read_b64_tr_b16 a[42:43], v14 offset:52224
v_mfma_f32_16x16x32_bf16 v[128:131], a[16:19], a[180:183], v[128:131]
ds_read_b64_tr_b16 a[44:45], v15 offset:50176
v_mfma_f32_16x16x32_bf16 v[144:147], a[16:19], a[244:247], v[144:147]
ds_read_b64_tr_b16 a[46:47], v15 offset:52224
v_mfma_f32_16x16x32_bf16 v[148:151], a[20:23], a[244:247], v[148:151]
s_bitcmp1_b32 s88, 12
s_cbranch_scc0 RED_H6
.p2align 3
s_add_u32 s63, s93, 12288
s_add_u32 s64, s63, 16384
buffer_load_dwordx4 a[112:115], v1, s[8:11], s63 offen offset:0 sc1
buffer_load_dwordx4 a[116:119], v1, s[8:11], s63 offen offset:1024 sc1
buffer_load_dwordx4 v[112:115], v1, s[28:31], s64 offen offset:0 sc1
buffer_load_dwordx4 v[116:119], v1, s[28:31], s64 offen offset:1024 sc1
RED_H6:
ds_read_b64_tr_b16 a[48:49], v14 offset:53760
v_mfma_f32_16x16x32_bf16 v[132:135], a[20:23], a[180:183], v[132:135]
ds_read_b64_tr_b16 a[50:51], v14 offset:55808
v_mfma_f32_16x16x32_bf16 v[136:139], a[24:27], a[180:183], v[136:139]
ds_read_b64_tr_b16 a[52:53], v15 offset:53760
v_mfma_f32_16x16x32_bf16 v[152:155], a[24:27], a[244:247], v[152:155]
s_waitcnt lgkmcnt(6)
ds_read_b64_tr_b16 a[54:55], v15 offset:55808
v_mfma_f32_16x16x32_bf16 v[156:159], a[28:31], a[244:247], v[156:159]
ds_read_b64_tr_b16 a[56:57], v12 offset:53760
v_mfma_f32_16x16x32_bf16 v[140:143], a[28:31], a[180:183], v[140:143]
ds_read_b64_tr_b16 a[58:59], v12 offset:55808
v_mfma_f32_16x16x32_bf16 v[128:131], a[32:35], a[184:187], v[128:131]
ds_read_b64_tr_b16 a[60:61], v13 offset:53760
v_mfma_f32_16x16x32_bf16 v[144:147], a[32:35], a[248:251], v[144:147]
ds_read_b64_tr_b16 a[62:63], v13 offset:55808
v_mfma_f32_16x16x32_bf16 v[148:151], a[36:39], a[248:251], v[148:151]
v_mfma_f32_16x16x32_bf16 v[132:135], a[36:39], a[184:187], v[132:135]
s_waitcnt lgkmcnt(5)
v_mfma_f32_16x16x32_bf16 v[136:139], a[40:43], a[184:187], v[136:139]
v_mfma_f32_16x16x32_bf16 v[152:155], a[40:43], a[248:251], v[152:155]
s_bitcmp1_b32 s88, 14
s_cbranch_scc0 RED_H7
.p2align 3
s_add_u32 s63, s93, 14336
s_add_u32 s64, s63, 16384
buffer_load_dwordx4 a[120:123], v1, s[8:11], s63 offen offset:0 sc1
buffer_load_dwordx4 a[124:127], v1, s[8:11], s63 offen offset:1024 sc1
buffer_load_dwordx4 v[120:123], v1, s[28:31], s64 offen offset:0 sc1
buffer_load_dwordx4 v[124:127], v1, s[28:31], s64 offen offset:1024 sc1
RED_H7:
v_mfma_f32_16x16x32_bf16 v[156:159], a[44:47], a[248:251], v[156:159]
v_mfma_f32_16x16x32_bf16 v[140:143], a[44:47], a[184:187], v[140:143]
v_mfma_f32_16x16x32_bf16 v[128:131], a[48:51], a[188:191], v[128:131]
v_mfma_f32_16x16x32_bf16 v[144:147], a[48:51], a[252:255], v[144:147]
s_waitcnt lgkmcnt(0)
v_mfma_f32_16x16x32_bf16 v[148:151], a[52:55], a[252:255], v[148:151]
v_mfma_f32_16x16x32_bf16 v[132:135], a[52:55], a[188:191], v[132:135]
v_mfma_f32_16x16x32_bf16 v[136:139], a[56:59], a[188:191], v[136:139]
v_mfma_f32_16x16x32_bf16 v[152:155], a[56:59], a[252:255], v[152:155]
v_mfma_f32_16x16x32_bf16 v[156:159], a[60:63], a[252:255], v[156:159]
v_mfma_f32_16x16x32_bf16 v[140:143], a[60:63], a[188:191], v[140:143]
s_nop 7
v_cvt_pk_bf16_f32 v128, v128, v129
v_cvt_pk_bf16_f32 v129, v130, v131
v_cvt_pk_bf16_f32 v130, v132, v133
v_cvt_pk_bf16_f32 v131, v134, v135
s_nop 1
v_permlane16_swap_b32 v128, v130
v_permlane16_swap_b32 v129, v131
buffer_store_dwordx4 v[128:131], v36, s[24:27], s101 offen offset:0
v_cvt_pk_bf16_f32 v136, v136, v137
v_cvt_pk_bf16_f32 v137, v138, v139
v_cvt_pk_bf16_f32 v138, v140, v141
v_cvt_pk_bf16_f32 v139, v142, v143
s_nop 1
v_permlane16_swap_b32 v136, v138
v_permlane16_swap_b32 v137, v139
buffer_store_dwordx4 v[136:139], v36, s[24:27], s101 offen offset:64
v_cvt_pk_bf16_f32 v144, v144, v145
v_cvt_pk_bf16_f32 v145, v146, v147
v_cvt_pk_bf16_f32 v146, v148, v149
v_cvt_pk_bf16_f32 v147, v150, v151
s_nop 1
v_permlane16_swap_b32 v144, v146
v_permlane16_swap_b32 v145, v147
buffer_store_dwordx4 v[144:147], v36, s[24:27], s70 offen offset:0
v_cvt_pk_bf16_f32 v152, v152, v153
v_cvt_pk_bf16_f32 v153, v154, v155
v_cvt_pk_bf16_f32 v154, v156, v157
v_cvt_pk_bf16_f32 v155, v158, v159
s_nop 1
v_permlane16_swap_b32 v152, v154
v_permlane16_swap_b32 v153, v155
buffer_store_dwordx4 v[152:155], v36, s[24:27], s70 offen offset:64
s_cmp_lt_u32 s91, 112
s_cbranch_scc1 RED_M
RED_X:
s_cmp_ge_u32 s92, 8
s_cbranch_scc1 DONE
s_sub_u32 s92, 15, s92
s_lshl_b32 s95, s92, 2
s_add_u32 s95, s95, s60
s_lshl_b32 s95, s95, 7
s_add_u32 s95, s95, 12288
v_mov_b32 v34, 1
s_mov_b64 exec, 1
buffer_atomic_add v34, off, s[8:11], s95 sc0 sc1
s_mov_b64 exec, -1
s_waitcnt vmcnt(0)
s_branch RED
RED_G:
s_bitcmp1_b32 s88, 0
s_cbranch_scc0 RED_N0
s_add_u32 s63, s93, 0
s_add_u32 s64, s63, 16384
buffer_load_dwordx4 a[64:67], v1, s[8:11], s63 offen offset:0 sc1
buffer_load_dwordx4 a[68:71], v1, s[8:11], s63 offen offset:1024 sc1
buffer_load_dwordx4 v[64:67], v1, s[28:31], s64 offen offset:0 sc1
buffer_load_dwordx4 v[68:71], v1, s[28:31], s64 offen offset:1024 sc1
RED_N0:
s_bitcmp1_b32 s88, 2
s_cbranch_scc0 RED_N1
.p2align 3
s_add_u32 s63, s93, 2048
s_add_u32 s64, s63, 16384
buffer_load_dwordx4 a[72:75], v1, s[8:11], s63 offen offset:0 sc1
buffer_load_dwordx4 a[76:79], v1, s[8:11], s63 offen offset:1024 sc1
buffer_load_dwordx4 v[72:75], v1, s[28:31], s64 offen offset:0 sc1
buffer_load_dwordx4 v[76:79], v1, s[28:31], s64 offen offset:1024 sc1
RED_N1:
s_bitcmp1_b32 s88, 4
s_cbranch_scc0 RED_N2
.p2align 3
s_add_u32 s63, s93, 4096
s_add_u32 s64, s63, 16384
buffer_load_dwordx4 a[80:83], v1, s[8:11], s63 offen offset:0 sc1
buffer_load_dwordx4 a[84:87], v1, s[8:11], s63 offen offset:1024 sc1
buffer_load_dwordx4 v[80:83], v1, s[28:31], s64 offen offset:0 sc1
buffer_load_dwordx4 v[84:87], v1, s[28:31], s64 offen offset:1024 sc1
RED_N2:
s_bitcmp1_b32 s88, 6
s_cbranch_scc0 RED_N3
.p2align 3
s_add_u32 s63, s93, 6144
s_add_u32 s64, s63, 16384
buffer_load_dwordx4 a[88:91], v1, s[8:11], s63 offen offset:0 sc1
buffer_load_dwordx4 a[92:95], v1, s[8:11], s63 offen offset:1024 sc1
buffer_load_dwordx4 v[88:91], v1, s[28:31], s64 offen offset:0 sc1
buffer_load_dwordx4 v[92:95], v1, s[28:31], s64 offen offset:1024 sc1
RED_N3:
s_bitcmp1_b32 s88, 8
s_cbranch_scc0 RED_N4
.p2align 3
s_add_u32 s63, s93, 8192
s_add_u32 s64, s63, 16384
buffer_load_dwordx4 a[96:99], v1, s[8:11], s63 offen offset:0 sc1
buffer_load_dwordx4 a[100:103], v1, s[8:11], s63 offen offset:1024 sc1
buffer_load_dwordx4 v[96:99], v1, s[28:31], s64 offen offset:0 sc1
buffer_load_dwordx4 v[100:103], v1, s[28:31], s64 offen offset:1024 sc1
RED_N4:
s_bitcmp1_b32 s88, 10
s_cbranch_scc0 RED_N5
.p2align 3
s_add_u32 s63, s93, 10240
s_add_u32 s64, s63, 16384
buffer_load_dwordx4 a[104:107], v1, s[8:11], s63 offen offset:0 sc1
buffer_load_dwordx4 a[108:111], v1, s[8:11], s63 offen offset:1024 sc1
buffer_load_dwordx4 v[104:107], v1, s[28:31], s64 offen offset:0 sc1
buffer_load_dwordx4 v[108:111], v1, s[28:31], s64 offen offset:1024 sc1
RED_N5:
s_bitcmp1_b32 s88, 12
s_cbranch_scc0 RED_N6
.p2align 3
s_add_u32 s63, s93, 12288
s_add_u32 s64, s63, 16384
buffer_load_dwordx4 a[112:115], v1, s[8:11], s63 offen offset:0 sc1
buffer_load_dwordx4 a[116:119], v1, s[8:11], s63 offen offset:1024 sc1
buffer_load_dwordx4 v[112:115], v1, s[28:31], s64 offen offset:0 sc1
buffer_load_dwordx4 v[116:119], v1, s[28:31], s64 offen offset:1024 sc1
RED_N6:
s_bitcmp1_b32 s88, 14
s_cbranch_scc0 RED_N7
.p2align 3
s_add_u32 s63, s93, 14336
s_add_u32 s64, s63, 16384
buffer_load_dwordx4 a[120:123], v1, s[8:11], s63 offen offset:0 sc1
buffer_load_dwordx4 a[124:127], v1, s[8:11], s63 offen offset:1024 sc1
buffer_load_dwordx4 v[120:123], v1, s[28:31], s64 offen offset:0 sc1
buffer_load_dwordx4 v[124:127], v1, s[28:31], s64 offen offset:1024 sc1
RED_N7:
RED_M:
s_bitcmp1_b32 s90, 0
s_cbranch_scc0 RED_P0
v_mfma_f32_16x16x32_bf16 v[128:131], v[56:59], a[64:67], 0
v_mfma_f32_16x16x32_bf16 v[132:135], v[60:63], a[64:67], 0
v_mfma_f32_16x16x32_bf16 v[192:195], v[56:59], v[64:67], 0
v_mfma_f32_16x16x32_bf16 v[196:199], v[60:63], v[64:67], 0
v_mfma_f32_16x16x32_bf16 v[128:131], v[56:59], a[68:71], v[128:131]
v_mfma_f32_16x16x32_bf16 v[132:135], v[60:63], a[68:71], v[132:135]
v_mfma_f32_16x16x32_bf16 v[192:195], v[56:59], v[68:71], v[192:195]
v_mfma_f32_16x16x32_bf16 v[196:199], v[60:63], v[68:71], v[196:199]
RED_P0:
s_bitcmp1_b32 s90, 2
s_cbranch_scc0 RED_P1
v_mfma_f32_16x16x32_bf16 v[136:139], v[56:59], a[72:75], 0
v_mfma_f32_16x16x32_bf16 v[140:143], v[60:63], a[72:75], 0
v_mfma_f32_16x16x32_bf16 v[200:203], v[56:59], v[72:75], 0
v_mfma_f32_16x16x32_bf16 v[204:207], v[60:63], v[72:75], 0
v_mfma_f32_16x16x32_bf16 v[136:139], v[56:59], a[76:79], v[136:139]
v_mfma_f32_16x16x32_bf16 v[140:143], v[60:63], a[76:79], v[140:143]
v_mfma_f32_16x16x32_bf16 v[200:203], v[56:59], v[76:79], v[200:203]
v_mfma_f32_16x16x32_bf16 v[204:207], v[60:63], v[76:79], v[204:207]
RED_P1:
s_bitcmp1_b32 s90, 4
s_cbranch_scc0 RED_P2
v_mfma_f32_16x16x32_bf16 v[144:147], v[56:59], a[80:83], 0
v_mfma_f32_16x16x32_bf16 v[148:151], v[60:63], a[80:83], 0
v_mfma_f32_16x16x32_bf16 v[208:211], v[56:59], v[80:83], 0
v_mfma_f32_16x16x32_bf16 v[212:215], v[60:63], v[80:83], 0
v_mfma_f32_16x16x32_bf16 v[144:147], v[56:59], a[84:87], v[144:147]
v_mfma_f32_16x16x32_bf16 v[148:151], v[60:63], a[84:87], v[148:151]
v_mfma_f32_16x16x32_bf16 v[208:211], v[56:59], v[84:87], v[208:211]
v_mfma_f32_16x16x32_bf16 v[212:215], v[60:63], v[84:87], v[212:215]
RED_P2:
s_bitcmp1_b32 s90, 6
s_cbranch_scc0 RED_P3
v_mfma_f32_16x16x32_bf16 v[152:155], v[56:59], a[88:91], 0
v_mfma_f32_16x16x32_bf16 v[156:159], v[60:63], a[88:91], 0
v_mfma_f32_16x16x32_bf16 v[216:219], v[56:59], v[88:91], 0
v_mfma_f32_16x16x32_bf16 v[220:223], v[60:63], v[88:91], 0
v_mfma_f32_16x16x32_bf16 v[152:155], v[56:59], a[92:95], v[152:155]
v_mfma_f32_16x16x32_bf16 v[156:159], v[60:63], a[92:95], v[156:159]
v_mfma_f32_16x16x32_bf16 v[216:219], v[56:59], v[92:95], v[216:219]
v_mfma_f32_16x16x32_bf16 v[220:223], v[60:63], v[92:95], v[220:223]
RED_P3:
s_bitcmp1_b32 s90, 8
s_cbranch_scc0 RED_P4
v_mfma_f32_16x16x32_bf16 v[160:163], v[56:59], a[96:99], 0
v_mfma_f32_16x16x32_bf16 v[164:167], v[60:63], a[96:99], 0
v_mfma_f32_16x16x32_bf16 v[224:227], v[56:59], v[96:99], 0
v_mfma_f32_16x16x32_bf16 v[228:231], v[60:63], v[96:99], 0
v_mfma_f32_16x16x32_bf16 v[160:163], v[56:59], a[100:103], v[160:163]
v_mfma_f32_16x16x32_bf16 v[164:167], v[60:63], a[100:103], v[164:167]
v_mfma_f32_16x16x32_bf16 v[224:227], v[56:59], v[100:103], v[224:227]
v_mfma_f32_16x16x32_bf16 v[228:231], v[60:63], v[100:103], v[228:231]
RED_P4:
s_bitcmp1_b32 s90, 10
s_cbranch_scc0 RED_P5
v_mfma_f32_16x16x32_bf16 v[168:171], v[56:59], a[104:107], 0
v_mfma_f32_16x16x32_bf16 v[172:175], v[60:63], a[104:107], 0
v_mfma_f32_16x16x32_bf16 v[232:235], v[56:59], v[104:107], 0
v_mfma_f32_16x16x32_bf16 v[236:239], v[60:63], v[104:107], 0
v_mfma_f32_16x16x32_bf16 v[168:171], v[56:59], a[108:111], v[168:171]
v_mfma_f32_16x16x32_bf16 v[172:175], v[60:63], a[108:111], v[172:175]
v_mfma_f32_16x16x32_bf16 v[232:235], v[56:59], v[108:111], v[232:235]
v_mfma_f32_16x16x32_bf16 v[236:239], v[60:63], v[108:111], v[236:239]
RED_P5:
s_bitcmp1_b32 s90, 12
s_cbranch_scc0 RED_P6
v_mfma_f32_16x16x32_bf16 v[176:179], v[56:59], a[112:115], 0
v_mfma_f32_16x16x32_bf16 v[180:183], v[60:63], a[112:115], 0
v_mfma_f32_16x16x32_bf16 v[240:243], v[56:59], v[112:115], 0
v_mfma_f32_16x16x32_bf16 v[244:247], v[60:63], v[112:115], 0
v_mfma_f32_16x16x32_bf16 v[176:179], v[56:59], a[116:119], v[176:179]
v_mfma_f32_16x16x32_bf16 v[180:183], v[60:63], a[116:119], v[180:183]
v_mfma_f32_16x16x32_bf16 v[240:243], v[56:59], v[116:119], v[240:243]
v_mfma_f32_16x16x32_bf16 v[244:247], v[60:63], v[116:119], v[244:247]
RED_P6:
s_bitcmp1_b32 s90, 14
s_cbranch_scc0 RED_P7
v_mfma_f32_16x16x32_bf16 v[184:187], v[56:59], a[120:123], 0
v_mfma_f32_16x16x32_bf16 v[188:191], v[60:63], a[120:123], 0
v_mfma_f32_16x16x32_bf16 v[248:251], v[56:59], v[120:123], 0
v_mfma_f32_16x16x32_bf16 v[252:255], v[60:63], v[120:123], 0
v_mfma_f32_16x16x32_bf16 v[184:187], v[56:59], a[124:127], v[184:187]
v_mfma_f32_16x16x32_bf16 v[188:191], v[60:63], a[124:127], v[188:191]
v_mfma_f32_16x16x32_bf16 v[248:251], v[56:59], v[124:127], v[248:251]
v_mfma_f32_16x16x32_bf16 v[252:255], v[60:63], v[124:127], v[252:255]
RED_P7:
s_mov_b32 s90, s88
s_mov_b32 s88, 0
s_cmp_lg_u32 s89, 0x5555
s_cbranch_scc1 RED_L
s_cmp_eq_u32 s90, 0
s_cbranch_scc1 RED_S
s_waitcnt vmcnt(0)
s_branch RED_M
RED_S:
s_mov_b32 s91, s92
s_cmp_ge_u32 s92, 8
s_cbranch_scc1 RED_T
s_sub_u32 s92, 15, s92
s_lshl_b32 s95, s92, 2
s_add_u32 s95, s95, s60
s_lshl_b32 s95, s95, 7
s_add_u32 s95, s95, 12288
v_mov_b32 v34, 1
s_mov_b64 exec, 1
buffer_atomic_add v34, off, s[8:11], s95 sc0 sc1
s_mov_b64 exec, -1
RED_T:
.p2align 3
v_pk_add_f32 v[128:129], v[128:129], v[136:137]
v_pk_add_f32 v[130:131], v[130:131], v[138:139]
v_pk_add_f32 v[132:133], v[132:133], v[140:141]
v_pk_add_f32 v[134:135], v[134:135], v[142:143]
v_pk_add_f32 v[144:145], v[144:145], v[152:153]
v_pk_add_f32 v[146:147], v[146:147], v[154:155]
v_pk_add_f32 v[148:149], v[148:149], v[156:157]
v_pk_add_f32 v[150:151], v[150:151], v[158:159]
v_pk_add_f32 v[160:161], v[160:161], v[168:169]
v_pk_add_f32 v[162:163], v[162:163], v[170:171]
v_pk_add_f32 v[164:165], v[164:165], v[172:173]
v_pk_add_f32 v[166:167], v[166:167], v[174:175]
v_pk_add_f32 v[176:177], v[176:177], v[184:185]
v_pk_add_f32 v[178:179], v[178:179], v[186:187]
v_pk_add_f32 v[180:181], v[180:181], v[188:189]
v_pk_add_f32 v[182:183], v[182:183], v[190:191]
v_pk_add_f32 v[128:129], v[128:129], v[144:145]
v_pk_add_f32 v[130:131], v[130:131], v[146:147]
v_pk_add_f32 v[132:133], v[132:133], v[148:149]
v_pk_add_f32 v[134:135], v[134:135], v[150:151]
v_pk_add_f32 v[160:161], v[160:161], v[176:177]
v_pk_add_f32 v[162:163], v[162:163], v[178:179]
v_pk_add_f32 v[164:165], v[164:165], v[180:181]
v_pk_add_f32 v[166:167], v[166:167], v[182:183]
v_pk_add_f32 v[128:129], v[128:129], v[160:161]
v_pk_add_f32 v[130:131], v[130:131], v[162:163]
v_pk_add_f32 v[132:133], v[132:133], v[164:165]
v_pk_add_f32 v[134:135], v[134:135], v[166:167]
v_cvt_pk_bf16_f32 v128, v128, v129
v_cvt_pk_bf16_f32 v129, v130, v131
v_cvt_pk_bf16_f32 v130, v132, v133
v_cvt_pk_bf16_f32 v131, v134, v135
s_nop 1
v_permlane16_swap_b32 v128, v130
v_permlane16_swap_b32 v129, v131
buffer_store_dwordx4 v[128:131], v36, s[24:27], s100 offen offset:0
s_cmp_eq_u32 s30, 0
s_cbranch_scc1 DONE
.p2align 3
v_pk_add_f32 v[192:193], v[192:193], v[200:201]
v_pk_add_f32 v[194:195], v[194:195], v[202:203]
v_pk_add_f32 v[196:197], v[196:197], v[204:205]
v_pk_add_f32 v[198:199], v[198:199], v[206:207]
v_pk_add_f32 v[208:209], v[208:209], v[216:217]
v_pk_add_f32 v[210:211], v[210:211], v[218:219]
v_pk_add_f32 v[212:213], v[212:213], v[220:221]
v_pk_add_f32 v[214:215], v[214:215], v[222:223]
v_pk_add_f32 v[224:225], v[224:225], v[232:233]
v_pk_add_f32 v[226:227], v[226:227], v[234:235]
v_pk_add_f32 v[228:229], v[228:229], v[236:237]
v_pk_add_f32 v[230:231], v[230:231], v[238:239]
v_pk_add_f32 v[240:241], v[240:241], v[248:249]
v_pk_add_f32 v[242:243], v[242:243], v[250:251]
v_pk_add_f32 v[244:245], v[244:245], v[252:253]
v_pk_add_f32 v[246:247], v[246:247], v[254:255]
v_pk_add_f32 v[192:193], v[192:193], v[208:209]
v_pk_add_f32 v[194:195], v[194:195], v[210:211]
v_pk_add_f32 v[196:197], v[196:197], v[212:213]
v_pk_add_f32 v[198:199], v[198:199], v[214:215]
v_pk_add_f32 v[224:225], v[224:225], v[240:241]
v_pk_add_f32 v[226:227], v[226:227], v[242:243]
v_pk_add_f32 v[228:229], v[228:229], v[244:245]
v_pk_add_f32 v[230:231], v[230:231], v[246:247]
v_pk_add_f32 v[192:193], v[192:193], v[224:225]
v_pk_add_f32 v[194:195], v[194:195], v[226:227]
v_pk_add_f32 v[196:197], v[196:197], v[228:229]
v_pk_add_f32 v[198:199], v[198:199], v[230:231]
v_cvt_pk_bf16_f32 v192, v192, v193
v_cvt_pk_bf16_f32 v193, v194, v195
v_cvt_pk_bf16_f32 v194, v196, v197
v_cvt_pk_bf16_f32 v195, v198, v199
s_nop 1
v_permlane16_swap_b32 v192, v194
v_permlane16_swap_b32 v193, v195
buffer_store_dwordx4 v[192:195], v36, s[24:27], s100 offen offset:64
s_cmp_ge_u32 s91, 8
s_cbranch_scc1 DONE
s_waitcnt vmcnt(2)
s_branch RED
DONE:
s_endpgm
HANDOFF:
s_waitcnt vmcnt(9)
v_cvt_pk_bf16_f32 v64, v128, v129
v_cvt_pk_bf16_f32 v65, v130, v131
v_cvt_pk_bf16_f32 v66, v132, v133
v_cvt_pk_bf16_f32 v67, v134, v135
s_add_u32 s65, s99, 0
buffer_store_dwordx4 v[64:67], v1, s[8:11], s65 offen offset:0 sc1
v_mov_b32 v22, v18
v_mov_b32 v23, v19
s_nop 1
v_permlane32_swap_b32 v22, v18
v_permlane32_swap_b32 v23, v19
v_add_f32 v18, v22, v18
v_add_f32 v19, v23, v19
v_cvt_pk_bf16_f32 v68, v136, v137
v_cvt_pk_bf16_f32 v69, v138, v139
v_cvt_pk_bf16_f32 v70, v140, v141
v_cvt_pk_bf16_f32 v71, v142, v143
buffer_store_dwordx4 v[68:71], v1, s[8:11], s65 offen offset:1024 sc1
v_mov_b32 v22, v18
v_mov_b32 v23, v19
s_nop 1
v_permlane16_swap_b32 v22, v18
v_permlane16_swap_b32 v23, v19
v_add_f32 v18, v22, v18
v_add_f32 v19, v23, v19
.p2align 3
v_accvgpr_read_b32 v64, a192
v_accvgpr_read_b32 v65, a193
v_accvgpr_read_b32 v66, a194
v_accvgpr_read_b32 v67, a195
v_cvt_pk_bf16_f32 v72, v144, v145
v_cvt_pk_bf16_f32 v73, v146, v147
v_cvt_pk_bf16_f32 v74, v148, v149
v_cvt_pk_bf16_f32 v75, v150, v151
buffer_store_dwordx4 v[72:75], v1, s[8:11], s65 offen offset:2048 sc1
v_add_f32 v23, v18, v19
v_cmp_nge_f32 vcc, 0x5f800000, v23
s_lshl_b32 s63, s60, 2
s_add_u32 s63, s63, 131072
s_cmp_lg_u64 vcc, 0
s_cselect_b32 s64, 1, 0
v_mov_b32 v24, s63
v_mov_b32 v25, s64
.p2align 3
ds_write_b32 v24, v25
v_mov_b32 v24, 131072
v_accvgpr_read_b32 v68, a196
v_accvgpr_read_b32 v69, a197
v_accvgpr_read_b32 v70, a198
v_accvgpr_read_b32 v71, a199
v_cvt_pk_bf16_f32 v76, v152, v153
v_cvt_pk_bf16_f32 v77, v154, v155
v_cvt_pk_bf16_f32 v78, v156, v157
v_cvt_pk_bf16_f32 v79, v158, v159
buffer_store_dwordx4 v[76:79], v1, s[8:11], s65 offen offset:3072 sc1
v_not_b32 v25, v46
.p2align 3
v_mov_b32 v34, 0x10000
v_bfi_b32 v12, v34, v25, v12
v_bfi_b32 v13, v34, v25, v13
v_bfi_b32 v14, v34, v25, v14
v_bfi_b32 v15, v34, v25, v15
v_accvgpr_read_b32 v72, a200
v_accvgpr_read_b32 v73, a201
v_accvgpr_read_b32 v74, a202
v_accvgpr_read_b32 v75, a203
v_cvt_pk_bf16_f32 v80, v160, v161
v_cvt_pk_bf16_f32 v81, v162, v163
v_cvt_pk_bf16_f32 v82, v164, v165
v_cvt_pk_bf16_f32 v83, v166, v167
s_add_u32 s65, s99, 4096
buffer_store_dwordx4 v[80:83], v1, s[8:11], s65 offen offset:0 sc1
v_mov_b32 v30, v18
v_mov_b32 v31, v19
v_mov_b32 v32, v48
v_mov_b32 v33, v52
.p2align 3
s_add_u32 s63, s99, 16384
buffer_store_dwordx4 v[30:33], v1, s[8:11], s63 offen sc1
v_accvgpr_read_b32 v76, a204
v_accvgpr_read_b32 v77, a205
v_accvgpr_read_b32 v78, a206
v_accvgpr_read_b32 v79, a207
v_cvt_pk_bf16_f32 v84, v168, v169
v_cvt_pk_bf16_f32 v85, v170, v171
v_cvt_pk_bf16_f32 v86, v172, v173
v_cvt_pk_bf16_f32 v87, v174, v175
buffer_store_dwordx4 v[84:87], v1, s[8:11], s65 offen offset:1024 sc1
v_accvgpr_read_b32 v80, a208
v_accvgpr_read_b32 v81, a209
v_accvgpr_read_b32 v82, a210
v_accvgpr_read_b32 v83, a211
v_cvt_pk_bf16_f32 v88, v176, v177
v_cvt_pk_bf16_f32 v89, v178, v179
v_cvt_pk_bf16_f32 v90, v180, v181
v_cvt_pk_bf16_f32 v91, v182, v183
buffer_store_dwordx4 v[88:91], v1, s[8:11], s65 offen offset:2048 sc1
v_accvgpr_read_b32 v84, a212
v_accvgpr_read_b32 v85, a213
v_accvgpr_read_b32 v86, a214
v_accvgpr_read_b32 v87, a215
v_cvt_pk_bf16_f32 v92, v184, v185
v_cvt_pk_bf16_f32 v93, v186, v187
v_cvt_pk_bf16_f32 v94, v188, v189
v_cvt_pk_bf16_f32 v95, v190, v191
buffer_store_dwordx4 v[92:95], v1, s[8:11], s65 offen offset:3072 sc1
v_accvgpr_read_b32 v88, a216
v_accvgpr_read_b32 v89, a217
v_accvgpr_read_b32 v90, a218
v_accvgpr_read_b32 v91, a219
v_cvt_pk_bf16_f32 v96, v192, v193
v_cvt_pk_bf16_f32 v97, v194, v195
v_cvt_pk_bf16_f32 v98, v196, v197
v_cvt_pk_bf16_f32 v99, v198, v199
s_add_u32 s65, s99, 8192
buffer_store_dwordx4 v[96:99], v1, s[8:11], s65 offen offset:0 sc1
v_accvgpr_read_b32 v92, a220
v_accvgpr_read_b32 v93, a221
v_accvgpr_read_b32 v94, a222
v_accvgpr_read_b32 v95, a223
v_cvt_pk_bf16_f32 v100, v200, v201
v_cvt_pk_bf16_f32 v101, v202, v203
v_cvt_pk_bf16_f32 v102, v204, v205
v_cvt_pk_bf16_f32 v103, v206, v207
buffer_store_dwordx4 v[100:103], v1, s[8:11], s65 offen offset:1024 sc1
v_accvgpr_read_b32 v96, a224
v_accvgpr_read_b32 v97, a225
v_accvgpr_read_b32 v98, a226
v_accvgpr_read_b32 v99, a227
v_cvt_pk_bf16_f32 v104, v208, v209
v_cvt_pk_bf16_f32 v105, v210, v211
v_cvt_pk_bf16_f32 v106, v212, v213
v_cvt_pk_bf16_f32 v107, v214, v215
buffer_store_dwordx4 v[104:107], v1, s[8:11], s65 offen offset:2048 sc1
v_accvgpr_read_b32 v100, a228
v_accvgpr_read_b32 v101, a229
v_accvgpr_read_b32 v102, a230
v_accvgpr_read_b32 v103, a231
v_cvt_pk_bf16_f32 v108, v216, v217
v_cvt_pk_bf16_f32 v109, v218, v219
v_cvt_pk_bf16_f32 v110, v220, v221
v_cvt_pk_bf16_f32 v111, v222, v223
buffer_store_dwordx4 v[108:111], v1, s[8:11], s65 offen offset:3072 sc1
v_accvgpr_read_b32 v104, a232
v_accvgpr_read_b32 v105, a233
v_accvgpr_read_b32 v106, a234
v_accvgpr_read_b32 v107, a235
v_cvt_pk_bf16_f32 v112, v224, v225
v_cvt_pk_bf16_f32 v113, v226, v227
v_cvt_pk_bf16_f32 v114, v228, v229
v_cvt_pk_bf16_f32 v115, v230, v231
s_add_u32 s65, s99, 12288
buffer_store_dwordx4 v[112:115], v1, s[8:11], s65 offen offset:0 sc1
v_accvgpr_read_b32 v108, a236
v_accvgpr_read_b32 v109, a237
v_accvgpr_read_b32 v110, a238
v_accvgpr_read_b32 v111, a239
v_cvt_pk_bf16_f32 v116, v232, v233
v_cvt_pk_bf16_f32 v117, v234, v235
v_cvt_pk_bf16_f32 v118, v236, v237
v_cvt_pk_bf16_f32 v119, v238, v239
buffer_store_dwordx4 v[116:119], v1, s[8:11], s65 offen offset:1024 sc1
v_accvgpr_read_b32 v112, a240
v_accvgpr_read_b32 v113, a241
v_accvgpr_read_b32 v114, a242
v_accvgpr_read_b32 v115, a243
v_cvt_pk_bf16_f32 v120, v240, v241
v_cvt_pk_bf16_f32 v121, v242, v243
v_cvt_pk_bf16_f32 v122, v244, v245
v_cvt_pk_bf16_f32 v123, v246, v247
buffer_store_dwordx4 v[120:123], v1, s[8:11], s65 offen offset:2048 sc1
v_accvgpr_read_b32 v116, a244
v_accvgpr_read_b32 v117, a245
v_accvgpr_read_b32 v118, a246
v_accvgpr_read_b32 v119, a247
v_cvt_pk_bf16_f32 v124, v248, v249
v_cvt_pk_bf16_f32 v125, v250, v251
v_cvt_pk_bf16_f32 v126, v252, v253
v_cvt_pk_bf16_f32 v127, v254, v255
buffer_store_dwordx4 v[124:127], v1, s[8:11], s65 offen offset:3072 sc1
v_accvgpr_read_b32 v120, a248
v_accvgpr_read_b32 v121, a249
v_accvgpr_read_b32 v122, a250
v_accvgpr_read_b32 v123, a251
s_waitcnt lgkmcnt(0)
s_barrier
.p2align 3
ds_read_b128 v[34:37], v24
ds_read_b64_tr_b16 a[0:1], v12 offset:0
ds_read_b64_tr_b16 a[2:3], v12 offset:2048
ds_read_b64_tr_b16 a[4:5], v12 offset:4096
ds_read_b64_tr_b16 a[6:7], v12 offset:6144
ds_read_b64_tr_b16 a[8:9], v12 offset:16384
ds_read_b64_tr_b16 a[10:11], v12 offset:18432
ds_read_b64_tr_b16 a[12:13], v12 offset:20480
ds_read_b64_tr_b16 a[14:15], v12 offset:22528
ds_read_b64_tr_b16 a[16:17], v12 offset:8192
ds_read_b64_tr_b16 a[18:19], v12 offset:10240
ds_read_b64_tr_b16 a[20:21], v12 offset:12288
ds_read_b64_tr_b16 a[22:23], v12 offset:14336
ds_read_b64_tr_b16 a[24:25], v12 offset:24576
ds_read_b64_tr_b16 a[26:27], v12 offset:26624
v_accvgpr_read_b32 v124, a252
v_accvgpr_read_b32 v125, a253
v_accvgpr_read_b32 v126, a254
v_accvgpr_read_b32 v127, a255
s_mov_b32 m0, s94
s_nop 0
buffer_load_dwordx4 v38, s[16:19], s101 offen offset:0 sc1 lds
buffer_load_dwordx4 v39, s[16:19], s101 offen offset:1024 sc1 lds
buffer_load_dwordx4 v40, s[16:19], s101 offen offset:2048 sc1 lds
buffer_load_dwordx4 v41, s[16:19], s101 offen offset:3072 sc1 lds
s_add_u32 m0, s94, 4096
s_nop 0
buffer_load_dwordx4 v38, s[16:19], s70 offen offset:0 sc1 lds
buffer_load_dwordx4 v39, s[16:19], s70 offen offset:1024 sc1 lds
buffer_load_dwordx4 v40, s[16:19], s70 offen offset:2048 sc1 lds
buffer_load_dwordx4 v41, s[16:19], s70 offen offset:3072 sc1 lds
s_add_u32 s101, s101, s71
s_add_u32 s70, s70, s71
s_add_u32 s94, s94, 32768
s_and_b32 s94, s94, 0x1ffff
s_waitcnt lgkmcnt(0)
v_or3_b32 v34, v34, v35, v36
v_or_b32 v34, v34, v37
s_nop 0
v_readfirstlane_b32 s63, v34
s_andn2_b32 s63, s63, s97
s_cbranch_scc1 REDO
s_waitcnt vmcnt(8)
v_mov_b32 v6, 3
buffer_store_dword v6, off, s[8:11], s80 sc1
s_branch OPROJ
REST0:
v_mov_b64 v[128:129], 0
v_mov_b64 v[130:131], 0
v_mov_b64 v[132:133], 0
v_mov_b64 v[134:135], 0
v_mov_b64 v[136:137], 0
v_mov_b64 v[138:139], 0
v_mov_b64 v[140:141], 0
v_mov_b64 v[142:143], 0
v_mov_b64 v[144:145], 0
v_mov_b64 v[146:147], 0
v_mov_b64 v[148:149], 0
v_mov_b64 v[150:151], 0
v_mov_b64 v[152:153], 0
v_mov_b64 v[154:155], 0
v_mov_b64 v[156:157], 0
v_mov_b64 v[158:159], 0
v_mov_b64 v[160:161], 0
v_mov_b64 v[162:163], 0
v_mov_b64 v[164:165], 0
v_mov_b64 v[166:167], 0
v_mov_b64 v[168:169], 0
v_mov_b64 v[170:171], 0
v_mov_b64 v[172:173], 0
v_mov_b64 v[174:175], 0
v_mov_b64 v[176:177], 0
v_mov_b64 v[178:179], 0
v_mov_b64 v[180:181], 0
v_mov_b64 v[182:183], 0
v_mov_b64 v[184:185], 0
v_mov_b64 v[186:187], 0
v_mov_b64 v[188:189], 0
v_mov_b64 v[190:191], 0
v_mov_b64 v[192:193], 0
v_mov_b64 v[194:195], 0
v_mov_b64 v[196:197], 0
v_mov_b64 v[198:199], 0
v_mov_b64 v[200:201], 0
v_mov_b64 v[202:203], 0
v_mov_b64 v[204:205], 0
v_mov_b64 v[206:207], 0
v_mov_b64 v[208:209], 0
v_mov_b64 v[210:211], 0
v_mov_b64 v[212:213], 0
v_mov_b64 v[214:215], 0
v_mov_b64 v[216:217], 0
v_mov_b64 v[218:219], 0
v_mov_b64 v[220:221], 0
v_mov_b64 v[222:223], 0
v_mov_b64 v[224:225], 0
v_mov_b64 v[226:227], 0
v_mov_b64 v[228:229], 0
v_mov_b64 v[230:231], 0
v_mov_b64 v[232:233], 0
v_mov_b64 v[234:235], 0
v_mov_b64 v[236:237], 0
v_mov_b64 v[238:239], 0
v_mov_b64 v[240:241], 0
v_mov_b64 v[242:243], 0
v_mov_b64 v[244:245], 0
v_mov_b64 v[246:247], 0
v_mov_b64 v[248:249], 0
v_mov_b64 v[250:251], 0
v_mov_b64 v[252:253], 0
v_mov_b64 v[254:255], 0
.p2align 3
v_accvgpr_read_b32 v26, a180
v_accvgpr_read_b32 v27, a181
v_accvgpr_read_b32 v28, a182
v_accvgpr_read_b32 v29, a183
v_accvgpr_read_b32 v22, a176
v_accvgpr_read_b32 v23, a177
v_accvgpr_read_b32 v24, a178
v_accvgpr_read_b32 v25, a179
v_cvt_pk_bf16_f32 v22, v22, v23
v_cvt_pk_bf16_f32 v23, v24, v25
v_cvt_pk_bf16_f32 v24, v26, v27
v_cvt_pk_bf16_f32 v25, v28, v29
buffer_store_dwordx4 v[22:25], v1, s[8:11], s76 offen offset:2048 sc1
v_accvgpr_read_b32 v26, a188
v_accvgpr_read_b32 v27, a189
v_accvgpr_read_b32 v28, a190
v_accvgpr_read_b32 v29, a191
v_accvgpr_read_b32 v22, a184
v_accvgpr_read_b32 v23, a185
v_accvgpr_read_b32 v24, a186
v_accvgpr_read_b32 v25, a187
v_cvt_pk_bf16_f32 v22, v22, v23
v_cvt_pk_bf16_f32 v23, v24, v25
v_cvt_pk_bf16_f32 v24, v26, v27
v_cvt_pk_bf16_f32 v25, v28, v29
buffer_store_dwordx4 v[22:25], v1, s[8:11], s76 offen offset:3072 sc1
REST1:
s_add_u32 s76, s76, s78
.p2align 3
v_accvgpr_read_b32 v26, a196
v_accvgpr_read_b32 v27, a197
v_accvgpr_read_b32 v28, a198
v_accvgpr_read_b32 v29, a199
v_accvgpr_read_b32 v22, a192
v_accvgpr_read_b32 v23, a193
v_accvgpr_read_b32 v24, a194
v_accvgpr_read_b32 v25, a195
v_cvt_pk_bf16_f32 v22, v22, v23
v_cvt_pk_bf16_f32 v23, v24, v25
v_cvt_pk_bf16_f32 v24, v26, v27
v_cvt_pk_bf16_f32 v25, v28, v29
buffer_store_dwordx4 v[22:25], v1, s[8:11], s76 offen offset:0 sc1
v_accvgpr_read_b32 v26, a204
v_accvgpr_read_b32 v27, a205
v_accvgpr_read_b32 v28, a206
v_accvgpr_read_b32 v29, a207
v_accvgpr_read_b32 v22, a200
v_accvgpr_read_b32 v23, a201
v_accvgpr_read_b32 v24, a202
v_accvgpr_read_b32 v25, a203
v_cvt_pk_bf16_f32 v22, v22, v23
v_cvt_pk_bf16_f32 v23, v24, v25
v_cvt_pk_bf16_f32 v24, v26, v27
v_cvt_pk_bf16_f32 v25, v28, v29
buffer_store_dwordx4 v[22:25], v1, s[8:11], s76 offen offset:1024 sc1
v_accvgpr_read_b32 v26, a212
v_accvgpr_read_b32 v27, a213
v_accvgpr_read_b32 v28, a214
v_accvgpr_read_b32 v29, a215
v_accvgpr_read_b32 v22, a208
v_accvgpr_read_b32 v23, a209
v_accvgpr_read_b32 v24, a210
v_accvgpr_read_b32 v25, a211
v_cvt_pk_bf16_f32 v22, v22, v23
v_cvt_pk_bf16_f32 v23, v24, v25
v_cvt_pk_bf16_f32 v24, v26, v27
v_cvt_pk_bf16_f32 v25, v28, v29
buffer_store_dwordx4 v[22:25], v1, s[8:11], s76 offen offset:2048 sc1
REST2:
.p2align 3
v_accvgpr_read_b32 v26, a220
v_accvgpr_read_b32 v27, a221
v_accvgpr_read_b32 v28, a222
v_accvgpr_read_b32 v29, a223
v_accvgpr_read_b32 v22, a216
v_accvgpr_read_b32 v23, a217
v_accvgpr_read_b32 v24, a218
v_accvgpr_read_b32 v25, a219
v_cvt_pk_bf16_f32 v22, v22, v23
v_cvt_pk_bf16_f32 v23, v24, v25
v_cvt_pk_bf16_f32 v24, v26, v27
v_cvt_pk_bf16_f32 v25, v28, v29
buffer_store_dwordx4 v[22:25], v1, s[8:11], s76 offen offset:3072 sc1
s_add_u32 s76, s76, s77
.p2align 3
v_accvgpr_read_b32 v26, a228
v_accvgpr_read_b32 v27, a229
v_accvgpr_read_b32 v28, a230
v_accvgpr_read_b32 v29, a231
v_accvgpr_read_b32 v22, a224
v_accvgpr_read_b32 v23, a225
v_accvgpr_read_b32 v24, a226
v_accvgpr_read_b32 v25, a227
v_cvt_pk_bf16_f32 v22, v22, v23
v_cvt_pk_bf16_f32 v23, v24, v25
v_cvt_pk_bf16_f32 v24, v26, v27
v_cvt_pk_bf16_f32 v25, v28, v29
buffer_store_dwordx4 v[22:25], v1, s[8:11], s76 offen offset:0 sc1
v_accvgpr_read_b32 v26, a236
v_accvgpr_read_b32 v27, a237
v_accvgpr_read_b32 v28, a238
v_accvgpr_read_b32 v29, a239
v_accvgpr_read_b32 v22, a232
v_accvgpr_read_b32 v23, a233
v_accvgpr_read_b32 v24, a234
v_accvgpr_read_b32 v25, a235
v_cvt_pk_bf16_f32 v22, v22, v23
v_cvt_pk_bf16_f32 v23, v24, v25
v_cvt_pk_bf16_f32 v24, v26, v27
v_cvt_pk_bf16_f32 v25, v28, v29
buffer_store_dwordx4 v[22:25], v1, s[8:11], s76 offen offset:1024 sc1
REST3:
.p2align 3
v_accvgpr_read_b32 v26, a244
v_accvgpr_read_b32 v27, a245
v_accvgpr_read_b32 v28, a246
v_accvgpr_read_b32 v29, a247
v_accvgpr_read_b32 v22, a240
v_accvgpr_read_b32 v23, a241
v_accvgpr_read_b32 v24, a242
v_accvgpr_read_b32 v25, a243
v_cvt_pk_bf16_f32 v22, v22, v23
v_cvt_pk_bf16_f32 v23, v24, v25
v_cvt_pk_bf16_f32 v24, v26, v27
v_cvt_pk_bf16_f32 v25, v28, v29
buffer_store_dwordx4 v[22:25], v1, s[8:11], s76 offen offset:2048 sc1
v_accvgpr_read_b32 v26, a252
v_accvgpr_read_b32 v27, a253
v_accvgpr_read_b32 v28, a254
v_accvgpr_read_b32 v29, a255
v_accvgpr_read_b32 v22, a248
v_accvgpr_read_b32 v23, a249
v_accvgpr_read_b32 v24, a250
v_accvgpr_read_b32 v25, a251
v_cvt_pk_bf16_f32 v22, v22, v23
v_cvt_pk_bf16_f32 v23, v24, v25
v_cvt_pk_bf16_f32 v24, v26, v27
v_cvt_pk_bf16_f32 v25, v28, v29
buffer_store_dwordx4 v[22:25], v1, s[8:11], s76 offen offset:3072 sc1
s_mov_b32 s98, 3
s_cmp_eq_u32 s89, 2
s_cbranch_scc1 NOANTE
s_branch ONDIAG
ONCE9:
s_waitcnt vmcnt(8)
v_mov_b32 v6, s98
buffer_store_dword v6, off, s[8:11], s79 sc1
s_mov_b32 s98, 0
s_branch BACK9
ONDIAG:
s_waitcnt lgkmcnt(5)
v_mfma_f32_16x16x32_bf16 v[80:83], a[0:3], a[64:67], v[48:51]
v_exp_f32 v72, v72
v_mfma_f32_16x16x32_bf16 v[80:83], a[4:7], a[68:71], v[80:83]
s_mov_b32 m0, s94
ds_read_b128 a[28:31], v46 offset:23552
v_add_f32 v96, 0x00000000, v42
v_mfma_f32_16x16x32_bf16 v[88:91], a[4:7], a[100:103], v[52:55]
v_exp_f32 v73, v73
v_mfma_f32_16x16x32_bf16 v[88:91], a[0:3], a[96:99], v[88:91]
s_waitcnt lgkmcnt(3)
buffer_load_dwordx4 v3, s[8:11], s93 offen offset:0 sc1 lds
v_mfma_f32_16x16x32_bf16 v[88:91], a[8:11], a[104:107], v[88:91]
ds_read_b128 a[32:35], v46 offset:24576
v_min_f32 v96, v48, v96
v_mfma_f32_16x16x32_bf16 v[88:91], a[12:15], a[108:111], v[88:91]
ds_read_b128 a[36:39], v46 offset:25600
v_add_f32 v19, v72, v19
v_mfma_f32_16x16x32_bf16 v[80:83], a[12:15], a[76:79], v[80:83]
v_exp_f32 v74, v74
v_mfma_f32_16x16x32_bf16 v[80:83], a[8:11], a[72:75], v[80:83]
ds_read_b128 a[40:43], v46 offset:26624
v_add_f32 v97, 0xf1800000, v42
v_mfma_f32_16x16x32_bf16 v[80:83], a[16:19], a[80:83], v[80:83]
s_waitcnt lgkmcnt(3)
ds_read_b128 a[44:47], v46 offset:27648
v_add_f32 v19, v73, v19
v_mfma_f32_16x16x32_bf16 v[80:83], a[20:23], a[84:87], v[80:83]
ds_read_b128 a[48:51], v46 offset:28672
v_cvt_pk_bf16_f32 v72, v72, v73
v_mfma_f32_16x16x32_bf16 v[88:91], a[20:23], a[116:119], v[88:91]
buffer_load_dwordx4 v3, s[8:11], s93 offen offset:1024 sc1 lds
v_mfma_f32_16x16x32_bf16 v[88:91], a[16:19], a[112:115], v[88:91]
ds_read_b128 a[52:55], v46 offset:29696
v_min_f32 v97, v48, v97
v_mfma_f32_16x16x32_bf16 v[88:91], a[24:27], a[120:123], v[88:91]
v_exp_f32 v75, v75
v_mfma_f32_16x16x32_bf16 v[88:91], a[28:31], a[124:127], v[88:91]
v_add_f32 v19, v74, v19
v_add_f32 v98, 0xf2000000, v42
v_mfma_f32_16x16x32_bf16 v[80:83], a[28:31], a[92:95], v[80:83]
v_exp_f32 v76, v76
v_mfma_f32_16x16x32_bf16 v[80:83], a[24:27], a[88:91], v[80:83]
s_waitcnt lgkmcnt(2)
ds_read_b128 a[56:59], v46 offset:30720
v_min_f32 v98, v48, v98
v_mfma_f32_16x16x32_bf16 v[84:87], a[32:35], a[64:67], v[48:51]
ds_read_b128 a[60:63], v46 offset:31744
v_add_f32 v19, v75, v19
v_mfma_f32_16x16x32_bf16 v[84:87], a[36:39], a[68:71], v[84:87]
buffer_load_dwordx4 v3, s[8:11], s93 offen offset:2048 sc1 lds
v_mfma_f32_16x16x32_bf16 v[92:95], a[36:39], a[100:103], v[52:55]
ds_read_b128 a[0:3], v46 offset:0
v_cvt_pk_bf16_f32 v73, v74, v75
v_mfma_f32_16x16x32_bf16 v[92:95], a[32:35], a[96:99], v[92:95]
v_exp_f32 v77, v77
v_mfma_f32_16x16x32_bf16 v[92:95], a[40:43], a[104:107], v[92:95]
ds_read_b128 a[4:7], v46 offset:1024
v_add_f32 v99, 0xf2400000, v42
v_mfma_f32_16x16x32_bf16 v[92:95], a[44:47], a[108:111], v[92:95]
ds_read_b128 a[8:11], v46 offset:2048
v_add_f32 v19, v76, v19
v_mfma_f32_16x16x32_bf16 v[84:87], a[44:47], a[76:79], v[84:87]
ds_read_b128 a[12:15], v46 offset:3072
v_min_f32 v99, v48, v99
v_mfma_f32_16x16x32_bf16 v[84:87], a[40:43], a[72:75], v[84:87]
s_waitcnt lgkmcnt(4)
v_exp_f32 v78, v78
v_mfma_f32_16x16x32_bf16 v[84:87], a[48:51], a[80:83], v[84:87]
buffer_load_dwordx4 v3, s[8:11], s93 offen offset:3072 sc1 lds
v_mfma_f32_16x16x32_bf16 v[84:87], a[52:55], a[84:87], v[84:87]
s_add_u32 m0, s94, 4096
ds_read_b128 a[16:19], v46 offset:4096
v_add_f32 v100, 0xf3800000, v42
v_mfma_f32_16x16x32_bf16 v[92:95], a[52:55], a[116:119], v[92:95]
v_add_f32 v19, v77, v19
v_cvt_pk_bf16_f32 v74, v76, v77
v_mfma_f32_16x16x32_bf16 v[92:95], a[48:51], a[112:115], v[92:95]
v_exp_f32 v79, v79
v_mfma_f32_16x16x32_bf16 v[92:95], a[56:59], a[120:123], v[92:95]
ds_read_b128 a[20:23], v46 offset:5120
v_add_f32 v19, v78, v19
v_mfma_f32_16x16x32_bf16 v[92:95], a[60:63], a[124:127], v[92:95]
v_add_f32 v19, v79, v19
v_cvt_pk_bf16_f32 v75, v78, v79
v_mfma_f32_16x16x32_bf16 v[84:87], a[60:63], a[92:95], v[84:87]
ds_read_b128 a[24:27], v46 offset:6144
v_min_f32 v100, v48, v100
v_mfma_f32_16x16x32_bf16 v[84:87], a[56:59], a[88:91], v[84:87]
s_waitcnt lgkmcnt(3)
ds_read_b128 a[28:31], v46 offset:7168
v_add_f32 v101, 0xf3880000, v42
v_mfma_f32_16x16x32_bf16 v[128:131], a[0:3], v[64:67], v[128:131]
buffer_load_dwordx4 v4, s[8:11], s93 offen offset:0 sc1 lds
v_mfma_f32_16x16x32_bf16 v[192:195], a[0:3], v[72:75], v[192:195]
ds_read_b128 a[32:35], v46 offset:8192
v_min_f32 v101, v48, v101
v_mfma_f32_16x16x32_bf16 v[196:199], a[4:7], v[72:75], v[196:199]
ds_read_b128 a[36:39], v46 offset:9216
v_add_f32 v102, 0xf3900000, v42
v_mfma_f32_16x16x32_bf16 v[132:135], a[4:7], v[64:67], v[132:135]
ds_read_b128 a[40:43], v46 offset:10240
v_min_f32 v102, v48, v102
v_mfma_f32_16x16x32_bf16 v[136:139], a[8:11], v[64:67], v[136:139]
v_exp_f32 v80, v80
v_mfma_f32_16x16x32_bf16 v[200:203], a[8:11], v[72:75], v[200:203]
ds_read_b128 a[44:47], v46 offset:11264
ds_read_b128 a[48:51], v46 offset:12288
v_mfma_f32_16x16x32_bf16 v[204:207], a[12:15], v[72:75], v[204:207]
ds_read_b128 a[52:55], v46 offset:13312
ds_read_b128 a[56:59], v46 offset:14336
v_mfma_f32_16x16x32_bf16 v[140:143], a[12:15], v[64:67], v[140:143]
s_waitcnt lgkmcnt(7)
ds_read_b128 a[60:63], v46 offset:15360
v_add_f32 v103, 0xf3980000, v42
v_mfma_f32_16x16x32_bf16 v[144:147], a[16:19], v[64:67], v[144:147]
buffer_load_dwordx4 v4, s[8:11], s93 offen offset:1024 sc1 lds
v_mfma_f32_16x16x32_bf16 v[208:211], a[16:19], v[72:75], v[208:211]
v_exp_f32 v81, v81
v_mfma_f32_16x16x32_bf16 v[212:215], a[20:23], v[72:75], v[212:215]
v_add_f32 v18, v80, v18
v_min_f32 v103, v48, v103
v_mfma_f32_16x16x32_bf16 v[148:151], a[20:23], v[64:67], v[148:151]
v_exp_f32 v82, v82
v_mfma_f32_16x16x32_bf16 v[152:155], a[24:27], v[64:67], v[152:155]
buffer_load_dwordx4 v4, s[8:11], s93 offen offset:2048 sc1 lds
v_mfma_f32_16x16x32_bf16 v[216:219], a[24:27], v[72:75], v[216:219]
v_add_f32 v18, v81, v18
v_cvt_pk_bf16_f32 v80, v80, v81
v_mfma_f32_16x16x32_bf16 v[220:223], a[28:31], v[72:75], v[220:223]
buffer_load_dwordx4 v4, s[8:11], s93 offen offset:3072 sc1 lds
v_mfma_f32_16x16x32_bf16 v[156:159], a[28:31], v[64:67], v[156:159]
s_waitcnt lgkmcnt(0)
s_add_u32 s93, s93, 32768
v_exp_f32 v83, v83
v_mfma_f32_16x16x32_bf16 v[160:163], a[32:35], v[64:67], v[160:163]
s_add_u32 s94, s94, 32768
v_add_f32 v104, 0x00000000, v42
v_add_f32 v18, v82, v18
v_mfma_f32_16x16x32_bf16 v[224:227], a[32:35], v[72:75], v[224:227]
s_and_b32 s94, s94, 0x1ffff
v_exp_f32 v84, v84
v_mfma_f32_16x16x32_bf16 v[228:231], a[36:39], v[72:75], v[228:231]
s_waitcnt vmcnt(16) lgkmcnt(0)
v_min_f32 v104, v52, v104
v_add_f32 v18, v83, v18
v_mfma_f32_16x16x32_bf16 v[164:167], a[36:39], v[64:67], v[164:167]
s_barrier
v_add_f32 v105, 0xf1800000, v42
v_cvt_pk_bf16_f32 v81, v82, v83
v_mfma_f32_16x16x32_bf16 v[168:171], a[40:43], v[64:67], v[168:171]
s_cmp_lg_u32 s98, 0
v_exp_f32 v85, v85
v_mfma_f32_16x16x32_bf16 v[232:235], a[40:43], v[72:75], v[232:235]
s_cbranch_scc1 ONCE9
BACK9:
v_min_f32 v105, v52, v105
v_add_f32 v18, v84, v18
v_mfma_f32_16x16x32_bf16 v[236:239], a[44:47], v[72:75], v[236:239]
v_exp_f32 v86, v86
v_mfma_f32_16x16x32_bf16 v[172:175], a[44:47], v[64:67], v[172:175]
ds_read_b128 a[0:3], v46 offset:49152
v_add_f32 v106, 0xf2000000, v42
v_mfma_f32_16x16x32_bf16 v[176:179], a[48:51], v[64:67], v[176:179]
ds_read_b128 a[4:7], v46 offset:50176
v_add_f32 v18, v85, v18
v_mfma_f32_16x16x32_bf16 v[240:243], a[48:51], v[72:75], v[240:243]
ds_read_b128 a[8:11], v46 offset:51200
v_min_f32 v106, v52, v106
v_mfma_f32_16x16x32_bf16 v[244:247], a[52:55], v[72:75], v[244:247]
ds_read_b128 a[12:15], v46 offset:52224
v_cvt_pk_bf16_f32 v82, v84, v85
v_mfma_f32_16x16x32_bf16 v[180:183], a[52:55], v[64:67], v[180:183]
v_exp_f32 v87, v87
v_mfma_f32_16x16x32_bf16 v[184:187], a[56:59], v[64:67], v[184:187]
ds_read_b128 a[16:19], v46 offset:53248
v_add_f32 v107, 0xf2400000, v42
v_mfma_f32_16x16x32_bf16 v[248:251], a[56:59], v[72:75], v[248:251]
v_min_f32 v107, v52, v107
v_add_f32 v18, v86, v18
v_mfma_f32_16x16x32_bf16 v[252:255], a[60:63], v[72:75], v[252:255]
ds_read_b128 a[20:23], v46 offset:54272
v_add_f32 v18, v87, v18
v_mfma_f32_16x16x32_bf16 v[188:191], a[60:63], v[64:67], v[188:191]
s_waitcnt lgkmcnt(4)
ds_read_b128 a[24:27], v46 offset:55296
v_cvt_pk_bf16_f32 v83, v86, v87
v_mfma_f32_16x16x32_bf16 v[64:67], a[0:3], a[64:67], v[96:99]
ds_read_b128 a[28:31], v46 offset:56320
v_add_f32 v108, 0xf3800000, v42
v_mfma_f32_16x16x32_bf16 v[64:67], a[4:7], a[68:71], v[64:67]
s_mov_b32 m0, s94
v_exp_f32 v88, v88
v_mfma_f32_16x16x32_bf16 v[72:75], a[4:7], a[100:103], v[52:55]
v_exp_f32 v89, v89
v_mfma_f32_16x16x32_bf16 v[72:75], a[0:3], a[96:99], v[72:75]
s_waitcnt lgkmcnt(3)
ds_read_b128 a[32:35], v46 offset:57344
v_min_f32 v108, v52, v108
v_mfma_f32_16x16x32_bf16 v[72:75], a[8:11], a[104:107], v[72:75]
buffer_load_dwordx4 v3, s[8:11], s93 offen offset:0 sc1 lds
v_mfma_f32_16x16x32_bf16 v[72:75], a[12:15], a[108:111], v[72:75]
ds_read_b128 a[36:39], v46 offset:58368
v_add_f32 v19, v88, v19
v_mfma_f32_16x16x32_bf16 v[64:67], a[12:15], a[76:79], v[64:67]
v_exp_f32 v90, v90
v_mfma_f32_16x16x32_bf16 v[64:67], a[8:11], a[72:75], v[64:67]
ds_read_b128 a[40:43], v46 offset:59392
v_add_f32 v109, 0xf3880000, v42
v_mfma_f32_16x16x32_bf16 v[64:67], a[16:19], a[80:83], v[64:67]
s_waitcnt lgkmcnt(3)
ds_read_b128 a[44:47], v46 offset:60416
v_add_f32 v19, v89, v19
v_mfma_f32_16x16x32_bf16 v[64:67], a[20:23], a[84:87], v[64:67]
v_min_f32 v109, v52, v109
v_cvt_pk_bf16_f32 v88, v88, v89
v_mfma_f32_16x16x32_bf16 v[72:75], a[20:23], a[116:119], v[72:75]
ds_read_b128 a[48:51], v46 offset:61440
v_add_f32 v110, 0xf3900000, v42
v_mfma_f32_16x16x32_bf16 v[72:75], a[16:19], a[112:115], v[72:75]
buffer_load_dwordx4 v3, s[8:11], s93 offen offset:1024 sc1 lds
v_mfma_f32_16x16x32_bf16 v[72:75], a[24:27], a[120:123], v[72:75]
v_exp_f32 v91, v91
v_mfma_f32_16x16x32_bf16 v[72:75], a[28:31], a[124:127], v[72:75]
ds_read_b128 a[52:55], v46 offset:62464
v_add_f32 v19, v90, v19
v_mfma_f32_16x16x32_bf16 v[64:67], a[28:31], a[92:95], v[64:67]
ds_read_b128 a[56:59], v46 offset:63488
v_min_f32 v110, v52, v110
v_mfma_f32_16x16x32_bf16 v[64:67], a[24:27], a[88:91], v[64:67]
s_waitcnt lgkmcnt(3)
v_exp_f32 v92, v92
v_mfma_f32_16x16x32_bf16 v[68:71], a[32:35], a[64:67], v[100:103]
ds_read_b128 a[60:63], v46 offset:64512
v_add_f32 v19, v91, v19
v_mfma_f32_16x16x32_bf16 v[68:71], a[36:39], a[68:71], v[68:71]
buffer_load_dwordx4 v3, s[8:11], s93 offen offset:2048 sc1 lds
v_mfma_f32_16x16x32_bf16 v[76:79], a[36:39], a[100:103], v[52:55]
ds_read_b128 a[0:3], v46 offset:32768
v_cvt_pk_bf16_f32 v89, v90, v91
v_mfma_f32_16x16x32_bf16 v[76:79], a[32:35], a[96:99], v[76:79]
v_exp_f32 v93, v93
v_mfma_f32_16x16x32_bf16 v[76:79], a[40:43], a[104:107], v[76:79]
ds_read_b128 a[4:7], v46 offset:33792
v_add_f32 v111, 0xf3980000, v42
v_mfma_f32_16x16x32_bf16 v[76:79], a[44:47], a[108:111], v[76:79]
ds_read_b128 a[8:11], v46 offset:34816
v_min_f32 v111, v52, v111
v_mfma_f32_16x16x32_bf16 v[68:71], a[44:47], a[76:79], v[68:71]
ds_read_b128 a[12:15], v46 offset:35840
v_add_f32 v19, v92, v19
v_mfma_f32_16x16x32_bf16 v[68:71], a[40:43], a[72:75], v[68:71]
s_waitcnt lgkmcnt(4)
v_exp_f32 v94, v94
v_mfma_f32_16x16x32_bf16 v[68:71], a[48:51], a[80:83], v[68:71]
buffer_load_dwordx4 v3, s[8:11], s93 offen offset:3072 sc1 lds
v_mfma_f32_16x16x32_bf16 v[68:71], a[52:55], a[84:87], v[68:71]
s_add_u32 m0, s94, 4096
ds_read_b128 a[16:19], v46 offset:36864
v_add_f32 v19, v93, v19
v_mfma_f32_16x16x32_bf16 v[76:79], a[52:55], a[116:119], v[76:79]
ds_read_b128 a[20:23], v46 offset:37888
v_cvt_pk_bf16_f32 v90, v92, v93
v_mfma_f32_16x16x32_bf16 v[76:79], a[48:51], a[112:115], v[76:79]
v_exp_f32 v95, v95
v_mfma_f32_16x16x32_bf16 v[76:79], a[56:59], a[120:123], v[76:79]
v_add_f32 v19, v94, v19
v_add_f32 v96, 0xf4000000, v42
v_mfma_f32_16x16x32_bf16 v[76:79], a[60:63], a[124:127], v[76:79]
v_add_f32 v19, v95, v19
v_cvt_pk_bf16_f32 v91, v94, v95
v_mfma_f32_16x16x32_bf16 v[68:71], a[60:63], a[92:95], v[68:71]
ds_read_b128 a[24:27], v46 offset:38912
v_min_f32 v96, v48, v96
v_mfma_f32_16x16x32_bf16 v[68:71], a[56:59], a[88:91], v[68:71]
s_waitcnt lgkmcnt(3)
ds_read_b128 a[28:31], v46 offset:39936
v_add_f32 v97, 0xf4040000, v42
v_mfma_f32_16x16x32_bf16 v[128:131], a[0:3], v[80:83], v[128:131]
buffer_load_dwordx4 v4, s[8:11], s93 offen offset:0 sc1 lds
v_mfma_f32_16x16x32_bf16 v[192:195], a[0:3], v[88:91], v[192:195]
ds_read_b128 a[32:35], v46 offset:40960
v_min_f32 v97, v48, v97
v_mfma_f32_16x16x32_bf16 v[196:199], a[4:7], v[88:91], v[196:199]
ds_read_b128 a[36:39], v46 offset:41984
v_add_f32 v98, 0xf4080000, v42
v_mfma_f32_16x16x32_bf16 v[132:135], a[4:7], v[80:83], v[132:135]
ds_read_b128 a[40:43], v46 offset:43008
v_min_f32 v98, v48, v98
v_mfma_f32_16x16x32_bf16 v[136:139], a[8:11], v[80:83], v[136:139]
v_exp_f32 v64, v64
v_mfma_f32_16x16x32_bf16 v[200:203], a[8:11], v[88:91], v[200:203]
ds_read_b128 a[44:47], v46 offset:44032
ds_read_b128 a[48:51], v46 offset:45056
v_mfma_f32_16x16x32_bf16 v[204:207], a[12:15], v[88:91], v[204:207]
ds_read_b128 a[52:55], v46 offset:46080
v_add_f32 v99, 0xf40c0000, v42
v_mfma_f32_16x16x32_bf16 v[140:143], a[12:15], v[80:83], v[140:143]
s_waitcnt lgkmcnt(6)
ds_read_b128 a[56:59], v46 offset:47104
ds_read_b128 a[60:63], v46 offset:48128
v_mfma_f32_16x16x32_bf16 v[144:147], a[16:19], v[80:83], v[144:147]
buffer_load_dwordx4 v4, s[8:11], s93 offen offset:1024 sc1 lds
v_mfma_f32_16x16x32_bf16 v[208:211], a[16:19], v[88:91], v[208:211]
v_exp_f32 v65, v65
v_mfma_f32_16x16x32_bf16 v[212:215], a[20:23], v[88:91], v[212:215]
v_add_f32 v18, v64, v18
v_min_f32 v99, v48, v99
v_mfma_f32_16x16x32_bf16 v[148:151], a[20:23], v[80:83], v[148:151]
v_exp_f32 v66, v66
v_mfma_f32_16x16x32_bf16 v[152:155], a[24:27], v[80:83], v[152:155]
v_add_f32 v18, v65, v18
v_cvt_pk_bf16_f32 v64, v64, v65
v_mfma_f32_16x16x32_bf16 v[216:219], a[24:27], v[88:91], v[216:219]
buffer_load_dwordx4 v4, s[8:11], s93 offen offset:2048 sc1 lds
v_mfma_f32_16x16x32_bf16 v[220:223], a[28:31], v[88:91], v[220:223]
buffer_load_dwordx4 v4, s[8:11], s93 offen offset:3072 sc1 lds
v_mfma_f32_16x16x32_bf16 v[156:159], a[28:31], v[80:83], v[156:159]
s_waitcnt lgkmcnt(0)
s_add_u32 s93, s93, 32768
v_exp_f32 v67, v67
v_mfma_f32_16x16x32_bf16 v[160:163], a[32:35], v[80:83], v[160:163]
s_add_u32 s94, s94, 32768
v_add_f32 v100, 0xf4400000, v42
v_add_f32 v18, v66, v18
v_mfma_f32_16x16x32_bf16 v[224:227], a[32:35], v[88:91], v[224:227]
s_and_b32 s94, s94, 0x1ffff
v_xor_b32 v46, 0x10000, v46
v_min_f32 v100, v48, v100
v_mfma_f32_16x16x32_bf16 v[228:231], a[36:39], v[88:91], v[228:231]
s_waitcnt vmcnt(16) lgkmcnt(0)
v_exp_f32 v68, v68
v_mfma_f32_16x16x32_bf16 v[164:167], a[36:39], v[80:83], v[164:167]
s_barrier
v_add_f32 v18, v67, v18
v_add_f32 v101, 0xf4440000, v42
v_mfma_f32_16x16x32_bf16 v[168:171], a[40:43], v[80:83], v[168:171]
v_cvt_pk_bf16_f32 v65, v66, v67
v_min_f32 v101, v48, v101
v_mfma_f32_16x16x32_bf16 v[232:235], a[40:43], v[88:91], v[232:235]
v_exp_f32 v69, v69
v_mfma_f32_16x16x32_bf16 v[236:239], a[44:47], v[88:91], v[236:239]
ds_read_b128 a[0:3], v46 offset:16384
v_add_f32 v18, v68, v18
v_mfma_f32_16x16x32_bf16 v[172:175], a[44:47], v[80:83], v[172:175]
v_exp_f32 v70, v70
v_mfma_f32_16x16x32_bf16 v[176:179], a[48:51], v[80:83], v[176:179]
ds_read_b128 a[4:7], v46 offset:17408
v_add_f32 v102, 0xf4480000, v42
v_mfma_f32_16x16x32_bf16 v[240:243], a[48:51], v[88:91], v[240:243]
v_add_f32 v18, v69, v18
v_min_f32 v102, v48, v102
v_mfma_f32_16x16x32_bf16 v[244:247], a[52:55], v[88:91], v[244:247]
ds_read_b128 a[8:11], v46 offset:18432
v_cvt_pk_bf16_f32 v66, v68, v69
v_mfma_f32_16x16x32_bf16 v[180:183], a[52:55], v[80:83], v[180:183]
v_exp_f32 v71, v71
v_mfma_f32_16x16x32_bf16 v[184:187], a[56:59], v[80:83], v[184:187]
ds_read_b128 a[12:15], v46 offset:19456
v_add_f32 v103, 0xf44c0000, v42
v_mfma_f32_16x16x32_bf16 v[248:251], a[56:59], v[88:91], v[248:251]
ds_read_b128 a[16:19], v46 offset:20480
ds_read_b128 a[20:23], v46 offset:21504
v_add_f32 v18, v70, v18
v_min_f32 v103, v48, v103
v_mfma_f32_16x16x32_bf16 v[252:255], a[60:63], v[88:91], v[252:255]
ds_read_b128 a[24:27], v46 offset:22528
v_add_f32 v18, v71, v18
v_cvt_pk_bf16_f32 v67, v70, v71
v_mfma_f32_16x16x32_bf16 v[188:191], a[60:63], v[80:83], v[188:191]
s_branch DIAG
ONCE11:
s_waitcnt vmcnt(8)
v_mov_b32 v6, s98
buffer_store_dword v6, off, s[8:11], s79 sc1
s_mov_b32 s98, 0
s_branch BACK11
NOANTE:
v_add_f32 v104, 0x00000000, v42
v_min_f32 v104, v52, v104
v_add_f32 v105, 0xf1800000, v42
v_min_f32 v105, v52, v105
v_add_f32 v106, 0xf2000000, v42
v_min_f32 v106, v52, v106
v_add_f32 v107, 0xf2400000, v42
v_min_f32 v107, v52, v107
v_add_f32 v108, 0xf3800000, v42
v_min_f32 v108, v52, v108
v_add_f32 v109, 0xf3880000, v42
v_min_f32 v109, v52, v109
v_add_f32 v110, 0xf3900000, v42
v_min_f32 v110, v52, v110
v_add_f32 v111, 0xf3980000, v42
v_min_f32 v111, v52, v111
v_add_f32 v100, 0xf4400000, v42
v_min_f32 v100, v48, v100
v_add_f32 v101, 0xf4440000, v42
v_min_f32 v101, v48, v101
v_add_f32 v102, 0xf4480000, v42
v_min_f32 v102, v48, v102
v_add_f32 v103, 0xf44c0000, v42
v_min_f32 v103, v48, v103
v_add_f32 v96, 0xf4000000, v42
v_min_f32 v96, v48, v96
v_add_f32 v97, 0xf4040000, v42
v_min_f32 v97, v48, v97
v_add_f32 v98, 0xf4080000, v42
v_min_f32 v98, v48, v98
v_add_f32 v99, 0xf40c0000, v42
v_min_f32 v99, v48, v99
DIAG:
s_sub_u32 s63, s101, 32768
s_cmp_ge_u32 s73, 2
s_cselect_b32 s93, s63, s93
s_waitcnt lgkmcnt(5)
v_mfma_f32_16x16x32_bf16 v[80:83], a[0:3], a[64:67], v[96:99]
v_exp_f32 v72, v72
v_mfma_f32_16x16x32_bf16 v[80:83], a[4:7], a[68:71], v[80:83]
s_mov_b32 m0, s94
ds_read_b128 a[28:31], v46 offset:23552
v_mfma_f32_16x16x32_bf16 v[88:91], a[4:7], a[100:103], v[52:55]
v_exp_f32 v73, v73
v_mfma_f32_16x16x32_bf16 v[88:91], a[0:3], a[96:99], v[88:91]
s_waitcnt lgkmcnt(3)
buffer_load_dwordx4 v3, s[8:11], s93 offen offset:0 sc1 lds
v_mfma_f32_16x16x32_bf16 v[88:91], a[8:11], a[104:107], v[88:91]
ds_read_b128 a[32:35], v46 offset:24576
v_add_f32 v19, v72, v19
v_mfma_f32_16x16x32_bf16 v[88:91], a[12:15], a[108:111], v[88:91]
v_exp_f32 v74, v74
v_mfma_f32_16x16x32_bf16 v[80:83], a[12:15], a[76:79], v[80:83]
ds_read_b128 a[36:39], v46 offset:25600
v_add_f32 v19, v73, v19
v_mfma_f32_16x16x32_bf16 v[80:83], a[8:11], a[72:75], v[80:83]
ds_read_b128 a[40:43], v46 offset:26624
v_cvt_pk_bf16_f32 v72, v72, v73
v_mfma_f32_16x16x32_bf16 v[80:83], a[16:19], a[80:83], v[80:83]
s_waitcnt lgkmcnt(3)
v_exp_f32 v75, v75
v_mfma_f32_16x16x32_bf16 v[80:83], a[20:23], a[84:87], v[80:83]
ds_read_b128 a[44:47], v46 offset:27648
v_add_f32 v19, v74, v19
v_mfma_f32_16x16x32_bf16 v[88:91], a[20:23], a[116:119], v[88:91]
buffer_load_dwordx4 v3, s[8:11], s93 offen offset:1024 sc1 lds
v_mfma_f32_16x16x32_bf16 v[88:91], a[16:19], a[112:115], v[88:91]
ds_read_b128 a[48:51], v46 offset:28672
ds_read_b128 a[52:55], v46 offset:29696
v_mfma_f32_16x16x32_bf16 v[88:91], a[24:27], a[120:123], v[88:91]
v_exp_f32 v76, v76
v_mfma_f32_16x16x32_bf16 v[88:91], a[28:31], a[124:127], v[88:91]
ds_read_b128 a[56:59], v46 offset:30720
v_add_f32 v19, v75, v19
v_mfma_f32_16x16x32_bf16 v[80:83], a[28:31], a[92:95], v[80:83]
ds_read_b128 a[60:63], v46 offset:31744
v_cvt_pk_bf16_f32 v73, v74, v75
v_mfma_f32_16x16x32_bf16 v[80:83], a[24:27], a[88:91], v[80:83]
s_waitcnt lgkmcnt(5)
v_exp_f32 v77, v77
v_mfma_f32_16x16x32_bf16 v[84:87], a[32:35], a[64:67], v[100:103]
buffer_load_dwordx4 v3, s[8:11], s93 offen offset:2048 sc1 lds
v_mfma_f32_16x16x32_bf16 v[84:87], a[36:39], a[68:71], v[84:87]
ds_read_b128 a[0:3], v46 offset:0
v_add_f32 v19, v76, v19
v_mfma_f32_16x16x32_bf16 v[92:95], a[36:39], a[100:103], v[52:55]
v_exp_f32 v78, v78
v_mfma_f32_16x16x32_bf16 v[92:95], a[32:35], a[96:99], v[92:95]
ds_read_b128 a[4:7], v46 offset:1024
v_add_f32 v19, v77, v19
v_mfma_f32_16x16x32_bf16 v[92:95], a[40:43], a[104:107], v[92:95]
s_waitcnt lgkmcnt(3)
ds_read_b128 a[8:11], v46 offset:2048
v_cvt_pk_bf16_f32 v74, v76, v77
v_mfma_f32_16x16x32_bf16 v[92:95], a[44:47], a[108:111], v[92:95]
v_exp_f32 v79, v79
v_mfma_f32_16x16x32_bf16 v[84:87], a[44:47], a[76:79], v[84:87]
ds_read_b128 a[12:15], v46 offset:3072
v_add_f32 v19, v78, v19
v_mfma_f32_16x16x32_bf16 v[84:87], a[40:43], a[72:75], v[84:87]
v_add_f32 v19, v79, v19
v_cvt_pk_bf16_f32 v75, v78, v79
v_mfma_f32_16x16x32_bf16 v[84:87], a[48:51], a[80:83], v[84:87]
buffer_load_dwordx4 v3, s[8:11], s93 offen offset:3072 sc1 lds
v_mfma_f32_16x16x32_bf16 v[84:87], a[52:55], a[84:87], v[84:87]
s_add_u32 m0, s94, 4096
ds_read_b128 a[16:19], v46 offset:4096
ds_read_b128 a[20:23], v46 offset:5120
v_mfma_f32_16x16x32_bf16 v[92:95], a[52:55], a[116:119], v[92:95]
v_exp_f32 v80, v80
v_mfma_f32_16x16x32_bf16 v[92:95], a[48:51], a[112:115], v[92:95]
v_exp_f32 v81, v81
v_mfma_f32_16x16x32_bf16 v[92:95], a[56:59], a[120:123], v[92:95]
s_waitcnt lgkmcnt(3)
ds_read_b128 a[24:27], v46 offset:6144
v_add_f32 v18, v80, v18
v_mfma_f32_16x16x32_bf16 v[92:95], a[60:63], a[124:127], v[92:95]
buffer_load_dwordx4 v4, s[8:11], s93 offen offset:0 sc1 lds
v_mfma_f32_16x16x32_bf16 v[84:87], a[60:63], a[92:95], v[84:87]
ds_read_b128 a[28:31], v46 offset:7168
ds_read_b128 a[32:35], v46 offset:8192
v_mfma_f32_16x16x32_bf16 v[84:87], a[56:59], a[88:91], v[84:87]
v_exp_f32 v82, v82
v_mfma_f32_16x16x32_bf16 v[128:131], a[0:3], v[64:67], v[128:131]
ds_read_b128 a[36:39], v46 offset:9216
v_add_f32 v18, v81, v18
v_mfma_f32_16x16x32_bf16 v[192:195], a[0:3], v[72:75], v[192:195]
ds_read_b128 a[40:43], v46 offset:10240
v_cvt_pk_bf16_f32 v80, v80, v81
v_mfma_f32_16x16x32_bf16 v[196:199], a[4:7], v[72:75], v[196:199]
v_exp_f32 v83, v83
v_mfma_f32_16x16x32_bf16 v[132:135], a[4:7], v[64:67], v[132:135]
buffer_load_dwordx4 v4, s[8:11], s93 offen offset:1024 sc1 lds
v_mfma_f32_16x16x32_bf16 v[136:139], a[8:11], v[64:67], v[136:139]
ds_read_b128 a[44:47], v46 offset:11264
v_add_f32 v18, v82, v18
v_mfma_f32_16x16x32_bf16 v[200:203], a[8:11], v[72:75], v[200:203]
s_waitcnt lgkmcnt(3)
v_exp_f32 v84, v84
v_mfma_f32_16x16x32_bf16 v[204:207], a[12:15], v[72:75], v[204:207]
ds_read_b128 a[48:51], v46 offset:12288
v_add_f32 v18, v83, v18
v_mfma_f32_16x16x32_bf16 v[140:143], a[12:15], v[64:67], v[140:143]
ds_read_b128 a[52:55], v46 offset:13312
ds_read_b128 a[56:59], v46 offset:14336
v_mfma_f32_16x16x32_bf16 v[144:147], a[16:19], v[64:67], v[144:147]
ds_read_b128 a[60:63], v46 offset:15360
v_cvt_pk_bf16_f32 v81, v82, v83
v_mfma_f32_16x16x32_bf16 v[208:211], a[16:19], v[72:75], v[208:211]
v_exp_f32 v85, v85
v_mfma_f32_16x16x32_bf16 v[212:215], a[20:23], v[72:75], v[212:215]
buffer_load_dwordx4 v4, s[8:11], s93 offen offset:2048 sc1 lds
v_mfma_f32_16x16x32_bf16 v[148:151], a[20:23], v[64:67], v[148:151]
v_add_f32 v18, v84, v18
v_mfma_f32_16x16x32_bf16 v[152:155], a[24:27], v[64:67], v[152:155]
v_exp_f32 v86, v86
v_mfma_f32_16x16x32_bf16 v[216:219], a[24:27], v[72:75], v[216:219]
v_add_f32 v18, v85, v18
v_cvt_pk_bf16_f32 v82, v84, v85
v_mfma_f32_16x16x32_bf16 v[220:223], a[28:31], v[72:75], v[220:223]
buffer_load_dwordx4 v4, s[8:11], s93 offen offset:3072 sc1 lds
v_mfma_f32_16x16x32_bf16 v[156:159], a[28:31], v[64:67], v[156:159]
s_add_u32 s93, s93, 32768
v_exp_f32 v87, v87
v_mfma_f32_16x16x32_bf16 v[160:163], a[32:35], v[64:67], v[160:163]
s_add_u32 s94, s94, 32768
v_add_f32 v18, v86, v18
v_add_f32 v18, v87, v18
v_mfma_f32_16x16x32_bf16 v[224:227], a[32:35], v[72:75], v[224:227]
s_waitcnt lgkmcnt(0)
s_and_b32 s94, s94, 0x1ffff
v_mfma_f32_16x16x32_bf16 v[228:231], a[36:39], v[72:75], v[228:231]
s_waitcnt vmcnt(16) lgkmcnt(0)
v_cvt_pk_bf16_f32 v83, v86, v87
v_mfma_f32_16x16x32_bf16 v[164:167], a[36:39], v[64:67], v[164:167]
s_barrier
s_cmp_lg_u32 s98, 0
s_cbranch_scc1 ONCE11
BACK11:
v_mfma_f32_16x16x32_bf16 v[168:171], a[40:43], v[64:67], v[168:171]
v_exp_f32 v88, v88
v_mfma_f32_16x16x32_bf16 v[232:235], a[40:43], v[72:75], v[232:235]
s_mov_b32 m0, s94
v_exp_f32 v89, v89
v_mfma_f32_16x16x32_bf16 v[236:239], a[44:47], v[72:75], v[236:239]
ds_read_b128 a[0:3], v46 offset:49152
v_add_f32 v19, v88, v19
v_mfma_f32_16x16x32_bf16 v[172:175], a[44:47], v[64:67], v[172:175]
ds_read_b128 a[4:7], v46 offset:50176
ds_read_b128 a[8:11], v46 offset:51200
v_mfma_f32_16x16x32_bf16 v[176:179], a[48:51], v[64:67], v[176:179]
buffer_load_dwordx4 v38, s[16:19], s101 offen offset:0 sc1 lds
v_mfma_f32_16x16x32_bf16 v[240:243], a[48:51], v[72:75], v[240:243]
v_exp_f32 v90, v90
v_mfma_f32_16x16x32_bf16 v[244:247], a[52:55], v[72:75], v[244:247]
ds_read_b128 a[12:15], v46 offset:52224
v_add_f32 v19, v89, v19
v_mfma_f32_16x16x32_bf16 v[180:183], a[52:55], v[64:67], v[180:183]
ds_read_b128 a[16:19], v46 offset:53248
v_cvt_pk_bf16_f32 v88, v88, v89
v_mfma_f32_16x16x32_bf16 v[184:187], a[56:59], v[64:67], v[184:187]
ds_read_b128 a[20:23], v46 offset:54272
ds_read_b128 a[24:27], v46 offset:55296
v_mfma_f32_16x16x32_bf16 v[248:251], a[56:59], v[72:75], v[248:251]
buffer_load_dwordx4 v39, s[16:19], s101 offen offset:1024 sc1 lds
v_mfma_f32_16x16x32_bf16 v[252:255], a[60:63], v[72:75], v[252:255]
v_exp_f32 v91, v91
v_mfma_f32_16x16x32_bf16 v[188:191], a[60:63], v[64:67], v[188:191]
s_waitcnt lgkmcnt(4)
ds_read_b128 a[28:31], v46 offset:56320
v_add_f32 v19, v90, v19
v_mfma_f32_16x16x32_bf16 v[72:75], a[0:3], a[96:99], v[104:107]
ds_read_b128 a[32:35], v46 offset:57344
ds_read_b128 a[36:39], v46 offset:58368
v_mfma_f32_16x16x32_bf16 v[72:75], a[4:7], a[100:103], v[72:75]
v_exp_f32 v92, v92
v_mfma_f32_16x16x32_bf16 v[72:75], a[8:11], a[104:107], v[72:75]
s_waitcnt lgkmcnt(5)
ds_read_b128 a[40:43], v46 offset:59392
v_add_f32 v19, v91, v19
v_mfma_f32_16x16x32_bf16 v[72:75], a[12:15], a[108:111], v[72:75]
ds_read_b128 a[44:47], v46 offset:60416
v_cvt_pk_bf16_f32 v89, v90, v91
v_mfma_f32_16x16x32_bf16 v[72:75], a[16:19], a[112:115], v[72:75]
s_waitcnt lgkmcnt(5)
buffer_load_dwordx4 v40, s[16:19], s101 offen offset:2048 sc1 lds
v_mfma_f32_16x16x32_bf16 v[72:75], a[20:23], a[116:119], v[72:75]
ds_read_b128 a[48:51], v46 offset:61440
ds_read_b128 a[52:55], v46 offset:62464
v_mfma_f32_16x16x32_bf16 v[72:75], a[24:27], a[120:123], v[72:75]
s_waitcnt lgkmcnt(6)
v_exp_f32 v93, v93
v_mfma_f32_16x16x32_bf16 v[72:75], a[28:31], a[124:127], v[72:75]
s_waitcnt lgkmcnt(4)
ds_read_b128 a[56:59], v46 offset:63488
v_add_f32 v19, v92, v19
v_mfma_f32_16x16x32_bf16 v[76:79], a[32:35], a[96:99], v[108:111]
ds_read_b128 a[60:63], v46 offset:64512
ds_read_b128 a[0:3], v46 offset:32768
v_mfma_f32_16x16x32_bf16 v[76:79], a[36:39], a[100:103], v[76:79]
s_waitcnt lgkmcnt(6)
v_exp_f32 v94, v94
v_mfma_f32_16x16x32_bf16 v[76:79], a[40:43], a[104:107], v[76:79]
s_waitcnt lgkmcnt(5)
v_add_f32 v19, v93, v19
v_cvt_pk_bf16_f32 v90, v92, v93
v_mfma_f32_16x16x32_bf16 v[76:79], a[44:47], a[108:111], v[76:79]
s_waitcnt lgkmcnt(4)
ds_read_b128 a[4:7], v46 offset:33792
v_exp_f32 v95, v95
v_mfma_f32_16x16x32_bf16 v[76:79], a[48:51], a[112:115], v[76:79]
s_waitcnt lgkmcnt(4)
ds_read_b128 a[8:11], v46 offset:34816
v_add_f32 v19, v94, v19
v_mfma_f32_16x16x32_bf16 v[76:79], a[52:55], a[116:119], v[76:79]
s_waitcnt lgkmcnt(4)
ds_read_b128 a[12:15], v46 offset:35840
v_add_f32 v19, v95, v19
v_cvt_pk_bf16_f32 v91, v94, v95
v_mfma_f32_16x16x32_bf16 v[76:79], a[56:59], a[120:123], v[76:79]
s_waitcnt lgkmcnt(4)
ds_read_b128 a[16:19], v46 offset:36864
ds_read_b128 a[20:23], v46 offset:37888
v_mfma_f32_16x16x32_bf16 v[76:79], a[60:63], a[124:127], v[76:79]
s_waitcnt lgkmcnt(5)
ds_read_b128 a[24:27], v46 offset:38912
ds_read_b128 a[28:31], v46 offset:39936
v_mfma_f32_16x16x32_bf16 v[128:131], a[0:3], v[80:83], v[128:131]
ds_read_b128 a[32:35], v46 offset:40960
ds_read_b128 a[36:39], v46 offset:41984
v_mfma_f32_16x16x32_bf16 v[192:195], a[0:3], v[88:91], v[192:195]
s_waitcnt lgkmcnt(8)
ds_read_b128 a[40:43], v46 offset:43008
ds_read_b128 a[44:47], v46 offset:44032
v_mfma_f32_16x16x32_bf16 v[196:199], a[4:7], v[88:91], v[196:199]
buffer_load_dwordx4 v41, s[16:19], s101 offen offset:3072 sc1 lds
ds_read_b128 a[48:51], v46 offset:45056
ds_read_b128 a[52:55], v46 offset:46080
v_mfma_f32_16x16x32_bf16 v[132:135], a[4:7], v[80:83], v[132:135]
s_waitcnt lgkmcnt(11)
s_add_u32 m0, s94, 4096
ds_read_b128 a[56:59], v46 offset:47104
ds_read_b128 a[60:63], v46 offset:48128
v_mfma_f32_16x16x32_bf16 v[136:139], a[8:11], v[80:83], v[136:139]
buffer_load_dwordx4 v38, s[16:19], s70 offen offset:0 sc1 lds
v_mfma_f32_16x16x32_bf16 v[200:203], a[8:11], v[88:91], v[200:203]
s_waitcnt lgkmcnt(10)
buffer_load_dwordx4 v39, s[16:19], s70 offen offset:1024 sc1 lds
v_mfma_f32_16x16x32_bf16 v[204:207], a[12:15], v[88:91], v[204:207]
buffer_load_dwordx4 v40, s[16:19], s70 offen offset:2048 sc1 lds
v_mfma_f32_16x16x32_bf16 v[140:143], a[12:15], v[80:83], v[140:143]
buffer_load_dwordx4 v41, s[16:19], s70 offen offset:3072 sc1 lds
v_mfma_f32_16x16x32_bf16 v[144:147], a[16:19], v[80:83], v[144:147]
s_add_u32 s101, s101, s71
v_add_f32 v104, 0xf4000000, v42
v_min_f32 v104, v52, v104
v_mfma_f32_16x16x32_bf16 v[208:211], a[16:19], v[88:91], v[208:211]
s_add_u32 s70, s70, s71
v_add_f32 v105, 0xf4040000, v42
v_min_f32 v105, v52, v105
v_mfma_f32_16x16x32_bf16 v[212:215], a[20:23], v[88:91], v[212:215]
s_add_u32 s94, s94, 32768
v_xor_b32 v46, 0x10000, v46
v_add_f32 v106, 0xf4080000, v42
v_mfma_f32_16x16x32_bf16 v[148:151], a[20:23], v[80:83], v[148:151]
s_waitcnt vmcnt(16) lgkmcnt(0)
s_and_b32 s94, s94, 0x1ffff
v_min_f32 v106, v52, v106
v_mfma_f32_16x16x32_bf16 v[152:155], a[24:27], v[80:83], v[152:155]
s_barrier
v_exp_f32 v72, v72
v_mfma_f32_16x16x32_bf16 v[216:219], a[24:27], v[88:91], v[216:219]
v_exp_f32 v73, v73
v_mfma_f32_16x16x32_bf16 v[220:223], a[28:31], v[88:91], v[220:223]
s_mov_b32 m0, s94
v_add_f32 v19, v72, v19
v_add_f32 v107, 0xf40c0000, v42
v_mfma_f32_16x16x32_bf16 v[156:159], a[28:31], v[80:83], v[156:159]
v_exp_f32 v74, v74
v_mfma_f32_16x16x32_bf16 v[160:163], a[32:35], v[80:83], v[160:163]
v_add_f32 v19, v73, v19
v_cvt_pk_bf16_f32 v72, v72, v73
v_mfma_f32_16x16x32_bf16 v[224:227], a[32:35], v[88:91], v[224:227]
v_exp_f32 v75, v75
v_mfma_f32_16x16x32_bf16 v[228:231], a[36:39], v[88:91], v[228:231]
ds_read_b128 a[0:3], v46 offset:16384
v_min_f32 v107, v52, v107
v_mfma_f32_16x16x32_bf16 v[164:167], a[36:39], v[80:83], v[164:167]
v_add_f32 v19, v74, v19
v_add_f32 v108, 0xf4400000, v42
v_mfma_f32_16x16x32_bf16 v[168:171], a[40:43], v[80:83], v[168:171]
ds_read_b128 a[4:7], v46 offset:17408
v_min_f32 v108, v52, v108
v_mfma_f32_16x16x32_bf16 v[232:235], a[40:43], v[88:91], v[232:235]
v_exp_f32 v76, v76
v_mfma_f32_16x16x32_bf16 v[236:239], a[44:47], v[88:91], v[236:239]
buffer_load_dwordx4 v38, s[16:19], s101 offen offset:0 sc1 lds
v_mfma_f32_16x16x32_bf16 v[172:175], a[44:47], v[80:83], v[172:175]
ds_read_b128 a[8:11], v46 offset:18432
v_add_f32 v19, v75, v19
v_mfma_f32_16x16x32_bf16 v[176:179], a[48:51], v[80:83], v[176:179]
ds_read_b128 a[12:15], v46 offset:19456
v_cvt_pk_bf16_f32 v73, v74, v75
v_mfma_f32_16x16x32_bf16 v[240:243], a[48:51], v[88:91], v[240:243]
v_exp_f32 v77, v77
v_mfma_f32_16x16x32_bf16 v[244:247], a[52:55], v[88:91], v[244:247]
ds_read_b128 a[16:19], v46 offset:20480
v_add_f32 v19, v76, v19
v_mfma_f32_16x16x32_bf16 v[180:183], a[52:55], v[80:83], v[180:183]
ds_read_b128 a[20:23], v46 offset:21504
v_add_f32 v109, 0xf4440000, v42
v_min_f32 v109, v52, v109
v_exp_f32 v78, v78
v_mfma_f32_16x16x32_bf16 v[184:187], a[56:59], v[80:83], v[184:187]
ds_read_b128 a[24:27], v46 offset:22528
ds_read_b128 a[28:31], v46 offset:23552
v_add_f32 v110, 0xf4480000, v42
v_add_f32 v19, v77, v19
v_min_f32 v110, v52, v110
v_cvt_pk_bf16_f32 v74, v76, v77
v_mfma_f32_16x16x32_bf16 v[248:251], a[56:59], v[88:91], v[248:251]
ds_read_b128 a[32:35], v46 offset:24576
ds_read_b128 a[36:39], v46 offset:25600
v_exp_f32 v79, v79
v_add_f32 v111, 0xf44c0000, v42
v_min_f32 v111, v52, v111
v_mfma_f32_16x16x32_bf16 v[252:255], a[60:63], v[88:91], v[252:255]
ds_read_b128 a[40:43], v46 offset:26624
ds_read_b128 a[44:47], v46 offset:27648
v_add_f32 v19, v78, v19
v_mfma_f32_16x16x32_bf16 v[188:191], a[60:63], v[80:83], v[188:191]
s_waitcnt lgkmcnt(8)
ds_read_b128 a[48:51], v46 offset:28672
ds_read_b128 a[52:55], v46 offset:29696
v_add_f32 v19, v79, v19
v_cvt_pk_bf16_f32 v75, v78, v79
v_mfma_f32_16x16x32_bf16 v[88:91], a[0:3], a[96:99], v[104:107]
ds_read_b128 a[56:59], v46 offset:30720
ds_read_b128 a[60:63], v46 offset:31744
v_mfma_f32_16x16x32_bf16 v[88:91], a[4:7], a[100:103], v[88:91]
buffer_load_dwordx4 v39, s[16:19], s101 offen offset:1024 sc1 lds
v_mfma_f32_16x16x32_bf16 v[88:91], a[8:11], a[104:107], v[88:91]
buffer_load_dwordx4 v40, s[16:19], s101 offen offset:2048 sc1 lds
v_mfma_f32_16x16x32_bf16 v[88:91], a[12:15], a[108:111], v[88:91]
s_waitcnt lgkmcnt(8)
buffer_load_dwordx4 v41, s[16:19], s101 offen offset:3072 sc1 lds
v_mfma_f32_16x16x32_bf16 v[88:91], a[16:19], a[112:115], v[88:91]
s_add_u32 m0, s94, 4096
ds_read_b128 a[0:3], v46 offset:0
ds_read_b128 a[4:7], v46 offset:1024
v_mfma_f32_16x16x32_bf16 v[88:91], a[20:23], a[116:119], v[88:91]
ds_read_b128 a[8:11], v46 offset:2048
ds_read_b128 a[12:15], v46 offset:3072
v_mfma_f32_16x16x32_bf16 v[88:91], a[24:27], a[120:123], v[88:91]
ds_read_b128 a[16:19], v46 offset:4096
ds_read_b128 a[20:23], v46 offset:5120
v_mfma_f32_16x16x32_bf16 v[88:91], a[28:31], a[124:127], v[88:91]
s_waitcnt lgkmcnt(6)
buffer_load_dwordx4 v38, s[16:19], s70 offen offset:0 sc1 lds
v_mfma_f32_16x16x32_bf16 v[92:95], a[32:35], a[96:99], v[108:111]
ds_read_b128 a[24:27], v46 offset:6144
ds_read_b128 a[28:31], v46 offset:7168
v_mfma_f32_16x16x32_bf16 v[92:95], a[36:39], a[100:103], v[92:95]
ds_read_b128 a[32:35], v46 offset:8192
v_mfma_f32_16x16x32_bf16 v[92:95], a[40:43], a[104:107], v[92:95]
ds_read_b128 a[36:39], v46 offset:9216
v_mfma_f32_16x16x32_bf16 v[92:95], a[44:47], a[108:111], v[92:95]
ds_read_b128 a[40:43], v46 offset:10240
v_mfma_f32_16x16x32_bf16 v[92:95], a[48:51], a[112:115], v[92:95]
v_exp_f32 v88, v88
v_mfma_f32_16x16x32_bf16 v[92:95], a[52:55], a[116:119], v[92:95]
v_exp_f32 v89, v89
v_mfma_f32_16x16x32_bf16 v[92:95], a[56:59], a[120:123], v[92:95]
ds_read_b128 a[44:47], v46 offset:11264
v_add_f32 v19, v88, v19
v_mfma_f32_16x16x32_bf16 v[92:95], a[60:63], a[124:127], v[92:95]
s_waitcnt lgkmcnt(4)
ds_read_b128 a[48:51], v46 offset:12288
ds_read_b128 a[52:55], v46 offset:13312
v_mfma_f32_16x16x32_bf16 v[192:195], a[0:3], v[72:75], v[192:195]
ds_read_b128 a[56:59], v46 offset:14336
ds_read_b128 a[60:63], v46 offset:15360
v_exp_f32 v90, v90
v_mfma_f32_16x16x32_bf16 v[196:199], a[4:7], v[72:75], v[196:199]
v_add_f32 v19, v89, v19
v_cvt_pk_bf16_f32 v88, v88, v89
v_mfma_f32_16x16x32_bf16 v[200:203], a[8:11], v[72:75], v[200:203]
v_exp_f32 v91, v91
v_mfma_f32_16x16x32_bf16 v[204:207], a[12:15], v[72:75], v[204:207]
v_add_f32 v19, v90, v19
v_mfma_f32_16x16x32_bf16 v[208:211], a[16:19], v[72:75], v[208:211]
v_exp_f32 v92, v92
v_mfma_f32_16x16x32_bf16 v[212:215], a[20:23], v[72:75], v[212:215]
v_add_f32 v19, v91, v19
v_cvt_pk_bf16_f32 v89, v90, v91
v_mfma_f32_16x16x32_bf16 v[216:219], a[24:27], v[72:75], v[216:219]
buffer_load_dwordx4 v39, s[16:19], s70 offen offset:1024 sc1 lds
v_mfma_f32_16x16x32_bf16 v[220:223], a[28:31], v[72:75], v[220:223]
s_waitcnt vmcnt(14) lgkmcnt(0)
v_exp_f32 v93, v93
v_mfma_f32_16x16x32_bf16 v[224:227], a[32:35], v[72:75], v[224:227]
s_barrier
v_add_f32 v19, v92, v19
v_mfma_f32_16x16x32_bf16 v[228:231], a[36:39], v[72:75], v[228:231]
ds_read_b128 a[0:3], v46 offset:32768
v_exp_f32 v94, v94
v_mfma_f32_16x16x32_bf16 v[232:235], a[40:43], v[72:75], v[232:235]
buffer_load_dwordx4 v40, s[16:19], s70 offen offset:2048 sc1 lds
ds_read_b128 a[4:7], v46 offset:33792
v_add_f32 v19, v93, v19
v_cvt_pk_bf16_f32 v90, v92, v93
v_mfma_f32_16x16x32_bf16 v[236:239], a[44:47], v[72:75], v[236:239]
buffer_load_dwordx4 v41, s[16:19], s70 offen offset:3072 sc1 lds
ds_read_b128 a[8:11], v46 offset:34816
v_exp_f32 v95, v95
v_mfma_f32_16x16x32_bf16 v[240:243], a[48:51], v[72:75], v[240:243]
s_add_u32 s101, s101, s71
ds_read_b128 a[12:15], v46 offset:35840
v_add_f32 v19, v94, v19
v_mfma_f32_16x16x32_bf16 v[244:247], a[52:55], v[72:75], v[244:247]
s_add_u32 s70, s70, s71
ds_read_b128 a[16:19], v46 offset:36864
v_add_f32 v19, v95, v19
v_cvt_pk_bf16_f32 v91, v94, v95
v_mfma_f32_16x16x32_bf16 v[248:251], a[56:59], v[72:75], v[248:251]
s_add_u32 s94, s94, 32768
ds_read_b128 a[20:23], v46 offset:37888
v_mfma_f32_16x16x32_bf16 v[252:255], a[60:63], v[72:75], v[252:255]
s_waitcnt lgkmcnt(5)
s_and_b32 s94, s94, 0x1ffff
ds_read_b128 a[24:27], v46 offset:38912
v_mfma_f32_16x16x32_bf16 v[192:195], a[0:3], v[88:91], v[192:195]
s_waitcnt lgkmcnt(5)
s_xor_b32 s65, s81, 0xf0
ds_read_b128 a[28:31], v46 offset:39936
v_mfma_f32_16x16x32_bf16 v[196:199], a[4:7], v[88:91], v[196:199]
s_waitcnt lgkmcnt(5)
buffer_load_dword v7, off, s[8:11], s65 sc1
ds_read_b128 a[32:35], v46 offset:40960
v_mfma_f32_16x16x32_bf16 v[200:203], a[8:11], v[88:91], v[200:203]
s_waitcnt lgkmcnt(5)
ds_read_b128 a[36:39], v46 offset:41984
v_mfma_f32_16x16x32_bf16 v[204:207], a[12:15], v[88:91], v[204:207]
s_waitcnt lgkmcnt(5)
ds_read_b128 a[40:43], v46 offset:43008
v_mfma_f32_16x16x32_bf16 v[208:211], a[16:19], v[88:91], v[208:211]
s_waitcnt lgkmcnt(5)
ds_read_b128 a[44:47], v46 offset:44032
v_mfma_f32_16x16x32_bf16 v[212:215], a[20:23], v[88:91], v[212:215]
s_waitcnt lgkmcnt(5)
ds_read_b128 a[48:51], v46 offset:45056
v_mfma_f32_16x16x32_bf16 v[216:219], a[24:27], v[88:91], v[216:219]
s_waitcnt lgkmcnt(5)
ds_read_b128 a[52:55], v46 offset:46080
v_mfma_f32_16x16x32_bf16 v[220:223], a[28:31], v[88:91], v[220:223]
s_waitcnt lgkmcnt(5)
ds_read_b128 a[56:59], v46 offset:47104
ds_read_b128 a[60:63], v46 offset:48128
v_mfma_f32_16x16x32_bf16 v[224:227], a[32:35], v[88:91], v[224:227]
s_waitcnt lgkmcnt(6)
v_mfma_f32_16x16x32_bf16 v[228:231], a[36:39], v[88:91], v[228:231]
s_waitcnt lgkmcnt(5)
v_mfma_f32_16x16x32_bf16 v[232:235], a[40:43], v[88:91], v[232:235]
s_waitcnt lgkmcnt(4)
v_mfma_f32_16x16x32_bf16 v[236:239], a[44:47], v[88:91], v[236:239]
s_waitcnt lgkmcnt(3)
v_mfma_f32_16x16x32_bf16 v[240:243], a[48:51], v[88:91], v[240:243]
s_waitcnt lgkmcnt(2)
v_mfma_f32_16x16x32_bf16 v[244:247], a[52:55], v[88:91], v[244:247]
s_waitcnt lgkmcnt(1)
v_mfma_f32_16x16x32_bf16 v[248:251], a[56:59], v[88:91], v[248:251]
s_waitcnt lgkmcnt(0)
v_mfma_f32_16x16x32_bf16 v[252:255], a[60:63], v[88:91], v[252:255]
FINISH:
s_cmp_eq_u32 s92, 0
s_cbranch_scc1 HANDOFF
v_mov_b32 v22, v18
v_mov_b32 v23, v19
s_nop 1
v_permlane32_swap_b32 v22, v18
v_permlane32_swap_b32 v23, v19
v_add_f32 v18, v22, v18
v_add_f32 v19, v23, v19
v_mov_b32 v22, v18
v_mov_b32 v23, v19
s_nop 1
v_permlane16_swap_b32 v22, v18
v_permlane16_swap_b32 v23, v19
v_add_f32 v18, v22, v18
v_add_f32 v19, v23, v19
v_add_f32 v23, v18, v19
v_cmp_nge_f32 vcc, 0x5f800000, v23
s_lshl_b32 s63, s60, 2
s_add_u32 s63, s63, 131072
s_cmp_lg_u64 vcc, 0
s_cselect_b32 s64, 1, 0
v_mov_b32 v24, s63
v_mov_b32 v25, s64
ds_write_b32 v24, v25
v_mov_b32 v24, 131072
v_not_b32 v25, v46
v_mov_b32 v34, 0x10000
v_bfi_b32 v12, v34, v25, v12
v_bfi_b32 v13, v34, v25, v13
v_bfi_b32 v14, v34, v25, v14
v_bfi_b32 v15, v34, v25, v15
v_rcp_f32 v26, v18
v_rcp_f32 v27, v18
v_rcp_f32 v28, v19
v_rcp_f32 v29, v19
s_waitcnt vmcnt(9) lgkmcnt(0)
s_barrier
ds_read_b128 v[34:37], v24
s_cmp_eq_u32 s92, 3
s_cbranch_scc1 PARK
.p2align 3
ds_read_b64_tr_b16 a[0:1], v12 offset:0
ds_read_b64_tr_b16 a[2:3], v12 offset:2048
ds_read_b64_tr_b16 a[4:5], v12 offset:4096
ds_read_b64_tr_b16 a[6:7], v12 offset:6144
ds_read_b64_tr_b16 a[8:9], v12 offset:16384
ds_read_b64_tr_b16 a[10:11], v12 offset:18432
ds_read_b64_tr_b16 a[12:13], v12 offset:20480
ds_read_b64_tr_b16 a[14:15], v12 offset:22528
ds_read_b64_tr_b16 a[16:17], v12 offset:8192
ds_read_b64_tr_b16 a[18:19], v12 offset:10240
ds_read_b64_tr_b16 a[20:21], v12 offset:12288
ds_read_b64_tr_b16 a[22:23], v12 offset:14336
ds_read_b64_tr_b16 a[24:25], v12 offset:24576
ds_read_b64_tr_b16 a[26:27], v12 offset:26624
v_pk_mul_f32 v[128:129], v[128:129], v[26:27]
s_mov_b32 m0, s94
.p2align 3
v_cvt_pk_bf16_f32 v64, v128, v129
v_pk_mul_f32 v[130:131], v[130:131], v[26:27]
v_cvt_pk_bf16_f32 v65, v130, v131
v_pk_mul_f32 v[132:133], v[132:133], v[26:27]
v_cvt_pk_bf16_f32 v66, v132, v133
v_pk_mul_f32 v[134:135], v[134:135], v[26:27]
v_cvt_pk_bf16_f32 v67, v134, v135
v_pk_mul_f32 v[136:137], v[136:137], v[26:27]
buffer_load_dwordx4 v38, s[16:19], s101 offen offset:0 sc1 lds
v_cvt_pk_bf16_f32 v68, v136, v137
v_pk_mul_f32 v[138:139], v[138:139], v[26:27]
v_cvt_pk_bf16_f32 v69, v138, v139
v_pk_mul_f32 v[140:141], v[140:141], v[26:27]
v_cvt_pk_bf16_f32 v70, v140, v141
v_pk_mul_f32 v[142:143], v[142:143], v[26:27]
v_cvt_pk_bf16_f32 v71, v142, v143
v_pk_mul_f32 v[144:145], v[144:145], v[26:27]
buffer_load_dwordx4 v39, s[16:19], s101 offen offset:1024 sc1 lds
v_cvt_pk_bf16_f32 v72, v144, v145
v_pk_mul_f32 v[146:147], v[146:147], v[26:27]
v_cvt_pk_bf16_f32 v73, v146, v147
v_pk_mul_f32 v[148:149], v[148:149], v[26:27]
v_cvt_pk_bf16_f32 v74, v148, v149
v_pk_mul_f32 v[150:151], v[150:151], v[26:27]
v_cvt_pk_bf16_f32 v75, v150, v151
v_pk_mul_f32 v[152:153], v[152:153], v[26:27]
buffer_load_dwordx4 v40, s[16:19], s101 offen offset:2048 sc1 lds
v_cvt_pk_bf16_f32 v76, v152, v153
v_pk_mul_f32 v[154:155], v[154:155], v[26:27]
v_cvt_pk_bf16_f32 v77, v154, v155
v_pk_mul_f32 v[156:157], v[156:157], v[26:27]
v_cvt_pk_bf16_f32 v78, v156, v157
v_pk_mul_f32 v[158:159], v[158:159], v[26:27]
v_cvt_pk_bf16_f32 v79, v158, v159
v_pk_mul_f32 v[160:161], v[160:161], v[26:27]
buffer_load_dwordx4 v41, s[16:19], s101 offen offset:3072 sc1 lds
v_cvt_pk_bf16_f32 v80, v160, v161
v_pk_mul_f32 v[162:163], v[162:163], v[26:27]
v_cvt_pk_bf16_f32 v81, v162, v163
v_pk_mul_f32 v[164:165], v[164:165], v[26:27]
v_cvt_pk_bf16_f32 v82, v164, v165
v_pk_mul_f32 v[166:167], v[166:167], v[26:27]
v_cvt_pk_bf16_f32 v83, v166, v167
v_pk_mul_f32 v[168:169], v[168:169], v[26:27]
v_cvt_pk_bf16_f32 v84, v168, v169
s_add_u32 m0, s94, 4096
v_pk_mul_f32 v[170:171], v[170:171], v[26:27]
v_cvt_pk_bf16_f32 v85, v170, v171
v_pk_mul_f32 v[172:173], v[172:173], v[26:27]
v_cvt_pk_bf16_f32 v86, v172, v173
v_pk_mul_f32 v[174:175], v[174:175], v[26:27]
v_cvt_pk_bf16_f32 v87, v174, v175
v_pk_mul_f32 v[176:177], v[176:177], v[26:27]
v_cvt_pk_bf16_f32 v88, v176, v177
buffer_load_dwordx4 v38, s[16:19], s70 offen offset:0 sc1 lds
v_pk_mul_f32 v[178:179], v[178:179], v[26:27]
v_cvt_pk_bf16_f32 v89, v178, v179
v_pk_mul_f32 v[180:181], v[180:181], v[26:27]
v_cvt_pk_bf16_f32 v90, v180, v181
v_pk_mul_f32 v[182:183], v[182:183], v[26:27]
v_cvt_pk_bf16_f32 v91, v182, v183
v_pk_mul_f32 v[184:185], v[184:185], v[26:27]
v_cvt_pk_bf16_f32 v92, v184, v185
buffer_load_dwordx4 v39, s[16:19], s70 offen offset:1024 sc1 lds
v_pk_mul_f32 v[186:187], v[186:187], v[26:27]
v_cvt_pk_bf16_f32 v93, v186, v187
v_pk_mul_f32 v[188:189], v[188:189], v[26:27]
v_cvt_pk_bf16_f32 v94, v188, v189
v_pk_mul_f32 v[190:191], v[190:191], v[26:27]
v_cvt_pk_bf16_f32 v95, v190, v191
v_pk_mul_f32 v[192:193], v[192:193], v[28:29]
v_cvt_pk_bf16_f32 v96, v192, v193
buffer_load_dwordx4 v40, s[16:19], s70 offen offset:2048 sc1 lds
v_pk_mul_f32 v[194:195], v[194:195], v[28:29]
v_cvt_pk_bf16_f32 v97, v194, v195
v_pk_mul_f32 v[196:197], v[196:197], v[28:29]
v_cvt_pk_bf16_f32 v98, v196, v197
v_pk_mul_f32 v[198:199], v[198:199], v[28:29]
v_cvt_pk_bf16_f32 v99, v198, v199
v_pk_mul_f32 v[200:201], v[200:201], v[28:29]
v_cvt_pk_bf16_f32 v100, v200, v201
buffer_load_dwordx4 v41, s[16:19], s70 offen offset:3072 sc1 lds
v_pk_mul_f32 v[202:203], v[202:203], v[28:29]
v_cvt_pk_bf16_f32 v101, v202, v203
v_pk_mul_f32 v[204:205], v[204:205], v[28:29]
v_cvt_pk_bf16_f32 v102, v204, v205
v_pk_mul_f32 v[206:207], v[206:207], v[28:29]
v_cvt_pk_bf16_f32 v103, v206, v207
v_pk_mul_f32 v[208:209], v[208:209], v[28:29]
v_cvt_pk_bf16_f32 v104, v208, v209
v_pk_mul_f32 v[210:211], v[210:211], v[28:29]
s_add_u32 s101, s101, s71
.p2align 3
v_cvt_pk_bf16_f32 v105, v210, v211
v_pk_mul_f32 v[212:213], v[212:213], v[28:29]
v_cvt_pk_bf16_f32 v106, v212, v213
v_pk_mul_f32 v[214:215], v[214:215], v[28:29]
v_cvt_pk_bf16_f32 v107, v214, v215
v_pk_mul_f32 v[216:217], v[216:217], v[28:29]
v_cvt_pk_bf16_f32 v108, v216, v217
v_pk_mul_f32 v[218:219], v[218:219], v[28:29]
s_add_u32 s70, s70, s71
.p2align 3
v_cvt_pk_bf16_f32 v109, v218, v219
v_pk_mul_f32 v[220:221], v[220:221], v[28:29]
v_cvt_pk_bf16_f32 v110, v220, v221
v_pk_mul_f32 v[222:223], v[222:223], v[28:29]
v_cvt_pk_bf16_f32 v111, v222, v223
v_pk_mul_f32 v[224:225], v[224:225], v[28:29]
v_cvt_pk_bf16_f32 v112, v224, v225
v_pk_mul_f32 v[226:227], v[226:227], v[28:29]
s_add_u32 s94, s94, 32768
v_cvt_pk_bf16_f32 v113, v226, v227
v_pk_mul_f32 v[228:229], v[228:229], v[28:29]
v_cvt_pk_bf16_f32 v114, v228, v229
v_pk_mul_f32 v[230:231], v[230:231], v[28:29]
v_cvt_pk_bf16_f32 v115, v230, v231
v_pk_mul_f32 v[232:233], v[232:233], v[28:29]
v_cvt_pk_bf16_f32 v116, v232, v233
v_pk_mul_f32 v[234:235], v[234:235], v[28:29]
s_and_b32 s94, s94, 0x1ffff
v_cvt_pk_bf16_f32 v117, v234, v235
v_pk_mul_f32 v[236:237], v[236:237], v[28:29]
v_cvt_pk_bf16_f32 v118, v236, v237
v_pk_mul_f32 v[238:239], v[238:239], v[28:29]
v_cvt_pk_bf16_f32 v119, v238, v239
v_pk_mul_f32 v[240:241], v[240:241], v[28:29]
v_cvt_pk_bf16_f32 v120, v240, v241
v_pk_mul_f32 v[242:243], v[242:243], v[28:29]
v_cvt_pk_bf16_f32 v121, v242, v243
v_pk_mul_f32 v[244:245], v[244:245], v[28:29]
v_cvt_pk_bf16_f32 v122, v244, v245
v_pk_mul_f32 v[246:247], v[246:247], v[28:29]
v_cvt_pk_bf16_f32 v123, v246, v247
v_pk_mul_f32 v[248:249], v[248:249], v[28:29]
v_cvt_pk_bf16_f32 v124, v248, v249
v_pk_mul_f32 v[250:251], v[250:251], v[28:29]
v_cvt_pk_bf16_f32 v125, v250, v251
v_pk_mul_f32 v[252:253], v[252:253], v[28:29]
v_cvt_pk_bf16_f32 v126, v252, v253
v_pk_mul_f32 v[254:255], v[254:255], v[28:29]
v_cvt_pk_bf16_f32 v127, v254, v255
s_branch PACKED
PARK:
.p2align 3
ds_read_b128 a[0:3], v46 offset:49152
ds_read_b128 a[4:7], v46 offset:50176
ds_read_b128 a[8:11], v46 offset:51200
ds_read_b128 a[12:15], v46 offset:52224
ds_read_b128 a[16:19], v46 offset:53248
ds_read_b128 a[20:23], v46 offset:54272
ds_read_b128 a[24:27], v46 offset:55296
ds_read_b128 a[28:31], v46 offset:56320
ds_read_b128 a[32:35], v46 offset:57344
ds_read_b128 a[36:39], v46 offset:58368
ds_read_b128 a[40:43], v46 offset:59392
ds_read_b128 a[44:47], v46 offset:60416
ds_read_b128 a[48:51], v46 offset:61440
ds_read_b128 a[52:55], v46 offset:62464
v_pk_mul_f32 v[128:129], v[128:129], v[26:27]
v_cvt_pk_bf16_f32 v64, v128, v129
v_pk_mul_f32 v[130:131], v[130:131], v[26:27]
v_cvt_pk_bf16_f32 v65, v130, v131
v_pk_mul_f32 v[132:133], v[132:133], v[26:27]
v_cvt_pk_bf16_f32 v66, v132, v133
v_pk_mul_f32 v[134:135], v[134:135], v[26:27]
v_cvt_pk_bf16_f32 v67, v134, v135
v_accvgpr_write_b32 a192, v64
v_accvgpr_write_b32 a193, v65
v_accvgpr_write_b32 a194, v66
v_accvgpr_write_b32 a195, v67
s_waitcnt lgkmcnt(14)
v_or3_b32 v34, v34, v35, v36
v_or_b32 v34, v34, v37
s_nop 0
v_readfirstlane_b32 s63, v34
s_andn2_b32 s63, s63, s97
s_cbranch_scc1 REDO
s_waitcnt vmcnt(0)
v_cmp_gt_u32 vcc, 2, v7
s_nop 0
s_cmp_lg_u64 vcc, 0
s_cbranch_scc1 SPIN13_0
OK13_0:
.p2align 3
ds_read_b128 a[56:59], v46 offset:63488
ds_read_b128 a[60:63], v46 offset:64512
v_pk_mul_f32 v[136:137], v[136:137], v[26:27]
s_add_u32 s63, s72, 16384
v_cvt_pk_bf16_f32 v68, v136, v137
v_pk_mul_f32 v[138:139], v[138:139], v[26:27]
v_cvt_pk_bf16_f32 v69, v138, v139
v_pk_mul_f32 v[140:141], v[140:141], v[26:27]
buffer_load_dword v20, v5, s[8:11], s63 offen offset:0 sc1
v_cvt_pk_bf16_f32 v70, v140, v141
v_pk_mul_f32 v[142:143], v[142:143], v[26:27]
v_cvt_pk_bf16_f32 v71, v142, v143
v_accvgpr_write_b32 a196, v68
v_accvgpr_write_b32 a197, v69
buffer_load_dword v21, v5, s[8:11], s63 offen offset:256 sc1
v_accvgpr_write_b32 a198, v70
v_accvgpr_write_b32 a199, v71
v_pk_mul_f32 v[144:145], v[144:145], v[26:27]
v_cvt_pk_bf16_f32 v72, v144, v145
v_pk_mul_f32 v[146:147], v[146:147], v[26:27]
s_add_u32 s63, s72, 0
.p2align 3
v_cvt_pk_bf16_f32 v73, v146, v147
v_pk_mul_f32 v[148:149], v[148:149], v[26:27]
v_cvt_pk_bf16_f32 v74, v148, v149
v_pk_mul_f32 v[150:151], v[150:151], v[26:27]
v_cvt_pk_bf16_f32 v75, v150, v151
s_add_u32 s64, s63, 8192
v_accvgpr_write_b32 a200, v72
v_accvgpr_write_b32 a201, v73
v_accvgpr_write_b32 a202, v74
v_accvgpr_write_b32 a203, v75
v_pk_mul_f32 v[152:153], v[152:153], v[26:27]
buffer_load_dwordx4 a[64:67], v1, s[8:11], s63 offen offset:0 sc1
v_cvt_pk_bf16_f32 v76, v152, v153
v_pk_mul_f32 v[154:155], v[154:155], v[26:27]
v_cvt_pk_bf16_f32 v77, v154, v155
v_pk_mul_f32 v[156:157], v[156:157], v[26:27]
v_cvt_pk_bf16_f32 v78, v156, v157
buffer_load_dwordx4 a[96:99], v1, s[8:11], s64 offen offset:0 sc1
v_pk_mul_f32 v[158:159], v[158:159], v[26:27]
v_cvt_pk_bf16_f32 v79, v158, v159
v_accvgpr_write_b32 a204, v76
v_accvgpr_write_b32 a205, v77
v_accvgpr_write_b32 a206, v78
buffer_load_dwordx4 a[68:71], v1, s[8:11], s63 offen offset:1024 sc1
v_accvgpr_write_b32 a207, v79
v_pk_mul_f32 v[160:161], v[160:161], v[26:27]
v_cvt_pk_bf16_f32 v80, v160, v161
v_pk_mul_f32 v[162:163], v[162:163], v[26:27]
buffer_load_dwordx4 a[100:103], v1, s[8:11], s64 offen offset:1024 sc1
v_cvt_pk_bf16_f32 v81, v162, v163
v_pk_mul_f32 v[164:165], v[164:165], v[26:27]
v_cvt_pk_bf16_f32 v82, v164, v165
v_pk_mul_f32 v[166:167], v[166:167], v[26:27]
v_cvt_pk_bf16_f32 v83, v166, v167
buffer_load_dwordx4 a[72:75], v1, s[8:11], s63 offen offset:2048 sc1
v_accvgpr_write_b32 a208, v80
v_accvgpr_write_b32 a209, v81
v_accvgpr_write_b32 a210, v82
v_accvgpr_write_b32 a211, v83
v_pk_mul_f32 v[168:169], v[168:169], v[26:27]
buffer_load_dwordx4 a[104:107], v1, s[8:11], s64 offen offset:2048 sc1
v_cvt_pk_bf16_f32 v84, v168, v169
v_pk_mul_f32 v[170:171], v[170:171], v[26:27]
v_cvt_pk_bf16_f32 v85, v170, v171
v_pk_mul_f32 v[172:173], v[172:173], v[26:27]
v_cvt_pk_bf16_f32 v86, v172, v173
buffer_load_dwordx4 a[76:79], v1, s[8:11], s63 offen offset:3072 sc1
v_pk_mul_f32 v[174:175], v[174:175], v[26:27]
v_cvt_pk_bf16_f32 v87, v174, v175
v_accvgpr_write_b32 a212, v84
v_accvgpr_write_b32 a213, v85
v_accvgpr_write_b32 a214, v86
buffer_load_dwordx4 a[108:111], v1, s[8:11], s64 offen offset:3072 sc1
v_accvgpr_write_b32 a215, v87
v_pk_mul_f32 v[176:177], v[176:177], v[26:27]
v_cvt_pk_bf16_f32 v88, v176, v177
v_pk_mul_f32 v[178:179], v[178:179], v[26:27]
v_cvt_pk_bf16_f32 v89, v178, v179
s_add_u32 s63, s72, 4096
v_pk_mul_f32 v[180:181], v[180:181], v[26:27]
v_cvt_pk_bf16_f32 v90, v180, v181
v_pk_mul_f32 v[182:183], v[182:183], v[26:27]
v_cvt_pk_bf16_f32 v91, v182, v183
v_accvgpr_write_b32 a216, v88
s_add_u32 s64, s63, 8192
v_accvgpr_write_b32 a217, v89
v_accvgpr_write_b32 a218, v90
v_accvgpr_write_b32 a219, v91
v_pk_mul_f32 v[184:185], v[184:185], v[26:27]
buffer_load_dwordx4 a[80:83], v1, s[8:11], s63 offen offset:0 sc1
v_cvt_pk_bf16_f32 v92, v184, v185
v_pk_mul_f32 v[186:187], v[186:187], v[26:27]
v_cvt_pk_bf16_f32 v93, v186, v187
v_pk_mul_f32 v[188:189], v[188:189], v[26:27]
v_cvt_pk_bf16_f32 v94, v188, v189
buffer_load_dwordx4 a[112:115], v1, s[8:11], s64 offen offset:0 sc1
v_pk_mul_f32 v[190:191], v[190:191], v[26:27]
v_cvt_pk_bf16_f32 v95, v190, v191
v_accvgpr_write_b32 a220, v92
v_accvgpr_write_b32 a221, v93
v_accvgpr_write_b32 a222, v94
buffer_load_dwordx4 a[84:87], v1, s[8:11], s63 offen offset:1024 sc1
v_accvgpr_write_b32 a223, v95
v_pk_mul_f32 v[192:193], v[192:193], v[28:29]
v_cvt_pk_bf16_f32 v96, v192, v193
v_pk_mul_f32 v[194:195], v[194:195], v[28:29]
v_cvt_pk_bf16_f32 v97, v194, v195
buffer_load_dwordx4 a[116:119], v1, s[8:11], s64 offen offset:1024 sc1
v_pk_mul_f32 v[196:197], v[196:197], v[28:29]
v_cvt_pk_bf16_f32 v98, v196, v197
v_pk_mul_f32 v[198:199], v[198:199], v[28:29]
v_cvt_pk_bf16_f32 v99, v198, v199
v_accvgpr_write_b32 a224, v96
buffer_load_dwordx4 a[88:91], v1, s[8:11], s63 offen offset:2048 sc1
v_accvgpr_write_b32 a225, v97
v_accvgpr_write_b32 a226, v98
v_accvgpr_write_b32 a227, v99
v_pk_mul_f32 v[200:201], v[200:201], v[28:29]
v_cvt_pk_bf16_f32 v100, v200, v201
buffer_load_dwordx4 a[120:123], v1, s[8:11], s64 offen offset:2048 sc1
v_pk_mul_f32 v[202:203], v[202:203], v[28:29]
v_cvt_pk_bf16_f32 v101, v202, v203
v_pk_mul_f32 v[204:205], v[204:205], v[28:29]
v_cvt_pk_bf16_f32 v102, v204, v205
v_pk_mul_f32 v[206:207], v[206:207], v[28:29]
buffer_load_dwordx4 a[92:95], v1, s[8:11], s63 offen offset:3072 sc1
v_cvt_pk_bf16_f32 v103, v206, v207
v_accvgpr_write_b32 a228, v100
v_accvgpr_write_b32 a229, v101
v_accvgpr_write_b32 a230, v102
v_accvgpr_write_b32 a231, v103
buffer_load_dwordx4 a[124:127], v1, s[8:11], s64 offen offset:3072 sc1
v_pk_mul_f32 v[208:209], v[208:209], v[28:29]
v_cvt_pk_bf16_f32 v104, v208, v209
v_pk_mul_f32 v[210:211], v[210:211], v[28:29]
v_cvt_pk_bf16_f32 v105, v210, v211
s_mov_b32 m0, s94
.p2align 3
v_pk_mul_f32 v[212:213], v[212:213], v[28:29]
v_cvt_pk_bf16_f32 v106, v212, v213
v_pk_mul_f32 v[214:215], v[214:215], v[28:29]
v_cvt_pk_bf16_f32 v107, v214, v215
v_accvgpr_write_b32 a232, v104
buffer_load_dwordx4 v38, s[16:19], s101 offen offset:0 sc1 lds
v_accvgpr_write_b32 a233, v105
v_accvgpr_write_b32 a234, v106
v_accvgpr_write_b32 a235, v107
v_pk_mul_f32 v[216:217], v[216:217], v[28:29]
v_cvt_pk_bf16_f32 v108, v216, v217
buffer_load_dwordx4 v39, s[16:19], s101 offen offset:1024 sc1 lds
v_pk_mul_f32 v[218:219], v[218:219], v[28:29]
v_cvt_pk_bf16_f32 v109, v218, v219
v_pk_mul_f32 v[220:221], v[220:221], v[28:29]
v_cvt_pk_bf16_f32 v110, v220, v221
v_pk_mul_f32 v[222:223], v[222:223], v[28:29]
buffer_load_dwordx4 v40, s[16:19], s101 offen offset:2048 sc1 lds
v_cvt_pk_bf16_f32 v111, v222, v223
v_accvgpr_write_b32 a236, v108
v_accvgpr_write_b32 a237, v109
v_accvgpr_write_b32 a238, v110
v_accvgpr_write_b32 a239, v111
buffer_load_dwordx4 v41, s[16:19], s101 offen offset:3072 sc1 lds
v_pk_mul_f32 v[224:225], v[224:225], v[28:29]
v_cvt_pk_bf16_f32 v112, v224, v225
v_pk_mul_f32 v[226:227], v[226:227], v[28:29]
v_cvt_pk_bf16_f32 v113, v226, v227
v_pk_mul_f32 v[228:229], v[228:229], v[28:29]
s_add_u32 m0, s94, 4096
v_cvt_pk_bf16_f32 v114, v228, v229
v_pk_mul_f32 v[230:231], v[230:231], v[28:29]
v_cvt_pk_bf16_f32 v115, v230, v231
v_accvgpr_write_b32 a240, v112
v_accvgpr_write_b32 a241, v113
buffer_load_dwordx4 v38, s[16:19], s70 offen offset:0 sc1 lds
v_accvgpr_write_b32 a242, v114
v_accvgpr_write_b32 a243, v115
v_pk_mul_f32 v[232:233], v[232:233], v[28:29]
v_cvt_pk_bf16_f32 v116, v232, v233
buffer_load_dwordx4 v39, s[16:19], s70 offen offset:1024 sc1 lds
v_pk_mul_f32 v[234:235], v[234:235], v[28:29]
v_cvt_pk_bf16_f32 v117, v234, v235
v_pk_mul_f32 v[236:237], v[236:237], v[28:29]
v_cvt_pk_bf16_f32 v118, v236, v237
v_pk_mul_f32 v[238:239], v[238:239], v[28:29]
buffer_load_dwordx4 v40, s[16:19], s70 offen offset:2048 sc1 lds
v_cvt_pk_bf16_f32 v119, v238, v239
v_accvgpr_write_b32 a244, v116
v_accvgpr_write_b32 a245, v117
v_accvgpr_write_b32 a246, v118
v_accvgpr_write_b32 a247, v119
buffer_load_dwordx4 v41, s[16:19], s70 offen offset:3072 sc1 lds
v_pk_mul_f32 v[240:241], v[240:241], v[28:29]
v_cvt_pk_bf16_f32 v120, v240, v241
v_pk_mul_f32 v[242:243], v[242:243], v[28:29]
v_cvt_pk_bf16_f32 v121, v242, v243
v_pk_mul_f32 v[244:245], v[244:245], v[28:29]
s_add_u32 s101, s101, s71
v_cvt_pk_bf16_f32 v122, v244, v245
v_pk_mul_f32 v[246:247], v[246:247], v[28:29]
v_cvt_pk_bf16_f32 v123, v246, v247
v_accvgpr_write_b32 a248, v120
v_accvgpr_write_b32 a249, v121
s_add_u32 s70, s70, s71
.p2align 3
v_accvgpr_write_b32 a250, v122
v_accvgpr_write_b32 a251, v123
v_pk_mul_f32 v[248:249], v[248:249], v[28:29]
v_cvt_pk_bf16_f32 v124, v248, v249
v_pk_mul_f32 v[250:251], v[250:251], v[28:29]
s_add_u32 s94, s94, 32768
v_cvt_pk_bf16_f32 v125, v250, v251
v_pk_mul_f32 v[252:253], v[252:253], v[28:29]
v_cvt_pk_bf16_f32 v126, v252, v253
v_pk_mul_f32 v[254:255], v[254:255], v[28:29]
v_cvt_pk_bf16_f32 v127, v254, v255
s_and_b32 s94, s94, 0x1ffff
v_accvgpr_write_b32 a252, v124
v_accvgpr_write_b32 a253, v125
v_accvgpr_write_b32 a254, v126
v_accvgpr_write_b32 a255, v127
s_mov_b32 s93, s101
s_sub_u32 s91, 15, s84
s_mov_b32 s88, 38
s_mov_b32 s92, 0
s_mov_b32 s97, 0
s_lshl_b32 s89, s91, 1
s_sub_u32 s89, s89, 17
s_waitcnt vmcnt(24) lgkmcnt(0)
s_barrier
.p2align 3
v_sub_f32 v48, 0xc2c00000, v20
v_sub_f32 v49, 0xc2c00000, v20
v_sub_f32 v50, 0xc2c00000, v20
v_sub_f32 v51, 0xc2c00000, v20
v_sub_f32 v52, 0xc2c00000, v21
v_sub_f32 v53, 0xc2c00000, v21
v_sub_f32 v54, 0xc2c00000, v21
v_sub_f32 v55, 0xc2c00000, v21
v_mov_b32 v18, 0
v_mov_b32 v19, 0
s_waitcnt vmcnt(22)
v_mfma_f32_16x16x32_bf16 v[64:67], a[0:3], a[64:67], v[48:51]
s_cmp_lg_u32 s92, 2
v_mov_b64 v[128:129], 0
v_mov_b64 v[130:131], 0
v_mfma_f32_16x16x32_bf16 v[68:71], a[32:35], a[64:67], v[48:51]
s_subb_u32 s63, s89, 2
v_mov_b64 v[132:133], 0
v_mov_b64 v[134:135], 0
v_mfma_f32_16x16x32_bf16 v[72:75], a[0:3], a[96:99], v[52:55]
v_mov_b64 v[136:137], 0
v_mov_b64 v[138:139], 0
v_mfma_f32_16x16x32_bf16 v[76:79], a[32:35], a[96:99], v[52:55]
s_waitcnt vmcnt(20)
v_mov_b64 v[140:141], 0
v_mov_b64 v[142:143], 0
v_mfma_f32_16x16x32_bf16 v[64:67], a[4:7], a[68:71], v[64:67]
s_max_i32 s90, s63, 0
v_mov_b64 v[144:145], 0
v_mov_b64 v[146:147], 0
v_mfma_f32_16x16x32_bf16 v[68:71], a[36:39], a[68:71], v[68:71]
s_mul_i32 s63, s61, 229376
v_mov_b64 v[148:149], 0
v_mfma_f32_16x16x32_bf16 v[72:75], a[4:7], a[100:103], v[72:75]
s_add_u32 s16, s42, s63
v_mov_b64 v[150:151], 0
v_mov_b64 v[152:153], 0
v_mfma_f32_16x16x32_bf16 v[76:79], a[36:39], a[100:103], v[76:79]
s_waitcnt vmcnt(18)
v_mov_b64 v[154:155], 0
v_mov_b64 v[156:157], 0
v_mfma_f32_16x16x32_bf16 v[64:67], a[8:11], a[72:75], v[64:67]
s_addc_u32 s17, s43, 0
v_mov_b64 v[158:159], 0
v_mov_b64 v[160:161], 0
v_mfma_f32_16x16x32_bf16 v[68:71], a[40:43], a[72:75], v[68:71]
v_mov_b64 v[162:163], 0
v_mov_b64 v[164:165], 0
v_mfma_f32_16x16x32_bf16 v[72:75], a[8:11], a[104:107], v[72:75]
s_add_u32 s64, s95, 1261568
v_mov_b64 v[166:167], 0
v_mfma_f32_16x16x32_bf16 v[76:79], a[40:43], a[104:107], v[76:79]
s_waitcnt vmcnt(16)
v_mov_b64 v[168:169], 0
v_mov_b64 v[170:171], 0
v_mfma_f32_16x16x32_bf16 v[64:67], a[12:15], a[76:79], v[64:67]
s_cmp_eq_u32 s92, 3
v_mov_b64 v[172:173], 0
v_mov_b64 v[174:175], 0
v_mfma_f32_16x16x32_bf16 v[68:71], a[44:47], a[76:79], v[68:71]
s_cselect_b64 vcc, -1, 0
v_mov_b64 v[176:177], 0
v_mov_b64 v[178:179], 0
v_mfma_f32_16x16x32_bf16 v[72:75], a[12:15], a[108:111], v[72:75]
v_mov_b64 v[180:181], 0
v_mov_b64 v[182:183], 0
v_mfma_f32_16x16x32_bf16 v[76:79], a[44:47], a[108:111], v[76:79]
s_waitcnt vmcnt(14)
v_mov_b64 v[184:185], 0
v_mfma_f32_16x16x32_bf16 v[64:67], a[16:19], a[80:83], v[64:67]
s_cselect_b64 s[16:17], s[8:9], s[16:17]
v_mov_b64 v[186:187], 0
v_mov_b64 v[188:189], 0
v_mfma_f32_16x16x32_bf16 v[68:71], a[48:51], a[80:83], v[68:71]
s_cselect_b32 s18, s10, 229376
v_mov_b64 v[190:191], 0
v_mov_b64 v[192:193], 0
v_mfma_f32_16x16x32_bf16 v[72:75], a[16:19], a[112:115], v[72:75]
s_cselect_b32 s101, s64, 0
v_mov_b64 v[194:195], 0
v_mov_b64 v[196:197], 0
v_mfma_f32_16x16x32_bf16 v[76:79], a[48:51], a[112:115], v[76:79]
s_waitcnt vmcnt(12)
v_mov_b64 v[198:199], 0
v_mov_b64 v[200:201], 0
v_mfma_f32_16x16x32_bf16 v[64:67], a[20:23], a[84:87], v[64:67]
s_mov_b32 s71, 128
v_mov_b64 v[202:203], 0
v_mov_b64 v[204:205], 0
v_mfma_f32_16x16x32_bf16 v[68:71], a[52:55], a[84:87], v[68:71]
v_mov_b64 v[206:207], 0
v_mfma_f32_16x16x32_bf16 v[72:75], a[20:23], a[116:119], v[72:75]
s_cselect_b32 s71, 32768, s71
v_mov_b64 v[208:209], 0
v_mov_b64 v[210:211], 0
v_mfma_f32_16x16x32_bf16 v[76:79], a[52:55], a[116:119], v[76:79]
s_waitcnt vmcnt(10)
v_mov_b64 v[212:213], 0
v_mov_b64 v[214:215], 0
v_mfma_f32_16x16x32_bf16 v[64:67], a[24:27], a[88:91], v[64:67]
s_mov_b32 s70, 28672
v_mov_b64 v[216:217], 0
v_mov_b64 v[218:219], 0
v_mfma_f32_16x16x32_bf16 v[68:71], a[56:59], a[88:91], v[68:71]
s_cselect_b32 s70, 4096, s70
v_mov_b64 v[220:221], 0
v_mov_b64 v[222:223], 0
v_mfma_f32_16x16x32_bf16 v[72:75], a[24:27], a[120:123], v[72:75]
v_mov_b64 v[224:225], 0
v_mfma_f32_16x16x32_bf16 v[76:79], a[56:59], a[120:123], v[76:79]
s_waitcnt vmcnt(8)
v_mov_b64 v[226:227], 0
v_mov_b64 v[228:229], 0
v_mfma_f32_16x16x32_bf16 v[64:67], a[28:31], a[92:95], v[64:67]
s_cselect_b32 s73, s60, 0
v_mov_b64 v[230:231], 0
v_mov_b64 v[232:233], 0
v_mfma_f32_16x16x32_bf16 v[68:71], a[60:63], a[92:95], v[68:71]
s_add_u32 s70, s70, s101
v_mov_b64 v[234:235], 0
v_mov_b64 v[236:237], 0
v_mfma_f32_16x16x32_bf16 v[72:75], a[28:31], a[124:127], v[72:75]
v_mov_b64 v[238:239], 0
v_mov_b64 v[240:241], 0
v_mfma_f32_16x16x32_bf16 v[76:79], a[60:63], a[124:127], v[76:79]
v_mov_b64 v[242:243], 0
.p2align 3
v_xor_b32 v46, 0x10000, v46
ds_read_b128 a[0:3], v46 offset:16384
ds_read_b128 a[4:7], v46 offset:17408
ds_read_b128 a[8:11], v46 offset:18432
ds_read_b128 a[12:15], v46 offset:19456
ds_read_b128 a[16:19], v46 offset:20480
ds_read_b128 a[20:23], v46 offset:21504
ds_read_b128 a[24:27], v46 offset:22528
v_mov_b64 v[244:245], 0
v_mov_b64 v[246:247], 0
v_mov_b64 v[248:249], 0
v_mov_b64 v[250:251], 0
v_mov_b64 v[252:253], 0
v_mov_b64 v[254:255], 0
v_cndmask_b32 v38, v8, v3, vcc
v_cndmask_b32 v39, v9, v3, vcc
v_cndmask_b32 v40, v10, v3, vcc
v_cndmask_b32 v41, v11, v3, vcc
s_branch PRO_S
PRO:
.p2align 3
ds_read_b128 a[28:31], v46 offset:56320
ds_read_b128 a[32:35], v46 offset:57344
ds_read_b128 a[36:39], v46 offset:58368
ds_read_b128 a[40:43], v46 offset:59392
ds_read_b128 a[44:47], v46 offset:60416
ds_read_b128 a[48:51], v46 offset:61440
ds_read_b128 a[52:55], v46 offset:62464
ds_read_b128 a[56:59], v46 offset:63488
ds_read_b128 a[60:63], v46 offset:64512
s_lshl_b32 s63, s91, 7
s_lshl_b32 s64, s88, 5
s_sub_i32 s63, s63, s64
v_add_u32 v22, s63, v17
v_cvt_f32_i32 v22, v22
v_add_f32 v22, 0.5, v22
v_mul_f32 v16, 0x71800000, v22
v_add_f32 v96, 0x00000000, v16
v_min_f32 v96, 0, v96
v_add_f32 v97, 0xf1800000, v16
v_min_f32 v97, 0, v97
v_add_f32 v98, 0xf2000000, v16
v_min_f32 v98, 0, v98
v_add_f32 v99, 0xf2400000, v16
v_min_f32 v99, 0, v99
v_add_f32 v104, 0x74800000, v16
v_min_f32 v104, 0, v104
v_add_f32 v105, 0x747c0000, v16
v_min_f32 v105, 0, v105
v_add_f32 v106, 0x74780000, v16
v_min_f32 v106, 0, v106
v_add_f32 v107, 0x74740000, v16
v_min_f32 v107, 0, v107
s_waitcnt lgkmcnt(0)
s_nop 0
v_mfma_f32_16x16x32_bf16 v[64:67], a[0:3], a[64:67], v[96:99]
s_barrier
v_add_f32 v100, 0xf3800000, v16
v_min_f32 v100, 0, v100
v_mfma_f32_16x16x32_bf16 v[64:67], a[4:7], a[68:71], v[64:67]
s_cmp_lg_u32 s92, 2
v_add_f32 v101, 0xf3880000, v16
v_mfma_f32_16x16x32_bf16 v[72:75], a[4:7], a[100:103], v[104:107]
s_subb_u32 s63, s89, 2
v_min_f32 v101, 0, v101
v_mfma_f32_16x16x32_bf16 v[72:75], a[0:3], a[96:99], v[72:75]
v_add_f32 v102, 0xf3900000, v16
v_min_f32 v102, 0, v102
v_mfma_f32_16x16x32_bf16 v[72:75], a[8:11], a[104:107], v[72:75]
s_max_i32 s90, s63, 0
v_add_f32 v103, 0xf3980000, v16
v_mfma_f32_16x16x32_bf16 v[72:75], a[12:15], a[108:111], v[72:75]
v_min_f32 v103, 0, v103
v_mfma_f32_16x16x32_bf16 v[64:67], a[12:15], a[76:79], v[64:67]
s_mul_i32 s63, s61, 229376
v_add_f32 v108, 0x74400000, v16
v_min_f32 v108, 0, v108
v_mfma_f32_16x16x32_bf16 v[64:67], a[8:11], a[72:75], v[64:67]
s_add_u32 s16, s42, s63
v_add_f32 v109, 0x743c0000, v16
v_mfma_f32_16x16x32_bf16 v[64:67], a[16:19], a[80:83], v[64:67]
v_min_f32 v109, 0, v109
v_mov_b64 v[128:129], 0
v_mfma_f32_16x16x32_bf16 v[64:67], a[20:23], a[84:87], v[64:67]
s_addc_u32 s17, s43, 0
v_add_f32 v110, 0x74380000, v16
v_min_f32 v110, 0, v110
v_mfma_f32_16x16x32_bf16 v[72:75], a[20:23], a[116:119], v[72:75]
v_add_f32 v111, 0x74340000, v16
v_mov_b64 v[130:131], 0
v_mfma_f32_16x16x32_bf16 v[72:75], a[16:19], a[112:115], v[72:75]
s_add_u32 s64, s95, 1261568
v_min_f32 v111, 0, v111
v_mov_b64 v[132:133], 0
v_mfma_f32_16x16x32_bf16 v[72:75], a[24:27], a[120:123], v[72:75]
v_mov_b64 v[134:135], 0
v_mov_b64 v[136:137], 0
v_mfma_f32_16x16x32_bf16 v[72:75], a[28:31], a[124:127], v[72:75]
s_cmp_eq_u32 s92, 3
v_mov_b64 v[138:139], 0
v_mov_b64 v[140:141], 0
v_mfma_f32_16x16x32_bf16 v[64:67], a[28:31], a[92:95], v[64:67]
s_cselect_b64 vcc, -1, 0
v_mov_b64 v[142:143], 0
v_mov_b64 v[144:145], 0
v_mfma_f32_16x16x32_bf16 v[64:67], a[24:27], a[88:91], v[64:67]
v_mov_b64 v[146:147], 0
v_mov_b64 v[148:149], 0
v_mfma_f32_16x16x32_bf16 v[68:71], a[32:35], a[64:67], v[100:103]
s_cselect_b64 s[16:17], s[8:9], s[16:17]
v_mov_b64 v[150:151], 0
v_mov_b64 v[152:153], 0
v_mfma_f32_16x16x32_bf16 v[68:71], a[36:39], a[68:71], v[68:71]
v_mov_b64 v[154:155], 0
v_mov_b64 v[156:157], 0
v_mfma_f32_16x16x32_bf16 v[76:79], a[36:39], a[100:103], v[108:111]
s_cselect_b32 s18, s10, 229376
v_mov_b64 v[158:159], 0
v_mov_b64 v[160:161], 0
v_mfma_f32_16x16x32_bf16 v[76:79], a[32:35], a[96:99], v[76:79]
s_cselect_b32 s101, s64, 0
v_mov_b64 v[162:163], 0
v_mov_b64 v[164:165], 0
v_mfma_f32_16x16x32_bf16 v[76:79], a[40:43], a[104:107], v[76:79]
v_mov_b64 v[166:167], 0
v_mov_b64 v[168:169], 0
v_mfma_f32_16x16x32_bf16 v[76:79], a[44:47], a[108:111], v[76:79]
s_mov_b32 s71, 128
v_mov_b64 v[170:171], 0
v_mov_b64 v[172:173], 0
v_mfma_f32_16x16x32_bf16 v[68:71], a[44:47], a[76:79], v[68:71]
v_mov_b64 v[174:175], 0
v_mov_b64 v[176:177], 0
v_mfma_f32_16x16x32_bf16 v[68:71], a[40:43], a[72:75], v[68:71]
s_cselect_b32 s71, 32768, s71
v_mov_b64 v[178:179], 0
v_mov_b64 v[180:181], 0
v_mfma_f32_16x16x32_bf16 v[68:71], a[48:51], a[80:83], v[68:71]
v_mov_b64 v[182:183], 0
v_mov_b64 v[184:185], 0
v_mfma_f32_16x16x32_bf16 v[68:71], a[52:55], a[84:87], v[68:71]
s_mov_b32 s70, 28672
v_mov_b64 v[186:187], 0
v_mov_b64 v[188:189], 0
v_mfma_f32_16x16x32_bf16 v[76:79], a[52:55], a[116:119], v[76:79]
s_cselect_b32 s70, 4096, s70
v_mov_b64 v[190:191], 0
v_mov_b64 v[192:193], 0
v_mfma_f32_16x16x32_bf16 v[76:79], a[48:51], a[112:115], v[76:79]
v_mov_b64 v[194:195], 0
v_mov_b64 v[196:197], 0
v_mfma_f32_16x16x32_bf16 v[76:79], a[56:59], a[120:123], v[76:79]
s_cselect_b32 s73, s60, 0
v_mov_b64 v[198:199], 0
v_mov_b64 v[200:201], 0
v_mfma_f32_16x16x32_bf16 v[76:79], a[60:63], a[124:127], v[76:79]
v_mov_b64 v[202:203], 0
v_mov_b64 v[204:205], 0
v_mfma_f32_16x16x32_bf16 v[68:71], a[60:63], a[92:95], v[68:71]
s_add_u32 s70, s70, s101
v_mov_b64 v[206:207], 0
v_mov_b64 v[208:209], 0
v_mfma_f32_16x16x32_bf16 v[68:71], a[56:59], a[88:91], v[68:71]
v_mov_b64 v[210:211], 0
v_mov_b64 v[212:213], 0
v_mov_b64 v[214:215], 0
.p2align 3
v_xor_b32 v46, 0x10000, v46
ds_read_b128 a[0:3], v46 offset:16384
ds_read_b128 a[4:7], v46 offset:17408
ds_read_b128 a[8:11], v46 offset:18432
ds_read_b128 a[12:15], v46 offset:19456
ds_read_b128 a[16:19], v46 offset:20480
ds_read_b128 a[20:23], v46 offset:21504
ds_read_b128 a[24:27], v46 offset:22528
v_mov_b64 v[216:217], 0
v_mov_b64 v[218:219], 0
v_mov_b64 v[220:221], 0
v_mov_b64 v[222:223], 0
v_mov_b64 v[224:225], 0
v_mov_b64 v[226:227], 0
v_mov_b64 v[228:229], 0
v_mov_b64 v[230:231], 0
v_mov_b64 v[232:233], 0
v_mov_b64 v[234:235], 0
v_mov_b64 v[236:237], 0
v_mov_b64 v[238:239], 0
v_mov_b64 v[240:241], 0
v_mov_b64 v[242:243], 0
v_mov_b64 v[244:245], 0
v_mov_b64 v[246:247], 0
v_mov_b64 v[248:249], 0
v_mov_b64 v[250:251], 0
v_mov_b64 v[252:253], 0
v_mov_b64 v[254:255], 0
s_branch PRO_T
BO:
s_lshl_b32 s65, s61, 16
s_add_u32 s65, s65, s68
s_add_u32 s65, s65, 125829120
s_lshl_b32 s63, s60, 20
s_lshl_b32 s64, s61, 11
s_add_u32 s63, s63, s64
.p2align 3
s_add_u32 s63, s63, 117440512
v_pk_mul_f32 v[128:129], v[128:129], v[22:23]
buffer_load_dwordx4 v[64:67], v1, s[8:11], s65 offen sc1
v_pk_mul_f32 v[130:131], v[130:131], v[22:23]
v_pk_mul_f32 v[132:133], v[132:133], v[22:23]
v_pk_mul_f32 v[134:135], v[134:135], v[22:23]
v_cvt_pk_bf16_f32 v128, v128, v129
s_add_u32 s65, s65, 4096
v_cvt_pk_bf16_f32 v129, v130, v131
v_cvt_pk_bf16_f32 v130, v132, v133
v_cvt_pk_bf16_f32 v131, v134, v135
v_accvgpr_write_b32 a64, v128
buffer_load_dwordx4 v[68:71], v1, s[8:11], s65 offen sc1
v_accvgpr_write_b32 a65, v129
v_accvgpr_write_b32 a66, v130
v_accvgpr_write_b32 a67, v131
v_pk_mul_f32 v[136:137], v[136:137], v[22:23]
v_pk_mul_f32 v[138:139], v[138:139], v[22:23]
s_add_u32 s65, s65, 4096
v_pk_mul_f32 v[140:141], v[140:141], v[22:23]
v_pk_mul_f32 v[142:143], v[142:143], v[22:23]
v_cvt_pk_bf16_f32 v136, v136, v137
v_cvt_pk_bf16_f32 v137, v138, v139
buffer_load_dwordx4 v[72:75], v1, s[8:11], s65 offen sc1
v_cvt_pk_bf16_f32 v138, v140, v141
v_cvt_pk_bf16_f32 v139, v142, v143
v_accvgpr_write_b32 a68, v136
v_accvgpr_write_b32 a69, v137
s_add_u32 s65, s65, 4096
v_accvgpr_write_b32 a70, v138
v_accvgpr_write_b32 a71, v139
v_pk_mul_f32 v[144:145], v[144:145], v[22:23]
v_pk_mul_f32 v[146:147], v[146:147], v[22:23]
v_pk_mul_f32 v[148:149], v[148:149], v[22:23]
buffer_load_dwordx4 v[76:79], v1, s[8:11], s65 offen sc1
v_pk_mul_f32 v[150:151], v[150:151], v[22:23]
v_cvt_pk_bf16_f32 v144, v144, v145
v_cvt_pk_bf16_f32 v145, v146, v147
v_cvt_pk_bf16_f32 v146, v148, v149
s_add_u32 s65, s65, 4096
v_cvt_pk_bf16_f32 v147, v150, v151
v_accvgpr_write_b32 a72, v144
v_accvgpr_write_b32 a73, v145
v_accvgpr_write_b32 a74, v146
buffer_load_dwordx4 v[80:83], v1, s[8:11], s65 offen sc1
v_accvgpr_write_b32 a75, v147
v_pk_mul_f32 v[152:153], v[152:153], v[22:23]
v_pk_mul_f32 v[154:155], v[154:155], v[22:23]
v_pk_mul_f32 v[156:157], v[156:157], v[22:23]
v_pk_mul_f32 v[158:159], v[158:159], v[22:23]
s_add_u32 s65, s65, 4096
v_cvt_pk_bf16_f32 v152, v152, v153
v_cvt_pk_bf16_f32 v153, v154, v155
v_cvt_pk_bf16_f32 v154, v156, v157
v_cvt_pk_bf16_f32 v155, v158, v159
buffer_load_dwordx4 v[84:87], v1, s[8:11], s65 offen sc1
v_accvgpr_write_b32 a76, v152
v_accvgpr_write_b32 a77, v153
v_accvgpr_write_b32 a78, v154
v_accvgpr_write_b32 a79, v155
v_pk_mul_f32 v[160:161], v[160:161], v[22:23]
s_add_u32 s65, s65, 4096
v_pk_mul_f32 v[162:163], v[162:163], v[22:23]
v_pk_mul_f32 v[164:165], v[164:165], v[22:23]
v_pk_mul_f32 v[166:167], v[166:167], v[22:23]
v_cvt_pk_bf16_f32 v160, v160, v161
buffer_load_dwordx4 v[88:91], v1, s[8:11], s65 offen sc1
v_cvt_pk_bf16_f32 v161, v162, v163
v_cvt_pk_bf16_f32 v162, v164, v165
v_cvt_pk_bf16_f32 v163, v166, v167
v_accvgpr_write_b32 a80, v160
s_add_u32 s65, s65, 4096
v_accvgpr_write_b32 a81, v161
v_accvgpr_write_b32 a82, v162
v_accvgpr_write_b32 a83, v163
v_pk_mul_f32 v[168:169], v[168:169], v[22:23]
v_pk_mul_f32 v[170:171], v[170:171], v[22:23]
buffer_load_dwordx4 v[92:95], v1, s[8:11], s65 offen sc1
v_pk_mul_f32 v[172:173], v[172:173], v[22:23]
v_pk_mul_f32 v[174:175], v[174:175], v[22:23]
v_cvt_pk_bf16_f32 v168, v168, v169
v_cvt_pk_bf16_f32 v169, v170, v171
s_add_u32 s65, s65, 4096
v_cvt_pk_bf16_f32 v170, v172, v173
v_cvt_pk_bf16_f32 v171, v174, v175
v_accvgpr_write_b32 a84, v168
v_accvgpr_write_b32 a85, v169
buffer_load_dwordx4 v[96:99], v1, s[8:11], s65 offen sc1
v_accvgpr_write_b32 a86, v170
v_accvgpr_write_b32 a87, v171
v_pk_mul_f32 v[176:177], v[176:177], v[22:23]
v_pk_mul_f32 v[178:179], v[178:179], v[22:23]
v_pk_mul_f32 v[180:181], v[180:181], v[22:23]
s_add_u32 s65, s65, 4096
v_pk_mul_f32 v[182:183], v[182:183], v[22:23]
v_cvt_pk_bf16_f32 v176, v176, v177
v_cvt_pk_bf16_f32 v177, v178, v179
v_cvt_pk_bf16_f32 v178, v180, v181
buffer_load_dwordx4 v[100:103], v1, s[8:11], s65 offen sc1
v_cvt_pk_bf16_f32 v179, v182, v183
v_accvgpr_write_b32 a88, v176
v_accvgpr_write_b32 a89, v177
v_accvgpr_write_b32 a90, v178
s_add_u32 s65, s65, 4096
v_accvgpr_write_b32 a91, v179
v_pk_mul_f32 v[184:185], v[184:185], v[22:23]
v_pk_mul_f32 v[186:187], v[186:187], v[22:23]
v_pk_mul_f32 v[188:189], v[188:189], v[22:23]
v_pk_mul_f32 v[190:191], v[190:191], v[22:23]
buffer_load_dwordx4 v[104:107], v1, s[8:11], s65 offen sc1
v_cvt_pk_bf16_f32 v184, v184, v185
v_cvt_pk_bf16_f32 v185, v186, v187
v_cvt_pk_bf16_f32 v186, v188, v189
v_cvt_pk_bf16_f32 v187, v190, v191
s_add_u32 s65, s65, 4096
v_accvgpr_write_b32 a92, v184
v_accvgpr_write_b32 a93, v185
v_accvgpr_write_b32 a94, v186
v_accvgpr_write_b32 a95, v187
v_pk_mul_f32 v[192:193], v[192:193], v[22:23]
buffer_load_dwordx4 v[108:111], v1, s[8:11], s65 offen sc1
v_pk_mul_f32 v[194:195], v[194:195], v[22:23]
v_pk_mul_f32 v[196:197], v[196:197], v[22:23]
v_pk_mul_f32 v[198:199], v[198:199], v[22:23]
v_cvt_pk_bf16_f32 v192, v192, v193
s_add_u32 s65, s65, 4096
v_cvt_pk_bf16_f32 v193, v194, v195
v_cvt_pk_bf16_f32 v194, v196, v197
v_cvt_pk_bf16_f32 v195, v198, v199
v_accvgpr_write_b32 a96, v192
buffer_load_dwordx4 v[112:115], v1, s[8:11], s65 offen sc1
v_accvgpr_write_b32 a97, v193
v_accvgpr_write_b32 a98, v194
v_accvgpr_write_b32 a99, v195
v_pk_mul_f32 v[200:201], v[200:201], v[22:23]
v_pk_mul_f32 v[202:203], v[202:203], v[22:23]
s_add_u32 s65, s65, 4096
v_pk_mul_f32 v[204:205], v[204:205], v[22:23]
v_pk_mul_f32 v[206:207], v[206:207], v[22:23]
v_cvt_pk_bf16_f32 v200, v200, v201
v_cvt_pk_bf16_f32 v201, v202, v203
buffer_load_dwordx4 v[116:119], v1, s[8:11], s65 offen sc1
v_cvt_pk_bf16_f32 v202, v204, v205
v_cvt_pk_bf16_f32 v203, v206, v207
v_accvgpr_write_b32 a100, v200
v_accvgpr_write_b32 a101, v201
s_add_u32 s65, s65, 4096
v_accvgpr_write_b32 a102, v202
v_accvgpr_write_b32 a103, v203
v_pk_mul_f32 v[208:209], v[208:209], v[22:23]
v_pk_mul_f32 v[210:211], v[210:211], v[22:23]
v_pk_mul_f32 v[212:213], v[212:213], v[22:23]
buffer_load_dwordx4 v[120:123], v1, s[8:11], s65 offen sc1
v_pk_mul_f32 v[214:215], v[214:215], v[22:23]
v_cvt_pk_bf16_f32 v208, v208, v209
v_cvt_pk_bf16_f32 v209, v210, v211
v_cvt_pk_bf16_f32 v210, v212, v213
s_add_u32 s65, s65, 4096
v_cvt_pk_bf16_f32 v211, v214, v215
v_accvgpr_write_b32 a104, v208
v_accvgpr_write_b32 a105, v209
v_accvgpr_write_b32 a106, v210
buffer_load_dwordx4 v[124:127], v1, s[8:11], s65 offen sc1
v_accvgpr_write_b32 a107, v211
v_pk_mul_f32 v[216:217], v[216:217], v[22:23]
v_pk_mul_f32 v[218:219], v[218:219], v[22:23]
v_pk_mul_f32 v[220:221], v[220:221], v[22:23]
v_pk_mul_f32 v[222:223], v[222:223], v[22:23]
s_add_u32 s65, s65, 4096
v_cvt_pk_bf16_f32 v216, v216, v217
v_cvt_pk_bf16_f32 v217, v218, v219
v_cvt_pk_bf16_f32 v218, v220, v221
v_cvt_pk_bf16_f32 v219, v222, v223
buffer_load_dwordx4 a[128:131], v1, s[8:11], s63 offen offset:0 sc1
v_accvgpr_write_b32 a108, v216
v_accvgpr_write_b32 a109, v217
v_accvgpr_write_b32 a110, v218
v_accvgpr_write_b32 a111, v219
v_pk_mul_f32 v[224:225], v[224:225], v[22:23]
buffer_load_dwordx4 a[132:135], v1, s[8:11], s63 offen offset:1024 sc1
v_pk_mul_f32 v[226:227], v[226:227], v[22:23]
v_pk_mul_f32 v[228:229], v[228:229], v[22:23]
v_pk_mul_f32 v[230:231], v[230:231], v[22:23]
v_cvt_pk_bf16_f32 v224, v224, v225
s_add_u32 s63, s63, 32768
v_cvt_pk_bf16_f32 v225, v226, v227
v_cvt_pk_bf16_f32 v226, v228, v229
v_cvt_pk_bf16_f32 v227, v230, v231
v_accvgpr_write_b32 a112, v224
buffer_load_dwordx4 a[136:139], v1, s[8:11], s63 offen offset:0 sc1
v_accvgpr_write_b32 a113, v225
v_accvgpr_write_b32 a114, v226
v_accvgpr_write_b32 a115, v227
v_pk_mul_f32 v[232:233], v[232:233], v[22:23]
v_pk_mul_f32 v[234:235], v[234:235], v[22:23]
buffer_load_dwordx4 a[140:143], v1, s[8:11], s63 offen offset:1024 sc1
v_pk_mul_f32 v[236:237], v[236:237], v[22:23]
v_pk_mul_f32 v[238:239], v[238:239], v[22:23]
v_cvt_pk_bf16_f32 v232, v232, v233
v_cvt_pk_bf16_f32 v233, v234, v235
s_add_u32 s63, s63, 32768
v_cvt_pk_bf16_f32 v234, v236, v237
v_cvt_pk_bf16_f32 v235, v238, v239
v_accvgpr_write_b32 a116, v232
v_accvgpr_write_b32 a117, v233
buffer_load_dwordx4 a[144:147], v1, s[8:11], s63 offen offset:0 sc1
v_accvgpr_write_b32 a118, v234
v_accvgpr_write_b32 a119, v235
v_pk_mul_f32 v[240:241], v[240:241], v[22:23]
v_pk_mul_f32 v[242:243], v[242:243], v[22:23]
v_pk_mul_f32 v[244:245], v[244:245], v[22:23]
buffer_load_dwordx4 a[148:151], v1, s[8:11], s63 offen offset:1024 sc1
v_pk_mul_f32 v[246:247], v[246:247], v[22:23]
v_cvt_pk_bf16_f32 v240, v240, v241
v_cvt_pk_bf16_f32 v241, v242, v243
v_cvt_pk_bf16_f32 v242, v244, v245
s_add_u32 s63, s63, 32768
v_cvt_pk_bf16_f32 v243, v246, v247
v_accvgpr_write_b32 a120, v240
v_accvgpr_write_b32 a121, v241
v_accvgpr_write_b32 a122, v242
buffer_load_dwordx4 a[152:155], v1, s[8:11], s63 offen offset:0 sc1
v_accvgpr_write_b32 a123, v243
v_pk_mul_f32 v[248:249], v[248:249], v[22:23]
v_pk_mul_f32 v[250:251], v[250:251], v[22:23]
v_pk_mul_f32 v[252:253], v[252:253], v[22:23]
v_pk_mul_f32 v[254:255], v[254:255], v[22:23]
buffer_load_dwordx4 a[156:159], v1, s[8:11], s63 offen offset:1024 sc1
v_cvt_pk_bf16_f32 v248, v248, v249
v_cvt_pk_bf16_f32 v249, v250, v251
v_cvt_pk_bf16_f32 v250, v252, v253
v_cvt_pk_bf16_f32 v251, v254, v255
s_add_u32 s63, s63, 32768
v_accvgpr_write_b32 a124, v248
v_accvgpr_write_b32 a125, v249
v_accvgpr_write_b32 a126, v250
v_accvgpr_write_b32 a127, v251
v_accvgpr_read_b32 v52, a180
v_accvgpr_read_b32 v53, a181
v_accvgpr_read_b32 v54, a182
v_accvgpr_read_b32 v55, a183
v_accvgpr_read_b32 v48, a176
v_accvgpr_read_b32 v49, a177
v_accvgpr_read_b32 v50, a178
v_accvgpr_read_b32 v51, a179
v_cvt_pk_bf16_f32 v48, v48, v49
v_cvt_pk_bf16_f32 v49, v50, v51
v_cvt_pk_bf16_f32 v50, v52, v53
v_cvt_pk_bf16_f32 v51, v54, v55
buffer_store_dwordx4 v[48:51], v1, s[8:11], s76 offen offset:2048 sc1
v_accvgpr_read_b32 v52, a188
v_accvgpr_read_b32 v53, a189
v_accvgpr_read_b32 v54, a190
v_accvgpr_read_b32 v55, a191
v_accvgpr_read_b32 v48, a184
v_accvgpr_read_b32 v49, a185
v_accvgpr_read_b32 v50, a186
v_accvgpr_read_b32 v51, a187
v_cvt_pk_bf16_f32 v48, v48, v49
v_cvt_pk_bf16_f32 v49, v50, v51
v_cvt_pk_bf16_f32 v50, v52, v53
v_cvt_pk_bf16_f32 v51, v54, v55
buffer_store_dwordx4 v[48:51], v1, s[8:11], s76 offen offset:3072 sc1
s_add_u32 s76, s76, s78
.p2align 3
v_accvgpr_read_b32 v52, a196
v_accvgpr_read_b32 v53, a197
v_accvgpr_read_b32 v54, a198
v_accvgpr_read_b32 v55, a199
v_accvgpr_read_b32 v48, a192
v_accvgpr_read_b32 v49, a193
v_accvgpr_read_b32 v50, a194
v_accvgpr_read_b32 v51, a195
v_cvt_pk_bf16_f32 v48, v48, v49
v_cvt_pk_bf16_f32 v49, v50, v51
v_cvt_pk_bf16_f32 v50, v52, v53
v_cvt_pk_bf16_f32 v51, v54, v55
buffer_store_dwordx4 v[48:51], v1, s[8:11], s76 offen offset:0 sc1
v_accvgpr_read_b32 v52, a204
v_accvgpr_read_b32 v53, a205
v_accvgpr_read_b32 v54, a206
v_accvgpr_read_b32 v55, a207
v_accvgpr_read_b32 v48, a200
v_accvgpr_read_b32 v49, a201
v_accvgpr_read_b32 v50, a202
v_accvgpr_read_b32 v51, a203
v_cvt_pk_bf16_f32 v48, v48, v49
v_cvt_pk_bf16_f32 v49, v50, v51
v_cvt_pk_bf16_f32 v50, v52, v53
v_cvt_pk_bf16_f32 v51, v54, v55
buffer_store_dwordx4 v[48:51], v1, s[8:11], s76 offen offset:1024 sc1
v_accvgpr_read_b32 v52, a212
v_accvgpr_read_b32 v53, a213
v_accvgpr_read_b32 v54, a214
v_accvgpr_read_b32 v55, a215
v_accvgpr_read_b32 v48, a208
v_accvgpr_read_b32 v49, a209
v_accvgpr_read_b32 v50, a210
v_accvgpr_read_b32 v51, a211
v_cvt_pk_bf16_f32 v48, v48, v49
v_cvt_pk_bf16_f32 v49, v50, v51
v_cvt_pk_bf16_f32 v50, v52, v53
v_cvt_pk_bf16_f32 v51, v54, v55
buffer_store_dwordx4 v[48:51], v1, s[8:11], s76 offen offset:2048 sc1
v_accvgpr_read_b32 v52, a220
v_accvgpr_read_b32 v53, a221
v_accvgpr_read_b32 v54, a222
v_accvgpr_read_b32 v55, a223
v_accvgpr_read_b32 v48, a216
v_accvgpr_read_b32 v49, a217
v_accvgpr_read_b32 v50, a218
v_accvgpr_read_b32 v51, a219
v_cvt_pk_bf16_f32 v48, v48, v49
v_cvt_pk_bf16_f32 v49, v50, v51
v_cvt_pk_bf16_f32 v50, v52, v53
v_cvt_pk_bf16_f32 v51, v54, v55
buffer_store_dwordx4 v[48:51], v1, s[8:11], s76 offen offset:3072 sc1
s_add_u32 s76, s76, s77
.p2align 3
v_accvgpr_read_b32 v52, a228
v_accvgpr_read_b32 v53, a229
v_accvgpr_read_b32 v54, a230
v_accvgpr_read_b32 v55, a231
v_accvgpr_read_b32 v48, a224
v_accvgpr_read_b32 v49, a225
v_accvgpr_read_b32 v50, a226
v_accvgpr_read_b32 v51, a227
v_cvt_pk_bf16_f32 v48, v48, v49
v_cvt_pk_bf16_f32 v49, v50, v51
v_cvt_pk_bf16_f32 v50, v52, v53
v_cvt_pk_bf16_f32 v51, v54, v55
buffer_store_dwordx4 v[48:51], v1, s[8:11], s76 offen offset:0 sc1
v_accvgpr_read_b32 v52, a236
v_accvgpr_read_b32 v53, a237
v_accvgpr_read_b32 v54, a238
v_accvgpr_read_b32 v55, a239
v_accvgpr_read_b32 v48, a232
v_accvgpr_read_b32 v49, a233
v_accvgpr_read_b32 v50, a234
v_accvgpr_read_b32 v51, a235
v_cvt_pk_bf16_f32 v48, v48, v49
v_cvt_pk_bf16_f32 v49, v50, v51
v_cvt_pk_bf16_f32 v50, v52, v53
v_cvt_pk_bf16_f32 v51, v54, v55
buffer_store_dwordx4 v[48:51], v1, s[8:11], s76 offen offset:1024 sc1
v_accvgpr_read_b32 v52, a244
v_accvgpr_read_b32 v53, a245
v_accvgpr_read_b32 v54, a246
v_accvgpr_read_b32 v55, a247
v_accvgpr_read_b32 v48, a240
v_accvgpr_read_b32 v49, a241
v_accvgpr_read_b32 v50, a242
v_accvgpr_read_b32 v51, a243
v_cvt_pk_bf16_f32 v48, v48, v49
v_cvt_pk_bf16_f32 v49, v50, v51
v_cvt_pk_bf16_f32 v50, v52, v53
v_cvt_pk_bf16_f32 v51, v54, v55
buffer_store_dwordx4 v[48:51], v1, s[8:11], s76 offen offset:2048 sc1
v_accvgpr_read_b32 v52, a252
v_accvgpr_read_b32 v53, a253
v_accvgpr_read_b32 v54, a254
v_accvgpr_read_b32 v55, a255
v_accvgpr_read_b32 v48, a248
v_accvgpr_read_b32 v49, a249
v_accvgpr_read_b32 v50, a250
v_accvgpr_read_b32 v51, a251
v_cvt_pk_bf16_f32 v48, v48, v49
v_cvt_pk_bf16_f32 v49, v50, v51
v_cvt_pk_bf16_f32 v50, v52, v53
v_cvt_pk_bf16_f32 v51, v54, v55
buffer_store_dwordx4 v[48:51], v1, s[8:11], s76 offen offset:3072 sc1
s_mov_b32 s74, 0
s_mov_b32 s98, 2
s_waitcnt vmcnt(18)
.p2align 3
buffer_load_dwordx4 a[160:163], v1, s[8:11], s63 offen offset:0 sc1
buffer_load_dwordx4 a[164:167], v1, s[8:11], s63 offen offset:1024 sc1
s_add_u32 s63, s63, 32768
buffer_load_dwordx4 a[168:171], v1, s[8:11], s63 offen offset:0 sc1
buffer_load_dwordx4 a[172:175], v1, s[8:11], s63 offen offset:1024 sc1
s_add_u32 s63, s63, 32768
buffer_load_dwordx4 a[176:179], v1, s[8:11], s63 offen offset:0 sc1
buffer_load_dwordx4 a[180:183], v1, s[8:11], s63 offen offset:1024 sc1
s_add_u32 s63, s63, 32768
buffer_load_dwordx4 a[184:187], v1, s[8:11], s63 offen offset:0 sc1
buffer_load_dwordx4 a[188:191], v1, s[8:11], s63 offen offset:1024 sc1
s_add_u32 s63, s63, 32768
buffer_load_dwordx4 a[192:195], v1, s[8:11], s63 offen offset:0 sc1
buffer_load_dwordx4 a[196:199], v1, s[8:11], s63 offen offset:1024 sc1
s_add_u32 s63, s63, 32768
buffer_load_dwordx4 a[200:203], v1, s[8:11], s63 offen offset:0 sc1
buffer_load_dwordx4 a[204:207], v1, s[8:11], s63 offen offset:1024 sc1
s_add_u32 s63, s63, 32768
buffer_load_dwordx4 a[208:211], v1, s[8:11], s63 offen offset:0 sc1
buffer_load_dwordx4 a[212:215], v1, s[8:11], s63 offen offset:1024 sc1
s_add_u32 s63, s63, 32768
buffer_load_dwordx4 a[216:219], v1, s[8:11], s63 offen offset:0 sc1
buffer_load_dwordx4 a[220:223], v1, s[8:11], s63 offen offset:1024 sc1
s_add_u32 s63, s63, 32768
buffer_load_dwordx4 a[224:227], v1, s[8:11], s63 offen offset:0 sc1
buffer_load_dwordx4 a[228:231], v1, s[8:11], s63 offen offset:1024 sc1
s_add_u32 s63, s63, 32768
buffer_load_dwordx4 a[232:235], v1, s[8:11], s63 offen offset:0 sc1
buffer_load_dwordx4 a[236:239], v1, s[8:11], s63 offen offset:1024 sc1
s_add_u32 s63, s63, 32768
buffer_load_dwordx4 a[240:243], v1, s[8:11], s63 offen offset:0 sc1
buffer_load_dwordx4 a[244:247], v1, s[8:11], s63 offen offset:1024 sc1
s_add_u32 s63, s63, 32768
v_mfma_f32_16x16x32_bf16 v[128:131], v[56:59], v[64:67], 0
v_mfma_f32_16x16x32_bf16 v[128:131], v[56:59], v[68:71], v[128:131]
v_mfma_f32_16x16x32_bf16 v[128:131], v[56:59], v[72:75], v[128:131]
v_mfma_f32_16x16x32_bf16 v[128:131], v[56:59], v[76:79], v[128:131]
v_mfma_f32_16x16x32_bf16 v[128:131], v[56:59], v[80:83], v[128:131]
v_mfma_f32_16x16x32_bf16 v[128:131], v[56:59], v[84:87], v[128:131]
v_mfma_f32_16x16x32_bf16 v[128:131], v[56:59], v[88:91], v[128:131]
v_mfma_f32_16x16x32_bf16 v[128:131], v[56:59], v[92:95], v[128:131]
v_mfma_f32_16x16x32_bf16 v[128:131], v[56:59], v[96:99], v[128:131]
v_mfma_f32_16x16x32_bf16 v[128:131], v[56:59], v[100:103], v[128:131]
v_mfma_f32_16x16x32_bf16 v[128:131], v[56:59], v[104:107], v[128:131]
v_mfma_f32_16x16x32_bf16 v[128:131], v[56:59], v[108:111], v[128:131]
v_mfma_f32_16x16x32_bf16 v[128:131], v[56:59], v[112:115], v[128:131]
v_mfma_f32_16x16x32_bf16 v[128:131], v[56:59], v[116:119], v[128:131]
v_mfma_f32_16x16x32_bf16 v[128:131], v[56:59], v[120:123], v[128:131]
v_mfma_f32_16x16x32_bf16 v[128:131], v[56:59], v[124:127], v[128:131]
v_mfma_f32_16x16x32_bf16 v[132:135], v[60:63], v[64:67], 0
v_mfma_f32_16x16x32_bf16 v[132:135], v[60:63], v[68:71], v[132:135]
v_mfma_f32_16x16x32_bf16 v[132:135], v[60:63], v[72:75], v[132:135]
v_mfma_f32_16x16x32_bf16 v[132:135], v[60:63], v[76:79], v[132:135]
v_mfma_f32_16x16x32_bf16 v[132:135], v[60:63], v[80:83], v[132:135]
v_mfma_f32_16x16x32_bf16 v[132:135], v[60:63], v[84:87], v[132:135]
v_mfma_f32_16x16x32_bf16 v[132:135], v[60:63], v[88:91], v[132:135]
v_mfma_f32_16x16x32_bf16 v[132:135], v[60:63], v[92:95], v[132:135]
v_mfma_f32_16x16x32_bf16 v[132:135], v[60:63], v[96:99], v[132:135]
v_mfma_f32_16x16x32_bf16 v[132:135], v[60:63], v[100:103], v[132:135]
v_mfma_f32_16x16x32_bf16 v[132:135], v[60:63], v[104:107], v[132:135]
v_mfma_f32_16x16x32_bf16 v[132:135], v[60:63], v[108:111], v[132:135]
v_mfma_f32_16x16x32_bf16 v[132:135], v[60:63], v[112:115], v[132:135]
v_mfma_f32_16x16x32_bf16 v[132:135], v[60:63], v[116:119], v[132:135]
v_mfma_f32_16x16x32_bf16 v[132:135], v[60:63], v[120:123], v[132:135]
v_mfma_f32_16x16x32_bf16 v[132:135], v[60:63], v[124:127], v[132:135]
s_nop 7
v_cvt_pk_bf16_f32 v128, v128, v129
v_cvt_pk_bf16_f32 v129, v130, v131
v_cvt_pk_bf16_f32 v130, v132, v133
v_cvt_pk_bf16_f32 v131, v134, v135
v_add_u32 v25, 132096, v1
v_add_u32 v22, s68, v25
ds_write_b128 v22, v[128:131]
v_and_b32 v23, 0xffffff00, v25
v_bfe_u32 v24, v1, 4, 4
v_cmp_gt_u32 vcc, 12, v24
s_waitcnt lgkmcnt(0)
s_barrier
.p2align 3
ds_read_b128 v[64:67], v25 offset:0
ds_read_b128 v[68:71], v25 offset:1024
ds_read_b128 v[72:75], v23 offset:1216
ds_read_b128 v[76:79], v25 offset:2048
ds_read_b128 v[80:83], v25 offset:3072
ds_read_b128 v[84:87], v23 offset:3264
s_lshl_b32 s65, s60, 19
s_lshl_b32 s64, s61, 10
s_add_u32 s65, s65, s64
s_add_u32 s65, s65, 130023424
s_waitcnt lgkmcnt(0)
v_cndmask_b32 v68, 0, v68, vcc
v_cndmask_b32 v69, 0, v69, vcc
v_cndmask_b32 v70, 0, v70, vcc
v_cndmask_b32 v71, 0, v71, vcc
v_cndmask_b32 v80, 0, v80, vcc
v_cndmask_b32 v81, 0, v81, vcc
v_cndmask_b32 v82, 0, v82, vcc
v_cndmask_b32 v83, 0, v83, vcc
s_waitcnt vmcnt(22)
v_mov_b32 v6, 3
buffer_store_dword v6, off, s[8:11], s81 sc1
v_mfma_f32_16x16x32_bf16 v[136:139], v[72:75], a[128:131], 0
buffer_load_dwordx4 a[248:251], v1, s[8:11], s63 offen offset:0 sc1
buffer_load_dwordx4 a[252:255], v1, s[8:11], s63 offen offset:1024 sc1
s_add_u32 s63, s63, 32768
v_mfma_f32_16x16x32_bf16 v[128:131], v[64:67], a[128:131], 0
v_mfma_f32_16x16x32_bf16 v[132:135], v[68:71], a[128:131], 0
v_mfma_f32_16x16x32_bf16 v[136:139], v[84:87], a[132:135], v[136:139]
v_mfma_f32_16x16x32_bf16 v[128:131], v[76:79], a[132:135], v[128:131]
v_mfma_f32_16x16x32_bf16 v[132:135], v[80:83], a[132:135], v[132:135]
s_waitcnt vmcnt(39)
v_mfma_f32_16x16x32_bf16 v[148:151], v[72:75], a[136:139], 0
buffer_load_dwordx4 a[128:131], v1, s[8:11], s63 offen offset:0 sc1
buffer_load_dwordx4 a[132:135], v1, s[8:11], s63 offen offset:1024 sc1
s_add_u32 s63, s63, 32768
v_mfma_f32_16x16x32_bf16 v[140:143], v[64:67], a[136:139], 0
v_mfma_f32_16x16x32_bf16 v[144:147], v[68:71], a[136:139], 0
v_mfma_f32_16x16x32_bf16 v[148:151], v[84:87], a[140:143], v[148:151]
v_mfma_f32_16x16x32_bf16 v[140:143], v[76:79], a[140:143], v[140:143]
v_mfma_f32_16x16x32_bf16 v[144:147], v[80:83], a[140:143], v[144:147]
s_waitcnt vmcnt(39)
v_mfma_f32_16x16x32_bf16 v[160:163], v[72:75], a[144:147], 0
buffer_load_dwordx4 a[136:139], v1, s[8:11], s63 offen offset:0 sc1
buffer_load_dwordx4 a[140:143], v1, s[8:11], s63 offen offset:1024 sc1
s_add_u32 s63, s63, 32768
v_add_f32 v136, 0x358637bd, v136
v_mfma_f32_16x16x32_bf16 v[152:155], v[64:67], a[144:147], 0
v_rcp_f32 v136, v136
v_mfma_f32_16x16x32_bf16 v[156:159], v[68:71], a[144:147], 0
v_mul_f32 v128, v136, v128
v_mul_f32 v129, v136, v129
v_mul_f32 v130, v136, v130
v_mfma_f32_16x16x32_bf16 v[160:163], v[84:87], a[148:151], v[160:163]
v_mul_f32 v131, v136, v131
v_mul_f32 v132, v136, v132
v_mul_f32 v133, v136, v133
v_mfma_f32_16x16x32_bf16 v[152:155], v[76:79], a[148:151], v[152:155]
v_mul_f32 v134, v136, v134
v_mul_f32 v135, v136, v135
v_cvt_pk_bf16_f32 v176, v128, v129
v_mfma_f32_16x16x32_bf16 v[156:159], v[80:83], a[148:151], v[156:159]
s_waitcnt vmcnt(39)
v_cvt_pk_bf16_f32 v177, v130, v131
v_cvt_pk_bf16_f32 v178, v132, v133
v_cvt_pk_bf16_f32 v179, v134, v135
v_mfma_f32_16x16x32_bf16 v[172:175], v[72:75], a[152:155], 0
buffer_load_dwordx4 a[144:147], v1, s[8:11], s63 offen offset:0 sc1
buffer_load_dwordx4 a[148:151], v1, s[8:11], s63 offen offset:1024 sc1
s_add_u32 s63, s63, 32768
v_add_f32 v148, 0x358637bd, v148
v_mfma_f32_16x16x32_bf16 v[164:167], v[64:67], a[152:155], 0
v_rcp_f32 v148, v148
v_mfma_f32_16x16x32_bf16 v[168:171], v[68:71], a[152:155], 0
v_mul_f32 v140, v148, v140
v_mul_f32 v141, v148, v141
v_mul_f32 v142, v148, v142
v_mfma_f32_16x16x32_bf16 v[172:175], v[84:87], a[156:159], v[172:175]
v_mul_f32 v143, v148, v143
v_mul_f32 v144, v148, v144
v_mul_f32 v145, v148, v145
v_mfma_f32_16x16x32_bf16 v[164:167], v[76:79], a[156:159], v[164:167]
v_mul_f32 v146, v148, v146
v_mul_f32 v147, v148, v147
v_cvt_pk_bf16_f32 v180, v140, v141
v_mfma_f32_16x16x32_bf16 v[168:171], v[80:83], a[156:159], v[168:171]
s_waitcnt vmcnt(29)
v_cvt_pk_bf16_f32 v181, v142, v143
v_cvt_pk_bf16_f32 v182, v144, v145
v_cvt_pk_bf16_f32 v183, v146, v147
v_mfma_f32_16x16x32_bf16 v[136:139], v[72:75], a[160:163], 0
buffer_load_dwordx4 a[152:155], v1, s[8:11], s63 offen offset:0 sc1
buffer_load_dwordx4 a[156:159], v1, s[8:11], s63 offen offset:1024 sc1
s_add_u32 s63, s63, 32768
v_add_f32 v160, 0x358637bd, v160
v_mfma_f32_16x16x32_bf16 v[128:131], v[64:67], a[160:163], 0
v_rcp_f32 v160, v160
v_mfma_f32_16x16x32_bf16 v[132:135], v[68:71], a[160:163], 0
v_mul_f32 v152, v160, v152
v_mul_f32 v153, v160, v153
v_mul_f32 v154, v160, v154
v_mfma_f32_16x16x32_bf16 v[136:139], v[84:87], a[164:167], v[136:139]
v_mul_f32 v155, v160, v155
v_mul_f32 v156, v160, v156
v_mul_f32 v157, v160, v157
v_mfma_f32_16x16x32_bf16 v[128:131], v[76:79], a[164:167], v[128:131]
v_mul_f32 v158, v160, v158
v_mul_f32 v159, v160, v159
v_cvt_pk_bf16_f32 v184, v152, v153
v_mfma_f32_16x16x32_bf16 v[132:135], v[80:83], a[164:167], v[132:135]
s_waitcnt vmcnt(29)
v_cvt_pk_bf16_f32 v185, v154, v155
v_cvt_pk_bf16_f32 v186, v156, v157
v_cvt_pk_bf16_f32 v187, v158, v159
v_mfma_f32_16x16x32_bf16 v[148:151], v[72:75], a[168:171], 0
buffer_load_dwordx4 a[160:163], v1, s[8:11], s63 offen offset:0 sc1
buffer_load_dwordx4 a[164:167], v1, s[8:11], s63 offen offset:1024 sc1
s_add_u32 s63, s63, 32768
v_add_f32 v172, 0x358637bd, v172
v_mfma_f32_16x16x32_bf16 v[140:143], v[64:67], a[168:171], 0
v_rcp_f32 v172, v172
v_mfma_f32_16x16x32_bf16 v[144:147], v[68:71], a[168:171], 0
v_mul_f32 v164, v172, v164
v_mul_f32 v165, v172, v165
v_mul_f32 v166, v172, v166
v_mfma_f32_16x16x32_bf16 v[148:151], v[84:87], a[172:175], v[148:151]
v_mul_f32 v167, v172, v167
v_mul_f32 v168, v172, v168
v_mul_f32 v169, v172, v169
v_mfma_f32_16x16x32_bf16 v[140:143], v[76:79], a[172:175], v[140:143]
v_mul_f32 v170, v172, v170
v_mul_f32 v171, v172, v171
v_cvt_pk_bf16_f32 v188, v164, v165
v_mfma_f32_16x16x32_bf16 v[144:147], v[80:83], a[172:175], v[144:147]
s_waitcnt vmcnt(29)
v_cvt_pk_bf16_f32 v189, v166, v167
v_cvt_pk_bf16_f32 v190, v168, v169
v_cvt_pk_bf16_f32 v191, v170, v171
v_mfma_f32_16x16x32_bf16 v[160:163], v[72:75], a[176:179], 0
buffer_load_dwordx4 a[168:171], v1, s[8:11], s63 offen offset:0 sc1
buffer_load_dwordx4 a[172:175], v1, s[8:11], s63 offen offset:1024 sc1
s_add_u32 s63, s63, 32768
v_add_f32 v136, 0x358637bd, v136
v_mfma_f32_16x16x32_bf16 v[152:155], v[64:67], a[176:179], 0
v_rcp_f32 v136, v136
v_mfma_f32_16x16x32_bf16 v[156:159], v[68:71], a[176:179], 0
v_mul_f32 v128, v136, v128
v_mul_f32 v129, v136, v129
v_mul_f32 v130, v136, v130
v_mfma_f32_16x16x32_bf16 v[160:163], v[84:87], a[180:183], v[160:163]
v_mul_f32 v131, v136, v131
v_mul_f32 v132, v136, v132
v_mul_f32 v133, v136, v133
v_mfma_f32_16x16x32_bf16 v[152:155], v[76:79], a[180:183], v[152:155]
v_mul_f32 v134, v136, v134
v_mul_f32 v135, v136, v135
v_cvt_pk_bf16_f32 v192, v128, v129
v_mfma_f32_16x16x32_bf16 v[156:159], v[80:83], a[180:183], v[156:159]
s_waitcnt vmcnt(29)
v_cvt_pk_bf16_f32 v193, v130, v131
v_cvt_pk_bf16_f32 v194, v132, v133
v_cvt_pk_bf16_f32 v195, v134, v135
v_mfma_f32_16x16x32_bf16 v[172:175], v[72:75], a[184:187], 0
buffer_load_dwordx4 a[176:179], v1, s[8:11], s63 offen offset:0 sc1
buffer_load_dwordx4 a[180:183], v1, s[8:11], s63 offen offset:1024 sc1
s_add_u32 s63, s63, 32768
v_add_f32 v148, 0x358637bd, v148
v_mfma_f32_16x16x32_bf16 v[164:167], v[64:67], a[184:187], 0
v_rcp_f32 v148, v148
v_mfma_f32_16x16x32_bf16 v[168:171], v[68:71], a[184:187], 0
v_mul_f32 v140, v148, v140
v_mul_f32 v141, v148, v141
v_mul_f32 v142, v148, v142
v_mfma_f32_16x16x32_bf16 v[172:175], v[84:87], a[188:191], v[172:175]
v_mul_f32 v143, v148, v143
v_mul_f32 v144, v148, v144
v_mul_f32 v145, v148, v145
v_mfma_f32_16x16x32_bf16 v[164:167], v[76:79], a[188:191], v[164:167]
v_mul_f32 v146, v148, v146
v_mul_f32 v147, v148, v147
v_cvt_pk_bf16_f32 v196, v140, v141
v_mfma_f32_16x16x32_bf16 v[168:171], v[80:83], a[188:191], v[168:171]
s_waitcnt vmcnt(29)
v_cvt_pk_bf16_f32 v197, v142, v143
v_cvt_pk_bf16_f32 v198, v144, v145
v_cvt_pk_bf16_f32 v199, v146, v147
v_mfma_f32_16x16x32_bf16 v[136:139], v[72:75], a[192:195], 0
buffer_load_dwordx4 a[184:187], v1, s[8:11], s63 offen offset:0 sc1
buffer_load_dwordx4 a[188:191], v1, s[8:11], s63 offen offset:1024 sc1
s_add_u32 s63, s63, 32768
v_add_f32 v160, 0x358637bd, v160
v_mfma_f32_16x16x32_bf16 v[128:131], v[64:67], a[192:195], 0
v_rcp_f32 v160, v160
v_mfma_f32_16x16x32_bf16 v[132:135], v[68:71], a[192:195], 0
v_mul_f32 v152, v160, v152
v_mul_f32 v153, v160, v153
v_mul_f32 v154, v160, v154
v_mfma_f32_16x16x32_bf16 v[136:139], v[84:87], a[196:199], v[136:139]
v_mul_f32 v155, v160, v155
v_mul_f32 v156, v160, v156
v_mul_f32 v157, v160, v157
v_mfma_f32_16x16x32_bf16 v[128:131], v[76:79], a[196:199], v[128:131]
v_mul_f32 v158, v160, v158
v_mul_f32 v159, v160, v159
v_cvt_pk_bf16_f32 v200, v152, v153
v_mfma_f32_16x16x32_bf16 v[132:135], v[80:83], a[196:199], v[132:135]
s_waitcnt vmcnt(29)
v_cvt_pk_bf16_f32 v201, v154, v155
v_cvt_pk_bf16_f32 v202, v156, v157
v_cvt_pk_bf16_f32 v203, v158, v159
v_mfma_f32_16x16x32_bf16 v[148:151], v[72:75], a[200:203], 0
buffer_load_dwordx4 a[192:195], v1, s[8:11], s63 offen offset:0 sc1
buffer_load_dwordx4 a[196:199], v1, s[8:11], s63 offen offset:1024 sc1
s_add_u32 s63, s63, 32768
v_add_f32 v172, 0x358637bd, v172
v_mfma_f32_16x16x32_bf16 v[140:143], v[64:67], a[200:203], 0
v_rcp_f32 v172, v172
v_mfma_f32_16x16x32_bf16 v[144:147], v[68:71], a[200:203], 0
v_mul_f32 v164, v172, v164
v_mul_f32 v165, v172, v165
v_mul_f32 v166, v172, v166
v_mfma_f32_16x16x32_bf16 v[148:151], v[84:87], a[204:207], v[148:151]
v_mul_f32 v167, v172, v167
v_mul_f32 v168, v172, v168
v_mul_f32 v169, v172, v169
v_mfma_f32_16x16x32_bf16 v[140:143], v[76:79], a[204:207], v[140:143]
v_mul_f32 v170, v172, v170
v_mul_f32 v171, v172, v171
v_cvt_pk_bf16_f32 v204, v164, v165
v_mfma_f32_16x16x32_bf16 v[144:147], v[80:83], a[204:207], v[144:147]
s_waitcnt vmcnt(29)
v_cvt_pk_bf16_f32 v205, v166, v167
v_cvt_pk_bf16_f32 v206, v168, v169
v_cvt_pk_bf16_f32 v207, v170, v171
v_mfma_f32_16x16x32_bf16 v[160:163], v[72:75], a[208:211], 0
buffer_load_dwordx4 a[200:203], v1, s[8:11], s63 offen offset:0 sc1
buffer_load_dwordx4 a[204:207], v1, s[8:11], s63 offen offset:1024 sc1
s_add_u32 s63, s63, 32768
v_add_f32 v136, 0x358637bd, v136
v_mfma_f32_16x16x32_bf16 v[152:155], v[64:67], a[208:211], 0
v_rcp_f32 v136, v136
v_mfma_f32_16x16x32_bf16 v[156:159], v[68:71], a[208:211], 0
v_mul_f32 v128, v136, v128
v_mul_f32 v129, v136, v129
v_mul_f32 v130, v136, v130
v_mfma_f32_16x16x32_bf16 v[160:163], v[84:87], a[212:215], v[160:163]
v_mul_f32 v131, v136, v131
v_mul_f32 v132, v136, v132
v_mul_f32 v133, v136, v133
v_mfma_f32_16x16x32_bf16 v[152:155], v[76:79], a[212:215], v[152:155]
v_mul_f32 v134, v136, v134
v_mul_f32 v135, v136, v135
v_cvt_pk_bf16_f32 v208, v128, v129
v_mfma_f32_16x16x32_bf16 v[156:159], v[80:83], a[212:215], v[156:159]
s_waitcnt vmcnt(29)
v_cvt_pk_bf16_f32 v209, v130, v131
v_cvt_pk_bf16_f32 v210, v132, v133
v_cvt_pk_bf16_f32 v211, v134, v135
v_mfma_f32_16x16x32_bf16 v[172:175], v[72:75], a[216:219], 0
buffer_load_dwordx4 a[208:211], v1, s[8:11], s63 offen offset:0 sc1
buffer_load_dwordx4 a[212:215], v1, s[8:11], s63 offen offset:1024 sc1
s_add_u32 s63, s63, 32768
v_add_f32 v148, 0x358637bd, v148
v_mfma_f32_16x16x32_bf16 v[164:167], v[64:67], a[216:219], 0
v_rcp_f32 v148, v148
v_mfma_f32_16x16x32_bf16 v[168:171], v[68:71], a[216:219], 0
v_mul_f32 v140, v148, v140
v_mul_f32 v141, v148, v141
v_mul_f32 v142, v148, v142
v_mfma_f32_16x16x32_bf16 v[172:175], v[84:87], a[220:223], v[172:175]
v_mul_f32 v143, v148, v143
v_mul_f32 v144, v148, v144
v_mul_f32 v145, v148, v145
v_mfma_f32_16x16x32_bf16 v[164:167], v[76:79], a[220:223], v[164:167]
v_mul_f32 v146, v148, v146
v_mul_f32 v147, v148, v147
v_cvt_pk_bf16_f32 v212, v140, v141
v_mfma_f32_16x16x32_bf16 v[168:171], v[80:83], a[220:223], v[168:171]
s_waitcnt vmcnt(29)
v_cvt_pk_bf16_f32 v213, v142, v143
v_cvt_pk_bf16_f32 v214, v144, v145
v_cvt_pk_bf16_f32 v215, v146, v147
v_mfma_f32_16x16x32_bf16 v[136:139], v[72:75], a[224:227], 0
buffer_load_dwordx4 a[216:219], v1, s[8:11], s63 offen offset:0 sc1
buffer_load_dwordx4 a[220:223], v1, s[8:11], s63 offen offset:1024 sc1
s_add_u32 s63, s63, 32768
v_add_f32 v160, 0x358637bd, v160
v_mfma_f32_16x16x32_bf16 v[128:131], v[64:67], a[224:227], 0
v_rcp_f32 v160, v160
v_mfma_f32_16x16x32_bf16 v[132:135], v[68:71], a[224:227], 0
v_mul_f32 v152, v160, v152
v_mul_f32 v153, v160, v153
v_mul_f32 v154, v160, v154
v_mfma_f32_16x16x32_bf16 v[136:139], v[84:87], a[228:231], v[136:139]
v_mul_f32 v155, v160, v155
v_mul_f32 v156, v160, v156
v_mul_f32 v157, v160, v157
v_mfma_f32_16x16x32_bf16 v[128:131], v[76:79], a[228:231], v[128:131]
v_mul_f32 v158, v160, v158
v_mul_f32 v159, v160, v159
v_cvt_pk_bf16_f32 v216, v152, v153
v_mfma_f32_16x16x32_bf16 v[132:135], v[80:83], a[228:231], v[132:135]
s_waitcnt vmcnt(29)
v_cvt_pk_bf16_f32 v217, v154, v155
v_cvt_pk_bf16_f32 v218, v156, v157
v_cvt_pk_bf16_f32 v219, v158, v159
v_mfma_f32_16x16x32_bf16 v[148:151], v[72:75], a[232:235], 0
buffer_load_dwordx4 a[224:227], v1, s[8:11], s63 offen offset:0 sc1
buffer_load_dwordx4 a[228:231], v1, s[8:11], s63 offen offset:1024 sc1
s_add_u32 s63, s63, 32768
v_add_f32 v172, 0x358637bd, v172
v_mfma_f32_16x16x32_bf16 v[140:143], v[64:67], a[232:235], 0
v_rcp_f32 v172, v172
v_mfma_f32_16x16x32_bf16 v[144:147], v[68:71], a[232:235], 0
v_mul_f32 v164, v172, v164
v_mul_f32 v165, v172, v165
v_mul_f32 v166, v172, v166
v_mfma_f32_16x16x32_bf16 v[148:151], v[84:87], a[236:239], v[148:151]
v_mul_f32 v167, v172, v167
v_mul_f32 v168, v172, v168
v_mul_f32 v169, v172, v169
v_mfma_f32_16x16x32_bf16 v[140:143], v[76:79], a[236:239], v[140:143]
v_mul_f32 v170, v172, v170
v_mul_f32 v171, v172, v171
v_cvt_pk_bf16_f32 v220, v164, v165
v_mfma_f32_16x16x32_bf16 v[144:147], v[80:83], a[236:239], v[144:147]
s_waitcnt vmcnt(29)
v_cvt_pk_bf16_f32 v221, v166, v167
v_cvt_pk_bf16_f32 v222, v168, v169
v_cvt_pk_bf16_f32 v223, v170, v171
v_mfma_f32_16x16x32_bf16 v[160:163], v[72:75], a[240:243], 0
buffer_load_dwordx4 a[232:235], v1, s[8:11], s63 offen offset:0 sc1
buffer_load_dwordx4 a[236:239], v1, s[8:11], s63 offen offset:1024 sc1
s_add_u32 s63, s63, 32768
v_add_f32 v136, 0x358637bd, v136
v_mfma_f32_16x16x32_bf16 v[152:155], v[64:67], a[240:243], 0
v_rcp_f32 v136, v136
v_mfma_f32_16x16x32_bf16 v[156:159], v[68:71], a[240:243], 0
v_mul_f32 v128, v136, v128
v_mul_f32 v129, v136, v129
v_mul_f32 v130, v136, v130
v_mfma_f32_16x16x32_bf16 v[160:163], v[84:87], a[244:247], v[160:163]
v_mul_f32 v131, v136, v131
v_mul_f32 v132, v136, v132
v_mul_f32 v133, v136, v133
v_mfma_f32_16x16x32_bf16 v[152:155], v[76:79], a[244:247], v[152:155]
v_mul_f32 v134, v136, v134
v_mul_f32 v135, v136, v135
v_cvt_pk_bf16_f32 v224, v128, v129
v_mfma_f32_16x16x32_bf16 v[156:159], v[80:83], a[244:247], v[156:159]
s_waitcnt vmcnt(28)
v_cvt_pk_bf16_f32 v225, v130, v131
v_cvt_pk_bf16_f32 v226, v132, v133
v_cvt_pk_bf16_f32 v227, v134, v135
v_mfma_f32_16x16x32_bf16 v[172:175], v[72:75], a[248:251], 0
buffer_load_dwordx4 a[240:243], v1, s[8:11], s63 offen offset:0 sc1
buffer_load_dwordx4 a[244:247], v1, s[8:11], s63 offen offset:1024 sc1
s_add_u32 s63, s63, 32768
v_add_f32 v148, 0x358637bd, v148
v_mfma_f32_16x16x32_bf16 v[164:167], v[64:67], a[248:251], 0
v_rcp_f32 v148, v148
v_mfma_f32_16x16x32_bf16 v[168:171], v[68:71], a[248:251], 0
v_mul_f32 v140, v148, v140
v_mul_f32 v141, v148, v141
v_mul_f32 v142, v148, v142
v_mfma_f32_16x16x32_bf16 v[172:175], v[84:87], a[252:255], v[172:175]
v_mul_f32 v143, v148, v143
v_mul_f32 v144, v148, v144
v_mul_f32 v145, v148, v145
v_mfma_f32_16x16x32_bf16 v[164:167], v[76:79], a[252:255], v[164:167]
v_mul_f32 v146, v148, v146
v_mul_f32 v147, v148, v147
v_cvt_pk_bf16_f32 v228, v140, v141
v_mfma_f32_16x16x32_bf16 v[168:171], v[80:83], a[252:255], v[168:171]
s_waitcnt vmcnt(28)
v_cvt_pk_bf16_f32 v229, v142, v143
v_cvt_pk_bf16_f32 v230, v144, v145
v_cvt_pk_bf16_f32 v231, v146, v147
v_mfma_f32_16x16x32_bf16 v[136:139], v[72:75], a[128:131], 0
buffer_load_dwordx4 a[248:251], v1, s[8:11], s63 offen offset:0 sc1
buffer_load_dwordx4 a[252:255], v1, s[8:11], s63 offen offset:1024 sc1
s_add_u32 s63, s63, 32768
v_add_f32 v160, 0x358637bd, v160
v_mfma_f32_16x16x32_bf16 v[128:131], v[64:67], a[128:131], 0
v_rcp_f32 v160, v160
v_mfma_f32_16x16x32_bf16 v[132:135], v[68:71], a[128:131], 0
v_mul_f32 v152, v160, v152
v_mul_f32 v153, v160, v153
v_mul_f32 v154, v160, v154
v_mfma_f32_16x16x32_bf16 v[136:139], v[84:87], a[132:135], v[136:139]
v_mul_f32 v155, v160, v155
v_mul_f32 v156, v160, v156
v_mul_f32 v157, v160, v157
v_mfma_f32_16x16x32_bf16 v[128:131], v[76:79], a[132:135], v[128:131]
v_mul_f32 v158, v160, v158
v_mul_f32 v159, v160, v159
v_cvt_pk_bf16_f32 v232, v152, v153
v_mfma_f32_16x16x32_bf16 v[132:135], v[80:83], a[132:135], v[132:135]
s_waitcnt vmcnt(28)
v_cvt_pk_bf16_f32 v233, v154, v155
v_cvt_pk_bf16_f32 v234, v156, v157
v_cvt_pk_bf16_f32 v235, v158, v159
v_mfma_f32_16x16x32_bf16 v[148:151], v[72:75], a[136:139], 0
buffer_store_dwordx4 v[176:179], v1, s[8:11], s65 offen sc1
s_add_u32 s65, s65, 16384
buffer_store_dwordx4 v[180:183], v1, s[8:11], s65 offen sc1
s_add_u32 s65, s65, 16384
v_add_f32 v172, 0x358637bd, v172
v_mfma_f32_16x16x32_bf16 v[140:143], v[64:67], a[136:139], 0
v_rcp_f32 v172, v172
v_mfma_f32_16x16x32_bf16 v[144:147], v[68:71], a[136:139], 0
v_mul_f32 v164, v172, v164
v_mul_f32 v165, v172, v165
v_mul_f32 v166, v172, v166
v_mfma_f32_16x16x32_bf16 v[148:151], v[84:87], a[140:143], v[148:151]
v_mul_f32 v167, v172, v167
v_mul_f32 v168, v172, v168
v_mul_f32 v169, v172, v169
v_mfma_f32_16x16x32_bf16 v[140:143], v[76:79], a[140:143], v[140:143]
v_mul_f32 v170, v172, v170
v_mul_f32 v171, v172, v171
v_cvt_pk_bf16_f32 v236, v164, v165
v_mfma_f32_16x16x32_bf16 v[144:147], v[80:83], a[140:143], v[144:147]
s_waitcnt vmcnt(28)
v_cvt_pk_bf16_f32 v237, v166, v167
v_cvt_pk_bf16_f32 v238, v168, v169
v_cvt_pk_bf16_f32 v239, v170, v171
v_mfma_f32_16x16x32_bf16 v[160:163], v[72:75], a[144:147], 0
buffer_store_dwordx4 v[184:187], v1, s[8:11], s65 offen sc1
s_add_u32 s65, s65, 16384
buffer_store_dwordx4 v[188:191], v1, s[8:11], s65 offen sc1
s_add_u32 s65, s65, 16384
v_add_f32 v136, 0x358637bd, v136
v_mfma_f32_16x16x32_bf16 v[152:155], v[64:67], a[144:147], 0
v_rcp_f32 v136, v136
v_mfma_f32_16x16x32_bf16 v[156:159], v[68:71], a[144:147], 0
v_mul_f32 v128, v136, v128
v_mul_f32 v129, v136, v129
v_mul_f32 v130, v136, v130
v_mfma_f32_16x16x32_bf16 v[160:163], v[84:87], a[148:151], v[160:163]
v_mul_f32 v131, v136, v131
v_mul_f32 v132, v136, v132
v_mul_f32 v133, v136, v133
v_mfma_f32_16x16x32_bf16 v[152:155], v[76:79], a[148:151], v[152:155]
v_mul_f32 v134, v136, v134
v_mul_f32 v135, v136, v135
v_cvt_pk_bf16_f32 v240, v128, v129
v_mfma_f32_16x16x32_bf16 v[156:159], v[80:83], a[148:151], v[156:159]
s_waitcnt vmcnt(28)
v_cvt_pk_bf16_f32 v241, v130, v131
v_cvt_pk_bf16_f32 v242, v132, v133
v_cvt_pk_bf16_f32 v243, v134, v135
v_mfma_f32_16x16x32_bf16 v[172:175], v[72:75], a[152:155], 0
buffer_store_dwordx4 v[192:195], v1, s[8:11], s65 offen sc1
s_add_u32 s65, s65, 16384
buffer_store_dwordx4 v[196:199], v1, s[8:11], s65 offen sc1
s_add_u32 s65, s65, 16384
v_add_f32 v148, 0x358637bd, v148
v_mfma_f32_16x16x32_bf16 v[164:167], v[64:67], a[152:155], 0
v_rcp_f32 v148, v148
v_mfma_f32_16x16x32_bf16 v[168:171], v[68:71], a[152:155], 0
v_mul_f32 v140, v148, v140
v_mul_f32 v141, v148, v141
v_mul_f32 v142, v148, v142
v_mfma_f32_16x16x32_bf16 v[172:175], v[84:87], a[156:159], v[172:175]
v_mul_f32 v143, v148, v143
v_mul_f32 v144, v148, v144
v_mul_f32 v145, v148, v145
v_mfma_f32_16x16x32_bf16 v[164:167], v[76:79], a[156:159], v[164:167]
v_mul_f32 v146, v148, v146
v_mul_f32 v147, v148, v147
v_cvt_pk_bf16_f32 v244, v140, v141
v_mfma_f32_16x16x32_bf16 v[168:171], v[80:83], a[156:159], v[168:171]
s_waitcnt vmcnt(28)
v_cvt_pk_bf16_f32 v245, v142, v143
v_cvt_pk_bf16_f32 v246, v144, v145
v_cvt_pk_bf16_f32 v247, v146, v147
v_mfma_f32_16x16x32_bf16 v[136:139], v[72:75], a[160:163], 0
buffer_store_dwordx4 v[200:203], v1, s[8:11], s65 offen sc1
s_add_u32 s65, s65, 16384
buffer_store_dwordx4 v[204:207], v1, s[8:11], s65 offen sc1
s_add_u32 s65, s65, 16384
v_add_f32 v160, 0x358637bd, v160
v_mfma_f32_16x16x32_bf16 v[128:131], v[64:67], a[160:163], 0
v_rcp_f32 v160, v160
v_mfma_f32_16x16x32_bf16 v[132:135], v[68:71], a[160:163], 0
v_mul_f32 v152, v160, v152
v_mul_f32 v153, v160, v153
v_mul_f32 v154, v160, v154
v_mfma_f32_16x16x32_bf16 v[136:139], v[84:87], a[164:167], v[136:139]
v_mul_f32 v155, v160, v155
v_mul_f32 v156, v160, v156
v_mul_f32 v157, v160, v157
v_mfma_f32_16x16x32_bf16 v[128:131], v[76:79], a[164:167], v[128:131]
v_mul_f32 v158, v160, v158
v_mul_f32 v159, v160, v159
v_cvt_pk_bf16_f32 v248, v152, v153
v_mfma_f32_16x16x32_bf16 v[132:135], v[80:83], a[164:167], v[132:135]
s_waitcnt vmcnt(28)
v_cvt_pk_bf16_f32 v249, v154, v155
v_cvt_pk_bf16_f32 v250, v156, v157
v_cvt_pk_bf16_f32 v251, v158, v159
v_mfma_f32_16x16x32_bf16 v[148:151], v[72:75], a[168:171], 0
buffer_store_dwordx4 v[208:211], v1, s[8:11], s65 offen sc1
s_add_u32 s65, s65, 16384
buffer_store_dwordx4 v[212:215], v1, s[8:11], s65 offen sc1
s_add_u32 s65, s65, 16384
v_add_f32 v172, 0x358637bd, v172
v_mfma_f32_16x16x32_bf16 v[140:143], v[64:67], a[168:171], 0
v_rcp_f32 v172, v172
v_mfma_f32_16x16x32_bf16 v[144:147], v[68:71], a[168:171], 0
v_mul_f32 v164, v172, v164
v_mul_f32 v165, v172, v165
v_mul_f32 v166, v172, v166
v_mfma_f32_16x16x32_bf16 v[148:151], v[84:87], a[172:175], v[148:151]
v_mul_f32 v167, v172, v167
v_mul_f32 v168, v172, v168
v_mul_f32 v169, v172, v169
v_mfma_f32_16x16x32_bf16 v[140:143], v[76:79], a[172:175], v[140:143]
v_mul_f32 v170, v172, v170
v_mul_f32 v171, v172, v171
v_cvt_pk_bf16_f32 v252, v164, v165
v_mfma_f32_16x16x32_bf16 v[144:147], v[80:83], a[172:175], v[144:147]
s_waitcnt vmcnt(28)
v_cvt_pk_bf16_f32 v253, v166, v167
v_cvt_pk_bf16_f32 v254, v168, v169
v_cvt_pk_bf16_f32 v255, v170, v171
v_mfma_f32_16x16x32_bf16 v[160:163], v[72:75], a[176:179], 0
buffer_store_dwordx4 v[216:219], v1, s[8:11], s65 offen sc1
s_add_u32 s65, s65, 16384
buffer_store_dwordx4 v[220:223], v1, s[8:11], s65 offen sc1
s_add_u32 s65, s65, 16384
v_add_f32 v136, 0x358637bd, v136
v_mfma_f32_16x16x32_bf16 v[152:155], v[64:67], a[176:179], 0
v_rcp_f32 v136, v136
v_mfma_f32_16x16x32_bf16 v[156:159], v[68:71], a[176:179], 0
v_mul_f32 v128, v136, v128
v_mul_f32 v129, v136, v129
v_mul_f32 v130, v136, v130
v_mfma_f32_16x16x32_bf16 v[160:163], v[84:87], a[180:183], v[160:163]
v_mul_f32 v131, v136, v131
v_mul_f32 v132, v136, v132
v_mul_f32 v133, v136, v133
v_mfma_f32_16x16x32_bf16 v[152:155], v[76:79], a[180:183], v[152:155]
v_mul_f32 v134, v136, v134
v_mul_f32 v135, v136, v135
v_cvt_pk_bf16_f32 v176, v128, v129
v_mfma_f32_16x16x32_bf16 v[156:159], v[80:83], a[180:183], v[156:159]
s_waitcnt vmcnt(28)
v_cvt_pk_bf16_f32 v177, v130, v131
v_cvt_pk_bf16_f32 v178, v132, v133
v_cvt_pk_bf16_f32 v179, v134, v135
v_mfma_f32_16x16x32_bf16 v[172:175], v[72:75], a[184:187], 0
buffer_store_dwordx4 v[224:227], v1, s[8:11], s65 offen sc1
s_add_u32 s65, s65, 16384
buffer_store_dwordx4 v[228:231], v1, s[8:11], s65 offen sc1
s_add_u32 s65, s65, 16384
v_add_f32 v148, 0x358637bd, v148
v_mfma_f32_16x16x32_bf16 v[164:167], v[64:67], a[184:187], 0
v_rcp_f32 v148, v148
v_mfma_f32_16x16x32_bf16 v[168:171], v[68:71], a[184:187], 0
v_mul_f32 v140, v148, v140
v_mul_f32 v141, v148, v141
v_mul_f32 v142, v148, v142
v_mfma_f32_16x16x32_bf16 v[172:175], v[84:87], a[188:191], v[172:175]
v_mul_f32 v143, v148, v143
v_mul_f32 v144, v148, v144
v_mul_f32 v145, v148, v145
v_mfma_f32_16x16x32_bf16 v[164:167], v[76:79], a[188:191], v[164:167]
v_mul_f32 v146, v148, v146
v_mul_f32 v147, v148, v147
v_cvt_pk_bf16_f32 v180, v140, v141
v_mfma_f32_16x16x32_bf16 v[168:171], v[80:83], a[188:191], v[168:171]
s_waitcnt vmcnt(28)
v_cvt_pk_bf16_f32 v181, v142, v143
v_cvt_pk_bf16_f32 v182, v144, v145
v_cvt_pk_bf16_f32 v183, v146, v147
v_mfma_f32_16x16x32_bf16 v[136:139], v[72:75], a[192:195], 0
buffer_store_dwordx4 v[232:235], v1, s[8:11], s65 offen sc1
s_add_u32 s65, s65, 16384
buffer_store_dwordx4 v[236:239], v1, s[8:11], s65 offen sc1
s_add_u32 s65, s65, 16384
v_add_f32 v160, 0x358637bd, v160
v_mfma_f32_16x16x32_bf16 v[128:131], v[64:67], a[192:195], 0
v_rcp_f32 v160, v160
v_mfma_f32_16x16x32_bf16 v[132:135], v[68:71], a[192:195], 0
v_mul_f32 v152, v160, v152
v_mul_f32 v153, v160, v153
v_mul_f32 v154, v160, v154
v_mfma_f32_16x16x32_bf16 v[136:139], v[84:87], a[196:199], v[136:139]
v_mul_f32 v155, v160, v155
v_mul_f32 v156, v160, v156
v_mul_f32 v157, v160, v157
v_mfma_f32_16x16x32_bf16 v[128:131], v[76:79], a[196:199], v[128:131]
v_mul_f32 v158, v160, v158
v_mul_f32 v159, v160, v159
v_cvt_pk_bf16_f32 v184, v152, v153
v_mfma_f32_16x16x32_bf16 v[132:135], v[80:83], a[196:199], v[132:135]
s_waitcnt vmcnt(28)
v_cvt_pk_bf16_f32 v185, v154, v155
v_cvt_pk_bf16_f32 v186, v156, v157
v_cvt_pk_bf16_f32 v187, v158, v159
v_mfma_f32_16x16x32_bf16 v[148:151], v[72:75], a[200:203], 0
buffer_store_dwordx4 v[240:243], v1, s[8:11], s65 offen sc1
s_add_u32 s65, s65, 16384
buffer_store_dwordx4 v[244:247], v1, s[8:11], s65 offen sc1
s_add_u32 s65, s65, 16384
v_add_f32 v172, 0x358637bd, v172
v_mfma_f32_16x16x32_bf16 v[140:143], v[64:67], a[200:203], 0
v_rcp_f32 v172, v172
v_mfma_f32_16x16x32_bf16 v[144:147], v[68:71], a[200:203], 0
v_mul_f32 v164, v172, v164
v_mul_f32 v165, v172, v165
v_mul_f32 v166, v172, v166
v_mfma_f32_16x16x32_bf16 v[148:151], v[84:87], a[204:207], v[148:151]
v_mul_f32 v167, v172, v167
v_mul_f32 v168, v172, v168
v_mul_f32 v169, v172, v169
v_mfma_f32_16x16x32_bf16 v[140:143], v[76:79], a[204:207], v[140:143]
v_mul_f32 v170, v172, v170
v_mul_f32 v171, v172, v171
v_cvt_pk_bf16_f32 v188, v164, v165
v_mfma_f32_16x16x32_bf16 v[144:147], v[80:83], a[204:207], v[144:147]
s_waitcnt vmcnt(28)
v_cvt_pk_bf16_f32 v189, v166, v167
v_cvt_pk_bf16_f32 v190, v168, v169
v_cvt_pk_bf16_f32 v191, v170, v171
v_mfma_f32_16x16x32_bf16 v[160:163], v[72:75], a[208:211], 0
buffer_store_dwordx4 v[248:251], v1, s[8:11], s65 offen sc1
s_add_u32 s65, s65, 16384
buffer_store_dwordx4 v[252:255], v1, s[8:11], s65 offen sc1
s_add_u32 s65, s65, 16384
v_add_f32 v136, 0x358637bd, v136
v_mfma_f32_16x16x32_bf16 v[152:155], v[64:67], a[208:211], 0
v_rcp_f32 v136, v136
v_mfma_f32_16x16x32_bf16 v[156:159], v[68:71], a[208:211], 0
v_mul_f32 v128, v136, v128
v_mul_f32 v129, v136, v129
v_mul_f32 v130, v136, v130
v_mfma_f32_16x16x32_bf16 v[160:163], v[84:87], a[212:215], v[160:163]
v_mul_f32 v131, v136, v131
v_mul_f32 v132, v136, v132
v_mul_f32 v133, v136, v133
v_mfma_f32_16x16x32_bf16 v[152:155], v[76:79], a[212:215], v[152:155]
v_mul_f32 v134, v136, v134
v_mul_f32 v135, v136, v135
v_cvt_pk_bf16_f32 v192, v128, v129
v_mfma_f32_16x16x32_bf16 v[156:159], v[80:83], a[212:215], v[156:159]
s_waitcnt vmcnt(28)
v_cvt_pk_bf16_f32 v193, v130, v131
v_cvt_pk_bf16_f32 v194, v132, v133
v_cvt_pk_bf16_f32 v195, v134, v135
v_mfma_f32_16x16x32_bf16 v[172:175], v[72:75], a[216:219], 0
buffer_store_dwordx4 v[176:179], v1, s[8:11], s65 offen sc1
s_add_u32 s65, s65, 16384
buffer_store_dwordx4 v[180:183], v1, s[8:11], s65 offen sc1
s_add_u32 s65, s65, 16384
v_add_f32 v148, 0x358637bd, v148
v_mfma_f32_16x16x32_bf16 v[164:167], v[64:67], a[216:219], 0
v_rcp_f32 v148, v148
v_mfma_f32_16x16x32_bf16 v[168:171], v[68:71], a[216:219], 0
v_mul_f32 v140, v148, v140
v_mul_f32 v141, v148, v141
v_mul_f32 v142, v148, v142
v_mfma_f32_16x16x32_bf16 v[172:175], v[84:87], a[220:223], v[172:175]
v_mul_f32 v143, v148, v143
v_mul_f32 v144, v148, v144
v_mul_f32 v145, v148, v145
v_mfma_f32_16x16x32_bf16 v[164:167], v[76:79], a[220:223], v[164:167]
v_mul_f32 v146, v148, v146
v_mul_f32 v147, v148, v147
v_cvt_pk_bf16_f32 v196, v140, v141
v_mfma_f32_16x16x32_bf16 v[168:171], v[80:83], a[220:223], v[168:171]
s_waitcnt vmcnt(28)
v_cvt_pk_bf16_f32 v197, v142, v143
v_cvt_pk_bf16_f32 v198, v144, v145
v_cvt_pk_bf16_f32 v199, v146, v147
v_mfma_f32_16x16x32_bf16 v[136:139], v[72:75], a[224:227], 0
buffer_store_dwordx4 v[184:187], v1, s[8:11], s65 offen sc1
s_add_u32 s65, s65, 16384
buffer_store_dwordx4 v[188:191], v1, s[8:11], s65 offen sc1
s_add_u32 s65, s65, 16384
v_add_f32 v160, 0x358637bd, v160
v_mfma_f32_16x16x32_bf16 v[128:131], v[64:67], a[224:227], 0
v_rcp_f32 v160, v160
v_mfma_f32_16x16x32_bf16 v[132:135], v[68:71], a[224:227], 0
v_mul_f32 v152, v160, v152
v_mul_f32 v153, v160, v153
v_mul_f32 v154, v160, v154
v_mfma_f32_16x16x32_bf16 v[136:139], v[84:87], a[228:231], v[136:139]
v_mul_f32 v155, v160, v155
v_mul_f32 v156, v160, v156
v_mul_f32 v157, v160, v157
v_mfma_f32_16x16x32_bf16 v[128:131], v[76:79], a[228:231], v[128:131]
v_mul_f32 v158, v160, v158
v_mul_f32 v159, v160, v159
v_cvt_pk_bf16_f32 v200, v152, v153
v_mfma_f32_16x16x32_bf16 v[132:135], v[80:83], a[228:231], v[132:135]
s_waitcnt vmcnt(28)
v_cvt_pk_bf16_f32 v201, v154, v155
v_cvt_pk_bf16_f32 v202, v156, v157
v_cvt_pk_bf16_f32 v203, v158, v159
v_mfma_f32_16x16x32_bf16 v[148:151], v[72:75], a[232:235], 0
buffer_store_dwordx4 v[192:195], v1, s[8:11], s65 offen sc1
s_add_u32 s65, s65, 16384
buffer_store_dwordx4 v[196:199], v1, s[8:11], s65 offen sc1
s_add_u32 s65, s65, 16384
v_add_f32 v172, 0x358637bd, v172
v_mfma_f32_16x16x32_bf16 v[140:143], v[64:67], a[232:235], 0
v_rcp_f32 v172, v172
v_mfma_f32_16x16x32_bf16 v[144:147], v[68:71], a[232:235], 0
v_mul_f32 v164, v172, v164
v_mul_f32 v165, v172, v165
v_mul_f32 v166, v172, v166
v_mfma_f32_16x16x32_bf16 v[148:151], v[84:87], a[236:239], v[148:151]
v_mul_f32 v167, v172, v167
v_mul_f32 v168, v172, v168
v_mul_f32 v169, v172, v169
v_mfma_f32_16x16x32_bf16 v[140:143], v[76:79], a[236:239], v[140:143]
v_mul_f32 v170, v172, v170
v_mul_f32 v171, v172, v171
v_cvt_pk_bf16_f32 v204, v164, v165
v_mfma_f32_16x16x32_bf16 v[144:147], v[80:83], a[236:239], v[144:147]
s_waitcnt vmcnt(28)
v_cvt_pk_bf16_f32 v205, v166, v167
v_cvt_pk_bf16_f32 v206, v168, v169
v_cvt_pk_bf16_f32 v207, v170, v171
v_mfma_f32_16x16x32_bf16 v[160:163], v[72:75], a[240:243], 0
buffer_store_dwordx4 v[200:203], v1, s[8:11], s65 offen sc1
s_add_u32 s65, s65, 16384
buffer_store_dwordx4 v[204:207], v1, s[8:11], s65 offen sc1
s_add_u32 s65, s65, 16384
v_add_f32 v136, 0x358637bd, v136
v_mfma_f32_16x16x32_bf16 v[152:155], v[64:67], a[240:243], 0
v_rcp_f32 v136, v136
v_mfma_f32_16x16x32_bf16 v[156:159], v[68:71], a[240:243], 0
v_mul_f32 v128, v136, v128
v_mul_f32 v129, v136, v129
v_mul_f32 v130, v136, v130
v_mfma_f32_16x16x32_bf16 v[160:163], v[84:87], a[244:247], v[160:163]
v_mul_f32 v131, v136, v131
v_mul_f32 v132, v136, v132
v_mul_f32 v133, v136, v133
v_mfma_f32_16x16x32_bf16 v[152:155], v[76:79], a[244:247], v[152:155]
v_mul_f32 v134, v136, v134
v_mul_f32 v135, v136, v135
v_cvt_pk_bf16_f32 v208, v128, v129
v_mfma_f32_16x16x32_bf16 v[156:159], v[80:83], a[244:247], v[156:159]
s_waitcnt vmcnt(28)
v_cvt_pk_bf16_f32 v209, v130, v131
v_cvt_pk_bf16_f32 v210, v132, v133
v_cvt_pk_bf16_f32 v211, v134, v135
v_mfma_f32_16x16x32_bf16 v[172:175], v[72:75], a[248:251], 0
buffer_store_dwordx4 v[208:211], v1, s[8:11], s65 offen sc1
s_add_u32 s65, s65, 16384
v_add_f32 v148, 0x358637bd, v148
v_mfma_f32_16x16x32_bf16 v[164:167], v[64:67], a[248:251], 0
v_rcp_f32 v148, v148
v_mfma_f32_16x16x32_bf16 v[168:171], v[68:71], a[248:251], 0
v_mul_f32 v140, v148, v140
v_mul_f32 v141, v148, v141
v_mul_f32 v142, v148, v142
v_mfma_f32_16x16x32_bf16 v[172:175], v[84:87], a[252:255], v[172:175]
v_mul_f32 v143, v148, v143
v_mul_f32 v144, v148, v144
v_mul_f32 v145, v148, v145
v_mfma_f32_16x16x32_bf16 v[164:167], v[76:79], a[252:255], v[164:167]
v_mul_f32 v146, v148, v146
v_mul_f32 v147, v148, v147
v_cvt_pk_bf16_f32 v212, v140, v141
v_mfma_f32_16x16x32_bf16 v[168:171], v[80:83], a[252:255], v[168:171]
v_cvt_pk_bf16_f32 v213, v142, v143
v_cvt_pk_bf16_f32 v214, v144, v145
v_cvt_pk_bf16_f32 v215, v146, v147
s_nop 0
v_add_f32 v160, 0x358637bd, v160
v_rcp_f32 v160, v160
s_nop 0
v_mul_f32 v152, v160, v152
v_mul_f32 v153, v160, v153
v_mul_f32 v154, v160, v154
v_mul_f32 v155, v160, v155
v_mul_f32 v156, v160, v156
v_mul_f32 v157, v160, v157
v_mul_f32 v158, v160, v158
v_mul_f32 v159, v160, v159
v_cvt_pk_bf16_f32 v216, v152, v153
v_cvt_pk_bf16_f32 v217, v154, v155
v_cvt_pk_bf16_f32 v218, v156, v157
v_cvt_pk_bf16_f32 v219, v158, v159
s_nop 0
v_add_f32 v172, 0x358637bd, v172
v_rcp_f32 v172, v172
s_nop 0
v_mul_f32 v164, v172, v164
v_mul_f32 v165, v172, v165
v_mul_f32 v166, v172, v166
v_mul_f32 v167, v172, v167
v_mul_f32 v168, v172, v168
v_mul_f32 v169, v172, v169
v_mul_f32 v170, v172, v170
v_mul_f32 v171, v172, v171
.p2align 3
v_cvt_pk_bf16_f32 v220, v164, v165
v_cvt_pk_bf16_f32 v221, v166, v167
v_cvt_pk_bf16_f32 v222, v168, v169
v_cvt_pk_bf16_f32 v223, v170, v171
buffer_store_dwordx4 v[212:215], v1, s[8:11], s65 offen sc1
s_add_u32 s65, s65, 16384
buffer_store_dwordx4 v[216:219], v1, s[8:11], s65 offen sc1
s_add_u32 s65, s65, 16384
buffer_store_dwordx4 v[220:223], v1, s[8:11], s65 offen sc1
s_add_u32 s65, s65, 16384
s_mov_b32 m0, s94
s_nop 0
buffer_load_dwordx4 v3, s[8:11], s93 offen offset:0 sc1 lds
buffer_load_dwordx4 v3, s[8:11], s93 offen offset:1024 sc1 lds
buffer_load_dwordx4 v3, s[8:11], s93 offen offset:2048 sc1 lds
buffer_load_dwordx4 v3, s[8:11], s93 offen offset:3072 sc1 lds
s_add_u32 m0, s94, 4096
s_nop 0
.p2align 3
buffer_load_dwordx4 v4, s[8:11], s93 offen offset:0 sc1 lds
buffer_load_dwordx4 v4, s[8:11], s93 offen offset:1024 sc1 lds
buffer_load_dwordx4 v4, s[8:11], s93 offen offset:2048 sc1 lds
buffer_load_dwordx4 v4, s[8:11], s93 offen offset:3072 sc1 lds
s_add_u32 s93, s93, 32768
s_add_u32 s94, s94, 32768
s_and_b32 s94, s94, 0x1ffff
s_lshl_b32 s63, s61, 4
s_lshl_b32 s64, s60, 2
s_add_u32 s63, s63, s64
s_add_u32 s79, s63, 8192
s_branch PRO
REDO:
s_mov_b32 s97, 1
s_lshl_b32 s96, s89, 1
s_add_u32 s96, s96, s88
v_mov_b32 v46, v1
v_mov_b32 v20, 0xec800000
v_mov_b32 v21, 0xec800000
REDO_L:
s_sub_u32 s96, s96, 1
s_waitcnt vmcnt(0) lgkmcnt(0)
s_barrier
s_lshl_b32 s93, s96, 15
s_add_u32 s93, s93, s95
s_add_u32 s94, s69, 32768
s_sub_u32 s65, s94, s67
s_add_u32 m0, s65, 16384
s_add_u32 s65, s93, s67
.p2align 3
buffer_load_dwordx4 v1, s[8:11], s65 offen offset:0 sc1 lds
buffer_load_dwordx4 v1, s[8:11], s65 offen offset:1024 sc1 lds
buffer_load_dwordx4 v1, s[8:11], s65 offen offset:2048 sc1 lds
buffer_load_dwordx4 v1, s[8:11], s65 offen offset:3072 sc1 lds
s_add_u32 s93, s93, 16384
s_add_u32 s94, s94, 32768
s_and_b32 s94, s94, 0x1ffff
s_cmp_eq_u32 s96, s88
s_cbranch_scc1 REDO_X
s_lshl_b32 s63, s91, 7
s_lshl_b32 s64, s96, 5
s_sub_i32 s63, s63, s64
v_add_u32 v22, s63, v17
v_cvt_f32_i32 v22, v22
v_add_f32 v22, 0.5, v22
v_mul_f32 v16, 0x71800000, v22
v_add_f32 v96, 0x00000000, v16
v_min_f32 v96, 0, v96
v_add_f32 v97, 0xf1800000, v16
v_min_f32 v97, 0, v97
v_add_f32 v98, 0xf2000000, v16
v_min_f32 v98, 0, v98
v_add_f32 v99, 0xf2400000, v16
v_min_f32 v99, 0, v99
v_add_f32 v104, 0x74800000, v16
v_min_f32 v104, 0, v104
v_add_f32 v105, 0x747c0000, v16
v_min_f32 v105, 0, v105
v_add_f32 v106, 0x74780000, v16
v_min_f32 v106, 0, v106
v_add_f32 v107, 0x74740000, v16
v_min_f32 v107, 0, v107
v_add_f32 v100, 0xf3800000, v16
v_min_f32 v100, 0, v100
v_add_f32 v101, 0xf3880000, v16
v_min_f32 v101, 0, v101
v_add_f32 v102, 0xf3900000, v16
v_min_f32 v102, 0, v102
v_add_f32 v103, 0xf3980000, v16
v_min_f32 v103, 0, v103
v_add_f32 v108, 0x74400000, v16
v_min_f32 v108, 0, v108
v_add_f32 v109, 0x743c0000, v16
v_min_f32 v109, 0, v109
v_add_f32 v110, 0x74380000, v16
v_min_f32 v110, 0, v110
v_add_f32 v111, 0x74340000, v16
v_min_f32 v111, 0, v111
s_waitcnt vmcnt(0)
s_barrier
.p2align 3
ds_read_b128 a[0:3], v46 offset:49152
ds_read_b128 a[4:7], v46 offset:50176
ds_read_b128 a[8:11], v46 offset:51200
ds_read_b128 a[12:15], v46 offset:52224
ds_read_b128 a[16:19], v46 offset:53248
ds_read_b128 a[20:23], v46 offset:54272
ds_read_b128 a[24:27], v46 offset:55296
ds_read_b128 a[28:31], v46 offset:56320
ds_read_b128 a[32:35], v46 offset:57344
ds_read_b128 a[36:39], v46 offset:58368
ds_read_b128 a[40:43], v46 offset:59392
ds_read_b128 a[44:47], v46 offset:60416
ds_read_b128 a[48:51], v46 offset:61440
ds_read_b128 a[52:55], v46 offset:62464
ds_read_b128 a[56:59], v46 offset:63488
ds_read_b128 a[60:63], v46 offset:64512
s_waitcnt lgkmcnt(0)
v_mfma_f32_16x16x32_bf16 v[64:67], a[0:3], a[64:67], v[96:99]
v_mfma_f32_16x16x32_bf16 v[64:67], a[4:7], a[68:71], v[64:67]
v_mfma_f32_16x16x32_bf16 v[72:75], a[4:7], a[100:103], v[104:107]
v_mfma_f32_16x16x32_bf16 v[72:75], a[0:3], a[96:99], v[72:75]
v_mfma_f32_16x16x32_bf16 v[72:75], a[8:11], a[104:107], v[72:75]
v_mfma_f32_16x16x32_bf16 v[72:75], a[12:15], a[108:111], v[72:75]
v_mfma_f32_16x16x32_bf16 v[64:67], a[12:15], a[76:79], v[64:67]
v_mfma_f32_16x16x32_bf16 v[64:67], a[8:11], a[72:75], v[64:67]
v_mfma_f32_16x16x32_bf16 v[64:67], a[16:19], a[80:83], v[64:67]
v_mfma_f32_16x16x32_bf16 v[64:67], a[20:23], a[84:87], v[64:67]
v_mfma_f32_16x16x32_bf16 v[72:75], a[20:23], a[116:119], v[72:75]
v_mfma_f32_16x16x32_bf16 v[72:75], a[16:19], a[112:115], v[72:75]
v_mfma_f32_16x16x32_bf16 v[72:75], a[24:27], a[120:123], v[72:75]
v_mfma_f32_16x16x32_bf16 v[72:75], a[28:31], a[124:127], v[72:75]
v_mfma_f32_16x16x32_bf16 v[64:67], a[28:31], a[92:95], v[64:67]
v_mfma_f32_16x16x32_bf16 v[64:67], a[24:27], a[88:91], v[64:67]
v_mfma_f32_16x16x32_bf16 v[68:71], a[32:35], a[64:67], v[100:103]
v_mfma_f32_16x16x32_bf16 v[68:71], a[36:39], a[68:71], v[68:71]
v_mfma_f32_16x16x32_bf16 v[76:79], a[36:39], a[100:103], v[108:111]
v_mfma_f32_16x16x32_bf16 v[76:79], a[32:35], a[96:99], v[76:79]
v_mfma_f32_16x16x32_bf16 v[76:79], a[40:43], a[104:107], v[76:79]
v_mfma_f32_16x16x32_bf16 v[76:79], a[44:47], a[108:111], v[76:79]
v_mfma_f32_16x16x32_bf16 v[68:71], a[44:47], a[76:79], v[68:71]
v_mfma_f32_16x16x32_bf16 v[68:71], a[40:43], a[72:75], v[68:71]
v_mfma_f32_16x16x32_bf16 v[68:71], a[48:51], a[80:83], v[68:71]
v_mfma_f32_16x16x32_bf16 v[68:71], a[52:55], a[84:87], v[68:71]
v_mfma_f32_16x16x32_bf16 v[76:79], a[52:55], a[116:119], v[76:79]
v_mfma_f32_16x16x32_bf16 v[76:79], a[48:51], a[112:115], v[76:79]
v_mfma_f32_16x16x32_bf16 v[76:79], a[56:59], a[120:123], v[76:79]
v_mfma_f32_16x16x32_bf16 v[76:79], a[60:63], a[124:127], v[76:79]
v_mfma_f32_16x16x32_bf16 v[68:71], a[60:63], a[92:95], v[68:71]
v_mfma_f32_16x16x32_bf16 v[68:71], a[56:59], a[88:91], v[68:71]
s_nop 7
.p2align 3
v_max3_f32 v20, v64, v65, v20
v_max3_f32 v20, v66, v67, v20
v_max3_f32 v20, v68, v69, v20
v_max3_f32 v20, v70, v71, v20
v_max3_f32 v21, v72, v73, v21
v_max3_f32 v21, v74, v75, v21
v_max3_f32 v21, v76, v77, v21
v_max3_f32 v21, v78, v79, v21
s_branch REDO_L
REDO_X:
s_mov_b32 m0, s94
s_nop 0
buffer_load_dwordx4 v3, s[8:11], s93 offen offset:0 sc1 lds
buffer_load_dwordx4 v3, s[8:11], s93 offen offset:1024 sc1 lds
buffer_load_dwordx4 v3, s[8:11], s93 offen offset:2048 sc1 lds
buffer_load_dwordx4 v3, s[8:11], s93 offen offset:3072 sc1 lds
s_add_u32 m0, s94, 4096
s_nop 0
.p2align 3
buffer_load_dwordx4 v4, s[8:11], s93 offen offset:0 sc1 lds
buffer_load_dwordx4 v4, s[8:11], s93 offen offset:1024 sc1 lds
buffer_load_dwordx4 v4, s[8:11], s93 offen offset:2048 sc1 lds
buffer_load_dwordx4 v4, s[8:11], s93 offen offset:3072 sc1 lds
s_add_u32 s93, s93, 32768
s_add_u32 s94, s94, 32768
s_and_b32 s94, s94, 0x1ffff
s_mov_b32 m0, s94
s_nop 0
buffer_load_dwordx4 v3, s[8:11], s93 offen offset:0 sc1 lds
buffer_load_dwordx4 v3, s[8:11], s93 offen offset:1024 sc1 lds
buffer_load_dwordx4 v3, s[8:11], s93 offen offset:2048 sc1 lds
buffer_load_dwordx4 v3, s[8:11], s93 offen offset:3072 sc1 lds
s_add_u32 m0, s94, 4096
s_nop 0
.p2align 3
buffer_load_dwordx4 v4, s[8:11], s93 offen offset:0 sc1 lds
buffer_load_dwordx4 v4, s[8:11], s93 offen offset:1024 sc1 lds
buffer_load_dwordx4 v4, s[8:11], s93 offen offset:2048 sc1 lds
buffer_load_dwordx4 v4, s[8:11], s93 offen offset:3072 sc1 lds
s_add_u32 s93, s93, 32768
s_add_u32 s94, s94, 32768
s_and_b32 s94, s94, 0x1ffff
s_mov_b32 m0, s94
s_nop 0
buffer_load_dwordx4 v3, s[8:11], s93 offen offset:0 sc1 lds
buffer_load_dwordx4 v3, s[8:11], s93 offen offset:1024 sc1 lds
buffer_load_dwordx4 v3, s[8:11], s93 offen offset:2048 sc1 lds
buffer_load_dwordx4 v3, s[8:11], s93 offen offset:3072 sc1 lds
s_add_u32 m0, s94, 4096
s_nop 0
.p2align 3
buffer_load_dwordx4 v4, s[8:11], s93 offen offset:0 sc1 lds
buffer_load_dwordx4 v4, s[8:11], s93 offen offset:1024 sc1 lds
buffer_load_dwordx4 v4, s[8:11], s93 offen offset:2048 sc1 lds
buffer_load_dwordx4 v4, s[8:11], s93 offen offset:3072 sc1 lds
s_add_u32 s93, s93, 32768
s_add_u32 s94, s94, 32768
s_and_b32 s94, s94, 0x1ffff
s_waitcnt vmcnt(16)
s_barrier
.p2align 3
ds_read_b128 a[0:3], v46 offset:49152
ds_read_b128 a[4:7], v46 offset:50176
ds_read_b128 a[8:11], v46 offset:51200
ds_read_b128 a[12:15], v46 offset:52224
ds_read_b128 a[16:19], v46 offset:53248
ds_read_b128 a[20:23], v46 offset:54272
ds_read_b128 a[24:27], v46 offset:55296
s_branch PRO
SLOWMERGE:
s_mov_b32 m0, s94
s_nop 0
buffer_load_dwordx4 v38, s[16:19], s101 offen offset:0 sc1 lds
buffer_load_dwordx4 v39, s[16:19], s101 offen offset:1024 sc1 lds
buffer_load_dwordx4 v40, s[16:19], s101 offen offset:2048 sc1 lds
buffer_load_dwordx4 v41, s[16:19], s101 offen offset:3072 sc1 lds
s_add_u32 m0, s94, 4096
s_nop 0
buffer_load_dwordx4 v38, s[16:19], s70 offen offset:0 sc1 lds
buffer_load_dwordx4 v39, s[16:19], s70 offen offset:1024 sc1 lds
buffer_load_dwordx4 v40, s[16:19], s70 offen offset:2048 sc1 lds
buffer_load_dwordx4 v41, s[16:19], s70 offen offset:3072 sc1 lds
s_add_u32 s101, s101, s71
s_add_u32 s70, s70, s71
s_add_u32 s94, s94, 32768
s_and_b32 s94, s94, 0x1ffff
s_waitcnt vmcnt(16) lgkmcnt(0)
s_barrier
.p2align 3
ds_read_b128 v[34:37], v24
ds_read_b64_tr_b16 a[0:1], v12 offset:0
ds_read_b64_tr_b16 a[2:3], v12 offset:2048
ds_read_b64_tr_b16 a[4:5], v12 offset:4096
ds_read_b64_tr_b16 a[6:7], v12 offset:6144
ds_read_b64_tr_b16 a[8:9], v12 offset:16384
ds_read_b64_tr_b16 a[10:11], v12 offset:18432
ds_read_b64_tr_b16 a[12:13], v12 offset:20480
ds_read_b64_tr_b16 a[14:15], v12 offset:22528
ds_read_b64_tr_b16 a[16:17], v12 offset:8192
ds_read_b64_tr_b16 a[18:19], v12 offset:10240
ds_read_b64_tr_b16 a[20:21], v12 offset:12288
ds_read_b64_tr_b16 a[22:23], v12 offset:14336
ds_read_b64_tr_b16 a[24:25], v12 offset:24576
ds_read_b64_tr_b16 a[26:27], v12 offset:26624
v_log_f32 v22, v18
v_log_f32 v23, v30
s_nop 0
v_sub_f32 v22, v22, v48
v_sub_f32 v23, v23, v32
v_sub_f32 v22, v22, v23
v_exp_f32 v23, v22
v_exp_f32 v22, -v22
v_max_f32 v25, 0x03800000, v30
v_add_f32 v23, 1.0, v23
v_add_f32 v22, 1.0, v22
v_rcp_f32 v23, v23
v_rcp_f32 v22, v22
v_rcp_f32 v25, v25
v_rcp_f32 v48, v18
s_nop 0
v_mul_f32 v48, v22, v48
v_mul_f32 v49, v23, v25
v_accvgpr_read_b32 v23, a128
v_pk_mul_f32 v[128:129], v[128:129], v[48:49] op_sel_hi:[1,0]
v_lshlrev_b32 v22, 16, v23
v_and_b32 v23, 0xffff0000, v23
v_pk_fma_f32 v[128:129], v[22:23], v[48:49], v[128:129] op_sel:[0,1,0] op_sel_hi:[1,1,1]
v_cvt_pk_bf16_f32 v64, v128, v129
v_accvgpr_read_b32 v23, a129
v_pk_mul_f32 v[130:131], v[130:131], v[48:49] op_sel_hi:[1,0]
v_lshlrev_b32 v22, 16, v23
v_and_b32 v23, 0xffff0000, v23
v_pk_fma_f32 v[130:131], v[22:23], v[48:49], v[130:131] op_sel:[0,1,0] op_sel_hi:[1,1,1]
v_cvt_pk_bf16_f32 v65, v130, v131
v_accvgpr_read_b32 v23, a130
v_pk_mul_f32 v[132:133], v[132:133], v[48:49] op_sel_hi:[1,0]
v_lshlrev_b32 v22, 16, v23
v_and_b32 v23, 0xffff0000, v23
v_pk_fma_f32 v[132:133], v[22:23], v[48:49], v[132:133] op_sel:[0,1,0] op_sel_hi:[1,1,1]
v_cvt_pk_bf16_f32 v66, v132, v133
v_accvgpr_read_b32 v23, a131
v_pk_mul_f32 v[134:135], v[134:135], v[48:49] op_sel_hi:[1,0]
v_lshlrev_b32 v22, 16, v23
v_and_b32 v23, 0xffff0000, v23
v_pk_fma_f32 v[134:135], v[22:23], v[48:49], v[134:135] op_sel:[0,1,0] op_sel_hi:[1,1,1]
v_cvt_pk_bf16_f32 v67, v134, v135
v_accvgpr_read_b32 v23, a132
v_pk_mul_f32 v[136:137], v[136:137], v[48:49] op_sel_hi:[1,0]
v_lshlrev_b32 v22, 16, v23
v_and_b32 v23, 0xffff0000, v23
v_pk_fma_f32 v[136:137], v[22:23], v[48:49], v[136:137] op_sel:[0,1,0] op_sel_hi:[1,1,1]
v_cvt_pk_bf16_f32 v68, v136, v137
v_accvgpr_read_b32 v23, a133
v_pk_mul_f32 v[138:139], v[138:139], v[48:49] op_sel_hi:[1,0]
v_lshlrev_b32 v22, 16, v23
v_and_b32 v23, 0xffff0000, v23
v_pk_fma_f32 v[138:139], v[22:23], v[48:49], v[138:139] op_sel:[0,1,0] op_sel_hi:[1,1,1]
v_cvt_pk_bf16_f32 v69, v138, v139
v_accvgpr_read_b32 v23, a134
v_pk_mul_f32 v[140:141], v[140:141], v[48:49] op_sel_hi:[1,0]
v_lshlrev_b32 v22, 16, v23
v_and_b32 v23, 0xffff0000, v23
v_pk_fma_f32 v[140:141], v[22:23], v[48:49], v[140:141] op_sel:[0,1,0] op_sel_hi:[1,1,1]
v_cvt_pk_bf16_f32 v70, v140, v141
v_accvgpr_read_b32 v23, a135
v_pk_mul_f32 v[142:143], v[142:143], v[48:49] op_sel_hi:[1,0]
v_lshlrev_b32 v22, 16, v23
v_and_b32 v23, 0xffff0000, v23
v_pk_fma_f32 v[142:143], v[22:23], v[48:49], v[142:143] op_sel:[0,1,0] op_sel_hi:[1,1,1]
v_cvt_pk_bf16_f32 v71, v142, v143
v_accvgpr_read_b32 v23, a136
v_pk_mul_f32 v[144:145], v[144:145], v[48:49] op_sel_hi:[1,0]
v_lshlrev_b32 v22, 16, v23
v_and_b32 v23, 0xffff0000, v23
v_pk_fma_f32 v[144:145], v[22:23], v[48:49], v[144:145] op_sel:[0,1,0] op_sel_hi:[1,1,1]
v_cvt_pk_bf16_f32 v72, v144, v145
v_accvgpr_read_b32 v23, a137
v_pk_mul_f32 v[146:147], v[146:147], v[48:49] op_sel_hi:[1,0]
v_lshlrev_b32 v22, 16, v23
v_and_b32 v23, 0xffff0000, v23
v_pk_fma_f32 v[146:147], v[22:23], v[48:49], v[146:147] op_sel:[0,1,0] op_sel_hi:[1,1,1]
v_cvt_pk_bf16_f32 v73, v146, v147
v_accvgpr_read_b32 v23, a138
v_pk_mul_f32 v[148:149], v[148:149], v[48:49] op_sel_hi:[1,0]
v_lshlrev_b32 v22, 16, v23
v_and_b32 v23, 0xffff0000, v23
v_pk_fma_f32 v[148:149], v[22:23], v[48:49], v[148:149] op_sel:[0,1,0] op_sel_hi:[1,1,1]
v_cvt_pk_bf16_f32 v74, v148, v149
v_accvgpr_read_b32 v23, a139
v_pk_mul_f32 v[150:151], v[150:151], v[48:49] op_sel_hi:[1,0]
v_lshlrev_b32 v22, 16, v23
v_and_b32 v23, 0xffff0000, v23
v_pk_fma_f32 v[150:151], v[22:23], v[48:49], v[150:151] op_sel:[0,1,0] op_sel_hi:[1,1,1]
v_cvt_pk_bf16_f32 v75, v150, v151
v_accvgpr_read_b32 v23, a140
v_pk_mul_f32 v[152:153], v[152:153], v[48:49] op_sel_hi:[1,0]
v_lshlrev_b32 v22, 16, v23
v_and_b32 v23, 0xffff0000, v23
v_pk_fma_f32 v[152:153], v[22:23], v[48:49], v[152:153] op_sel:[0,1,0] op_sel_hi:[1,1,1]
v_cvt_pk_bf16_f32 v76, v152, v153
v_accvgpr_read_b32 v23, a141
v_pk_mul_f32 v[154:155], v[154:155], v[48:49] op_sel_hi:[1,0]
v_lshlrev_b32 v22, 16, v23
v_and_b32 v23, 0xffff0000, v23
v_pk_fma_f32 v[154:155], v[22:23], v[48:49], v[154:155] op_sel:[0,1,0] op_sel_hi:[1,1,1]
v_cvt_pk_bf16_f32 v77, v154, v155
v_accvgpr_read_b32 v23, a142
v_pk_mul_f32 v[156:157], v[156:157], v[48:49] op_sel_hi:[1,0]
v_lshlrev_b32 v22, 16, v23
v_and_b32 v23, 0xffff0000, v23
v_pk_fma_f32 v[156:157], v[22:23], v[48:49], v[156:157] op_sel:[0,1,0] op_sel_hi:[1,1,1]
v_cvt_pk_bf16_f32 v78, v156, v157
v_accvgpr_read_b32 v23, a143
v_pk_mul_f32 v[158:159], v[158:159], v[48:49] op_sel_hi:[1,0]
v_lshlrev_b32 v22, 16, v23
v_and_b32 v23, 0xffff0000, v23
v_pk_fma_f32 v[158:159], v[22:23], v[48:49], v[158:159] op_sel:[0,1,0] op_sel_hi:[1,1,1]
v_cvt_pk_bf16_f32 v79, v158, v159
v_accvgpr_read_b32 v23, a144
v_pk_mul_f32 v[160:161], v[160:161], v[48:49] op_sel_hi:[1,0]
v_lshlrev_b32 v22, 16, v23
v_and_b32 v23, 0xffff0000, v23
v_pk_fma_f32 v[160:161], v[22:23], v[48:49], v[160:161] op_sel:[0,1,0] op_sel_hi:[1,1,1]
v_cvt_pk_bf16_f32 v80, v160, v161
v_accvgpr_read_b32 v23, a145
v_pk_mul_f32 v[162:163], v[162:163], v[48:49] op_sel_hi:[1,0]
v_lshlrev_b32 v22, 16, v23
v_and_b32 v23, 0xffff0000, v23
v_pk_fma_f32 v[162:163], v[22:23], v[48:49], v[162:163] op_sel:[0,1,0] op_sel_hi:[1,1,1]
v_cvt_pk_bf16_f32 v81, v162, v163
v_accvgpr_read_b32 v23, a146
v_pk_mul_f32 v[164:165], v[164:165], v[48:49] op_sel_hi:[1,0]
v_lshlrev_b32 v22, 16, v23
v_and_b32 v23, 0xffff0000, v23
v_pk_fma_f32 v[164:165], v[22:23], v[48:49], v[164:165] op_sel:[0,1,0] op_sel_hi:[1,1,1]
v_cvt_pk_bf16_f32 v82, v164, v165
v_accvgpr_read_b32 v23, a147
v_pk_mul_f32 v[166:167], v[166:167], v[48:49] op_sel_hi:[1,0]
v_lshlrev_b32 v22, 16, v23
v_and_b32 v23, 0xffff0000, v23
v_pk_fma_f32 v[166:167], v[22:23], v[48:49], v[166:167] op_sel:[0,1,0] op_sel_hi:[1,1,1]
v_cvt_pk_bf16_f32 v83, v166, v167
v_accvgpr_read_b32 v23, a148
v_pk_mul_f32 v[168:169], v[168:169], v[48:49] op_sel_hi:[1,0]
v_lshlrev_b32 v22, 16, v23
v_and_b32 v23, 0xffff0000, v23
v_pk_fma_f32 v[168:169], v[22:23], v[48:49], v[168:169] op_sel:[0,1,0] op_sel_hi:[1,1,1]
v_cvt_pk_bf16_f32 v84, v168, v169
v_accvgpr_read_b32 v23, a149
v_pk_mul_f32 v[170:171], v[170:171], v[48:49] op_sel_hi:[1,0]
v_lshlrev_b32 v22, 16, v23
v_and_b32 v23, 0xffff0000, v23
v_pk_fma_f32 v[170:171], v[22:23], v[48:49], v[170:171] op_sel:[0,1,0] op_sel_hi:[1,1,1]
v_cvt_pk_bf16_f32 v85, v170, v171
v_accvgpr_read_b32 v23, a150
v_pk_mul_f32 v[172:173], v[172:173], v[48:49] op_sel_hi:[1,0]
v_lshlrev_b32 v22, 16, v23
v_and_b32 v23, 0xffff0000, v23
v_pk_fma_f32 v[172:173], v[22:23], v[48:49], v[172:173] op_sel:[0,1,0] op_sel_hi:[1,1,1]
v_cvt_pk_bf16_f32 v86, v172, v173
v_accvgpr_read_b32 v23, a151
v_pk_mul_f32 v[174:175], v[174:175], v[48:49] op_sel_hi:[1,0]
v_lshlrev_b32 v22, 16, v23
v_and_b32 v23, 0xffff0000, v23
v_pk_fma_f32 v[174:175], v[22:23], v[48:49], v[174:175] op_sel:[0,1,0] op_sel_hi:[1,1,1]
v_cvt_pk_bf16_f32 v87, v174, v175
v_accvgpr_read_b32 v23, a152
v_pk_mul_f32 v[176:177], v[176:177], v[48:49] op_sel_hi:[1,0]
v_lshlrev_b32 v22, 16, v23
v_and_b32 v23, 0xffff0000, v23
v_pk_fma_f32 v[176:177], v[22:23], v[48:49], v[176:177] op_sel:[0,1,0] op_sel_hi:[1,1,1]
v_cvt_pk_bf16_f32 v88, v176, v177
v_accvgpr_read_b32 v23, a153
v_pk_mul_f32 v[178:179], v[178:179], v[48:49] op_sel_hi:[1,0]
v_lshlrev_b32 v22, 16, v23
v_and_b32 v23, 0xffff0000, v23
v_pk_fma_f32 v[178:179], v[22:23], v[48:49], v[178:179] op_sel:[0,1,0] op_sel_hi:[1,1,1]
v_cvt_pk_bf16_f32 v89, v178, v179
v_accvgpr_read_b32 v23, a154
v_pk_mul_f32 v[180:181], v[180:181], v[48:49] op_sel_hi:[1,0]
v_lshlrev_b32 v22, 16, v23
v_and_b32 v23, 0xffff0000, v23
v_pk_fma_f32 v[180:181], v[22:23], v[48:49], v[180:181] op_sel:[0,1,0] op_sel_hi:[1,1,1]
v_cvt_pk_bf16_f32 v90, v180, v181
v_accvgpr_read_b32 v23, a155
v_pk_mul_f32 v[182:183], v[182:183], v[48:49] op_sel_hi:[1,0]
v_lshlrev_b32 v22, 16, v23
v_and_b32 v23, 0xffff0000, v23
v_pk_fma_f32 v[182:183], v[22:23], v[48:49], v[182:183] op_sel:[0,1,0] op_sel_hi:[1,1,1]
v_cvt_pk_bf16_f32 v91, v182, v183
v_accvgpr_read_b32 v23, a156
v_pk_mul_f32 v[184:185], v[184:185], v[48:49] op_sel_hi:[1,0]
v_lshlrev_b32 v22, 16, v23
v_and_b32 v23, 0xffff0000, v23
v_pk_fma_f32 v[184:185], v[22:23], v[48:49], v[184:185] op_sel:[0,1,0] op_sel_hi:[1,1,1]
v_cvt_pk_bf16_f32 v92, v184, v185
v_accvgpr_read_b32 v23, a157
v_pk_mul_f32 v[186:187], v[186:187], v[48:49] op_sel_hi:[1,0]
v_lshlrev_b32 v22, 16, v23
v_and_b32 v23, 0xffff0000, v23
v_pk_fma_f32 v[186:187], v[22:23], v[48:49], v[186:187] op_sel:[0,1,0] op_sel_hi:[1,1,1]
v_cvt_pk_bf16_f32 v93, v186, v187
v_accvgpr_read_b32 v23, a158
v_pk_mul_f32 v[188:189], v[188:189], v[48:49] op_sel_hi:[1,0]
v_lshlrev_b32 v22, 16, v23
v_and_b32 v23, 0xffff0000, v23
v_pk_fma_f32 v[188:189], v[22:23], v[48:49], v[188:189] op_sel:[0,1,0] op_sel_hi:[1,1,1]
v_cvt_pk_bf16_f32 v94, v188, v189
v_accvgpr_read_b32 v23, a159
v_pk_mul_f32 v[190:191], v[190:191], v[48:49] op_sel_hi:[1,0]
v_lshlrev_b32 v22, 16, v23
v_and_b32 v23, 0xffff0000, v23
v_pk_fma_f32 v[190:191], v[22:23], v[48:49], v[190:191] op_sel:[0,1,0] op_sel_hi:[1,1,1]
v_cvt_pk_bf16_f32 v95, v190, v191
v_log_f32 v22, v19
v_log_f32 v23, v31
s_nop 0
v_sub_f32 v22, v22, v52
v_sub_f32 v23, v23, v33
v_sub_f32 v22, v22, v23
v_exp_f32 v23, v22
v_exp_f32 v22, -v22
v_max_f32 v25, 0x03800000, v31
v_add_f32 v23, 1.0, v23
v_add_f32 v22, 1.0, v22
v_rcp_f32 v23, v23
v_rcp_f32 v22, v22
v_rcp_f32 v25, v25
v_rcp_f32 v52, v19
s_nop 0
v_mul_f32 v52, v22, v52
v_mul_f32 v53, v23, v25
v_accvgpr_read_b32 v23, a160
v_pk_mul_f32 v[192:193], v[192:193], v[52:53] op_sel_hi:[1,0]
v_lshlrev_b32 v22, 16, v23
v_and_b32 v23, 0xffff0000, v23
v_pk_fma_f32 v[192:193], v[22:23], v[52:53], v[192:193] op_sel:[0,1,0] op_sel_hi:[1,1,1]
v_cvt_pk_bf16_f32 v96, v192, v193
v_accvgpr_read_b32 v23, a161
v_pk_mul_f32 v[194:195], v[194:195], v[52:53] op_sel_hi:[1,0]
v_lshlrev_b32 v22, 16, v23
v_and_b32 v23, 0xffff0000, v23
v_pk_fma_f32 v[194:195], v[22:23], v[52:53], v[194:195] op_sel:[0,1,0] op_sel_hi:[1,1,1]
v_cvt_pk_bf16_f32 v97, v194, v195
v_accvgpr_read_b32 v23, a162
v_pk_mul_f32 v[196:197], v[196:197], v[52:53] op_sel_hi:[1,0]
v_lshlrev_b32 v22, 16, v23
v_and_b32 v23, 0xffff0000, v23
v_pk_fma_f32 v[196:197], v[22:23], v[52:53], v[196:197] op_sel:[0,1,0] op_sel_hi:[1,1,1]
v_cvt_pk_bf16_f32 v98, v196, v197
v_accvgpr_read_b32 v23, a163
v_pk_mul_f32 v[198:199], v[198:199], v[52:53] op_sel_hi:[1,0]
v_lshlrev_b32 v22, 16, v23
v_and_b32 v23, 0xffff0000, v23
v_pk_fma_f32 v[198:199], v[22:23], v[52:53], v[198:199] op_sel:[0,1,0] op_sel_hi:[1,1,1]
v_cvt_pk_bf16_f32 v99, v198, v199
v_accvgpr_read_b32 v23, a164
v_pk_mul_f32 v[200:201], v[200:201], v[52:53] op_sel_hi:[1,0]
v_lshlrev_b32 v22, 16, v23
v_and_b32 v23, 0xffff0000, v23
v_pk_fma_f32 v[200:201], v[22:23], v[52:53], v[200:201] op_sel:[0,1,0] op_sel_hi:[1,1,1]
v_cvt_pk_bf16_f32 v100, v200, v201
v_accvgpr_read_b32 v23, a165
v_pk_mul_f32 v[202:203], v[202:203], v[52:53] op_sel_hi:[1,0]
v_lshlrev_b32 v22, 16, v23
v_and_b32 v23, 0xffff0000, v23
v_pk_fma_f32 v[202:203], v[22:23], v[52:53], v[202:203] op_sel:[0,1,0] op_sel_hi:[1,1,1]
v_cvt_pk_bf16_f32 v101, v202, v203
v_accvgpr_read_b32 v23, a166
v_pk_mul_f32 v[204:205], v[204:205], v[52:53] op_sel_hi:[1,0]
v_lshlrev_b32 v22, 16, v23
v_and_b32 v23, 0xffff0000, v23
v_pk_fma_f32 v[204:205], v[22:23], v[52:53], v[204:205] op_sel:[0,1,0] op_sel_hi:[1,1,1]
v_cvt_pk_bf16_f32 v102, v204, v205
v_accvgpr_read_b32 v23, a167
v_pk_mul_f32 v[206:207], v[206:207], v[52:53] op_sel_hi:[1,0]
v_lshlrev_b32 v22, 16, v23
v_and_b32 v23, 0xffff0000, v23
v_pk_fma_f32 v[206:207], v[22:23], v[52:53], v[206:207] op_sel:[0,1,0] op_sel_hi:[1,1,1]
v_cvt_pk_bf16_f32 v103, v206, v207
v_accvgpr_read_b32 v23, a168
v_pk_mul_f32 v[208:209], v[208:209], v[52:53] op_sel_hi:[1,0]
v_lshlrev_b32 v22, 16, v23
v_and_b32 v23, 0xffff0000, v23
v_pk_fma_f32 v[208:209], v[22:23], v[52:53], v[208:209] op_sel:[0,1,0] op_sel_hi:[1,1,1]
v_cvt_pk_bf16_f32 v104, v208, v209
v_accvgpr_read_b32 v23, a169
v_pk_mul_f32 v[210:211], v[210:211], v[52:53] op_sel_hi:[1,0]
v_lshlrev_b32 v22, 16, v23
v_and_b32 v23, 0xffff0000, v23
v_pk_fma_f32 v[210:211], v[22:23], v[52:53], v[210:211] op_sel:[0,1,0] op_sel_hi:[1,1,1]
v_cvt_pk_bf16_f32 v105, v210, v211
v_accvgpr_read_b32 v23, a170
v_pk_mul_f32 v[212:213], v[212:213], v[52:53] op_sel_hi:[1,0]
v_lshlrev_b32 v22, 16, v23
v_and_b32 v23, 0xffff0000, v23
v_pk_fma_f32 v[212:213], v[22:23], v[52:53], v[212:213] op_sel:[0,1,0] op_sel_hi:[1,1,1]
v_cvt_pk_bf16_f32 v106, v212, v213
v_accvgpr_read_b32 v23, a171
v_pk_mul_f32 v[214:215], v[214:215], v[52:53] op_sel_hi:[1,0]
v_lshlrev_b32 v22, 16, v23
v_and_b32 v23, 0xffff0000, v23
v_pk_fma_f32 v[214:215], v[22:23], v[52:53], v[214:215] op_sel:[0,1,0] op_sel_hi:[1,1,1]
v_cvt_pk_bf16_f32 v107, v214, v215
v_accvgpr_read_b32 v23, a172
v_pk_mul_f32 v[216:217], v[216:217], v[52:53] op_sel_hi:[1,0]
v_lshlrev_b32 v22, 16, v23
v_and_b32 v23, 0xffff0000, v23
v_pk_fma_f32 v[216:217], v[22:23], v[52:53], v[216:217] op_sel:[0,1,0] op_sel_hi:[1,1,1]
v_cvt_pk_bf16_f32 v108, v216, v217
v_accvgpr_read_b32 v23, a173
v_pk_mul_f32 v[218:219], v[218:219], v[52:53] op_sel_hi:[1,0]
v_lshlrev_b32 v22, 16, v23
v_and_b32 v23, 0xffff0000, v23
v_pk_fma_f32 v[218:219], v[22:23], v[52:53], v[218:219] op_sel:[0,1,0] op_sel_hi:[1,1,1]
v_cvt_pk_bf16_f32 v109, v218, v219
v_accvgpr_read_b32 v23, a174
v_pk_mul_f32 v[220:221], v[220:221], v[52:53] op_sel_hi:[1,0]
v_lshlrev_b32 v22, 16, v23
v_and_b32 v23, 0xffff0000, v23
v_pk_fma_f32 v[220:221], v[22:23], v[52:53], v[220:221] op_sel:[0,1,0] op_sel_hi:[1,1,1]
v_cvt_pk_bf16_f32 v110, v220, v221
v_accvgpr_read_b32 v23, a175
v_pk_mul_f32 v[222:223], v[222:223], v[52:53] op_sel_hi:[1,0]
v_lshlrev_b32 v22, 16, v23
v_and_b32 v23, 0xffff0000, v23
v_pk_fma_f32 v[222:223], v[22:23], v[52:53], v[222:223] op_sel:[0,1,0] op_sel_hi:[1,1,1]
v_cvt_pk_bf16_f32 v111, v222, v223
v_accvgpr_read_b32 v23, a176
v_pk_mul_f32 v[224:225], v[224:225], v[52:53] op_sel_hi:[1,0]
v_lshlrev_b32 v22, 16, v23
v_and_b32 v23, 0xffff0000, v23
v_pk_fma_f32 v[224:225], v[22:23], v[52:53], v[224:225] op_sel:[0,1,0] op_sel_hi:[1,1,1]
v_cvt_pk_bf16_f32 v112, v224, v225
v_accvgpr_read_b32 v23, a177
v_pk_mul_f32 v[226:227], v[226:227], v[52:53] op_sel_hi:[1,0]
v_lshlrev_b32 v22, 16, v23
v_and_b32 v23, 0xffff0000, v23
v_pk_fma_f32 v[226:227], v[22:23], v[52:53], v[226:227] op_sel:[0,1,0] op_sel_hi:[1,1,1]
v_cvt_pk_bf16_f32 v113, v226, v227
v_accvgpr_read_b32 v23, a178
v_pk_mul_f32 v[228:229], v[228:229], v[52:53] op_sel_hi:[1,0]
v_lshlrev_b32 v22, 16, v23
v_and_b32 v23, 0xffff0000, v23
v_pk_fma_f32 v[228:229], v[22:23], v[52:53], v[228:229] op_sel:[0,1,0] op_sel_hi:[1,1,1]
v_cvt_pk_bf16_f32 v114, v228, v229
v_accvgpr_read_b32 v23, a179
v_pk_mul_f32 v[230:231], v[230:231], v[52:53] op_sel_hi:[1,0]
v_lshlrev_b32 v22, 16, v23
v_and_b32 v23, 0xffff0000, v23
v_pk_fma_f32 v[230:231], v[22:23], v[52:53], v[230:231] op_sel:[0,1,0] op_sel_hi:[1,1,1]
v_cvt_pk_bf16_f32 v115, v230, v231
v_accvgpr_read_b32 v23, a180
v_pk_mul_f32 v[232:233], v[232:233], v[52:53] op_sel_hi:[1,0]
v_lshlrev_b32 v22, 16, v23
v_and_b32 v23, 0xffff0000, v23
v_pk_fma_f32 v[232:233], v[22:23], v[52:53], v[232:233] op_sel:[0,1,0] op_sel_hi:[1,1,1]
v_cvt_pk_bf16_f32 v116, v232, v233
v_accvgpr_read_b32 v23, a181
v_pk_mul_f32 v[234:235], v[234:235], v[52:53] op_sel_hi:[1,0]
v_lshlrev_b32 v22, 16, v23
v_and_b32 v23, 0xffff0000, v23
v_pk_fma_f32 v[234:235], v[22:23], v[52:53], v[234:235] op_sel:[0,1,0] op_sel_hi:[1,1,1]
v_cvt_pk_bf16_f32 v117, v234, v235
v_accvgpr_read_b32 v23, a182
v_pk_mul_f32 v[236:237], v[236:237], v[52:53] op_sel_hi:[1,0]
v_lshlrev_b32 v22, 16, v23
v_and_b32 v23, 0xffff0000, v23
v_pk_fma_f32 v[236:237], v[22:23], v[52:53], v[236:237] op_sel:[0,1,0] op_sel_hi:[1,1,1]
v_cvt_pk_bf16_f32 v118, v236, v237
v_accvgpr_read_b32 v23, a183
v_pk_mul_f32 v[238:239], v[238:239], v[52:53] op_sel_hi:[1,0]
v_lshlrev_b32 v22, 16, v23
v_and_b32 v23, 0xffff0000, v23
v_pk_fma_f32 v[238:239], v[22:23], v[52:53], v[238:239] op_sel:[0,1,0] op_sel_hi:[1,1,1]
v_cvt_pk_bf16_f32 v119, v238, v239
v_accvgpr_read_b32 v23, a184
v_pk_mul_f32 v[240:241], v[240:241], v[52:53] op_sel_hi:[1,0]
v_lshlrev_b32 v22, 16, v23
v_and_b32 v23, 0xffff0000, v23
v_pk_fma_f32 v[240:241], v[22:23], v[52:53], v[240:241] op_sel:[0,1,0] op_sel_hi:[1,1,1]
v_cvt_pk_bf16_f32 v120, v240, v241
v_accvgpr_read_b32 v23, a185
v_pk_mul_f32 v[242:243], v[242:243], v[52:53] op_sel_hi:[1,0]
v_lshlrev_b32 v22, 16, v23
v_and_b32 v23, 0xffff0000, v23
v_pk_fma_f32 v[242:243], v[22:23], v[52:53], v[242:243] op_sel:[0,1,0] op_sel_hi:[1,1,1]
v_cvt_pk_bf16_f32 v121, v242, v243
v_accvgpr_read_b32 v23, a186
v_pk_mul_f32 v[244:245], v[244:245], v[52:53] op_sel_hi:[1,0]
v_lshlrev_b32 v22, 16, v23
v_and_b32 v23, 0xffff0000, v23
v_pk_fma_f32 v[244:245], v[22:23], v[52:53], v[244:245] op_sel:[0,1,0] op_sel_hi:[1,1,1]
v_cvt_pk_bf16_f32 v122, v244, v245
v_accvgpr_read_b32 v23, a187
v_pk_mul_f32 v[246:247], v[246:247], v[52:53] op_sel_hi:[1,0]
v_lshlrev_b32 v22, 16, v23
v_and_b32 v23, 0xffff0000, v23
v_pk_fma_f32 v[246:247], v[22:23], v[52:53], v[246:247] op_sel:[0,1,0] op_sel_hi:[1,1,1]
v_cvt_pk_bf16_f32 v123, v246, v247
v_accvgpr_read_b32 v23, a188
v_pk_mul_f32 v[248:249], v[248:249], v[52:53] op_sel_hi:[1,0]
v_lshlrev_b32 v22, 16, v23
v_and_b32 v23, 0xffff0000, v23
v_pk_fma_f32 v[248:249], v[22:23], v[52:53], v[248:249] op_sel:[0,1,0] op_sel_hi:[1,1,1]
v_cvt_pk_bf16_f32 v124, v248, v249
v_accvgpr_read_b32 v23, a189
v_pk_mul_f32 v[250:251], v[250:251], v[52:53] op_sel_hi:[1,0]
v_lshlrev_b32 v22, 16, v23
v_and_b32 v23, 0xffff0000, v23
v_pk_fma_f32 v[250:251], v[22:23], v[52:53], v[250:251] op_sel:[0,1,0] op_sel_hi:[1,1,1]
v_cvt_pk_bf16_f32 v125, v250, v251
v_accvgpr_read_b32 v23, a190
v_pk_mul_f32 v[252:253], v[252:253], v[52:53] op_sel_hi:[1,0]
v_lshlrev_b32 v22, 16, v23
v_and_b32 v23, 0xffff0000, v23
v_pk_fma_f32 v[252:253], v[22:23], v[52:53], v[252:253] op_sel:[0,1,0] op_sel_hi:[1,1,1]
v_cvt_pk_bf16_f32 v126, v252, v253
v_accvgpr_read_b32 v23, a191
v_pk_mul_f32 v[254:255], v[254:255], v[52:53] op_sel_hi:[1,0]
v_lshlrev_b32 v22, 16, v23
v_and_b32 v23, 0xffff0000, v23
v_pk_fma_f32 v[254:255], v[22:23], v[52:53], v[254:255] op_sel:[0,1,0] op_sel_hi:[1,1,1]
v_cvt_pk_bf16_f32 v127, v254, v255
s_branch PACKED
SPIN3_0:
s_sleep 8
buffer_load_dword v7, v5, s[56:59], 0 offen sc1
s_waitcnt vmcnt(0)
v_cmp_ne_u32 vcc, 0x01010101, v7
s_sub_u32 s83, s83, 1
s_cbranch_scc1 GIVE3_0
s_cmp_lg_u64 vcc, 0
s_cbranch_scc1 SPIN3_0
s_branch OK3_0
GIVE3_0:
s_mov_b32 s83, 0
s_branch OK3_0
SPIN6_0:
s_sleep 8
buffer_load_dword v7, v5, s[56:59], 0 offen sc1
s_waitcnt vmcnt(0)
v_cmp_ne_u32 vcc, 0x01010101, v7
s_sub_u32 s83, s83, 1
s_cbranch_scc1 GIVE6_0
s_cmp_lg_u64 vcc, 0
s_cbranch_scc1 SPIN6_0
s_branch OK6_0
GIVE6_0:
s_mov_b32 s83, 0
s_branch OK6_0
SPIN7_0:
s_sleep 8
buffer_load_dword v7, v5, s[8:11], s64 offen sc1
s_waitcnt vmcnt(0)
v_cmp_eq_u32 vcc, 0, v7
s_sub_u32 s83, s83, 1
s_cbranch_scc1 GIVE7_0
s_cmp_lg_u64 vcc, 0
s_cbranch_scc1 SPIN7_0
s_branch OK7_0
GIVE7_0:
s_mov_b32 s83, 0
s_branch OK7_0
SPIN10_0:
s_sleep 1
buffer_load_dword v7, off, s[8:11], s80 sc1
s_waitcnt vmcnt(0)
v_cmp_eq_u32 vcc, 0, v7
s_sub_u32 s83, s83, 1
s_cbranch_scc1 GIVE10_0
s_cmp_lg_u64 vcc, 0
s_cbranch_scc1 SPIN10_0
s_branch OK10_0
GIVE10_0:
s_mov_b32 s83, 0
s_branch OK10_0
SPIN12_0:
s_sleep 8
buffer_load_dword v7, v5, s[8:11], s65 offen sc1
s_waitcnt vmcnt(0)
v_cmp_gt_u32 vcc, 3, v7
s_sub_u32 s83, s83, 1
s_cbranch_scc1 GIVE12_0
s_cmp_lg_u64 vcc, 0
s_cbranch_scc1 SPIN12_0
s_branch OK12_0
GIVE12_0:
s_mov_b32 s83, 0
s_branch OK12_0
SPIN13_0:
s_sleep 8
buffer_load_dword v7, off, s[8:11], s65 sc1
s_waitcnt vmcnt(0)
v_cmp_gt_u32 vcc, 2, v7
s_sub_u32 s83, s83, 1
s_cbranch_scc1 GIVE13_0
s_cmp_lg_u64 vcc, 0
s_cbranch_scc1 SPIN13_0
s_branch OK13_0
GIVE13_0:
s_mov_b32 s83, 0
s_branch OK13_0
SPIN14_0:
s_sleep 8
buffer_load_dword v35, v5, s[8:11], s65 offen sc1
s_waitcnt vmcnt(0)
v_cmp_eq_u32 vcc, 0, v35
s_sub_u32 s83, s83, 1
s_cbranch_scc1 GIVE14_0
s_cmp_lg_u64 vcc, 0
s_cbranch_scc1 SPIN14_0
s_branch OK14_0
GIVE14_0:
s_mov_b32 s83, 0
s_branch OK14_0
.fill 6849, 4, 0xbf810000
.section .rodata,"a"
.p2align 6
.amdhsa_kernel concat_heads__compressed_kv_cla__linear_kernel_hedgehog__prompt_kernel
  .amdhsa_next_free_vgpr 512
  .amdhsa_next_free_sgpr 102
  .amdhsa_accum_offset 256
  .amdhsa_group_segment_fixed_size 0
  .amdhsa_kernarg_size 104
  .amdhsa_user_sgpr_count 2
  .amdhsa_user_sgpr_kernarg_segment_ptr 1
  .amdhsa_system_sgpr_workgroup_id_x 1
  .amdhsa_float_denorm_mode_32 3
  .amdhsa_float_denorm_mode_16_64 3
.end_amdhsa_kernel
```
